```python
import torch

def _softmax(x, axis=-1):
    return torch.softmax(x, dim=axis)
def _gelu(x):
    return torch.nn.functional.gelu(x, approximate="tanh")
def _silu(x):
    return torch.nn.functional.silu(x)
def _sigmoid(x):
    return torch.sigmoid(x)
def _layernorm(x, axis=-1, eps=1e-5):
    m = x.mean(dim=axis, keepdim=True)
    v = x.var(dim=axis, keepdim=True, unbiased=False)
    return (x - m) / torch.sqrt(v + eps)
def _scatter_add(tgt, idx, src, axis=0):
    return tgt.clone().index_add_(axis, idx, src)
def _segment_sum(src, seg, n):
    out = torch.zeros((n,) + src.shape[1:], dtype=src.dtype)
    return out.index_add_(0, seg, src)
def _pad(x, pw):
    flat = tuple(v for pair in reversed(pw) for v in pair)
    return torch.nn.functional.pad(x, flat)

kernel_name = 'concat_heads__mha_block_cached__gqa_block_cached__near_ridge'

def setup_inputs():

    _w = (lambda a: (lambda t: t.to(torch.bfloat16) if t.is_floating_point() else t)(torch.as_tensor(a)))
    def _A_setup():
        B, Sq, D = 8, 96, 512
        H, Sk, Dh = 32, 512, 128
        return {
            "x": _w((lambda *s: torch.randn(*s, dtype=torch.bfloat16) * 0.8)(B, Sq, D)),
            "k_cache": _w((lambda *s: torch.randn(*s, dtype=torch.bfloat16) * 0.8)(B, H, Sk, Dh)),
            "v_cache": _w((lambda *s: torch.randn(*s, dtype=torch.bfloat16) * 0.05)(B, H, Sk, Dh)),
            "wq": _w((lambda *s: torch.randn(*s, dtype=torch.bfloat16) * 0.8)(D, H * Dh) * (D ** -0.5)),
            "wo": _w((lambda *s: torch.randn(*s, dtype=torch.bfloat16) * 0.05)(H * Dh, D) * ((H * Dh) ** -0.5)),
        }
    _A_in = _A_setup()

    def _B_setup():
        B, Sq, D = 8, 96, 512
        Hq, Hkv, Sk, Dh = 32, 32, 512, 128
        assert Hq % Hkv == 0, (Hq, Hkv)
        return {
            "x": _w((lambda *s: torch.randn(*s, dtype=torch.bfloat16) * 0.8)(B, Sq, D)),
            "k_cache": _w((lambda *s: torch.randn(*s, dtype=torch.bfloat16) * 0.8)(B, Hkv, Sk, Dh)),
            "v_cache": _w((lambda *s: torch.randn(*s, dtype=torch.bfloat16) * 0.05)(B, Hkv, Sk, Dh)),
            "wq": _w((lambda *s: torch.randn(*s, dtype=torch.bfloat16) * 0.8)(D, Hq * Dh) * (D ** -0.5)),
            "wo": _w((lambda *s: torch.randn(*s, dtype=torch.bfloat16) * 0.05)(Hq * Dh, D) * ((Hq * Dh) ** -0.5)),
        }
    _B_in = _B_setup()

    return {
        "A_x": _A_in["x"],
        "A_k_cache": _A_in["k_cache"],
        "A_v_cache": _A_in["v_cache"],
        "A_wq": _A_in["wq"],
        "A_wo": _A_in["wo"],
        "B_x": _B_in["x"],
        "B_k_cache": _B_in["k_cache"],
        "B_v_cache": _B_in["v_cache"],
        "B_wq": _B_in["wq"],
        "B_wo": _B_in["wo"],
    }

def reference(A_x, A_k_cache, A_v_cache, A_wq, A_wo, B_x, B_k_cache, B_v_cache, B_wq, B_wo):
    def _A_ref(x, k_cache, v_cache, wq, wo):
        B, Sq, D = x.shape
        H, Dh = 32, 128
        q = (lambda x, *d: x.permute(*d))((x @ wq).reshape(B, Sq, H, Dh), 0, 2, 1, 3)
        scores = torch.einsum("bhqd,bhkd->bhqk", q, k_cache) * (Dh ** -0.5)
        p = _softmax(scores, axis=-1)
        o = torch.einsum("bhqk,bhkd->bhqd", p, v_cache)
        return (lambda x, *d: x.permute(*d))(o, 0, 2, 1, 3).reshape(B, Sq, H * Dh) @ wo

    def _B_ref(x, k_cache, v_cache, wq, wo):
        B, Sq, D = x.shape
        Hq, Dh = 32, 128
        Hkv = k_cache.shape[1]
        rep = Hq // Hkv
        q = (lambda x, *d: x.permute(*d))((x @ wq).reshape(B, Sq, Hq, Dh), 0, 2, 1, 3)
        k = (lambda x, n, axis: torch.repeat_interleave(x, n, dim=axis))(k_cache, rep, axis=1)
        v = (lambda x, n, axis: torch.repeat_interleave(x, n, dim=axis))(v_cache, rep, axis=1)
        scores = torch.einsum("bhqd,bhkd->bhqk", q, k) * (Dh ** -0.5)
        p = _softmax(scores, axis=-1)
        o = torch.einsum("bhqk,bhkd->bhqd", p, v)
        return (lambda x, *d: x.permute(*d))(o, 0, 2, 1, 3).reshape(B, Sq, Hq * Dh) @ wo

    a = _A_ref(A_x, A_k_cache, A_v_cache, A_wq, A_wo)
    b = _B_ref(B_x, B_k_cache, B_v_cache, B_wq, B_wo)
    return torch.concatenate([a, b], axis=-1)
```

```asm
; @launch kernel=mha_fused_kernel grid=(256,1,1) block=(256,1,1) lds=163840
.amdgcn_target "amdgcn-amd-amdhsa--gfx950"
.text
.globl mha_fused_kernel
.p2align 8
.type mha_fused_kernel,@function
mha_fused_kernel:
  s_cmp_ge_u32 s2, 256
  s_cbranch_scc1 K1_EXIT
  s_and_b32 s3, s2, 4
  s_mul_i32 s3, s3, 10
  s_add_u32 s4, s0, s3
  s_addc_u32 s5, s1, 0
  s_load_dwordx4 s[52:55], s[4:5], 0
  s_load_dwordx4 s[56:59], s[4:5], 16
  s_load_dwordx2 s[60:61], s[4:5], 32
  s_load_dwordx2 s[62:63], s[0:1], 96
  s_getpc_b64 s[98:99]
PF_PC:
  v_and_b32 v1, 7, v0
  v_lshlrev_b32 v1, 7, v1
  v_lshrrev_b32 v2, 6, v0
  s_lshr_b32 s3, s2, 3
  s_lshl_b32 s3, s3, 2
  v_add_u32 v2, s3, v2
  v_lshl_add_u32 v1, v2, 10, v1
  v_min_u32 v1, TEXT_END-PF_PC-4, v1
  v_add_co_u32 v2, vcc, s98, v1
  v_mov_b32 v3, s99
  v_addc_co_u32 v3, vcc, 0, v3, vcc
  s_mov_b64 exec, 0xff
  global_load_dword v7, v[2:3], off
  s_mov_b64 exec, -1
  v_lshrrev_b32 v1, 6, v0
  s_lshr_b32 s3, s2, 3
  v_readfirstlane_b32 s38, v1
  s_and_b32 s41, s3, 7
  s_lshr_b32 s3, s3, 3
  s_mov_b32 s97, s3
  s_and_b32 s6, s2, 3
  s_lshl_b32 s7, s6, 2
  s_add_u32 s7, s7, s3
  s_lshr_b32 s39, s38, 1
  s_and_b32 s40, s38, 1
  s_lshl_b32 s34, s40, 13
  s_mul_i32 s35, s40, 6144
  s_lshl_b32 s36, s40, 17
  s_lshl_b32 s37, s40, 16
  s_mul_i32 s46, s39, 12288
  s_add_u32 s46, s46, 98304
  s_mul_i32 s47, s38, 12288
  s_add_u32 s47, s47, 16384
  s_xor_b32 s3, s38, 1
  s_mul_i32 s48, s3, 12288
  s_add_u32 s48, s48, 16384
  s_mul_i32 s49, s38, 1536
  s_add_u32 s49, s49, 147456
  s_mul_i32 s50, s3, 1536
  s_add_u32 s50, s50, 147456
  s_mul_i32 s51, s39, 24576
  s_add_u32 s51, s51, 16384
  s_waitcnt lgkmcnt(0)
  s_mul_i32 s3, s41, 98304
  s_add_u32 s8, s52, s3
  s_addc_u32 s9, s53, 0
  s_mov_b32 s10, 98304
  s_mov_b32 s11, 0x20000
  s_lshl_b32 s3, s41, 22
  s_lshl_b32 s6, s7, 18
  s_add_u32 s3, s3, s6
  s_add_u32 s12, s54, s3
  s_addc_u32 s13, s55, 0
  s_mov_b32 s14, 0x40000
  s_mov_b32 s15, 0x20000
  s_add_u32 s16, s56, s3
  s_addc_u32 s17, s57, 0
  s_mov_b32 s18, 0x40000
  s_mov_b32 s19, 0x20000
  s_lshl_b32 s3, s7, 9
  s_add_u32 s20, s58, s3
  s_addc_u32 s21, s59, 0
  s_sub_u32 s22, 0x400000, s3
  s_mov_b32 s23, 0x20000
  s_add_u32 s24, s60, s6
  s_addc_u32 s25, s61, 0
  s_mov_b32 s26, 0x40000
  s_mov_b32 s27, 0x20000
  s_and_b32 s3, s2, 4
  s_lshl_b32 s3, s3, 1
  s_add_u32 s3, s3, s41
  s_lshl_b32 s3, s3, 4
  s_add_u32 s3, s3, s7
  s_lshl_b32 s3, s3, 2
  s_add_u32 s3, s3, s38
  s_mul_i32 s3, s3, 24576
  s_add_u32 s28, s62, s3
  s_addc_u32 s29, s63, 0
  s_mov_b32 s30, 24576
  s_mov_b32 s31, 0x20000
  s_and_b32 s3, s2, 4
  s_lshl_b32 s3, s3, 1
  s_add_u32 s3, s3, s41
  s_lshl_b32 s101, s3, 4
  s_add_u32 s101, s101, s7
  s_lshl_b32 s3, s3, 7
  s_lshl_b32 s6, s7, 2
  s_add_u32 s3, s3, s6
  s_add_u32 s3, s3, 0x2000000
  s_load_dword s100, s[62:63], s3
  s_load_dwordx2 s[98:99], s[0:1], 88
  s_cmp_eq_u32 s39, 0
  s_cbranch_scc0 K1_ROLE1
  v_and_b32 v200, 63, v0
  v_and_b32 v201, 15, v0
  v_lshrrev_b32 v202, 4, v200
  v_bfe_u32 v203, v0, 2, 2
  v_and_b32 v204, 3, v0
  v_lshlrev_b32 v0, 4, v200
  v_xor_b32 v205, v202, v201
  v_lshlrev_b32 v205, 4, v205
  v_lshl_add_u32 v205, v201, 8, v205
  v_add_u32 v8, s34, v205
  v_xor_b32 v9, 64, v8
  v_xor_b32 v10, 128, v8
  v_xor_b32 v11, 192, v8
  v_lshl_add_u32 v205, v202, 2, v203
  v_and_b32 v206, 7, v205
  s_lshl_b32 s42, s40, 2
  v_xor_b32 v206, s42, v206
  v_lshlrev_b32 v206, 5, v206
  v_lshl_add_u32 v206, v205, 8, v206
  v_lshl_add_u32 v206, v204, 3, v206
  v_add_u32 v12, s34, v206
  v_xor_b32 v13, 32, v12
  v_xor_b32 v14, 64, v12
  v_xor_b32 v15, 96, v12
  v_xor_b32 v16, 128, v12
  v_xor_b32 v17, 160, v12
  v_xor_b32 v18, 192, v12
  v_xor_b32 v19, 224, v12
  v_and_b32 v207, 1, v202
  v_lshl_or_b32 v206, v207, 2, v203
  v_xor_b32 v206, s42, v206
  v_lshlrev_b32 v206, 5, v206
  v_lshl_add_u32 v205, v202, 3, v203
  v_lshl_add_u32 v206, v205, 9, v206
  v_lshl_add_u32 v206, v204, 3, v206
  v_add_u32 v192, 0x18000, v206
  v_xor_b32 v193, 32, v192
  v_xor_b32 v194, 64, v192
  v_xor_b32 v195, 96, v192
  v_lshrrev_b32 v206, 1, v203
  v_lshl_or_b32 v206, v207, 1, v206
  s_lshl_b32 s43, s40, 1
  v_xor_b32 v206, s43, v206
  v_lshlrev_b32 v206, 5, v206
  v_lshl_add_u32 v206, v205, 7, v206
  v_lshl_add_u32 v206, v204, 3, v206
  v_add_u32 v20, 0x18000, v206
  v_xor_b32 v21, 32, v20
  v_lshrrev_b32 v206, 1, v201
  v_xor_b32 v206, v202, v206
  v_lshlrev_b32 v206, 4, v206
  v_lshl_add_u32 v206, v201, 7, v206
  s_mul_i32 s43, s39, 6144
  v_add_u32 v196, s43, v206
  v_xor_b32 v197, 64, v196
  v_mov_b32 v206, 0x3f803f80
  v_accvgpr_write_b32 a252, v206
  v_accvgpr_write_b32 a253, v206
  v_accvgpr_write_b32 a254, v206
  v_accvgpr_write_b32 a255, v206
  v_and_b32 v205, 7, v200
  v_xor_b32 v205, v202, v205
  v_lshlrev_b32 v205, 4, v205
  v_lshrrev_b32 v206, 3, v200
  v_lshl_add_u32 v205, v206, 10, v205
  s_mul_i32 s42, s40, 49152
  v_add_u32 v184, s42, v205
  v_xor_b32 v185, 64, v184
  v_add_u32 v185, 0x1c00, v185
  v_add_u32 v186, 0x3800, v184
  v_xor_b32 v187, 64, v184
  v_add_u32 v187, 0x5400, v187
  v_lshrrev_b32 v205, 2, v200
  v_lshlrev_b32 v205, 13, v205
  v_and_b32 v206, 3, v200
  v_lshl_add_u32 v205, v206, 7, v205
  s_lshl_b32 s42, s41, 19
  s_lshl_b32 s43, s40, 18
  s_add_u32 s42, s42, s43
  v_add_u32 v188, s42, v205
  s_lshl_b32 s42, s41, 15
  s_lshl_b32 s43, s40, 14
  s_add_u32 s42, s42, s43
  v_lshlrev_b32 v205, 7, v200
  v_add_u32 v189, s42, v205
  v_lshlrev_b32 v205, 7, v200
  v_add_u32 v28, s34, v205
  s_lshl_b32 s42, s97, 1
  s_add_u32 s42, s42, s40
  s_mul_i32 s42, s42, 12288
  v_add_u32 v190, s42, v205
  v_xor_b32 v205, v202, v201
  v_lshlrev_b32 v205, 4, v205
  v_lshl_add_u32 v1, v202, 8, v205
  v_xor_b32 v2, 64, v1
  v_xor_b32 v3, 128, v1
  v_xor_b32 v4, 192, v1
  v_lshlrev_b32 v205, 1, v202
  v_xor_b32 v205, v201, v205
  v_lshlrev_b32 v205, 4, v205
  v_lshl_add_u32 v5, v202, 8, v205
  v_xor_b32 v6, 0x80, v5
  s_add_u32 m0, s35, 0x0
  s_mov_b32 s32, 0x0
  buffer_load_dwordx4 v184, s[8:11], s32 offen offset:0 lds
  buffer_load_dwordx4 v185, s[8:11], s32 offen offset:1024 lds
  buffer_load_dwordx4 v186, s[8:11], s32 offen offset:2048 lds
  buffer_load_dwordx4 v187, s[8:11], s32 offen offset:3072 lds
  s_add_u32 m0, s35, 0x1000
  s_mov_b32 s32, 0x8000
  buffer_load_dwordx4 v184, s[8:11], s32 offen offset:0 lds
  buffer_load_dwordx4 v185, s[8:11], s32 offen offset:1024 lds
  s_add_u32 m0, s35, 0x3000
  s_mov_b32 s32, 0x80
  buffer_load_dwordx4 v184, s[8:11], s32 offen offset:0 lds
  buffer_load_dwordx4 v185, s[8:11], s32 offen offset:1024 lds
  buffer_load_dwordx4 v186, s[8:11], s32 offen offset:2048 lds
  buffer_load_dwordx4 v187, s[8:11], s32 offen offset:3072 lds
  s_add_u32 m0, s35, 0x4000
  s_mov_b32 s32, 0x8080
  buffer_load_dwordx4 v184, s[8:11], s32 offen offset:0 lds
  buffer_load_dwordx4 v185, s[8:11], s32 offen offset:1024 lds
  s_waitcnt lgkmcnt(0)
  s_waitcnt vmcnt(6)
  s_barrier
  ds_read_b128 v[160:163], v196 offset:0
  ds_read_b128 v[164:167], v196 offset:2048
  ds_read_b128 v[168:171], v196 offset:4096
  ds_read_b64_tr_b16 v[32:33], v192 offset:0
  ds_read_b64_tr_b16 v[34:35], v192 offset:2048
  ds_read_b64_tr_b16 v[36:37], v193 offset:0
  ds_read_b64_tr_b16 v[38:39], v193 offset:2048
  ds_read_b64_tr_b16 v[40:41], v194 offset:0
  ds_read_b64_tr_b16 v[42:43], v194 offset:2048
  ds_read_b64_tr_b16 v[44:45], v195 offset:0
  ds_read_b64_tr_b16 v[46:47], v195 offset:2048
  ds_read_b64_tr_b16 v[48:49], v192 offset:256
  ds_read_b64_tr_b16 v[50:51], v192 offset:2304
  ds_read_b64_tr_b16 v[52:53], v193 offset:256
  ds_read_b64_tr_b16 v[54:55], v193 offset:2304
  ds_read_b64_tr_b16 v[56:57], v194 offset:256
  ds_read_b64_tr_b16 v[58:59], v194 offset:2304
  ds_read_b64_tr_b16 v[60:61], v195 offset:256
  ds_read_b64_tr_b16 v[62:63], v195 offset:2304
  s_waitcnt lgkmcnt(15)
  s_waitcnt lgkmcnt(12)
  v_mfma_f32_16x16x32_bf16 v[64:67], v[32:35], v[160:163], 0
  v_mfma_f32_16x16x32_bf16 v[68:71], v[32:35], v[164:167], 0
  v_mfma_f32_16x16x32_bf16 v[72:75], v[32:35], v[168:171], 0
  v_mfma_f32_16x16x32_bf16 v[76:79], v[36:39], v[160:163], 0
  v_mfma_f32_16x16x32_bf16 v[80:83], v[36:39], v[164:167], 0
  v_mfma_f32_16x16x32_bf16 v[84:87], v[36:39], v[168:171], 0
  s_waitcnt lgkmcnt(8)
  v_mfma_f32_16x16x32_bf16 v[88:91], v[40:43], v[160:163], 0
  v_mfma_f32_16x16x32_bf16 v[92:95], v[40:43], v[164:167], 0
  v_mfma_f32_16x16x32_bf16 v[96:99], v[40:43], v[168:171], 0
  v_mfma_f32_16x16x32_bf16 v[100:103], v[44:47], v[160:163], 0
  v_mfma_f32_16x16x32_bf16 v[104:107], v[44:47], v[164:167], 0
  v_mfma_f32_16x16x32_bf16 v[108:111], v[44:47], v[168:171], 0
  s_waitcnt lgkmcnt(0)
  v_mfma_f32_16x16x32_bf16 v[112:115], v[48:51], v[160:163], 0
  s_barrier
  ds_read_b128 v[172:175], v197 offset:0
  ds_read_b128 v[176:179], v197 offset:2048
  v_mfma_f32_16x16x32_bf16 v[116:119], v[48:51], v[164:167], 0
  ds_read_b128 v[180:183], v197 offset:4096
  ds_read_b64_tr_b16 v[32:33], v192 offset:16384
  v_mfma_f32_16x16x32_bf16 v[120:123], v[48:51], v[168:171], 0
  ds_read_b64_tr_b16 v[34:35], v192 offset:18432
  ds_read_b64_tr_b16 v[36:37], v193 offset:16384
  v_mfma_f32_16x16x32_bf16 v[124:127], v[52:55], v[160:163], 0
  ds_read_b64_tr_b16 v[38:39], v193 offset:18432
  ds_read_b64_tr_b16 v[40:41], v194 offset:16384
  v_mfma_f32_16x16x32_bf16 v[128:131], v[52:55], v[164:167], 0
  ds_read_b64_tr_b16 v[42:43], v194 offset:18432
  ds_read_b64_tr_b16 v[44:45], v195 offset:16384
  v_mfma_f32_16x16x32_bf16 v[132:135], v[52:55], v[168:171], 0
  ds_read_b64_tr_b16 v[46:47], v195 offset:18432
  ds_read_b64_tr_b16 v[48:49], v192 offset:16640
  v_mfma_f32_16x16x32_bf16 v[136:139], v[56:59], v[160:163], 0
  ds_read_b64_tr_b16 v[50:51], v192 offset:18688
  ds_read_b64_tr_b16 v[52:53], v193 offset:16640
  v_mfma_f32_16x16x32_bf16 v[140:143], v[56:59], v[164:167], 0
  ds_read_b64_tr_b16 v[54:55], v193 offset:18688
  s_add_u32 m0, s35, 0x6000
  v_mfma_f32_16x16x32_bf16 v[144:147], v[56:59], v[168:171], 0
  ds_read_b64_tr_b16 v[56:57], v194 offset:16640
  ds_read_b64_tr_b16 v[58:59], v194 offset:18688
  v_mfma_f32_16x16x32_bf16 v[148:151], v[60:63], v[160:163], 0
  s_mov_b32 s32, 0x100
  buffer_load_dwordx4 v184, s[8:11], s32 offen offset:0 lds
  v_mfma_f32_16x16x32_bf16 v[152:155], v[60:63], v[164:167], 0
  buffer_load_dwordx4 v185, s[8:11], s32 offen offset:1024 lds
  buffer_load_dwordx4 v186, s[8:11], s32 offen offset:2048 lds
  v_mfma_f32_16x16x32_bf16 v[156:159], v[60:63], v[168:171], 0
  ds_read_b64_tr_b16 v[60:61], v195 offset:16640
  ds_read_b64_tr_b16 v[62:63], v195 offset:18688
  s_waitcnt lgkmcnt(15)
  s_waitcnt lgkmcnt(12)
  v_mfma_f32_16x16x32_bf16 v[64:67], v[32:35], v[172:175], v[64:67]
  buffer_load_dwordx4 v187, s[8:11], s32 offen offset:3072 lds
  s_add_u32 m0, s35, 0x7000
  v_mfma_f32_16x16x32_bf16 v[68:71], v[32:35], v[176:179], v[68:71]
  s_mov_b32 s32, 0x8100
  buffer_load_dwordx4 v184, s[8:11], s32 offen offset:0 lds
  v_mfma_f32_16x16x32_bf16 v[72:75], v[32:35], v[180:183], v[72:75]
  buffer_load_dwordx4 v185, s[8:11], s32 offen offset:1024 lds
  v_mfma_f32_16x16x32_bf16 v[76:79], v[36:39], v[172:175], v[76:79]
  v_mfma_f32_16x16x32_bf16 v[80:83], v[36:39], v[176:179], v[80:83]
  v_mfma_f32_16x16x32_bf16 v[84:87], v[36:39], v[180:183], v[84:87]
  s_waitcnt lgkmcnt(8)
  v_mfma_f32_16x16x32_bf16 v[88:91], v[40:43], v[172:175], v[88:91]
  v_mfma_f32_16x16x32_bf16 v[92:95], v[40:43], v[176:179], v[92:95]
  v_mfma_f32_16x16x32_bf16 v[96:99], v[40:43], v[180:183], v[96:99]
  v_mfma_f32_16x16x32_bf16 v[100:103], v[44:47], v[172:175], v[100:103]
  v_mfma_f32_16x16x32_bf16 v[104:107], v[44:47], v[176:179], v[104:107]
  v_mfma_f32_16x16x32_bf16 v[108:111], v[44:47], v[180:183], v[108:111]
  s_waitcnt lgkmcnt(0)
  v_mfma_f32_16x16x32_bf16 v[112:115], v[48:51], v[172:175], v[112:115]
  s_waitcnt vmcnt(6)
  s_barrier
  ds_read_b128 v[160:163], v196 offset:12288
  ds_read_b128 v[164:167], v196 offset:14336
  v_mfma_f32_16x16x32_bf16 v[116:119], v[48:51], v[176:179], v[116:119]
  ds_read_b128 v[168:171], v196 offset:16384
  ds_read_b64_tr_b16 v[32:33], v192 offset:32768
  v_mfma_f32_16x16x32_bf16 v[120:123], v[48:51], v[180:183], v[120:123]
  ds_read_b64_tr_b16 v[34:35], v192 offset:34816
  ds_read_b64_tr_b16 v[36:37], v193 offset:32768
  v_mfma_f32_16x16x32_bf16 v[124:127], v[52:55], v[172:175], v[124:127]
  ds_read_b64_tr_b16 v[38:39], v193 offset:34816
  ds_read_b64_tr_b16 v[40:41], v194 offset:32768
  v_mfma_f32_16x16x32_bf16 v[128:131], v[52:55], v[176:179], v[128:131]
  ds_read_b64_tr_b16 v[42:43], v194 offset:34816
  ds_read_b64_tr_b16 v[44:45], v195 offset:32768
  v_mfma_f32_16x16x32_bf16 v[132:135], v[52:55], v[180:183], v[132:135]
  ds_read_b64_tr_b16 v[46:47], v195 offset:34816
  ds_read_b64_tr_b16 v[48:49], v192 offset:33024
  v_mfma_f32_16x16x32_bf16 v[136:139], v[56:59], v[172:175], v[136:139]
  ds_read_b64_tr_b16 v[50:51], v192 offset:35072
  ds_read_b64_tr_b16 v[52:53], v193 offset:33024
  v_mfma_f32_16x16x32_bf16 v[140:143], v[56:59], v[176:179], v[140:143]
  ds_read_b64_tr_b16 v[54:55], v193 offset:35072
  v_mfma_f32_16x16x32_bf16 v[144:147], v[56:59], v[180:183], v[144:147]
  ds_read_b64_tr_b16 v[56:57], v194 offset:33024
  ds_read_b64_tr_b16 v[58:59], v194 offset:35072
  v_mfma_f32_16x16x32_bf16 v[148:151], v[60:63], v[172:175], v[148:151]
  v_mfma_f32_16x16x32_bf16 v[152:155], v[60:63], v[176:179], v[152:155]
  v_mfma_f32_16x16x32_bf16 v[156:159], v[60:63], v[180:183], v[156:159]
  ds_read_b64_tr_b16 v[60:61], v195 offset:33024
  ds_read_b64_tr_b16 v[62:63], v195 offset:35072
  s_waitcnt lgkmcnt(15)
  s_waitcnt lgkmcnt(12)
  v_mfma_f32_16x16x32_bf16 v[64:67], v[32:35], v[160:163], v[64:67]
  v_mfma_f32_16x16x32_bf16 v[68:71], v[32:35], v[164:167], v[68:71]
  v_mfma_f32_16x16x32_bf16 v[72:75], v[32:35], v[168:171], v[72:75]
  v_mfma_f32_16x16x32_bf16 v[76:79], v[36:39], v[160:163], v[76:79]
  v_mfma_f32_16x16x32_bf16 v[80:83], v[36:39], v[164:167], v[80:83]
  v_mfma_f32_16x16x32_bf16 v[84:87], v[36:39], v[168:171], v[84:87]
  s_waitcnt lgkmcnt(8)
  v_mfma_f32_16x16x32_bf16 v[88:91], v[40:43], v[160:163], v[88:91]
  v_mfma_f32_16x16x32_bf16 v[92:95], v[40:43], v[164:167], v[92:95]
  v_mfma_f32_16x16x32_bf16 v[96:99], v[40:43], v[168:171], v[96:99]
  v_mfma_f32_16x16x32_bf16 v[100:103], v[44:47], v[160:163], v[100:103]
  v_mfma_f32_16x16x32_bf16 v[104:107], v[44:47], v[164:167], v[104:107]
  v_mfma_f32_16x16x32_bf16 v[108:111], v[44:47], v[168:171], v[108:111]
  s_waitcnt lgkmcnt(0)
  v_mfma_f32_16x16x32_bf16 v[112:115], v[48:51], v[160:163], v[112:115]
  s_barrier
  ds_read_b128 v[172:175], v197 offset:12288
  ds_read_b128 v[176:179], v197 offset:14336
  v_mfma_f32_16x16x32_bf16 v[116:119], v[48:51], v[164:167], v[116:119]
  ds_read_b128 v[180:183], v197 offset:16384
  ds_read_b64_tr_b16 v[32:33], v192 offset:49152
  v_mfma_f32_16x16x32_bf16 v[120:123], v[48:51], v[168:171], v[120:123]
  ds_read_b64_tr_b16 v[34:35], v192 offset:51200
  ds_read_b64_tr_b16 v[36:37], v193 offset:49152
  v_mfma_f32_16x16x32_bf16 v[124:127], v[52:55], v[160:163], v[124:127]
  ds_read_b64_tr_b16 v[38:39], v193 offset:51200
  ds_read_b64_tr_b16 v[40:41], v194 offset:49152
  v_mfma_f32_16x16x32_bf16 v[128:131], v[52:55], v[164:167], v[128:131]
  ds_read_b64_tr_b16 v[42:43], v194 offset:51200
  ds_read_b64_tr_b16 v[44:45], v195 offset:49152
  v_mfma_f32_16x16x32_bf16 v[132:135], v[52:55], v[168:171], v[132:135]
  ds_read_b64_tr_b16 v[46:47], v195 offset:51200
  ds_read_b64_tr_b16 v[48:49], v192 offset:49408
  v_mfma_f32_16x16x32_bf16 v[136:139], v[56:59], v[160:163], v[136:139]
  ds_read_b64_tr_b16 v[50:51], v192 offset:51456
  ds_read_b64_tr_b16 v[52:53], v193 offset:49408
  v_mfma_f32_16x16x32_bf16 v[140:143], v[56:59], v[164:167], v[140:143]
  ds_read_b64_tr_b16 v[54:55], v193 offset:51456
  s_add_u32 m0, s35, 0x9000
  v_mfma_f32_16x16x32_bf16 v[144:147], v[56:59], v[168:171], v[144:147]
  ds_read_b64_tr_b16 v[56:57], v194 offset:49408
  ds_read_b64_tr_b16 v[58:59], v194 offset:51456
  v_mfma_f32_16x16x32_bf16 v[148:151], v[60:63], v[160:163], v[148:151]
  s_mov_b32 s32, 0x180
  buffer_load_dwordx4 v184, s[8:11], s32 offen offset:0 lds
  v_mfma_f32_16x16x32_bf16 v[152:155], v[60:63], v[164:167], v[152:155]
  buffer_load_dwordx4 v185, s[8:11], s32 offen offset:1024 lds
  buffer_load_dwordx4 v186, s[8:11], s32 offen offset:2048 lds
  v_mfma_f32_16x16x32_bf16 v[156:159], v[60:63], v[168:171], v[156:159]
  ds_read_b64_tr_b16 v[60:61], v195 offset:49408
  ds_read_b64_tr_b16 v[62:63], v195 offset:51456
  s_waitcnt lgkmcnt(15)
  s_waitcnt lgkmcnt(12)
  v_mfma_f32_16x16x32_bf16 v[64:67], v[32:35], v[172:175], v[64:67]
  buffer_load_dwordx4 v187, s[8:11], s32 offen offset:3072 lds
  s_add_u32 m0, s35, 0xa000
  v_mfma_f32_16x16x32_bf16 v[68:71], v[32:35], v[176:179], v[68:71]
  s_mov_b32 s32, 0x8180
  buffer_load_dwordx4 v184, s[8:11], s32 offen offset:0 lds
  v_mfma_f32_16x16x32_bf16 v[72:75], v[32:35], v[180:183], v[72:75]
  buffer_load_dwordx4 v185, s[8:11], s32 offen offset:1024 lds
  v_mfma_f32_16x16x32_bf16 v[76:79], v[36:39], v[172:175], v[76:79]
  v_mfma_f32_16x16x32_bf16 v[80:83], v[36:39], v[176:179], v[80:83]
  v_mfma_f32_16x16x32_bf16 v[84:87], v[36:39], v[180:183], v[84:87]
  s_waitcnt lgkmcnt(8)
  v_mfma_f32_16x16x32_bf16 v[88:91], v[40:43], v[172:175], v[88:91]
  v_mfma_f32_16x16x32_bf16 v[92:95], v[40:43], v[176:179], v[92:95]
  v_mfma_f32_16x16x32_bf16 v[96:99], v[40:43], v[180:183], v[96:99]
  v_mfma_f32_16x16x32_bf16 v[100:103], v[44:47], v[172:175], v[100:103]
  v_mfma_f32_16x16x32_bf16 v[104:107], v[44:47], v[176:179], v[104:107]
  v_mfma_f32_16x16x32_bf16 v[108:111], v[44:47], v[180:183], v[108:111]
  s_waitcnt lgkmcnt(0)
  v_mfma_f32_16x16x32_bf16 v[112:115], v[48:51], v[172:175], v[112:115]
  s_waitcnt vmcnt(6)
  s_barrier
  ds_read_b128 v[160:163], v196 offset:24576
  ds_read_b128 v[164:167], v196 offset:26624
  v_mfma_f32_16x16x32_bf16 v[116:119], v[48:51], v[176:179], v[116:119]
  ds_read_b128 v[168:171], v196 offset:28672
  ds_read_b64_tr_b16 v[32:33], v192 offset:0
  v_mfma_f32_16x16x32_bf16 v[120:123], v[48:51], v[180:183], v[120:123]
  ds_read_b64_tr_b16 v[34:35], v192 offset:2048
  ds_read_b64_tr_b16 v[36:37], v193 offset:0
  v_mfma_f32_16x16x32_bf16 v[124:127], v[52:55], v[172:175], v[124:127]
  ds_read_b64_tr_b16 v[38:39], v193 offset:2048
  ds_read_b64_tr_b16 v[40:41], v194 offset:0
  v_mfma_f32_16x16x32_bf16 v[128:131], v[52:55], v[176:179], v[128:131]
  ds_read_b64_tr_b16 v[42:43], v194 offset:2048
  ds_read_b64_tr_b16 v[44:45], v195 offset:0
  v_mfma_f32_16x16x32_bf16 v[132:135], v[52:55], v[180:183], v[132:135]
  ds_read_b64_tr_b16 v[46:47], v195 offset:2048
  ds_read_b64_tr_b16 v[48:49], v192 offset:256
  v_mfma_f32_16x16x32_bf16 v[136:139], v[56:59], v[172:175], v[136:139]
  ds_read_b64_tr_b16 v[50:51], v192 offset:2304
  ds_read_b64_tr_b16 v[52:53], v193 offset:256
  v_mfma_f32_16x16x32_bf16 v[140:143], v[56:59], v[176:179], v[140:143]
  ds_read_b64_tr_b16 v[54:55], v193 offset:2304
  s_add_u32 m0, s34, 0x0
  v_mfma_f32_16x16x32_bf16 v[144:147], v[56:59], v[180:183], v[144:147]
  ds_read_b64_tr_b16 v[56:57], v194 offset:256
  ds_read_b64_tr_b16 v[58:59], v194 offset:2304
  v_mfma_f32_16x16x32_bf16 v[148:151], v[60:63], v[172:175], v[148:151]
  s_add_u32 s32, s34, 0x0
  buffer_load_dwordx4 v1, s[12:15], s32 offen offset:0 nt lds
  v_mfma_f32_16x16x32_bf16 v[152:155], v[60:63], v[176:179], v[152:155]
  buffer_load_dwordx4 v2, s[12:15], s32 offen offset:1024 nt lds
  buffer_load_dwordx4 v3, s[12:15], s32 offen offset:2048 nt lds
  v_mfma_f32_16x16x32_bf16 v[156:159], v[60:63], v[180:183], v[156:159]
  ds_read_b64_tr_b16 v[60:61], v195 offset:256
  ds_read_b64_tr_b16 v[62:63], v195 offset:2304
  s_waitcnt lgkmcnt(15)
  s_waitcnt lgkmcnt(12)
  v_mfma_f32_16x16x32_bf16 v[64:67], v[32:35], v[160:163], v[64:67]
  buffer_load_dwordx4 v4, s[12:15], s32 offen offset:3072 nt lds
  s_add_u32 m0, s34, 0x1000
  v_mfma_f32_16x16x32_bf16 v[68:71], v[32:35], v[164:167], v[68:71]
  s_add_u32 s32, s34, 0x1000
  buffer_load_dwordx4 v1, s[12:15], s32 offen offset:0 nt lds
  v_mfma_f32_16x16x32_bf16 v[72:75], v[32:35], v[168:171], v[72:75]
  buffer_load_dwordx4 v2, s[12:15], s32 offen offset:1024 nt lds
  buffer_load_dwordx4 v3, s[12:15], s32 offen offset:2048 nt lds
  v_mfma_f32_16x16x32_bf16 v[76:79], v[36:39], v[160:163], v[76:79]
  buffer_load_dwordx4 v4, s[12:15], s32 offen offset:3072 nt lds
  v_mfma_f32_16x16x32_bf16 v[80:83], v[36:39], v[164:167], v[80:83]
  v_mfma_f32_16x16x32_bf16 v[84:87], v[36:39], v[168:171], v[84:87]
  s_waitcnt lgkmcnt(8)
  v_mfma_f32_16x16x32_bf16 v[88:91], v[40:43], v[160:163], v[88:91]
  v_mfma_f32_16x16x32_bf16 v[92:95], v[40:43], v[164:167], v[92:95]
  v_mfma_f32_16x16x32_bf16 v[96:99], v[40:43], v[168:171], v[96:99]
  v_mfma_f32_16x16x32_bf16 v[100:103], v[44:47], v[160:163], v[100:103]
  v_mfma_f32_16x16x32_bf16 v[104:107], v[44:47], v[164:167], v[104:107]
  v_mfma_f32_16x16x32_bf16 v[108:111], v[44:47], v[168:171], v[108:111]
  s_waitcnt lgkmcnt(0)
  v_mfma_f32_16x16x32_bf16 v[112:115], v[48:51], v[160:163], v[112:115]
  s_barrier
  ds_read_b128 v[172:175], v197 offset:24576
  ds_read_b128 v[176:179], v197 offset:26624
  v_mfma_f32_16x16x32_bf16 v[116:119], v[48:51], v[164:167], v[116:119]
  ds_read_b128 v[180:183], v197 offset:28672
  ds_read_b64_tr_b16 v[32:33], v192 offset:16384
  v_mfma_f32_16x16x32_bf16 v[120:123], v[48:51], v[168:171], v[120:123]
  ds_read_b64_tr_b16 v[34:35], v192 offset:18432
  ds_read_b64_tr_b16 v[36:37], v193 offset:16384
  v_mfma_f32_16x16x32_bf16 v[124:127], v[52:55], v[160:163], v[124:127]
  ds_read_b64_tr_b16 v[38:39], v193 offset:18432
  ds_read_b64_tr_b16 v[40:41], v194 offset:16384
  v_mfma_f32_16x16x32_bf16 v[128:131], v[52:55], v[164:167], v[128:131]
  ds_read_b64_tr_b16 v[42:43], v194 offset:18432
  ds_read_b64_tr_b16 v[44:45], v195 offset:16384
  v_mfma_f32_16x16x32_bf16 v[132:135], v[52:55], v[168:171], v[132:135]
  ds_read_b64_tr_b16 v[46:47], v195 offset:18432
  ds_read_b64_tr_b16 v[48:49], v192 offset:16640
  v_mfma_f32_16x16x32_bf16 v[136:139], v[56:59], v[160:163], v[136:139]
  ds_read_b64_tr_b16 v[50:51], v192 offset:18688
  ds_read_b64_tr_b16 v[52:53], v193 offset:16640
  v_mfma_f32_16x16x32_bf16 v[140:143], v[56:59], v[164:167], v[140:143]
  ds_read_b64_tr_b16 v[54:55], v193 offset:18688
  s_add_u32 m0, s35, 0xc000
  v_mfma_f32_16x16x32_bf16 v[144:147], v[56:59], v[168:171], v[144:147]
  ds_read_b64_tr_b16 v[56:57], v194 offset:16640
  ds_read_b64_tr_b16 v[58:59], v194 offset:18688
  v_mfma_f32_16x16x32_bf16 v[148:151], v[60:63], v[160:163], v[148:151]
  s_mov_b32 s32, 0x200
  buffer_load_dwordx4 v184, s[8:11], s32 offen offset:0 lds
  v_mfma_f32_16x16x32_bf16 v[152:155], v[60:63], v[164:167], v[152:155]
  buffer_load_dwordx4 v185, s[8:11], s32 offen offset:1024 lds
  buffer_load_dwordx4 v186, s[8:11], s32 offen offset:2048 lds
  v_mfma_f32_16x16x32_bf16 v[156:159], v[60:63], v[168:171], v[156:159]
  ds_read_b64_tr_b16 v[60:61], v195 offset:16640
  ds_read_b64_tr_b16 v[62:63], v195 offset:18688
  s_waitcnt lgkmcnt(15)
  s_waitcnt lgkmcnt(12)
  v_mfma_f32_16x16x32_bf16 v[64:67], v[32:35], v[172:175], v[64:67]
  buffer_load_dwordx4 v187, s[8:11], s32 offen offset:3072 lds
  s_add_u32 m0, s35, 0xd000
  v_mfma_f32_16x16x32_bf16 v[68:71], v[32:35], v[176:179], v[68:71]
  s_mov_b32 s32, 0x8200
  buffer_load_dwordx4 v184, s[8:11], s32 offen offset:0 lds
  v_mfma_f32_16x16x32_bf16 v[72:75], v[32:35], v[180:183], v[72:75]
  buffer_load_dwordx4 v185, s[8:11], s32 offen offset:1024 lds
  v_mfma_f32_16x16x32_bf16 v[76:79], v[36:39], v[172:175], v[76:79]
  v_mfma_f32_16x16x32_bf16 v[80:83], v[36:39], v[176:179], v[80:83]
  v_mfma_f32_16x16x32_bf16 v[84:87], v[36:39], v[180:183], v[84:87]
  s_waitcnt lgkmcnt(8)
  v_mfma_f32_16x16x32_bf16 v[88:91], v[40:43], v[172:175], v[88:91]
  v_mfma_f32_16x16x32_bf16 v[92:95], v[40:43], v[176:179], v[92:95]
  v_mfma_f32_16x16x32_bf16 v[96:99], v[40:43], v[180:183], v[96:99]
  v_mfma_f32_16x16x32_bf16 v[100:103], v[44:47], v[172:175], v[100:103]
  v_mfma_f32_16x16x32_bf16 v[104:107], v[44:47], v[176:179], v[104:107]
  v_mfma_f32_16x16x32_bf16 v[108:111], v[44:47], v[180:183], v[108:111]
  s_waitcnt lgkmcnt(0)
  v_mfma_f32_16x16x32_bf16 v[112:115], v[48:51], v[172:175], v[112:115]
  s_waitcnt vmcnt(14)
  s_barrier
  ds_read_b128 v[160:163], v196 offset:36864
  ds_read_b128 v[164:167], v196 offset:38912
  v_mfma_f32_16x16x32_bf16 v[116:119], v[48:51], v[176:179], v[116:119]
  ds_read_b128 v[168:171], v196 offset:40960
  ds_read_b64_tr_b16 v[32:33], v192 offset:32768
  v_mfma_f32_16x16x32_bf16 v[120:123], v[48:51], v[180:183], v[120:123]
  ds_read_b64_tr_b16 v[34:35], v192 offset:34816
  ds_read_b64_tr_b16 v[36:37], v193 offset:32768
  v_mfma_f32_16x16x32_bf16 v[124:127], v[52:55], v[172:175], v[124:127]
  ds_read_b64_tr_b16 v[38:39], v193 offset:34816
  ds_read_b64_tr_b16 v[40:41], v194 offset:32768
  v_mfma_f32_16x16x32_bf16 v[128:131], v[52:55], v[176:179], v[128:131]
  ds_read_b64_tr_b16 v[42:43], v194 offset:34816
  ds_read_b64_tr_b16 v[44:45], v195 offset:32768
  v_mfma_f32_16x16x32_bf16 v[132:135], v[52:55], v[180:183], v[132:135]
  ds_read_b64_tr_b16 v[46:47], v195 offset:34816
  ds_read_b64_tr_b16 v[48:49], v192 offset:33024
  v_mfma_f32_16x16x32_bf16 v[136:139], v[56:59], v[172:175], v[136:139]
  ds_read_b64_tr_b16 v[50:51], v192 offset:35072
  ds_read_b64_tr_b16 v[52:53], v193 offset:33024
  v_mfma_f32_16x16x32_bf16 v[140:143], v[56:59], v[176:179], v[140:143]
  ds_read_b64_tr_b16 v[54:55], v193 offset:35072
  s_add_u32 m0, s34, 0x4000
  v_mfma_f32_16x16x32_bf16 v[144:147], v[56:59], v[180:183], v[144:147]
  ds_read_b64_tr_b16 v[56:57], v194 offset:33024
  ds_read_b64_tr_b16 v[58:59], v194 offset:35072
  v_mfma_f32_16x16x32_bf16 v[148:151], v[60:63], v[172:175], v[148:151]
  s_add_u32 s32, s34, 0x4000
  buffer_load_dwordx4 v1, s[12:15], s32 offen offset:0 nt lds
  v_mfma_f32_16x16x32_bf16 v[152:155], v[60:63], v[176:179], v[152:155]
  buffer_load_dwordx4 v2, s[12:15], s32 offen offset:1024 nt lds
  buffer_load_dwordx4 v3, s[12:15], s32 offen offset:2048 nt lds
  v_mfma_f32_16x16x32_bf16 v[156:159], v[60:63], v[180:183], v[156:159]
  ds_read_b64_tr_b16 v[60:61], v195 offset:33024
  ds_read_b64_tr_b16 v[62:63], v195 offset:35072
  s_waitcnt lgkmcnt(15)
  s_waitcnt lgkmcnt(12)
  v_mfma_f32_16x16x32_bf16 v[64:67], v[32:35], v[160:163], v[64:67]
  buffer_load_dwordx4 v4, s[12:15], s32 offen offset:3072 nt lds
  s_add_u32 m0, s34, 0x5000
  v_mfma_f32_16x16x32_bf16 v[68:71], v[32:35], v[164:167], v[68:71]
  s_add_u32 s32, s34, 0x5000
  buffer_load_dwordx4 v1, s[12:15], s32 offen offset:0 nt lds
  v_mfma_f32_16x16x32_bf16 v[72:75], v[32:35], v[168:171], v[72:75]
  buffer_load_dwordx4 v2, s[12:15], s32 offen offset:1024 nt lds
  buffer_load_dwordx4 v3, s[12:15], s32 offen offset:2048 nt lds
  v_mfma_f32_16x16x32_bf16 v[76:79], v[36:39], v[160:163], v[76:79]
  buffer_load_dwordx4 v4, s[12:15], s32 offen offset:3072 nt lds
  v_mfma_f32_16x16x32_bf16 v[80:83], v[36:39], v[164:167], v[80:83]
  v_mfma_f32_16x16x32_bf16 v[84:87], v[36:39], v[168:171], v[84:87]
  s_waitcnt lgkmcnt(8)
  v_mfma_f32_16x16x32_bf16 v[88:91], v[40:43], v[160:163], v[88:91]
  v_mfma_f32_16x16x32_bf16 v[92:95], v[40:43], v[164:167], v[92:95]
  v_mfma_f32_16x16x32_bf16 v[96:99], v[40:43], v[168:171], v[96:99]
  v_mfma_f32_16x16x32_bf16 v[100:103], v[44:47], v[160:163], v[100:103]
  v_mfma_f32_16x16x32_bf16 v[104:107], v[44:47], v[164:167], v[104:107]
  v_mfma_f32_16x16x32_bf16 v[108:111], v[44:47], v[168:171], v[108:111]
  s_waitcnt lgkmcnt(0)
  v_mfma_f32_16x16x32_bf16 v[112:115], v[48:51], v[160:163], v[112:115]
  s_barrier
  ds_read_b128 v[172:175], v197 offset:36864
  ds_read_b128 v[176:179], v197 offset:38912
  v_mfma_f32_16x16x32_bf16 v[116:119], v[48:51], v[164:167], v[116:119]
  ds_read_b128 v[180:183], v197 offset:40960
  ds_read_b64_tr_b16 v[32:33], v192 offset:49152
  v_mfma_f32_16x16x32_bf16 v[120:123], v[48:51], v[168:171], v[120:123]
  ds_read_b64_tr_b16 v[34:35], v192 offset:51200
  ds_read_b64_tr_b16 v[36:37], v193 offset:49152
  v_mfma_f32_16x16x32_bf16 v[124:127], v[52:55], v[160:163], v[124:127]
  ds_read_b64_tr_b16 v[38:39], v193 offset:51200
  ds_read_b64_tr_b16 v[40:41], v194 offset:49152
  v_mfma_f32_16x16x32_bf16 v[128:131], v[52:55], v[164:167], v[128:131]
  ds_read_b64_tr_b16 v[42:43], v194 offset:51200
  ds_read_b64_tr_b16 v[44:45], v195 offset:49152
  v_mfma_f32_16x16x32_bf16 v[132:135], v[52:55], v[168:171], v[132:135]
  ds_read_b64_tr_b16 v[46:47], v195 offset:51200
  ds_read_b64_tr_b16 v[48:49], v192 offset:49408
  v_mfma_f32_16x16x32_bf16 v[136:139], v[56:59], v[160:163], v[136:139]
  ds_read_b64_tr_b16 v[50:51], v192 offset:51456
  ds_read_b64_tr_b16 v[52:53], v193 offset:49408
  v_mfma_f32_16x16x32_bf16 v[140:143], v[56:59], v[164:167], v[140:143]
  ds_read_b64_tr_b16 v[54:55], v193 offset:51456
  s_add_u32 m0, s35, 0xf000
  v_mfma_f32_16x16x32_bf16 v[144:147], v[56:59], v[168:171], v[144:147]
  ds_read_b64_tr_b16 v[56:57], v194 offset:49408
  ds_read_b64_tr_b16 v[58:59], v194 offset:51456
  v_mfma_f32_16x16x32_bf16 v[148:151], v[60:63], v[160:163], v[148:151]
  s_mov_b32 s32, 0x280
  buffer_load_dwordx4 v184, s[8:11], s32 offen offset:0 lds
  v_mfma_f32_16x16x32_bf16 v[152:155], v[60:63], v[164:167], v[152:155]
  buffer_load_dwordx4 v185, s[8:11], s32 offen offset:1024 lds
  buffer_load_dwordx4 v186, s[8:11], s32 offen offset:2048 lds
  v_mfma_f32_16x16x32_bf16 v[156:159], v[60:63], v[168:171], v[156:159]
  ds_read_b64_tr_b16 v[60:61], v195 offset:49408
  ds_read_b64_tr_b16 v[62:63], v195 offset:51456
  s_waitcnt lgkmcnt(15)
  s_waitcnt lgkmcnt(12)
  v_mfma_f32_16x16x32_bf16 v[64:67], v[32:35], v[172:175], v[64:67]
  buffer_load_dwordx4 v187, s[8:11], s32 offen offset:3072 lds
  s_add_u32 m0, s35, 0x10000
  v_mfma_f32_16x16x32_bf16 v[68:71], v[32:35], v[176:179], v[68:71]
  s_mov_b32 s32, 0x8280
  buffer_load_dwordx4 v184, s[8:11], s32 offen offset:0 lds
  v_mfma_f32_16x16x32_bf16 v[72:75], v[32:35], v[180:183], v[72:75]
  buffer_load_dwordx4 v185, s[8:11], s32 offen offset:1024 lds
  v_mfma_f32_16x16x32_bf16 v[76:79], v[36:39], v[172:175], v[76:79]
  v_mfma_f32_16x16x32_bf16 v[80:83], v[36:39], v[176:179], v[80:83]
  v_mfma_f32_16x16x32_bf16 v[84:87], v[36:39], v[180:183], v[84:87]
  s_waitcnt lgkmcnt(8)
  v_mfma_f32_16x16x32_bf16 v[88:91], v[40:43], v[172:175], v[88:91]
  v_mfma_f32_16x16x32_bf16 v[92:95], v[40:43], v[176:179], v[92:95]
  v_mfma_f32_16x16x32_bf16 v[96:99], v[40:43], v[180:183], v[96:99]
  v_mfma_f32_16x16x32_bf16 v[100:103], v[44:47], v[172:175], v[100:103]
  v_mfma_f32_16x16x32_bf16 v[104:107], v[44:47], v[176:179], v[104:107]
  v_mfma_f32_16x16x32_bf16 v[108:111], v[44:47], v[180:183], v[108:111]
  s_waitcnt lgkmcnt(0)
  v_mfma_f32_16x16x32_bf16 v[112:115], v[48:51], v[172:175], v[112:115]
  s_waitcnt vmcnt(14)
  s_barrier
  ds_read_b128 v[160:163], v196 offset:49152
  ds_read_b128 v[164:167], v196 offset:51200
  v_mfma_f32_16x16x32_bf16 v[116:119], v[48:51], v[176:179], v[116:119]
  ds_read_b128 v[168:171], v196 offset:53248
  ds_read_b64_tr_b16 v[32:33], v192 offset:0
  v_mfma_f32_16x16x32_bf16 v[120:123], v[48:51], v[180:183], v[120:123]
  ds_read_b64_tr_b16 v[34:35], v192 offset:2048
  ds_read_b64_tr_b16 v[36:37], v193 offset:0
  v_mfma_f32_16x16x32_bf16 v[124:127], v[52:55], v[172:175], v[124:127]
  ds_read_b64_tr_b16 v[38:39], v193 offset:2048
  ds_read_b64_tr_b16 v[40:41], v194 offset:0
  v_mfma_f32_16x16x32_bf16 v[128:131], v[52:55], v[176:179], v[128:131]
  ds_read_b64_tr_b16 v[42:43], v194 offset:2048
  ds_read_b64_tr_b16 v[44:45], v195 offset:0
  v_mfma_f32_16x16x32_bf16 v[132:135], v[52:55], v[180:183], v[132:135]
  ds_read_b64_tr_b16 v[46:47], v195 offset:2048
  ds_read_b64_tr_b16 v[48:49], v192 offset:256
  v_mfma_f32_16x16x32_bf16 v[136:139], v[56:59], v[172:175], v[136:139]
  ds_read_b64_tr_b16 v[50:51], v192 offset:2304
  ds_read_b64_tr_b16 v[52:53], v193 offset:256
  v_mfma_f32_16x16x32_bf16 v[140:143], v[56:59], v[176:179], v[140:143]
  ds_read_b64_tr_b16 v[54:55], v193 offset:2304
  s_add_u32 m0, s34, 0x8000
  v_mfma_f32_16x16x32_bf16 v[144:147], v[56:59], v[180:183], v[144:147]
  ds_read_b64_tr_b16 v[56:57], v194 offset:256
  ds_read_b64_tr_b16 v[58:59], v194 offset:2304
  v_mfma_f32_16x16x32_bf16 v[148:151], v[60:63], v[172:175], v[148:151]
  s_add_u32 s32, s34, 0x8000
  buffer_load_dwordx4 v1, s[12:15], s32 offen offset:0 nt lds
  v_mfma_f32_16x16x32_bf16 v[152:155], v[60:63], v[176:179], v[152:155]
  buffer_load_dwordx4 v2, s[12:15], s32 offen offset:1024 nt lds
  buffer_load_dwordx4 v3, s[12:15], s32 offen offset:2048 nt lds
  v_mfma_f32_16x16x32_bf16 v[156:159], v[60:63], v[180:183], v[156:159]
  ds_read_b64_tr_b16 v[60:61], v195 offset:256
  ds_read_b64_tr_b16 v[62:63], v195 offset:2304
  s_waitcnt lgkmcnt(15)
  s_waitcnt lgkmcnt(12)
  v_mfma_f32_16x16x32_bf16 v[64:67], v[32:35], v[160:163], v[64:67]
  buffer_load_dwordx4 v4, s[12:15], s32 offen offset:3072 nt lds
  s_add_u32 m0, s34, 0x9000
  v_mfma_f32_16x16x32_bf16 v[68:71], v[32:35], v[164:167], v[68:71]
  s_add_u32 s32, s34, 0x9000
  buffer_load_dwordx4 v1, s[12:15], s32 offen offset:0 nt lds
  v_mfma_f32_16x16x32_bf16 v[72:75], v[32:35], v[168:171], v[72:75]
  buffer_load_dwordx4 v2, s[12:15], s32 offen offset:1024 nt lds
  buffer_load_dwordx4 v3, s[12:15], s32 offen offset:2048 nt lds
  v_mfma_f32_16x16x32_bf16 v[76:79], v[36:39], v[160:163], v[76:79]
  buffer_load_dwordx4 v4, s[12:15], s32 offen offset:3072 nt lds
  v_mfma_f32_16x16x32_bf16 v[80:83], v[36:39], v[164:167], v[80:83]
  v_mfma_f32_16x16x32_bf16 v[84:87], v[36:39], v[168:171], v[84:87]
  s_waitcnt lgkmcnt(8)
  v_mfma_f32_16x16x32_bf16 v[88:91], v[40:43], v[160:163], v[88:91]
  v_mfma_f32_16x16x32_bf16 v[92:95], v[40:43], v[164:167], v[92:95]
  v_mfma_f32_16x16x32_bf16 v[96:99], v[40:43], v[168:171], v[96:99]
  v_mfma_f32_16x16x32_bf16 v[100:103], v[44:47], v[160:163], v[100:103]
  v_mfma_f32_16x16x32_bf16 v[104:107], v[44:47], v[164:167], v[104:107]
  v_mfma_f32_16x16x32_bf16 v[108:111], v[44:47], v[168:171], v[108:111]
  s_waitcnt lgkmcnt(0)
  v_mfma_f32_16x16x32_bf16 v[112:115], v[48:51], v[160:163], v[112:115]
  s_barrier
  ds_read_b128 v[172:175], v197 offset:49152
  ds_read_b128 v[176:179], v197 offset:51200
  v_mfma_f32_16x16x32_bf16 v[116:119], v[48:51], v[164:167], v[116:119]
  ds_read_b128 v[180:183], v197 offset:53248
  ds_read_b64_tr_b16 v[32:33], v192 offset:16384
  v_mfma_f32_16x16x32_bf16 v[120:123], v[48:51], v[168:171], v[120:123]
  ds_read_b64_tr_b16 v[34:35], v192 offset:18432
  ds_read_b64_tr_b16 v[36:37], v193 offset:16384
  v_mfma_f32_16x16x32_bf16 v[124:127], v[52:55], v[160:163], v[124:127]
  ds_read_b64_tr_b16 v[38:39], v193 offset:18432
  ds_read_b64_tr_b16 v[40:41], v194 offset:16384
  v_mfma_f32_16x16x32_bf16 v[128:131], v[52:55], v[164:167], v[128:131]
  ds_read_b64_tr_b16 v[42:43], v194 offset:18432
  ds_read_b64_tr_b16 v[44:45], v195 offset:16384
  v_mfma_f32_16x16x32_bf16 v[132:135], v[52:55], v[168:171], v[132:135]
  ds_read_b64_tr_b16 v[46:47], v195 offset:18432
  ds_read_b64_tr_b16 v[48:49], v192 offset:16640
  v_mfma_f32_16x16x32_bf16 v[136:139], v[56:59], v[160:163], v[136:139]
  ds_read_b64_tr_b16 v[50:51], v192 offset:18688
  ds_read_b64_tr_b16 v[52:53], v193 offset:16640
  v_mfma_f32_16x16x32_bf16 v[140:143], v[56:59], v[164:167], v[140:143]
  ds_read_b64_tr_b16 v[54:55], v193 offset:18688
  s_add_u32 m0, s35, 0x12000
  v_mfma_f32_16x16x32_bf16 v[144:147], v[56:59], v[168:171], v[144:147]
  ds_read_b64_tr_b16 v[56:57], v194 offset:16640
  ds_read_b64_tr_b16 v[58:59], v194 offset:18688
  v_mfma_f32_16x16x32_bf16 v[148:151], v[60:63], v[160:163], v[148:151]
  s_mov_b32 s32, 0x300
  buffer_load_dwordx4 v184, s[8:11], s32 offen offset:0 lds
  v_mfma_f32_16x16x32_bf16 v[152:155], v[60:63], v[164:167], v[152:155]
  buffer_load_dwordx4 v185, s[8:11], s32 offen offset:1024 lds
  buffer_load_dwordx4 v186, s[8:11], s32 offen offset:2048 lds
  v_mfma_f32_16x16x32_bf16 v[156:159], v[60:63], v[168:171], v[156:159]
  ds_read_b64_tr_b16 v[60:61], v195 offset:16640
  ds_read_b64_tr_b16 v[62:63], v195 offset:18688
  s_waitcnt lgkmcnt(15)
  s_waitcnt lgkmcnt(12)
  v_mfma_f32_16x16x32_bf16 v[64:67], v[32:35], v[172:175], v[64:67]
  buffer_load_dwordx4 v187, s[8:11], s32 offen offset:3072 lds
  s_add_u32 m0, s35, 0x13000
  v_mfma_f32_16x16x32_bf16 v[68:71], v[32:35], v[176:179], v[68:71]
  s_mov_b32 s32, 0x8300
  buffer_load_dwordx4 v184, s[8:11], s32 offen offset:0 lds
  v_mfma_f32_16x16x32_bf16 v[72:75], v[32:35], v[180:183], v[72:75]
  buffer_load_dwordx4 v185, s[8:11], s32 offen offset:1024 lds
  v_mfma_f32_16x16x32_bf16 v[76:79], v[36:39], v[172:175], v[76:79]
  v_mfma_f32_16x16x32_bf16 v[80:83], v[36:39], v[176:179], v[80:83]
  v_mfma_f32_16x16x32_bf16 v[84:87], v[36:39], v[180:183], v[84:87]
  s_waitcnt lgkmcnt(8)
  v_mfma_f32_16x16x32_bf16 v[88:91], v[40:43], v[172:175], v[88:91]
  v_mfma_f32_16x16x32_bf16 v[92:95], v[40:43], v[176:179], v[92:95]
  v_mfma_f32_16x16x32_bf16 v[96:99], v[40:43], v[180:183], v[96:99]
  v_mfma_f32_16x16x32_bf16 v[100:103], v[44:47], v[172:175], v[100:103]
  v_mfma_f32_16x16x32_bf16 v[104:107], v[44:47], v[176:179], v[104:107]
  v_mfma_f32_16x16x32_bf16 v[108:111], v[44:47], v[180:183], v[108:111]
  s_waitcnt lgkmcnt(0)
  v_mfma_f32_16x16x32_bf16 v[112:115], v[48:51], v[172:175], v[112:115]
  s_waitcnt vmcnt(14)
  s_barrier
  ds_read_b128 v[160:163], v196 offset:61440
  ds_read_b128 v[164:167], v196 offset:63488
  v_mfma_f32_16x16x32_bf16 v[116:119], v[48:51], v[176:179], v[116:119]
  v_add_u32 v196, 0x10000, v196
  ds_read_b128 v[168:171], v196 offset:0
  ds_read_b64_tr_b16 v[32:33], v192 offset:32768
  v_mfma_f32_16x16x32_bf16 v[120:123], v[48:51], v[180:183], v[120:123]
  ds_read_b64_tr_b16 v[34:35], v192 offset:34816
  ds_read_b64_tr_b16 v[36:37], v193 offset:32768
  v_mfma_f32_16x16x32_bf16 v[124:127], v[52:55], v[172:175], v[124:127]
  ds_read_b64_tr_b16 v[38:39], v193 offset:34816
  ds_read_b64_tr_b16 v[40:41], v194 offset:32768
  v_mfma_f32_16x16x32_bf16 v[128:131], v[52:55], v[176:179], v[128:131]
  ds_read_b64_tr_b16 v[42:43], v194 offset:34816
  ds_read_b64_tr_b16 v[44:45], v195 offset:32768
  v_mfma_f32_16x16x32_bf16 v[132:135], v[52:55], v[180:183], v[132:135]
  ds_read_b64_tr_b16 v[46:47], v195 offset:34816
  ds_read_b64_tr_b16 v[48:49], v192 offset:33024
  v_mfma_f32_16x16x32_bf16 v[136:139], v[56:59], v[172:175], v[136:139]
  ds_read_b64_tr_b16 v[50:51], v192 offset:35072
  ds_read_b64_tr_b16 v[52:53], v193 offset:33024
  v_mfma_f32_16x16x32_bf16 v[140:143], v[56:59], v[176:179], v[140:143]
  ds_read_b64_tr_b16 v[54:55], v193 offset:35072
  v_mfma_f32_16x16x32_bf16 v[144:147], v[56:59], v[180:183], v[144:147]
  ds_read_b64_tr_b16 v[56:57], v194 offset:33024
  ds_read_b64_tr_b16 v[58:59], v194 offset:35072
  v_mfma_f32_16x16x32_bf16 v[148:151], v[60:63], v[172:175], v[148:151]
  v_mfma_f32_16x16x32_bf16 v[152:155], v[60:63], v[176:179], v[152:155]
  v_mfma_f32_16x16x32_bf16 v[156:159], v[60:63], v[180:183], v[156:159]
  ds_read_b64_tr_b16 v[60:61], v195 offset:33024
  ds_read_b64_tr_b16 v[62:63], v195 offset:35072
  s_waitcnt lgkmcnt(15)
  s_waitcnt lgkmcnt(12)
  v_mfma_f32_16x16x32_bf16 v[64:67], v[32:35], v[160:163], v[64:67]
  v_mfma_f32_16x16x32_bf16 v[68:71], v[32:35], v[164:167], v[68:71]
  v_mfma_f32_16x16x32_bf16 v[72:75], v[32:35], v[168:171], v[72:75]
  v_mfma_f32_16x16x32_bf16 v[76:79], v[36:39], v[160:163], v[76:79]
  v_mfma_f32_16x16x32_bf16 v[80:83], v[36:39], v[164:167], v[80:83]
  v_mfma_f32_16x16x32_bf16 v[84:87], v[36:39], v[168:171], v[84:87]
  s_waitcnt lgkmcnt(8)
  v_mfma_f32_16x16x32_bf16 v[88:91], v[40:43], v[160:163], v[88:91]
  v_mfma_f32_16x16x32_bf16 v[92:95], v[40:43], v[164:167], v[92:95]
  v_mfma_f32_16x16x32_bf16 v[96:99], v[40:43], v[168:171], v[96:99]
  v_mfma_f32_16x16x32_bf16 v[100:103], v[44:47], v[160:163], v[100:103]
  v_mfma_f32_16x16x32_bf16 v[104:107], v[44:47], v[164:167], v[104:107]
  v_mfma_f32_16x16x32_bf16 v[108:111], v[44:47], v[168:171], v[108:111]
  s_waitcnt lgkmcnt(0)
  v_mfma_f32_16x16x32_bf16 v[112:115], v[48:51], v[160:163], v[112:115]
  s_barrier
  ds_read_b128 v[172:175], v197 offset:61440
  ds_read_b128 v[176:179], v197 offset:63488
  v_mfma_f32_16x16x32_bf16 v[116:119], v[48:51], v[164:167], v[116:119]
  v_add_u32 v197, 0x10000, v197
  ds_read_b128 v[180:183], v197 offset:0
  ds_read_b64_tr_b16 v[32:33], v192 offset:49152
  v_mfma_f32_16x16x32_bf16 v[120:123], v[48:51], v[168:171], v[120:123]
  ds_read_b64_tr_b16 v[34:35], v192 offset:51200
  ds_read_b64_tr_b16 v[36:37], v193 offset:49152
  v_mfma_f32_16x16x32_bf16 v[124:127], v[52:55], v[160:163], v[124:127]
  ds_read_b64_tr_b16 v[38:39], v193 offset:51200
  ds_read_b64_tr_b16 v[40:41], v194 offset:49152
  v_mfma_f32_16x16x32_bf16 v[128:131], v[52:55], v[164:167], v[128:131]
  ds_read_b64_tr_b16 v[42:43], v194 offset:51200
  ds_read_b64_tr_b16 v[44:45], v195 offset:49152
  v_mfma_f32_16x16x32_bf16 v[132:135], v[52:55], v[168:171], v[132:135]
  ds_read_b64_tr_b16 v[46:47], v195 offset:51200
  ds_read_b64_tr_b16 v[48:49], v192 offset:49408
  v_mfma_f32_16x16x32_bf16 v[136:139], v[56:59], v[160:163], v[136:139]
  ds_read_b64_tr_b16 v[50:51], v192 offset:51456
  ds_read_b64_tr_b16 v[52:53], v193 offset:49408
  v_mfma_f32_16x16x32_bf16 v[140:143], v[56:59], v[164:167], v[140:143]
  ds_read_b64_tr_b16 v[54:55], v193 offset:51456
  s_add_u32 m0, s35, 0x15000
  v_mfma_f32_16x16x32_bf16 v[144:147], v[56:59], v[168:171], v[144:147]
  ds_read_b64_tr_b16 v[56:57], v194 offset:49408
  ds_read_b64_tr_b16 v[58:59], v194 offset:51456
  v_mfma_f32_16x16x32_bf16 v[148:151], v[60:63], v[160:163], v[148:151]
  s_mov_b32 s32, 0x380
  buffer_load_dwordx4 v184, s[8:11], s32 offen offset:0 lds
  v_mfma_f32_16x16x32_bf16 v[152:155], v[60:63], v[164:167], v[152:155]
  buffer_load_dwordx4 v185, s[8:11], s32 offen offset:1024 lds
  buffer_load_dwordx4 v186, s[8:11], s32 offen offset:2048 lds
  v_mfma_f32_16x16x32_bf16 v[156:159], v[60:63], v[168:171], v[156:159]
  ds_read_b64_tr_b16 v[60:61], v195 offset:49408
  ds_read_b64_tr_b16 v[62:63], v195 offset:51456
  s_waitcnt lgkmcnt(15)
  s_waitcnt lgkmcnt(12)
  v_mfma_f32_16x16x32_bf16 v[64:67], v[32:35], v[172:175], v[64:67]
  buffer_load_dwordx4 v187, s[8:11], s32 offen offset:3072 lds
  s_add_u32 m0, s35, 0x16000
  v_mfma_f32_16x16x32_bf16 v[68:71], v[32:35], v[176:179], v[68:71]
  s_mov_b32 s32, 0x8380
  buffer_load_dwordx4 v184, s[8:11], s32 offen offset:0 lds
  v_mfma_f32_16x16x32_bf16 v[72:75], v[32:35], v[180:183], v[72:75]
  buffer_load_dwordx4 v185, s[8:11], s32 offen offset:1024 lds
  v_mfma_f32_16x16x32_bf16 v[76:79], v[36:39], v[172:175], v[76:79]
  v_mfma_f32_16x16x32_bf16 v[80:83], v[36:39], v[176:179], v[80:83]
  v_mfma_f32_16x16x32_bf16 v[84:87], v[36:39], v[180:183], v[84:87]
  s_waitcnt lgkmcnt(8)
  v_mfma_f32_16x16x32_bf16 v[88:91], v[40:43], v[172:175], v[88:91]
  v_mfma_f32_16x16x32_bf16 v[92:95], v[40:43], v[176:179], v[92:95]
  v_mfma_f32_16x16x32_bf16 v[96:99], v[40:43], v[180:183], v[96:99]
  v_mfma_f32_16x16x32_bf16 v[100:103], v[44:47], v[172:175], v[100:103]
  v_mfma_f32_16x16x32_bf16 v[104:107], v[44:47], v[176:179], v[104:107]
  v_mfma_f32_16x16x32_bf16 v[108:111], v[44:47], v[180:183], v[108:111]
  s_waitcnt lgkmcnt(0)
  v_mfma_f32_16x16x32_bf16 v[112:115], v[48:51], v[172:175], v[112:115]
  s_waitcnt vmcnt(6)
  s_barrier
  ds_read_b128 v[160:163], v196 offset:8192
  ds_read_b128 v[164:167], v196 offset:10240
  v_mfma_f32_16x16x32_bf16 v[116:119], v[48:51], v[176:179], v[116:119]
  ds_read_b128 v[168:171], v196 offset:12288
  ds_read_b64_tr_b16 v[32:33], v192 offset:0
  v_mfma_f32_16x16x32_bf16 v[120:123], v[48:51], v[180:183], v[120:123]
  ds_read_b64_tr_b16 v[34:35], v192 offset:2048
  ds_read_b64_tr_b16 v[36:37], v193 offset:0
  v_mfma_f32_16x16x32_bf16 v[124:127], v[52:55], v[172:175], v[124:127]
  ds_read_b64_tr_b16 v[38:39], v193 offset:2048
  ds_read_b64_tr_b16 v[40:41], v194 offset:0
  v_mfma_f32_16x16x32_bf16 v[128:131], v[52:55], v[176:179], v[128:131]
  ds_read_b64_tr_b16 v[42:43], v194 offset:2048
  ds_read_b64_tr_b16 v[44:45], v195 offset:0
  v_mfma_f32_16x16x32_bf16 v[132:135], v[52:55], v[180:183], v[132:135]
  ds_read_b64_tr_b16 v[46:47], v195 offset:2048
  ds_read_b64_tr_b16 v[48:49], v192 offset:256
  v_mfma_f32_16x16x32_bf16 v[136:139], v[56:59], v[172:175], v[136:139]
  ds_read_b64_tr_b16 v[50:51], v192 offset:2304
  ds_read_b64_tr_b16 v[52:53], v193 offset:256
  v_mfma_f32_16x16x32_bf16 v[140:143], v[56:59], v[176:179], v[140:143]
  ds_read_b64_tr_b16 v[54:55], v193 offset:2304
  s_add_u32 m0, s34, 0xc000
  v_mfma_f32_16x16x32_bf16 v[144:147], v[56:59], v[180:183], v[144:147]
  ds_read_b64_tr_b16 v[56:57], v194 offset:256
  ds_read_b64_tr_b16 v[58:59], v194 offset:2304
  v_mfma_f32_16x16x32_bf16 v[148:151], v[60:63], v[172:175], v[148:151]
  s_add_u32 s32, s34, 0xc000
  buffer_load_dwordx4 v1, s[12:15], s32 offen offset:0 nt lds
  v_mfma_f32_16x16x32_bf16 v[152:155], v[60:63], v[176:179], v[152:155]
  buffer_load_dwordx4 v2, s[12:15], s32 offen offset:1024 nt lds
  buffer_load_dwordx4 v3, s[12:15], s32 offen offset:2048 nt lds
  v_mfma_f32_16x16x32_bf16 v[156:159], v[60:63], v[180:183], v[156:159]
  ds_read_b64_tr_b16 v[60:61], v195 offset:256
  ds_read_b64_tr_b16 v[62:63], v195 offset:2304
  s_waitcnt lgkmcnt(15)
  s_waitcnt lgkmcnt(12)
  v_mfma_f32_16x16x32_bf16 v[64:67], v[32:35], v[160:163], v[64:67]
  buffer_load_dwordx4 v4, s[12:15], s32 offen offset:3072 nt lds
  s_add_u32 m0, s34, 0xd000
  v_mfma_f32_16x16x32_bf16 v[68:71], v[32:35], v[164:167], v[68:71]
  s_add_u32 s32, s34, 0xd000
  buffer_load_dwordx4 v1, s[12:15], s32 offen offset:0 nt lds
  v_mfma_f32_16x16x32_bf16 v[72:75], v[32:35], v[168:171], v[72:75]
  buffer_load_dwordx4 v2, s[12:15], s32 offen offset:1024 nt lds
  buffer_load_dwordx4 v3, s[12:15], s32 offen offset:2048 nt lds
  v_mfma_f32_16x16x32_bf16 v[76:79], v[36:39], v[160:163], v[76:79]
  buffer_load_dwordx4 v4, s[12:15], s32 offen offset:3072 nt lds
  v_mfma_f32_16x16x32_bf16 v[80:83], v[36:39], v[164:167], v[80:83]
  v_mfma_f32_16x16x32_bf16 v[84:87], v[36:39], v[168:171], v[84:87]
  s_waitcnt lgkmcnt(8)
  v_mfma_f32_16x16x32_bf16 v[88:91], v[40:43], v[160:163], v[88:91]
  v_mfma_f32_16x16x32_bf16 v[92:95], v[40:43], v[164:167], v[92:95]
  v_mfma_f32_16x16x32_bf16 v[96:99], v[40:43], v[168:171], v[96:99]
  v_mfma_f32_16x16x32_bf16 v[100:103], v[44:47], v[160:163], v[100:103]
  v_mfma_f32_16x16x32_bf16 v[104:107], v[44:47], v[164:167], v[104:107]
  v_mfma_f32_16x16x32_bf16 v[108:111], v[44:47], v[168:171], v[108:111]
  s_waitcnt lgkmcnt(0)
  v_mfma_f32_16x16x32_bf16 v[112:115], v[48:51], v[160:163], v[112:115]
  s_barrier
  ds_read_b128 v[172:175], v197 offset:8192
  ds_read_b128 v[176:179], v197 offset:10240
  v_mfma_f32_16x16x32_bf16 v[116:119], v[48:51], v[164:167], v[116:119]
  ds_read_b128 v[180:183], v197 offset:12288
  ds_read_b64_tr_b16 v[32:33], v192 offset:16384
  v_mfma_f32_16x16x32_bf16 v[120:123], v[48:51], v[168:171], v[120:123]
  ds_read_b64_tr_b16 v[34:35], v192 offset:18432
  ds_read_b64_tr_b16 v[36:37], v193 offset:16384
  v_mfma_f32_16x16x32_bf16 v[124:127], v[52:55], v[160:163], v[124:127]
  ds_read_b64_tr_b16 v[38:39], v193 offset:18432
  ds_read_b64_tr_b16 v[40:41], v194 offset:16384
  v_mfma_f32_16x16x32_bf16 v[128:131], v[52:55], v[164:167], v[128:131]
  ds_read_b64_tr_b16 v[42:43], v194 offset:18432
  ds_read_b64_tr_b16 v[44:45], v195 offset:16384
  v_mfma_f32_16x16x32_bf16 v[132:135], v[52:55], v[168:171], v[132:135]
  ds_read_b64_tr_b16 v[46:47], v195 offset:18432
  ds_read_b64_tr_b16 v[48:49], v192 offset:16640
  v_mfma_f32_16x16x32_bf16 v[136:139], v[56:59], v[160:163], v[136:139]
  ds_read_b64_tr_b16 v[50:51], v192 offset:18688
  ds_read_b64_tr_b16 v[52:53], v193 offset:16640
  v_mfma_f32_16x16x32_bf16 v[140:143], v[56:59], v[164:167], v[140:143]
  ds_read_b64_tr_b16 v[54:55], v193 offset:18688
  v_mfma_f32_16x16x32_bf16 v[144:147], v[56:59], v[168:171], v[144:147]
  ds_read_b64_tr_b16 v[56:57], v194 offset:16640
  ds_read_b64_tr_b16 v[58:59], v194 offset:18688
  v_mfma_f32_16x16x32_bf16 v[148:151], v[60:63], v[160:163], v[148:151]
  v_mfma_f32_16x16x32_bf16 v[152:155], v[60:63], v[164:167], v[152:155]
  v_mfma_f32_16x16x32_bf16 v[156:159], v[60:63], v[168:171], v[156:159]
  ds_read_b64_tr_b16 v[60:61], v195 offset:16640
  ds_read_b64_tr_b16 v[62:63], v195 offset:18688
  s_waitcnt lgkmcnt(15)
  s_waitcnt lgkmcnt(12)
  v_mfma_f32_16x16x32_bf16 v[64:67], v[32:35], v[172:175], v[64:67]
  v_mfma_f32_16x16x32_bf16 v[68:71], v[32:35], v[176:179], v[68:71]
  v_mfma_f32_16x16x32_bf16 v[72:75], v[32:35], v[180:183], v[72:75]
  v_mfma_f32_16x16x32_bf16 v[76:79], v[36:39], v[172:175], v[76:79]
  v_mfma_f32_16x16x32_bf16 v[80:83], v[36:39], v[176:179], v[80:83]
  v_mfma_f32_16x16x32_bf16 v[84:87], v[36:39], v[180:183], v[84:87]
  s_waitcnt lgkmcnt(8)
  v_mfma_f32_16x16x32_bf16 v[88:91], v[40:43], v[172:175], v[88:91]
  v_mfma_f32_16x16x32_bf16 v[92:95], v[40:43], v[176:179], v[92:95]
  v_mfma_f32_16x16x32_bf16 v[96:99], v[40:43], v[180:183], v[96:99]
  v_mfma_f32_16x16x32_bf16 v[100:103], v[44:47], v[172:175], v[100:103]
  v_mfma_f32_16x16x32_bf16 v[104:107], v[44:47], v[176:179], v[104:107]
  v_mfma_f32_16x16x32_bf16 v[108:111], v[44:47], v[180:183], v[108:111]
  s_waitcnt lgkmcnt(0)
  v_mfma_f32_16x16x32_bf16 v[112:115], v[48:51], v[172:175], v[112:115]
  s_waitcnt vmcnt(8)
  s_barrier
  ds_read_b128 v[160:163], v196 offset:20480
  ds_read_b128 v[164:167], v196 offset:22528
  v_mfma_f32_16x16x32_bf16 v[116:119], v[48:51], v[176:179], v[116:119]
  ds_read_b128 v[168:171], v196 offset:24576
  ds_read_b64_tr_b16 v[32:33], v192 offset:32768
  v_mfma_f32_16x16x32_bf16 v[120:123], v[48:51], v[180:183], v[120:123]
  ds_read_b64_tr_b16 v[34:35], v192 offset:34816
  ds_read_b64_tr_b16 v[36:37], v193 offset:32768
  v_mfma_f32_16x16x32_bf16 v[124:127], v[52:55], v[172:175], v[124:127]
  ds_read_b64_tr_b16 v[38:39], v193 offset:34816
  ds_read_b64_tr_b16 v[40:41], v194 offset:32768
  v_mfma_f32_16x16x32_bf16 v[128:131], v[52:55], v[176:179], v[128:131]
  ds_read_b64_tr_b16 v[42:43], v194 offset:34816
  ds_read_b64_tr_b16 v[44:45], v195 offset:32768
  v_mfma_f32_16x16x32_bf16 v[132:135], v[52:55], v[180:183], v[132:135]
  ds_read_b64_tr_b16 v[46:47], v195 offset:34816
  ds_read_b64_tr_b16 v[48:49], v192 offset:33024
  v_mfma_f32_16x16x32_bf16 v[136:139], v[56:59], v[172:175], v[136:139]
  ds_read_b64_tr_b16 v[50:51], v192 offset:35072
  ds_read_b64_tr_b16 v[52:53], v193 offset:33024
  v_mfma_f32_16x16x32_bf16 v[140:143], v[56:59], v[176:179], v[140:143]
  ds_read_b64_tr_b16 v[54:55], v193 offset:35072
  s_add_u32 m0, s34, 0x10000
  v_mfma_f32_16x16x32_bf16 v[144:147], v[56:59], v[180:183], v[144:147]
  ds_read_b64_tr_b16 v[56:57], v194 offset:33024
  ds_read_b64_tr_b16 v[58:59], v194 offset:35072
  v_mfma_f32_16x16x32_bf16 v[148:151], v[60:63], v[172:175], v[148:151]
  s_add_u32 s32, s34, 0x10000
  buffer_load_dwordx4 v1, s[12:15], s32 offen offset:0 nt lds
  v_mfma_f32_16x16x32_bf16 v[152:155], v[60:63], v[176:179], v[152:155]
  buffer_load_dwordx4 v2, s[12:15], s32 offen offset:1024 nt lds
  v_mfma_f32_16x16x32_bf16 v[156:159], v[60:63], v[180:183], v[156:159]
  ds_read_b64_tr_b16 v[60:61], v195 offset:33024
  ds_read_b64_tr_b16 v[62:63], v195 offset:35072
  s_waitcnt lgkmcnt(15)
  s_waitcnt lgkmcnt(12)
  v_mfma_f32_16x16x32_bf16 v[64:67], v[32:35], v[160:163], v[64:67]
  v_mfma_f32_16x16x32_bf16 v[68:71], v[32:35], v[164:167], v[68:71]
  v_mfma_f32_16x16x32_bf16 v[72:75], v[32:35], v[168:171], v[72:75]
  v_mfma_f32_16x16x32_bf16 v[76:79], v[36:39], v[160:163], v[76:79]
  buffer_load_dwordx4 v3, s[12:15], s32 offen offset:2048 nt lds
  v_mfma_f32_16x16x32_bf16 v[80:83], v[36:39], v[164:167], v[80:83]
  v_mfma_f32_16x16x32_bf16 v[84:87], v[36:39], v[168:171], v[84:87]
  s_waitcnt lgkmcnt(8)
  v_mfma_f32_16x16x32_bf16 v[88:91], v[40:43], v[160:163], v[88:91]
  v_mfma_f32_16x16x32_bf16 v[92:95], v[40:43], v[164:167], v[92:95]
  v_mfma_f32_16x16x32_bf16 v[96:99], v[40:43], v[168:171], v[96:99]
  v_mfma_f32_16x16x32_bf16 v[100:103], v[44:47], v[160:163], v[100:103]
  v_mfma_f32_16x16x32_bf16 v[104:107], v[44:47], v[164:167], v[104:107]
  buffer_load_dwordx4 v4, s[12:15], s32 offen offset:3072 nt lds
  v_mfma_f32_16x16x32_bf16 v[108:111], v[44:47], v[168:171], v[108:111]
  s_waitcnt lgkmcnt(0)
  v_mfma_f32_16x16x32_bf16 v[112:115], v[48:51], v[160:163], v[112:115]
  s_barrier
  ds_read_b128 v[172:175], v197 offset:20480
  ds_read_b128 v[176:179], v197 offset:22528
  v_mfma_f32_16x16x32_bf16 v[116:119], v[48:51], v[164:167], v[116:119]
  ds_read_b128 v[180:183], v197 offset:24576
  ds_read_b64_tr_b16 v[32:33], v192 offset:49152
  v_mfma_f32_16x16x32_bf16 v[120:123], v[48:51], v[168:171], v[120:123]
  ds_read_b64_tr_b16 v[34:35], v192 offset:51200
  ds_read_b64_tr_b16 v[36:37], v193 offset:49152
  v_mfma_f32_16x16x32_bf16 v[124:127], v[52:55], v[160:163], v[124:127]
  ds_read_b64_tr_b16 v[38:39], v193 offset:51200
  ds_read_b64_tr_b16 v[40:41], v194 offset:49152
  v_mfma_f32_16x16x32_bf16 v[128:131], v[52:55], v[164:167], v[128:131]
  ds_read_b64_tr_b16 v[42:43], v194 offset:51200
  ds_read_b64_tr_b16 v[44:45], v195 offset:49152
  v_mfma_f32_16x16x32_bf16 v[132:135], v[52:55], v[168:171], v[132:135]
  ds_read_b64_tr_b16 v[46:47], v195 offset:51200
  ds_read_b64_tr_b16 v[48:49], v192 offset:49408
  v_mfma_f32_16x16x32_bf16 v[136:139], v[56:59], v[160:163], v[136:139]
  ds_read_b64_tr_b16 v[50:51], v192 offset:51456
  ds_read_b64_tr_b16 v[52:53], v193 offset:49408
  v_mfma_f32_16x16x32_bf16 v[140:143], v[56:59], v[164:167], v[140:143]
  ds_read_b64_tr_b16 v[54:55], v193 offset:51456
  s_add_u32 m0, s34, 0x11000
  v_mfma_f32_16x16x32_bf16 v[144:147], v[56:59], v[168:171], v[144:147]
  ds_read_b64_tr_b16 v[56:57], v194 offset:49408
  ds_read_b64_tr_b16 v[58:59], v194 offset:51456
  v_mfma_f32_16x16x32_bf16 v[148:151], v[60:63], v[160:163], v[148:151]
  s_add_u32 s32, s34, 0x11000
  buffer_load_dwordx4 v1, s[12:15], s32 offen offset:0 nt lds
  v_mfma_f32_16x16x32_bf16 v[152:155], v[60:63], v[164:167], v[152:155]
  v_mfma_f32_16x16x32_bf16 v[156:159], v[60:63], v[168:171], v[156:159]
  ds_read_b64_tr_b16 v[60:61], v195 offset:49408
  ds_read_b64_tr_b16 v[62:63], v195 offset:51456
  s_waitcnt lgkmcnt(15)
  s_waitcnt lgkmcnt(12)
  v_mfma_f32_16x16x32_bf16 v[64:67], v[32:35], v[172:175], v[64:67]
  buffer_load_dwordx4 v2, s[12:15], s32 offen offset:1024 nt lds
  v_mfma_f32_16x16x32_bf16 v[68:71], v[32:35], v[176:179], v[68:71]
  v_mfma_f32_16x16x32_bf16 v[72:75], v[32:35], v[180:183], v[72:75]
  v_mfma_f32_16x16x32_bf16 v[76:79], v[36:39], v[172:175], v[76:79]
  v_mfma_f32_16x16x32_bf16 v[80:83], v[36:39], v[176:179], v[80:83]
  v_mfma_f32_16x16x32_bf16 v[84:87], v[36:39], v[180:183], v[84:87]
  s_waitcnt lgkmcnt(8)
  v_mfma_f32_16x16x32_bf16 v[88:91], v[40:43], v[172:175], v[88:91]
  v_mfma_f32_16x16x32_bf16 v[92:95], v[40:43], v[176:179], v[92:95]
  buffer_load_dwordx4 v3, s[12:15], s32 offen offset:2048 nt lds
  v_mfma_f32_16x16x32_bf16 v[96:99], v[40:43], v[180:183], v[96:99]
  v_mfma_f32_16x16x32_bf16 v[100:103], v[44:47], v[172:175], v[100:103]
  v_mfma_f32_16x16x32_bf16 v[104:107], v[44:47], v[176:179], v[104:107]
  v_mfma_f32_16x16x32_bf16 v[108:111], v[44:47], v[180:183], v[108:111]
  s_waitcnt lgkmcnt(0)
  v_mfma_f32_16x16x32_bf16 v[112:115], v[48:51], v[172:175], v[112:115]
  s_barrier
  ds_read_b128 v[32:35], v8 offset:0
  ds_read_b128 v[36:39], v8 offset:4096
  v_mfma_f32_16x16x32_bf16 v[116:119], v[48:51], v[176:179], v[116:119]
  ds_read_b128 v[40:43], v9 offset:0
  ds_read_b128 v[44:47], v9 offset:4096
  v_mfma_f32_16x16x32_bf16 v[120:123], v[48:51], v[180:183], v[120:123]
  ds_read_b128 v[48:51], v10 offset:0
  buffer_load_dwordx4 v4, s[12:15], s32 offen offset:3072 nt lds
  v_mfma_f32_16x16x32_bf16 v[124:127], v[52:55], v[172:175], v[124:127]
  v_mfma_f32_16x16x32_bf16 v[128:131], v[52:55], v[176:179], v[128:131]
  v_mfma_f32_16x16x32_bf16 v[132:135], v[52:55], v[180:183], v[132:135]
  ds_read_b128 v[52:55], v10 offset:4096
  v_mfma_f32_16x16x32_bf16 v[136:139], v[56:59], v[172:175], v[136:139]
  v_mfma_f32_16x16x32_bf16 v[140:143], v[56:59], v[176:179], v[140:143]
  v_mfma_f32_16x16x32_bf16 v[144:147], v[56:59], v[180:183], v[144:147]
  ds_read_b128 v[56:59], v11 offset:0
  v_mfma_f32_16x16x32_bf16 v[148:151], v[60:63], v[172:175], v[148:151]
  s_add_u32 m0, s34, 0x14000
  s_add_u32 s32, s34, 0x14000
  v_mfma_f32_16x16x32_bf16 v[152:155], v[60:63], v[176:179], v[152:155]
  buffer_load_dwordx4 v1, s[12:15], s32 offen offset:0 nt lds
  v_mfma_f32_16x16x32_bf16 v[156:159], v[60:63], v[180:183], v[156:159]
  ds_read_b128 v[60:63], v11 offset:4096
  v_bfe_u32 v200, v0, 4, 4
  v_lshrrev_b32 v201, 8, v0
  v_lshrrev_b32 v205, 1, v201
  s_lshl_b32 s42, s40, 3
  v_xor_b32 v205, s42, v205
  v_xor_b32 v205, v200, v205
  v_lshlrev_b32 v205, 4, v205
  v_lshl_add_u32 v204, v200, 8, v205
  v_and_b32 v205, 1, v201
  v_lshl_add_u32 v204, v205, 3, v204
  v_add_u32 v204, s46, v204
  v_xor_b32 v205, 32, v204
  v_xor_b32 v206, 64, v204
  v_xor_b32 v207, 96, v204
  s_sub_u32 s42, s46, s34
  s_sub_u32 s42, s42, 0x0
  v_add_u32 v208, s42, v8
  v_add_u32 v209, s42, v9
  v_add_u32 v210, s42, v10
  v_add_u32 v211, s42, v11
  v_cvt_pk_bf16_f32 v64, v64, v65
  v_cvt_pk_bf16_f32 v65, v66, v67
  ds_write_b64 v204, v[64:65] offset:0
  v_cvt_pk_bf16_f32 v68, v68, v69
  v_cvt_pk_bf16_f32 v69, v70, v71
  ds_write_b64 v204, v[68:69] offset:4096
  v_cvt_pk_bf16_f32 v72, v72, v73
  v_cvt_pk_bf16_f32 v73, v74, v75
  ds_write_b64 v204, v[72:73] offset:8192
  v_cvt_pk_bf16_f32 v76, v76, v77
  v_cvt_pk_bf16_f32 v77, v78, v79
  ds_write_b64 v205, v[76:77] offset:0
  v_cvt_pk_bf16_f32 v80, v80, v81
  v_cvt_pk_bf16_f32 v81, v82, v83
  ds_write_b64 v205, v[80:81] offset:4096
  v_cvt_pk_bf16_f32 v84, v84, v85
  v_cvt_pk_bf16_f32 v85, v86, v87
  ds_write_b64 v205, v[84:85] offset:8192
  buffer_load_dwordx4 v2, s[12:15], s32 offen offset:1024 nt lds
  v_cvt_pk_bf16_f32 v88, v88, v89
  v_cvt_pk_bf16_f32 v89, v90, v91
  ds_write_b64 v206, v[88:89] offset:0
  v_cvt_pk_bf16_f32 v92, v92, v93
  v_cvt_pk_bf16_f32 v93, v94, v95
  ds_write_b64 v206, v[92:93] offset:4096
  v_cvt_pk_bf16_f32 v96, v96, v97
  v_cvt_pk_bf16_f32 v97, v98, v99
  ds_write_b64 v206, v[96:97] offset:8192
  buffer_load_dwordx4 v3, s[12:15], s32 offen offset:2048 nt lds
  v_cvt_pk_bf16_f32 v100, v100, v101
  v_cvt_pk_bf16_f32 v101, v102, v103
  ds_write_b64 v207, v[100:101] offset:0
  v_cvt_pk_bf16_f32 v104, v104, v105
  v_cvt_pk_bf16_f32 v105, v106, v107
  ds_write_b64 v207, v[104:105] offset:4096
  v_cvt_pk_bf16_f32 v108, v108, v109
  v_cvt_pk_bf16_f32 v109, v110, v111
  ds_write_b64 v207, v[108:109] offset:8192
  v_cvt_pk_bf16_f32 v112, v112, v113
  v_cvt_pk_bf16_f32 v113, v114, v115
  ds_write_b64 v204, v[112:113] offset:24576
  v_cvt_pk_bf16_f32 v116, v116, v117
  v_cvt_pk_bf16_f32 v117, v118, v119
  ds_write_b64 v204, v[116:117] offset:28672
  v_cvt_pk_bf16_f32 v120, v120, v121
  v_cvt_pk_bf16_f32 v121, v122, v123
  ds_write_b64 v204, v[120:121] offset:32768
  buffer_load_dwordx4 v4, s[12:15], s32 offen offset:3072 nt lds
  v_cvt_pk_bf16_f32 v124, v124, v125
  v_cvt_pk_bf16_f32 v125, v126, v127
  ds_write_b64 v205, v[124:125] offset:24576
  v_cvt_pk_bf16_f32 v128, v128, v129
  v_cvt_pk_bf16_f32 v129, v130, v131
  ds_write_b64 v205, v[128:129] offset:28672
  v_cvt_pk_bf16_f32 v132, v132, v133
  v_cvt_pk_bf16_f32 v133, v134, v135
  ds_write_b64 v205, v[132:133] offset:32768
  s_add_u32 m0, s34, 0x15000
  s_add_u32 s32, s34, 0x15000
  v_cvt_pk_bf16_f32 v136, v136, v137
  v_cvt_pk_bf16_f32 v137, v138, v139
  ds_write_b64 v206, v[136:137] offset:24576
  v_cvt_pk_bf16_f32 v140, v140, v141
  v_cvt_pk_bf16_f32 v141, v142, v143
  ds_write_b64 v206, v[140:141] offset:28672
  v_cvt_pk_bf16_f32 v144, v144, v145
  v_cvt_pk_bf16_f32 v145, v146, v147
  ds_write_b64 v206, v[144:145] offset:32768
  buffer_load_dwordx4 v1, s[12:15], s32 offen offset:0 nt lds
  v_cvt_pk_bf16_f32 v148, v148, v149
  v_cvt_pk_bf16_f32 v149, v150, v151
  ds_write_b64 v207, v[148:149] offset:24576
  v_cvt_pk_bf16_f32 v152, v152, v153
  v_cvt_pk_bf16_f32 v153, v154, v155
  ds_write_b64 v207, v[152:153] offset:28672
  v_cvt_pk_bf16_f32 v156, v156, v157
  v_cvt_pk_bf16_f32 v157, v158, v159
  ds_write_b64 v207, v[156:157] offset:32768
  buffer_load_dwordx4 v2, s[12:15], s32 offen offset:1024 nt lds
  s_waitcnt lgkmcnt(0)
  s_barrier
  ds_read_b128 a[0:3], v208 offset:0
  ds_read_b128 a[16:19], v208 offset:4096
  ds_read_b128 a[32:35], v208 offset:8192
  ds_read_b128 a[4:7], v209 offset:0
  ds_read_b128 a[20:23], v209 offset:4096
  ds_read_b128 a[36:39], v209 offset:8192
  ds_read_b128 a[8:11], v210 offset:0
  ds_read_b128 a[24:27], v210 offset:4096
  ds_read_b128 a[40:43], v210 offset:8192
  ds_read_b128 a[12:15], v211 offset:0
  ds_read_b128 a[28:31], v211 offset:4096
  ds_read_b128 a[44:47], v211 offset:8192
  ds_read_b128 a[192:195], v208 offset:24576
  ds_read_b128 a[208:211], v208 offset:28672
  ds_read_b128 a[224:227], v208 offset:32768
  ds_read_b128 a[196:199], v209 offset:24576
  ds_read_b128 a[212:215], v209 offset:28672
  ds_read_b128 a[228:231], v209 offset:32768
  ds_read_b128 a[200:203], v210 offset:24576
  ds_read_b128 a[216:219], v210 offset:28672
  ds_read_b128 a[232:235], v210 offset:32768
  ds_read_b128 a[204:207], v211 offset:24576
  ds_read_b128 a[220:223], v211 offset:28672
  ds_read_b128 a[236:239], v211 offset:32768
  buffer_load_dwordx4 v3, s[12:15], s32 offen offset:2048 nt lds
  buffer_load_dwordx4 v4, s[12:15], s32 offen offset:3072 nt lds
  s_waitcnt lgkmcnt(12)
  v_mfma_f32_16x16x32_bf16 v[64:67], v[32:35], a[0:3], 0
  v_mfma_f32_16x16x32_bf16 v[72:75], v[32:35], a[16:19], 0
  v_mfma_f32_16x16x32_bf16 v[80:83], v[32:35], a[32:35], 0
  v_mfma_f32_16x16x32_bf16 v[68:71], v[36:39], a[0:3], 0
  v_mfma_f32_16x16x32_bf16 v[76:79], v[36:39], a[16:19], 0
  v_mfma_f32_16x16x32_bf16 v[84:87], v[36:39], a[32:35], 0
  v_mfma_f32_16x16x32_bf16 v[64:67], v[40:43], a[4:7], v[64:67]
  v_mfma_f32_16x16x32_bf16 v[72:75], v[40:43], a[20:23], v[72:75]
  v_mfma_f32_16x16x32_bf16 v[80:83], v[40:43], a[36:39], v[80:83]
  v_mfma_f32_16x16x32_bf16 v[68:71], v[44:47], a[4:7], v[68:71]
  v_mfma_f32_16x16x32_bf16 v[76:79], v[44:47], a[20:23], v[76:79]
  v_mfma_f32_16x16x32_bf16 v[84:87], v[44:47], a[36:39], v[84:87]
  s_waitcnt lgkmcnt(0)
  v_mfma_f32_16x16x32_bf16 v[64:67], v[48:51], a[8:11], v[64:67]
  s_barrier
  ds_read_b128 v[32:35], v8 offset:16384
  ds_read_b128 v[36:39], v8 offset:20480
  v_mfma_f32_16x16x32_bf16 v[72:75], v[48:51], a[24:27], v[72:75]
  ds_read_b128 v[40:43], v9 offset:16384
  ds_read_b128 v[44:47], v9 offset:20480
  v_mfma_f32_16x16x32_bf16 v[80:83], v[48:51], a[40:43], v[80:83]
  ds_read_b128 v[48:51], v10 offset:16384
  s_add_u32 m0, s34, 0x0
  v_mfma_f32_16x16x32_bf16 v[68:71], v[52:55], a[8:11], v[68:71]
  s_add_u32 s32, s34, 0x18000
  buffer_load_dwordx4 v1, s[12:15], s32 offen offset:0 nt lds
  v_mfma_f32_16x16x32_bf16 v[76:79], v[52:55], a[24:27], v[76:79]
  v_mfma_f32_16x16x32_bf16 v[84:87], v[52:55], a[40:43], v[84:87]
  ds_read_b128 v[52:55], v10 offset:20480
  v_mfma_f32_16x16x32_bf16 v[64:67], v[56:59], a[12:15], v[64:67]
  v_mfma_f32_16x16x32_bf16 v[72:75], v[56:59], a[28:31], v[72:75]
  v_mfma_f32_16x16x32_bf16 v[80:83], v[56:59], a[44:47], v[80:83]
  ds_read_b128 v[56:59], v11 offset:16384
  v_mfma_f32_16x16x32_bf16 v[68:71], v[60:63], a[12:15], v[68:71]
  v_mfma_f32_16x16x32_bf16 v[76:79], v[60:63], a[28:31], v[76:79]
  buffer_load_dwordx4 v2, s[12:15], s32 offen offset:1024 nt lds
  v_mfma_f32_16x16x32_bf16 v[84:87], v[60:63], a[44:47], v[84:87]
  ds_read_b128 v[60:63], v11 offset:20480
  s_waitcnt lgkmcnt(6)
  v_mfma_f32_16x16x32_bf16 v[88:91], v[32:35], a[0:3], 0
  v_mfma_f32_16x16x32_bf16 v[96:99], v[32:35], a[16:19], 0
  v_mfma_f32_16x16x32_bf16 v[104:107], v[32:35], a[32:35], 0
  v_mfma_f32_16x16x32_bf16 v[92:95], v[36:39], a[0:3], 0
  v_mfma_f32_16x16x32_bf16 v[100:103], v[36:39], a[16:19], 0
  v_mfma_f32_16x16x32_bf16 v[108:111], v[36:39], a[32:35], 0
  s_waitcnt lgkmcnt(4)
  v_mfma_f32_16x16x32_bf16 v[88:91], v[40:43], a[4:7], v[88:91]
  v_mfma_f32_16x16x32_bf16 v[96:99], v[40:43], a[20:23], v[96:99]
  buffer_load_dwordx4 v3, s[12:15], s32 offen offset:2048 nt lds
  v_mfma_f32_16x16x32_bf16 v[104:107], v[40:43], a[36:39], v[104:107]
  v_mfma_f32_16x16x32_bf16 v[92:95], v[44:47], a[4:7], v[92:95]
  v_mfma_f32_16x16x32_bf16 v[100:103], v[44:47], a[20:23], v[100:103]
  v_mfma_f32_16x16x32_bf16 v[108:111], v[44:47], a[36:39], v[108:111]
  s_waitcnt lgkmcnt(0)
  v_mfma_f32_16x16x32_bf16 v[88:91], v[48:51], a[8:11], v[88:91]
  s_barrier
  ds_read_b128 v[32:35], v8 offset:32768
  ds_read_b128 v[36:39], v8 offset:36864
  v_mfma_f32_16x16x32_bf16 v[96:99], v[48:51], a[24:27], v[96:99]
  ds_read_b128 v[40:43], v9 offset:32768
  ds_read_b128 v[44:47], v9 offset:36864
  v_mfma_f32_16x16x32_bf16 v[104:107], v[48:51], a[40:43], v[104:107]
  ds_read_b128 v[48:51], v10 offset:32768
  v_mfma_f32_16x16x32_bf16 v[92:95], v[52:55], a[8:11], v[92:95]
  v_mfma_f32_16x16x32_bf16 v[100:103], v[52:55], a[24:27], v[100:103]
  buffer_load_dwordx4 v4, s[12:15], s32 offen offset:3072 nt lds
  v_mfma_f32_16x16x32_bf16 v[108:111], v[52:55], a[40:43], v[108:111]
  ds_read_b128 v[52:55], v10 offset:36864
  v_mfma_f32_16x16x32_bf16 v[88:91], v[56:59], a[12:15], v[88:91]
  v_mfma_f32_16x16x32_bf16 v[96:99], v[56:59], a[28:31], v[96:99]
  v_mfma_f32_16x16x32_bf16 v[104:107], v[56:59], a[44:47], v[104:107]
  ds_read_b128 v[56:59], v11 offset:32768
  v_mfma_f32_16x16x32_bf16 v[92:95], v[60:63], a[12:15], v[92:95]
  v_mfma_f32_16x16x32_bf16 v[100:103], v[60:63], a[28:31], v[100:103]
  v_mfma_f32_16x16x32_bf16 v[108:111], v[60:63], a[44:47], v[108:111]
  ds_read_b128 v[60:63], v11 offset:36864
  s_waitcnt lgkmcnt(6)
  v_mfma_f32_16x16x32_bf16 v[112:115], v[32:35], a[0:3], 0
  v_mfma_f32_16x16x32_bf16 v[120:123], v[32:35], a[16:19], 0
  v_mfma_f32_16x16x32_bf16 v[128:131], v[32:35], a[32:35], 0
  s_add_u32 m0, s34, 0x1000
  s_add_u32 s32, s34, 0x19000
  v_mfma_f32_16x16x32_bf16 v[116:119], v[36:39], a[0:3], 0
  buffer_load_dwordx4 v1, s[12:15], s32 offen offset:0 nt lds
  v_mfma_f32_16x16x32_bf16 v[124:127], v[36:39], a[16:19], 0
  v_mfma_f32_16x16x32_bf16 v[132:135], v[36:39], a[32:35], 0
  s_waitcnt lgkmcnt(4)
  v_mfma_f32_16x16x32_bf16 v[112:115], v[40:43], a[4:7], v[112:115]
  v_mfma_f32_16x16x32_bf16 v[120:123], v[40:43], a[20:23], v[120:123]
  v_mfma_f32_16x16x32_bf16 v[128:131], v[40:43], a[36:39], v[128:131]
  v_mfma_f32_16x16x32_bf16 v[116:119], v[44:47], a[4:7], v[116:119]
  v_mfma_f32_16x16x32_bf16 v[124:127], v[44:47], a[20:23], v[124:127]
  v_mfma_f32_16x16x32_bf16 v[132:135], v[44:47], a[36:39], v[132:135]
  buffer_load_dwordx4 v2, s[12:15], s32 offen offset:1024 nt lds
  s_waitcnt lgkmcnt(0)
  v_mfma_f32_16x16x32_bf16 v[112:115], v[48:51], a[8:11], v[112:115]
  s_waitcnt vmcnt(22)
  s_barrier
  ds_read_b128 v[32:35], v8 offset:49152
  ds_read_b128 v[36:39], v8 offset:53248
  v_mfma_f32_16x16x32_bf16 v[120:123], v[48:51], a[24:27], v[120:123]
  ds_read_b128 v[40:43], v9 offset:49152
  ds_read_b128 v[44:47], v9 offset:53248
  v_mfma_f32_16x16x32_bf16 v[128:131], v[48:51], a[40:43], v[128:131]
  ds_read_b128 v[48:51], v10 offset:49152
  v_mfma_f32_16x16x32_bf16 v[116:119], v[52:55], a[8:11], v[116:119]
  v_mfma_f32_16x16x32_bf16 v[124:127], v[52:55], a[24:27], v[124:127]
  v_mfma_f32_16x16x32_bf16 v[132:135], v[52:55], a[40:43], v[132:135]
  ds_read_b128 v[52:55], v10 offset:53248
  v_mfma_f32_16x16x32_bf16 v[112:115], v[56:59], a[12:15], v[112:115]
  v_mfma_f32_16x16x32_bf16 v[120:123], v[56:59], a[28:31], v[120:123]
  v_mfma_f32_16x16x32_bf16 v[128:131], v[56:59], a[44:47], v[128:131]
  ds_read_b128 v[56:59], v11 offset:49152
  buffer_load_dwordx4 v3, s[12:15], s32 offen offset:2048 nt lds
  v_mfma_f32_16x16x32_bf16 v[116:119], v[60:63], a[12:15], v[116:119]
  v_mfma_f32_16x16x32_bf16 v[124:127], v[60:63], a[28:31], v[124:127]
  v_mfma_f32_16x16x32_bf16 v[132:135], v[60:63], a[44:47], v[132:135]
  ds_read_b128 v[60:63], v11 offset:53248
  s_waitcnt lgkmcnt(6)
  v_mfma_f32_16x16x32_bf16 v[136:139], v[32:35], a[0:3], 0
  v_mfma_f32_16x16x32_bf16 v[144:147], v[32:35], a[16:19], 0
  v_mfma_f32_16x16x32_bf16 v[152:155], v[32:35], a[32:35], 0
  v_mfma_f32_16x16x32_bf16 v[140:143], v[36:39], a[0:3], 0
  v_mfma_f32_16x16x32_bf16 v[148:151], v[36:39], a[16:19], 0
  v_mfma_f32_16x16x32_bf16 v[156:159], v[36:39], a[32:35], 0
  buffer_load_dwordx4 v4, s[12:15], s32 offen offset:3072 nt lds
  s_waitcnt lgkmcnt(4)
  v_mfma_f32_16x16x32_bf16 v[136:139], v[40:43], a[4:7], v[136:139]
  v_mfma_f32_16x16x32_bf16 v[144:147], v[40:43], a[20:23], v[144:147]
  v_mfma_f32_16x16x32_bf16 v[152:155], v[40:43], a[36:39], v[152:155]
  v_mfma_f32_16x16x32_bf16 v[140:143], v[44:47], a[4:7], v[140:143]
  v_mfma_f32_16x16x32_bf16 v[148:151], v[44:47], a[20:23], v[148:151]
  v_mfma_f32_16x16x32_bf16 v[156:159], v[44:47], a[36:39], v[156:159]
  s_waitcnt lgkmcnt(0)
  v_mfma_f32_16x16x32_bf16 v[136:139], v[48:51], a[8:11], v[136:139]
  s_waitcnt vmcnt(16)
  s_barrier
  v_add_u32 v8, 0x10000, v8
  ds_read_b128 v[32:35], v8 offset:0
  ds_read_b128 v[36:39], v8 offset:4096
  v_mfma_f32_16x16x32_bf16 v[144:147], v[48:51], a[24:27], v[144:147]
  v_add_u32 v9, 0x10000, v9
  ds_read_b128 v[40:43], v9 offset:0
  ds_read_b128 v[44:47], v9 offset:4096
  v_mfma_f32_16x16x32_bf16 v[152:155], v[48:51], a[40:43], v[152:155]
  v_add_u32 v10, 0x10000, v10
  ds_read_b128 v[48:51], v10 offset:0
  s_add_u32 m0, s34, 0x4000
  v_mfma_f32_16x16x32_bf16 v[140:143], v[52:55], a[8:11], v[140:143]
  s_add_u32 s32, s34, 0x1c000
  buffer_load_dwordx4 v1, s[12:15], s32 offen offset:0 nt lds
  v_mfma_f32_16x16x32_bf16 v[148:151], v[52:55], a[24:27], v[148:151]
  buffer_load_dwordx4 v2, s[12:15], s32 offen offset:1024 nt lds
  buffer_load_dwordx4 v3, s[12:15], s32 offen offset:2048 nt lds
  v_mfma_f32_16x16x32_bf16 v[156:159], v[52:55], a[40:43], v[156:159]
  ds_read_b128 v[52:55], v10 offset:4096
  buffer_load_dwordx4 v4, s[12:15], s32 offen offset:3072 nt lds
  v_mfma_f32_16x16x32_bf16 v[136:139], v[56:59], a[12:15], v[136:139]
  v_mfma_f32_16x16x32_bf16 v[144:147], v[56:59], a[28:31], v[144:147]
  v_mfma_f32_16x16x32_bf16 v[152:155], v[56:59], a[44:47], v[152:155]
  v_add_u32 v11, 0x10000, v11
  ds_read_b128 v[56:59], v11 offset:0
  s_add_u32 m0, s34, 0x5000
  v_mfma_f32_16x16x32_bf16 v[140:143], v[60:63], a[12:15], v[140:143]
  s_add_u32 s32, s34, 0x1d000
  buffer_load_dwordx4 v1, s[12:15], s32 offen offset:0 nt lds
  v_mfma_f32_16x16x32_bf16 v[148:151], v[60:63], a[28:31], v[148:151]
  v_mfma_f32_16x16x32_bf16 v[156:159], v[60:63], a[44:47], v[156:159]
  ds_read_b128 v[60:63], v11 offset:4096
  s_waitcnt lgkmcnt(6)
  v_mfma_f32_16x16x32_bf16 v[160:163], v[32:35], a[0:3], 0
  v_mfma_f32_16x16x32_bf16 v[168:171], v[32:35], a[16:19], 0
  v_mfma_f32_16x16x32_bf16 v[176:179], v[32:35], a[32:35], 0
  v_mfma_f32_16x16x32_bf16 v[164:167], v[36:39], a[0:3], 0
  v_mfma_f32_16x16x32_bf16 v[172:175], v[36:39], a[16:19], 0
  v_mfma_f32_16x16x32_bf16 v[180:183], v[36:39], a[32:35], 0
  buffer_load_dwordx4 v2, s[12:15], s32 offen offset:1024 nt lds
  s_waitcnt lgkmcnt(4)
  v_mfma_f32_16x16x32_bf16 v[160:163], v[40:43], a[4:7], v[160:163]
  v_mfma_f32_16x16x32_bf16 v[168:171], v[40:43], a[20:23], v[168:171]
  v_mfma_f32_16x16x32_bf16 v[176:179], v[40:43], a[36:39], v[176:179]
  v_mfma_f32_16x16x32_bf16 v[164:167], v[44:47], a[4:7], v[164:167]
  v_mfma_f32_16x16x32_bf16 v[172:175], v[44:47], a[20:23], v[172:175]
  v_mfma_f32_16x16x32_bf16 v[180:183], v[44:47], a[36:39], v[180:183]
  s_waitcnt lgkmcnt(0)
  v_mfma_f32_16x16x32_bf16 v[160:163], v[48:51], a[8:11], v[160:163]
  s_waitcnt vmcnt(14)
  s_barrier
  ds_read_b128 v[32:35], v8 offset:16384
  ds_read_b128 v[36:39], v8 offset:20480
  v_mfma_f32_16x16x32_bf16 v[168:171], v[48:51], a[24:27], v[168:171]
  ds_read_b128 v[40:43], v9 offset:16384
  ds_read_b128 v[44:47], v9 offset:20480
  v_mfma_f32_16x16x32_bf16 v[176:179], v[48:51], a[40:43], v[176:179]
  ds_read_b128 v[48:51], v10 offset:16384
  buffer_load_dwordx4 v3, s[12:15], s32 offen offset:2048 nt lds
  v_mfma_f32_16x16x32_bf16 v[164:167], v[52:55], a[8:11], v[164:167]
  buffer_load_dwordx4 v4, s[12:15], s32 offen offset:3072 nt lds
  s_add_u32 m0, s34, 0x8000
  v_mfma_f32_16x16x32_bf16 v[172:175], v[52:55], a[24:27], v[172:175]
  s_add_u32 s32, s34, 0x0
  buffer_load_dwordx4 v5, s[16:19], s32 offen offset:0 nt lds
  v_mfma_f32_16x16x32_bf16 v[180:183], v[52:55], a[40:43], v[180:183]
  ds_read_b128 v[52:55], v10 offset:20480
  buffer_load_dwordx4 v6, s[16:19], s32 offen offset:1024 nt lds
  v_mfma_f32_16x16x32_bf16 v[160:163], v[56:59], a[12:15], v[160:163]
  buffer_load_dwordx4 v5, s[16:19], s32 offen offset:2048 nt lds
  buffer_load_dwordx4 v6, s[16:19], s32 offen offset:3072 nt lds
  v_mfma_f32_16x16x32_bf16 v[168:171], v[56:59], a[28:31], v[168:171]
  v_mfma_f32_16x16x32_bf16 v[176:179], v[56:59], a[44:47], v[176:179]
  ds_read_b128 v[56:59], v11 offset:16384
  s_add_u32 m0, s34, 0x9000
  v_mfma_f32_16x16x32_bf16 v[164:167], v[60:63], a[12:15], v[164:167]
  s_add_u32 s32, s34, 0x1000
  buffer_load_dwordx4 v5, s[16:19], s32 offen offset:0 nt lds
  v_mfma_f32_16x16x32_bf16 v[172:175], v[60:63], a[28:31], v[172:175]
  v_mfma_f32_16x16x32_bf16 v[180:183], v[60:63], a[44:47], v[180:183]
  ds_read_b128 v[60:63], v11 offset:20480
  s_waitcnt lgkmcnt(6)
  v_mfma_f32_16x16x32_bf16 v[184:187], v[32:35], a[0:3], 0
  v_mfma_f32_16x16x32_bf16 v[192:195], v[32:35], a[16:19], 0
  v_mfma_f32_16x16x32_bf16 v[200:203], v[32:35], a[32:35], 0
  v_mfma_f32_16x16x32_bf16 v[188:191], v[36:39], a[0:3], 0
  v_mfma_f32_16x16x32_bf16 v[196:199], v[36:39], a[16:19], 0
  v_mfma_f32_16x16x32_bf16 v[204:207], v[36:39], a[32:35], 0
  buffer_load_dwordx4 v6, s[16:19], s32 offen offset:1024 nt lds
  s_waitcnt lgkmcnt(4)
  v_mfma_f32_16x16x32_bf16 v[184:187], v[40:43], a[4:7], v[184:187]
  v_mfma_f32_16x16x32_bf16 v[192:195], v[40:43], a[20:23], v[192:195]
  v_mfma_f32_16x16x32_bf16 v[200:203], v[40:43], a[36:39], v[200:203]
  v_mfma_f32_16x16x32_bf16 v[188:191], v[44:47], a[4:7], v[188:191]
  v_mfma_f32_16x16x32_bf16 v[196:199], v[44:47], a[20:23], v[196:199]
  v_mfma_f32_16x16x32_bf16 v[204:207], v[44:47], a[36:39], v[204:207]
  s_waitcnt lgkmcnt(0)
  v_mfma_f32_16x16x32_bf16 v[184:187], v[48:51], a[8:11], v[184:187]
  s_waitcnt vmcnt(14)
  s_barrier
  v_subrev_u32 v8, 0x10000, v8
  ds_read_b128 v[32:35], v8 offset:0
  ds_read_b128 v[36:39], v8 offset:4096
  v_mfma_f32_16x16x32_bf16 v[192:195], v[48:51], a[24:27], v[192:195]
  v_subrev_u32 v9, 0x10000, v9
  ds_read_b128 v[40:43], v9 offset:0
  ds_read_b128 v[44:47], v9 offset:4096
  v_mfma_f32_16x16x32_bf16 v[200:203], v[48:51], a[40:43], v[200:203]
  v_subrev_u32 v10, 0x10000, v10
  ds_read_b128 v[48:51], v10 offset:0
  buffer_load_dwordx4 v5, s[16:19], s32 offen offset:2048 nt lds
  v_mfma_f32_16x16x32_bf16 v[188:191], v[52:55], a[8:11], v[188:191]
  buffer_load_dwordx4 v6, s[16:19], s32 offen offset:3072 nt lds
  s_add_u32 m0, s34, 0xc000
  v_mfma_f32_16x16x32_bf16 v[196:199], v[52:55], a[24:27], v[196:199]
  s_add_u32 s32, s34, 0x4000
  buffer_load_dwordx4 v5, s[16:19], s32 offen offset:0 nt lds
  v_mfma_f32_16x16x32_bf16 v[204:207], v[52:55], a[40:43], v[204:207]
  ds_read_b128 v[52:55], v10 offset:4096
  buffer_load_dwordx4 v6, s[16:19], s32 offen offset:1024 nt lds
  v_mfma_f32_16x16x32_bf16 v[184:187], v[56:59], a[12:15], v[184:187]
  buffer_load_dwordx4 v5, s[16:19], s32 offen offset:2048 nt lds
  buffer_load_dwordx4 v6, s[16:19], s32 offen offset:3072 nt lds
  v_mfma_f32_16x16x32_bf16 v[192:195], v[56:59], a[28:31], v[192:195]
  s_add_u32 m0, s34, 0xd000
  s_add_u32 s32, s34, 0x5000
  v_mfma_f32_16x16x32_bf16 v[200:203], v[56:59], a[44:47], v[200:203]
  v_subrev_u32 v11, 0x10000, v11
  ds_read_b128 v[56:59], v11 offset:0
  buffer_load_dwordx4 v5, s[16:19], s32 offen offset:0 nt lds
  v_mfma_f32_16x16x32_bf16 v[188:191], v[60:63], a[12:15], v[188:191]
  buffer_load_dwordx4 v6, s[16:19], s32 offen offset:1024 nt lds
  v_mfma_f32_16x16x32_bf16 v[196:199], v[60:63], a[28:31], v[196:199]
  buffer_load_dwordx4 v5, s[16:19], s32 offen offset:2048 nt lds
  v_mfma_f32_16x16x32_bf16 v[204:207], v[60:63], a[44:47], v[204:207]
  ds_read_b128 v[60:63], v11 offset:4096
  s_waitcnt lgkmcnt(6)
  v_mfma_f32_16x16x32_bf16 v[208:211], v[32:35], a[0:3], 0
  v_mfma_f32_16x16x32_bf16 v[216:219], v[32:35], a[16:19], 0
  v_mfma_f32_16x16x32_bf16 v[224:227], v[32:35], a[32:35], 0
  v_mfma_f32_16x16x32_bf16 v[212:215], v[36:39], a[0:3], 0
  v_mfma_f32_16x16x32_bf16 v[220:223], v[36:39], a[16:19], 0
  v_mfma_f32_16x16x32_bf16 v[228:231], v[36:39], a[32:35], 0
  s_waitcnt lgkmcnt(4)
  v_mfma_f32_16x16x32_bf16 v[208:211], v[40:43], a[4:7], v[208:211]
  v_mfma_f32_16x16x32_bf16 v[216:219], v[40:43], a[20:23], v[216:219]
  v_mfma_f32_16x16x32_bf16 v[224:227], v[40:43], a[36:39], v[224:227]
  buffer_load_dwordx4 v6, s[16:19], s32 offen offset:3072 nt lds
  v_mfma_f32_16x16x32_bf16 v[212:215], v[44:47], a[4:7], v[212:215]
  v_mfma_f32_16x16x32_bf16 v[220:223], v[44:47], a[20:23], v[220:223]
  v_mfma_f32_16x16x32_bf16 v[228:231], v[44:47], a[36:39], v[228:231]
  s_waitcnt lgkmcnt(0)
  v_mfma_f32_16x16x32_bf16 v[208:211], v[48:51], a[8:11], v[208:211]
  s_waitcnt vmcnt(16)
  s_barrier
  ds_read_b128 v[32:35], v8 offset:16384
  ds_read_b128 v[36:39], v8 offset:20480
  v_mfma_f32_16x16x32_bf16 v[216:219], v[48:51], a[24:27], v[216:219]
  ds_read_b128 v[40:43], v9 offset:16384
  ds_read_b128 v[44:47], v9 offset:20480
  v_mfma_f32_16x16x32_bf16 v[224:227], v[48:51], a[40:43], v[224:227]
  ds_read_b128 v[48:51], v10 offset:16384
  s_add_u32 m0, s34, 0x10000
  v_mfma_f32_16x16x32_bf16 v[212:215], v[52:55], a[8:11], v[212:215]
  s_add_u32 s32, s34, 0x8000
  buffer_load_dwordx4 v5, s[16:19], s32 offen offset:0 nt lds
  v_mfma_f32_16x16x32_bf16 v[220:223], v[52:55], a[24:27], v[220:223]
  buffer_load_dwordx4 v6, s[16:19], s32 offen offset:1024 nt lds
  buffer_load_dwordx4 v5, s[16:19], s32 offen offset:2048 nt lds
  v_mfma_f32_16x16x32_bf16 v[228:231], v[52:55], a[40:43], v[228:231]
  ds_read_b128 v[52:55], v10 offset:20480
  buffer_load_dwordx4 v6, s[16:19], s32 offen offset:3072 nt lds
  v_mfma_f32_16x16x32_bf16 v[208:211], v[56:59], a[12:15], v[208:211]
  s_add_u32 m0, s34, 0x11000
  s_add_u32 s32, s34, 0x9000
  v_mfma_f32_16x16x32_bf16 v[216:219], v[56:59], a[28:31], v[216:219]
  buffer_load_dwordx4 v5, s[16:19], s32 offen offset:0 nt lds
  buffer_load_dwordx4 v6, s[16:19], s32 offen offset:1024 nt lds
  v_mfma_f32_16x16x32_bf16 v[224:227], v[56:59], a[44:47], v[224:227]
  ds_read_b128 v[56:59], v11 offset:16384
  v_mfma_f32_16x16x32_bf16 v[212:215], v[60:63], a[12:15], v[212:215]
  v_mfma_f32_16x16x32_bf16 v[220:223], v[60:63], a[28:31], v[220:223]
  buffer_load_dwordx4 v5, s[16:19], s32 offen offset:2048 nt lds
  v_mfma_f32_16x16x32_bf16 v[228:231], v[60:63], a[44:47], v[228:231]
  ds_read_b128 v[60:63], v11 offset:20480
  s_waitcnt lgkmcnt(6)
  v_mfma_f32_16x16x32_bf16 v[232:235], v[32:35], a[0:3], 0
  v_mfma_f32_16x16x32_bf16 v[240:243], v[32:35], a[16:19], 0
  v_mfma_f32_16x16x32_bf16 v[248:251], v[32:35], a[32:35], 0
  v_mfma_f32_16x16x32_bf16 v[236:239], v[36:39], a[0:3], 0
  v_mfma_f32_16x16x32_bf16 v[244:247], v[36:39], a[16:19], 0
  v_mfma_f32_16x16x32_bf16 v[252:255], v[36:39], a[32:35], 0
  s_waitcnt lgkmcnt(4)
  v_mfma_f32_16x16x32_bf16 v[232:235], v[40:43], a[4:7], v[232:235]
  v_mfma_f32_16x16x32_bf16 v[240:243], v[40:43], a[20:23], v[240:243]
  v_mfma_f32_16x16x32_bf16 v[248:251], v[40:43], a[36:39], v[248:251]
  buffer_load_dwordx4 v6, s[16:19], s32 offen offset:3072 nt lds
  v_mfma_f32_16x16x32_bf16 v[236:239], v[44:47], a[4:7], v[236:239]
  v_mfma_f32_16x16x32_bf16 v[244:247], v[44:47], a[20:23], v[244:247]
  v_mfma_f32_16x16x32_bf16 v[252:255], v[44:47], a[36:39], v[252:255]
  s_waitcnt lgkmcnt(0)
  v_mfma_f32_16x16x32_bf16 v[232:235], v[48:51], a[8:11], v[232:235]
  s_barrier
  v_mfma_f32_16x16x32_bf16 v[240:243], v[48:51], a[24:27], v[240:243]
  v_mfma_f32_16x16x32_bf16 v[248:251], v[48:51], a[40:43], v[248:251]
  v_mfma_f32_16x16x32_bf16 v[236:239], v[52:55], a[8:11], v[236:239]
  v_mfma_f32_16x16x32_bf16 v[244:247], v[52:55], a[24:27], v[244:247]
  v_mfma_f32_16x16x32_bf16 v[252:255], v[52:55], a[40:43], v[252:255]
  s_add_u32 m0, s34, 0x14000
  s_add_u32 s32, s34, 0xc000
  v_mfma_f32_16x16x32_bf16 v[232:235], v[56:59], a[12:15], v[232:235]
  buffer_load_dwordx4 v5, s[16:19], s32 offen offset:0 nt lds
  v_mfma_f32_16x16x32_bf16 v[240:243], v[56:59], a[28:31], v[240:243]
  v_mfma_f32_16x16x32_bf16 v[248:251], v[56:59], a[44:47], v[248:251]
  v_mfma_f32_16x16x32_bf16 v[236:239], v[60:63], a[12:15], v[236:239]
  v_mfma_f32_16x16x32_bf16 v[244:247], v[60:63], a[28:31], v[244:247]
  v_mfma_f32_16x16x32_bf16 v[252:255], v[60:63], a[44:47], v[252:255]
  v_max3_f32 v22, v64, v65, v66
  v_max3_f32 v22, v22, v67, v68
  v_max3_f32 v22, v22, v69, v70
  v_max_f32 v22, v22, v71
  v_max3_f32 v23, v72, v73, v74
  v_max3_f32 v23, v23, v75, v76
  v_max3_f32 v23, v23, v77, v78
  v_max_f32 v23, v23, v79
  v_max3_f32 v24, v80, v81, v82
  v_max3_f32 v24, v24, v83, v84
  v_max3_f32 v24, v24, v85, v86
  v_max_f32 v24, v24, v87
  buffer_load_dwordx4 v6, s[16:19], s32 offen offset:1024 nt lds
  v_max3_f32 v22, v22, v88, v89
  v_max3_f32 v22, v22, v90, v91
  v_max3_f32 v22, v22, v92, v93
  v_max3_f32 v22, v22, v94, v95
  v_max3_f32 v23, v23, v96, v97
  v_max3_f32 v23, v23, v98, v99
  v_max3_f32 v23, v23, v100, v101
  v_max3_f32 v23, v23, v102, v103
  v_max3_f32 v24, v24, v104, v105
  v_max3_f32 v24, v24, v106, v107
  v_max3_f32 v24, v24, v108, v109
  v_max3_f32 v24, v24, v110, v111
  v_max3_f32 v22, v22, v112, v113
  v_max3_f32 v22, v22, v114, v115
  v_max3_f32 v22, v22, v116, v117
  v_max3_f32 v22, v22, v118, v119
  v_max3_f32 v23, v23, v120, v121
  v_max3_f32 v23, v23, v122, v123
  v_max3_f32 v23, v23, v124, v125
  v_max3_f32 v23, v23, v126, v127
  v_max3_f32 v24, v24, v128, v129
  v_max3_f32 v24, v24, v130, v131
  v_max3_f32 v24, v24, v132, v133
  v_max3_f32 v24, v24, v134, v135
  v_max3_f32 v22, v22, v136, v137
  v_max3_f32 v22, v22, v138, v139
  v_max3_f32 v22, v22, v140, v141
  v_max3_f32 v22, v22, v142, v143
  v_max3_f32 v23, v23, v144, v145
  v_max3_f32 v23, v23, v146, v147
  v_max3_f32 v23, v23, v148, v149
  v_max3_f32 v23, v23, v150, v151
  v_max3_f32 v24, v24, v152, v153
  v_max3_f32 v24, v24, v154, v155
  v_max3_f32 v24, v24, v156, v157
  v_max3_f32 v24, v24, v158, v159
  buffer_load_dwordx4 v5, s[16:19], s32 offen offset:2048 nt lds
  v_max3_f32 v22, v22, v160, v161
  v_max3_f32 v22, v22, v162, v163
  v_max3_f32 v22, v22, v164, v165
  v_max3_f32 v22, v22, v166, v167
  v_max3_f32 v23, v23, v168, v169
  v_max3_f32 v23, v23, v170, v171
  v_max3_f32 v23, v23, v172, v173
  v_max3_f32 v23, v23, v174, v175
  v_max3_f32 v24, v24, v176, v177
  v_max3_f32 v24, v24, v178, v179
  v_max3_f32 v24, v24, v180, v181
  v_max3_f32 v24, v24, v182, v183
  v_max3_f32 v22, v22, v184, v185
  v_max3_f32 v22, v22, v186, v187
  v_max3_f32 v22, v22, v188, v189
  v_max3_f32 v22, v22, v190, v191
  v_max3_f32 v23, v23, v192, v193
  v_max3_f32 v23, v23, v194, v195
  v_max3_f32 v23, v23, v196, v197
  v_max3_f32 v23, v23, v198, v199
  v_max3_f32 v24, v24, v200, v201
  v_max3_f32 v24, v24, v202, v203
  v_max3_f32 v24, v24, v204, v205
  v_max3_f32 v24, v24, v206, v207
  v_max3_f32 v22, v22, v208, v209
  v_max3_f32 v22, v22, v210, v211
  v_max3_f32 v22, v22, v212, v213
  v_max3_f32 v22, v22, v214, v215
  v_max3_f32 v23, v23, v216, v217
  v_max3_f32 v23, v23, v218, v219
  v_max3_f32 v23, v23, v220, v221
  v_max3_f32 v23, v23, v222, v223
  v_max3_f32 v24, v24, v224, v225
  v_max3_f32 v24, v24, v226, v227
  v_max3_f32 v24, v24, v228, v229
  v_max3_f32 v24, v24, v230, v231
  buffer_load_dwordx4 v6, s[16:19], s32 offen offset:3072 nt lds
  v_max3_f32 v22, v22, v232, v233
  v_max3_f32 v22, v22, v234, v235
  v_max3_f32 v22, v22, v236, v237
  v_max3_f32 v22, v22, v238, v239
  v_max3_f32 v23, v23, v240, v241
  v_max3_f32 v23, v23, v242, v243
  v_max3_f32 v23, v23, v244, v245
  v_max3_f32 v23, v23, v246, v247
  v_max3_f32 v24, v24, v248, v249
  v_max3_f32 v24, v24, v250, v251
  v_max3_f32 v24, v24, v252, v253
  v_max3_f32 v24, v24, v254, v255
  v_mov_b32 v25, v22
  v_mov_b32 v26, v23
  v_mov_b32 v27, v24
  v_permlane32_swap_b32 v22, v25
  v_permlane32_swap_b32 v23, v26
  v_permlane32_swap_b32 v24, v27
  v_max_f32 v22, v22, v25
  v_max_f32 v23, v23, v26
  v_max_f32 v24, v24, v27
  v_mov_b32 v25, v22
  v_mov_b32 v26, v23
  v_mov_b32 v27, v24
  v_permlane16_swap_b32 v22, v25
  v_permlane16_swap_b32 v23, v26
  v_permlane16_swap_b32 v24, v27
  v_max_f32 v22, v22, v25
  v_max_f32 v23, v23, v26
  v_max_f32 v24, v24, v27
  v_mul_f32 v22, 0xbe0293ee, v22
  v_mul_f32 v23, 0xbe0293ee, v23
  v_mul_f32 v24, 0xbe0293ee, v24
  v_fmamk_f32 v64, v64, 0x3e0293ee, v22
  v_fmamk_f32 v65, v65, 0x3e0293ee, v22
  v_fmamk_f32 v66, v66, 0x3e0293ee, v22
  v_fmamk_f32 v67, v67, 0x3e0293ee, v22
  v_fmamk_f32 v68, v68, 0x3e0293ee, v22
  s_add_u32 m0, s34, 0x15000
  s_add_u32 s32, s34, 0xd000
  v_fmamk_f32 v69, v69, 0x3e0293ee, v22
  v_fmamk_f32 v70, v70, 0x3e0293ee, v22
  v_fmamk_f32 v71, v71, 0x3e0293ee, v22
  v_exp_f32 v64, v64
  v_exp_f32 v65, v65
  buffer_load_dwordx4 v5, s[16:19], s32 offen offset:0 nt lds
  v_exp_f32 v66, v66
  v_exp_f32 v67, v67
  v_exp_f32 v68, v68
  v_exp_f32 v69, v69
  v_exp_f32 v70, v70
  v_exp_f32 v71, v71
  v_cvt_pk_bf16_f32 v64, v64, v65
  v_cvt_pk_bf16_f32 v65, v66, v67
  v_cvt_pk_bf16_f32 v66, v68, v69
  v_cvt_pk_bf16_f32 v67, v70, v71
  v_fmamk_f32 v72, v72, 0x3e0293ee, v23
  v_fmamk_f32 v73, v73, 0x3e0293ee, v23
  v_fmamk_f32 v74, v74, 0x3e0293ee, v23
  v_fmamk_f32 v75, v75, 0x3e0293ee, v23
  v_fmamk_f32 v76, v76, 0x3e0293ee, v23
  v_fmamk_f32 v77, v77, 0x3e0293ee, v23
  v_fmamk_f32 v78, v78, 0x3e0293ee, v23
  v_fmamk_f32 v79, v79, 0x3e0293ee, v23
  v_exp_f32 v72, v72
  v_exp_f32 v73, v73
  buffer_load_dwordx4 v6, s[16:19], s32 offen offset:1024 nt lds
  v_exp_f32 v74, v74
  v_exp_f32 v75, v75
  v_exp_f32 v76, v76
  v_exp_f32 v77, v77
  v_exp_f32 v78, v78
  v_exp_f32 v79, v79
  v_cvt_pk_bf16_f32 v68, v72, v73
  v_cvt_pk_bf16_f32 v69, v74, v75
  v_cvt_pk_bf16_f32 v70, v76, v77
  v_cvt_pk_bf16_f32 v71, v78, v79
  v_fmamk_f32 v80, v80, 0x3e0293ee, v24
  v_fmamk_f32 v81, v81, 0x3e0293ee, v24
  v_fmamk_f32 v82, v82, 0x3e0293ee, v24
  v_fmamk_f32 v83, v83, 0x3e0293ee, v24
  v_fmamk_f32 v84, v84, 0x3e0293ee, v24
  v_fmamk_f32 v85, v85, 0x3e0293ee, v24
  v_fmamk_f32 v86, v86, 0x3e0293ee, v24
  v_fmamk_f32 v87, v87, 0x3e0293ee, v24
  v_exp_f32 v80, v80
  v_exp_f32 v81, v81
  v_exp_f32 v82, v82
  v_exp_f32 v83, v83
  v_exp_f32 v84, v84
  v_exp_f32 v85, v85
  v_exp_f32 v86, v86
  buffer_load_dwordx4 v5, s[16:19], s32 offen offset:2048 nt lds
  v_exp_f32 v87, v87
  v_cvt_pk_bf16_f32 v72, v80, v81
  v_cvt_pk_bf16_f32 v73, v82, v83
  v_cvt_pk_bf16_f32 v74, v84, v85
  v_cvt_pk_bf16_f32 v75, v86, v87
  v_fmamk_f32 v88, v88, 0x3e0293ee, v22
  v_fmamk_f32 v89, v89, 0x3e0293ee, v22
  v_fmamk_f32 v90, v90, 0x3e0293ee, v22
  v_fmamk_f32 v91, v91, 0x3e0293ee, v22
  v_fmamk_f32 v92, v92, 0x3e0293ee, v22
  v_fmamk_f32 v93, v93, 0x3e0293ee, v22
  v_fmamk_f32 v94, v94, 0x3e0293ee, v22
  v_fmamk_f32 v95, v95, 0x3e0293ee, v22
  v_exp_f32 v88, v88
  v_exp_f32 v89, v89
  v_exp_f32 v90, v90
  v_exp_f32 v91, v91
  v_exp_f32 v92, v92
  v_exp_f32 v93, v93
  v_exp_f32 v94, v94
  v_exp_f32 v95, v95
  v_cvt_pk_bf16_f32 v76, v88, v89
  v_cvt_pk_bf16_f32 v77, v90, v91
  v_cvt_pk_bf16_f32 v78, v92, v93
  v_cvt_pk_bf16_f32 v79, v94, v95
  buffer_load_dwordx4 v6, s[16:19], s32 offen offset:3072 nt lds
  v_fmamk_f32 v96, v96, 0x3e0293ee, v23
  v_fmamk_f32 v97, v97, 0x3e0293ee, v23
  v_fmamk_f32 v98, v98, 0x3e0293ee, v23
  v_fmamk_f32 v99, v99, 0x3e0293ee, v23
  v_fmamk_f32 v100, v100, 0x3e0293ee, v23
  v_fmamk_f32 v101, v101, 0x3e0293ee, v23
  v_fmamk_f32 v102, v102, 0x3e0293ee, v23
  v_fmamk_f32 v103, v103, 0x3e0293ee, v23
  v_exp_f32 v96, v96
  v_exp_f32 v97, v97
  v_exp_f32 v98, v98
  v_exp_f32 v99, v99
  v_exp_f32 v100, v100
  v_exp_f32 v101, v101
  v_exp_f32 v102, v102
  v_exp_f32 v103, v103
  v_cvt_pk_bf16_f32 v80, v96, v97
  v_cvt_pk_bf16_f32 v81, v98, v99
  v_cvt_pk_bf16_f32 v82, v100, v101
  v_cvt_pk_bf16_f32 v83, v102, v103
  v_fmamk_f32 v104, v104, 0x3e0293ee, v24
  v_fmamk_f32 v105, v105, 0x3e0293ee, v24
  v_fmamk_f32 v106, v106, 0x3e0293ee, v24
  v_fmamk_f32 v107, v107, 0x3e0293ee, v24
  v_fmamk_f32 v108, v108, 0x3e0293ee, v24
  s_add_u32 m0, s34, 0x0
  s_add_u32 s32, s34, 0x10000
  v_fmamk_f32 v109, v109, 0x3e0293ee, v24
  v_fmamk_f32 v110, v110, 0x3e0293ee, v24
  v_fmamk_f32 v111, v111, 0x3e0293ee, v24
  v_exp_f32 v104, v104
  v_exp_f32 v105, v105
  buffer_load_dwordx4 v5, s[16:19], s32 offen offset:0 nt lds
  v_exp_f32 v106, v106
  v_exp_f32 v107, v107
  v_exp_f32 v108, v108
  v_exp_f32 v109, v109
  v_exp_f32 v110, v110
  v_exp_f32 v111, v111
  v_cvt_pk_bf16_f32 v84, v104, v105
  v_cvt_pk_bf16_f32 v85, v106, v107
  v_cvt_pk_bf16_f32 v86, v108, v109
  v_cvt_pk_bf16_f32 v87, v110, v111
  v_fmamk_f32 v112, v112, 0x3e0293ee, v22
  v_fmamk_f32 v113, v113, 0x3e0293ee, v22
  v_fmamk_f32 v114, v114, 0x3e0293ee, v22
  v_fmamk_f32 v115, v115, 0x3e0293ee, v22
  v_fmamk_f32 v116, v116, 0x3e0293ee, v22
  v_fmamk_f32 v117, v117, 0x3e0293ee, v22
  v_fmamk_f32 v118, v118, 0x3e0293ee, v22
  v_fmamk_f32 v119, v119, 0x3e0293ee, v22
  v_exp_f32 v112, v112
  v_exp_f32 v113, v113
  v_exp_f32 v114, v114
  v_exp_f32 v115, v115
  v_exp_f32 v116, v116
  v_exp_f32 v117, v117
  v_exp_f32 v118, v118
  buffer_load_dwordx4 v6, s[16:19], s32 offen offset:1024 nt lds
  v_exp_f32 v119, v119
  v_cvt_pk_bf16_f32 v88, v112, v113
  v_cvt_pk_bf16_f32 v89, v114, v115
  v_cvt_pk_bf16_f32 v90, v116, v117
  v_cvt_pk_bf16_f32 v91, v118, v119
  v_fmamk_f32 v120, v120, 0x3e0293ee, v23
  v_fmamk_f32 v121, v121, 0x3e0293ee, v23
  v_fmamk_f32 v122, v122, 0x3e0293ee, v23
  v_fmamk_f32 v123, v123, 0x3e0293ee, v23
  v_fmamk_f32 v124, v124, 0x3e0293ee, v23
  v_fmamk_f32 v125, v125, 0x3e0293ee, v23
  v_fmamk_f32 v126, v126, 0x3e0293ee, v23
  v_fmamk_f32 v127, v127, 0x3e0293ee, v23
  v_exp_f32 v120, v120
  v_exp_f32 v121, v121
  v_exp_f32 v122, v122
  v_exp_f32 v123, v123
  v_exp_f32 v124, v124
  v_exp_f32 v125, v125
  v_exp_f32 v126, v126
  v_exp_f32 v127, v127
  v_cvt_pk_bf16_f32 v92, v120, v121
  v_cvt_pk_bf16_f32 v93, v122, v123
  v_cvt_pk_bf16_f32 v94, v124, v125
  v_cvt_pk_bf16_f32 v95, v126, v127
  buffer_load_dwordx4 v5, s[16:19], s32 offen offset:2048 nt lds
  v_fmamk_f32 v128, v128, 0x3e0293ee, v24
  v_fmamk_f32 v129, v129, 0x3e0293ee, v24
  v_fmamk_f32 v130, v130, 0x3e0293ee, v24
  v_fmamk_f32 v131, v131, 0x3e0293ee, v24
  v_fmamk_f32 v132, v132, 0x3e0293ee, v24
  v_fmamk_f32 v133, v133, 0x3e0293ee, v24
  v_fmamk_f32 v134, v134, 0x3e0293ee, v24
  v_fmamk_f32 v135, v135, 0x3e0293ee, v24
  v_exp_f32 v128, v128
  v_exp_f32 v129, v129
  v_exp_f32 v130, v130
  v_exp_f32 v131, v131
  v_exp_f32 v132, v132
  v_exp_f32 v133, v133
  v_exp_f32 v134, v134
  v_exp_f32 v135, v135
  v_cvt_pk_bf16_f32 v96, v128, v129
  v_cvt_pk_bf16_f32 v97, v130, v131
  v_cvt_pk_bf16_f32 v98, v132, v133
  v_cvt_pk_bf16_f32 v99, v134, v135
  v_fmamk_f32 v136, v136, 0x3e0293ee, v22
  v_fmamk_f32 v137, v137, 0x3e0293ee, v22
  v_fmamk_f32 v138, v138, 0x3e0293ee, v22
  v_fmamk_f32 v139, v139, 0x3e0293ee, v22
  v_fmamk_f32 v140, v140, 0x3e0293ee, v22
  buffer_load_dwordx4 v6, s[16:19], s32 offen offset:3072 nt lds
  v_fmamk_f32 v141, v141, 0x3e0293ee, v22
  v_fmamk_f32 v142, v142, 0x3e0293ee, v22
  v_fmamk_f32 v143, v143, 0x3e0293ee, v22
  v_exp_f32 v136, v136
  v_exp_f32 v137, v137
  v_exp_f32 v138, v138
  v_exp_f32 v139, v139
  v_exp_f32 v140, v140
  v_exp_f32 v141, v141
  v_exp_f32 v142, v142
  v_exp_f32 v143, v143
  v_cvt_pk_bf16_f32 v100, v136, v137
  v_cvt_pk_bf16_f32 v101, v138, v139
  v_cvt_pk_bf16_f32 v102, v140, v141
  v_cvt_pk_bf16_f32 v103, v142, v143
  v_fmamk_f32 v144, v144, 0x3e0293ee, v23
  v_fmamk_f32 v145, v145, 0x3e0293ee, v23
  v_fmamk_f32 v146, v146, 0x3e0293ee, v23
  v_fmamk_f32 v147, v147, 0x3e0293ee, v23
  v_fmamk_f32 v148, v148, 0x3e0293ee, v23
  v_fmamk_f32 v149, v149, 0x3e0293ee, v23
  v_fmamk_f32 v150, v150, 0x3e0293ee, v23
  v_fmamk_f32 v151, v151, 0x3e0293ee, v23
  v_exp_f32 v144, v144
  v_exp_f32 v145, v145
  s_add_u32 m0, s34, 0x1000
  s_add_u32 s32, s34, 0x11000
  v_exp_f32 v146, v146
  v_exp_f32 v147, v147
  v_exp_f32 v148, v148
  v_exp_f32 v149, v149
  v_exp_f32 v150, v150
  buffer_load_dwordx4 v5, s[16:19], s32 offen offset:0 nt lds
  v_exp_f32 v151, v151
  v_cvt_pk_bf16_f32 v104, v144, v145
  v_cvt_pk_bf16_f32 v105, v146, v147
  v_cvt_pk_bf16_f32 v106, v148, v149
  v_cvt_pk_bf16_f32 v107, v150, v151
  v_fmamk_f32 v152, v152, 0x3e0293ee, v24
  v_fmamk_f32 v153, v153, 0x3e0293ee, v24
  v_fmamk_f32 v154, v154, 0x3e0293ee, v24
  v_fmamk_f32 v155, v155, 0x3e0293ee, v24
  v_fmamk_f32 v156, v156, 0x3e0293ee, v24
  v_fmamk_f32 v157, v157, 0x3e0293ee, v24
  v_fmamk_f32 v158, v158, 0x3e0293ee, v24
  v_fmamk_f32 v159, v159, 0x3e0293ee, v24
  v_exp_f32 v152, v152
  v_exp_f32 v153, v153
  v_exp_f32 v154, v154
  v_exp_f32 v155, v155
  v_exp_f32 v156, v156
  v_exp_f32 v157, v157
  v_exp_f32 v158, v158
  buffer_load_dwordx4 v6, s[16:19], s32 offen offset:1024 nt lds
  v_exp_f32 v159, v159
  v_cvt_pk_bf16_f32 v108, v152, v153
  v_cvt_pk_bf16_f32 v109, v154, v155
  v_cvt_pk_bf16_f32 v110, v156, v157
  v_cvt_pk_bf16_f32 v111, v158, v159
  v_fmamk_f32 v160, v160, 0x3e0293ee, v22
  v_fmamk_f32 v161, v161, 0x3e0293ee, v22
  v_fmamk_f32 v162, v162, 0x3e0293ee, v22
  v_fmamk_f32 v163, v163, 0x3e0293ee, v22
  v_fmamk_f32 v164, v164, 0x3e0293ee, v22
  v_fmamk_f32 v165, v165, 0x3e0293ee, v22
  v_fmamk_f32 v166, v166, 0x3e0293ee, v22
  v_fmamk_f32 v167, v167, 0x3e0293ee, v22
  v_exp_f32 v160, v160
  v_exp_f32 v161, v161
  v_exp_f32 v162, v162
  v_exp_f32 v163, v163
  v_exp_f32 v164, v164
  v_exp_f32 v165, v165
  v_exp_f32 v166, v166
  v_exp_f32 v167, v167
  v_cvt_pk_bf16_f32 v112, v160, v161
  v_cvt_pk_bf16_f32 v113, v162, v163
  v_cvt_pk_bf16_f32 v114, v164, v165
  v_cvt_pk_bf16_f32 v115, v166, v167
  buffer_load_dwordx4 v5, s[16:19], s32 offen offset:2048 nt lds
  v_fmamk_f32 v168, v168, 0x3e0293ee, v23
  v_fmamk_f32 v169, v169, 0x3e0293ee, v23
  v_fmamk_f32 v170, v170, 0x3e0293ee, v23
  v_fmamk_f32 v171, v171, 0x3e0293ee, v23
  v_fmamk_f32 v172, v172, 0x3e0293ee, v23
  v_fmamk_f32 v173, v173, 0x3e0293ee, v23
  v_fmamk_f32 v174, v174, 0x3e0293ee, v23
  v_fmamk_f32 v175, v175, 0x3e0293ee, v23
  v_exp_f32 v168, v168
  v_exp_f32 v169, v169
  v_exp_f32 v170, v170
  v_exp_f32 v171, v171
  v_exp_f32 v172, v172
  v_exp_f32 v173, v173
  v_exp_f32 v174, v174
  v_exp_f32 v175, v175
  v_cvt_pk_bf16_f32 v116, v168, v169
  v_cvt_pk_bf16_f32 v117, v170, v171
  v_cvt_pk_bf16_f32 v118, v172, v173
  v_cvt_pk_bf16_f32 v119, v174, v175
  v_fmamk_f32 v176, v176, 0x3e0293ee, v24
  v_fmamk_f32 v177, v177, 0x3e0293ee, v24
  v_fmamk_f32 v178, v178, 0x3e0293ee, v24
  v_fmamk_f32 v179, v179, 0x3e0293ee, v24
  v_fmamk_f32 v180, v180, 0x3e0293ee, v24
  v_fmamk_f32 v181, v181, 0x3e0293ee, v24
  v_fmamk_f32 v182, v182, 0x3e0293ee, v24
  v_fmamk_f32 v183, v183, 0x3e0293ee, v24
  v_exp_f32 v176, v176
  v_exp_f32 v177, v177
  buffer_load_dwordx4 v6, s[16:19], s32 offen offset:3072 nt lds
  v_exp_f32 v178, v178
  v_exp_f32 v179, v179
  v_exp_f32 v180, v180
  v_exp_f32 v181, v181
  v_exp_f32 v182, v182
  v_exp_f32 v183, v183
  v_cvt_pk_bf16_f32 v120, v176, v177
  v_cvt_pk_bf16_f32 v121, v178, v179
  v_cvt_pk_bf16_f32 v122, v180, v181
  v_cvt_pk_bf16_f32 v123, v182, v183
  v_fmamk_f32 v184, v184, 0x3e0293ee, v22
  v_fmamk_f32 v185, v185, 0x3e0293ee, v22
  v_fmamk_f32 v186, v186, 0x3e0293ee, v22
  v_fmamk_f32 v187, v187, 0x3e0293ee, v22
  v_fmamk_f32 v188, v188, 0x3e0293ee, v22
  v_fmamk_f32 v189, v189, 0x3e0293ee, v22
  v_fmamk_f32 v190, v190, 0x3e0293ee, v22
  v_fmamk_f32 v191, v191, 0x3e0293ee, v22
  v_exp_f32 v184, v184
  v_exp_f32 v185, v185
  v_exp_f32 v186, v186
  v_exp_f32 v187, v187
  v_exp_f32 v188, v188
  v_exp_f32 v189, v189
  v_exp_f32 v190, v190
  s_add_u32 m0, s34, 0x4000
  s_add_u32 s32, s34, 0x14000
  v_exp_f32 v191, v191
  v_cvt_pk_bf16_f32 v124, v184, v185
  v_cvt_pk_bf16_f32 v125, v186, v187
  v_cvt_pk_bf16_f32 v126, v188, v189
  v_cvt_pk_bf16_f32 v127, v190, v191
  buffer_load_dwordx4 v5, s[16:19], s32 offen offset:0 nt lds
  v_fmamk_f32 v192, v192, 0x3e0293ee, v23
  v_fmamk_f32 v193, v193, 0x3e0293ee, v23
  v_fmamk_f32 v194, v194, 0x3e0293ee, v23
  v_fmamk_f32 v195, v195, 0x3e0293ee, v23
  v_fmamk_f32 v196, v196, 0x3e0293ee, v23
  v_fmamk_f32 v197, v197, 0x3e0293ee, v23
  v_fmamk_f32 v198, v198, 0x3e0293ee, v23
  v_fmamk_f32 v199, v199, 0x3e0293ee, v23
  v_exp_f32 v192, v192
  v_exp_f32 v193, v193
  v_exp_f32 v194, v194
  v_exp_f32 v195, v195
  v_exp_f32 v196, v196
  v_exp_f32 v197, v197
  v_exp_f32 v198, v198
  v_exp_f32 v199, v199
  v_cvt_pk_bf16_f32 v128, v192, v193
  v_cvt_pk_bf16_f32 v129, v194, v195
  v_cvt_pk_bf16_f32 v130, v196, v197
  v_cvt_pk_bf16_f32 v131, v198, v199
  buffer_load_dwordx4 v6, s[16:19], s32 offen offset:1024 nt lds
  v_fmamk_f32 v200, v200, 0x3e0293ee, v24
  v_fmamk_f32 v201, v201, 0x3e0293ee, v24
  v_fmamk_f32 v202, v202, 0x3e0293ee, v24
  v_fmamk_f32 v203, v203, 0x3e0293ee, v24
  v_fmamk_f32 v204, v204, 0x3e0293ee, v24
  v_fmamk_f32 v205, v205, 0x3e0293ee, v24
  v_fmamk_f32 v206, v206, 0x3e0293ee, v24
  v_fmamk_f32 v207, v207, 0x3e0293ee, v24
  v_exp_f32 v200, v200
  v_exp_f32 v201, v201
  v_exp_f32 v202, v202
  v_exp_f32 v203, v203
  v_exp_f32 v204, v204
  v_exp_f32 v205, v205
  v_exp_f32 v206, v206
  v_exp_f32 v207, v207
  v_cvt_pk_bf16_f32 v132, v200, v201
  v_cvt_pk_bf16_f32 v133, v202, v203
  v_cvt_pk_bf16_f32 v134, v204, v205
  v_cvt_pk_bf16_f32 v135, v206, v207
  s_waitcnt vmcnt(34)
  s_barrier
  v_fmamk_f32 v208, v208, 0x3e0293ee, v22
  v_fmamk_f32 v209, v209, 0x3e0293ee, v22
  v_fmamk_f32 v210, v210, 0x3e0293ee, v22
  v_fmamk_f32 v211, v211, 0x3e0293ee, v22
  v_fmamk_f32 v212, v212, 0x3e0293ee, v22
  ds_read_b64_tr_b16 v[32:33], v12 offset:32768
  v_fmamk_f32 v213, v213, 0x3e0293ee, v22
  v_fmamk_f32 v214, v214, 0x3e0293ee, v22
  v_fmamk_f32 v215, v215, 0x3e0293ee, v22
  v_exp_f32 v208, v208
  v_exp_f32 v209, v209
  ds_read_b64_tr_b16 v[34:35], v12 offset:36864
  v_exp_f32 v210, v210
  v_exp_f32 v211, v211
  v_exp_f32 v212, v212
  v_exp_f32 v213, v213
  v_exp_f32 v214, v214
  ds_read_b64_tr_b16 v[36:37], v13 offset:32768
  v_exp_f32 v215, v215
  v_cvt_pk_bf16_f32 v136, v208, v209
  v_cvt_pk_bf16_f32 v137, v210, v211
  v_cvt_pk_bf16_f32 v138, v212, v213
  v_cvt_pk_bf16_f32 v139, v214, v215
  ds_read_b64_tr_b16 v[38:39], v13 offset:36864
  v_fmamk_f32 v216, v216, 0x3e0293ee, v23
  v_fmamk_f32 v217, v217, 0x3e0293ee, v23
  v_fmamk_f32 v218, v218, 0x3e0293ee, v23
  v_fmamk_f32 v219, v219, 0x3e0293ee, v23
  v_fmamk_f32 v220, v220, 0x3e0293ee, v23
  ds_read_b64_tr_b16 v[40:41], v14 offset:32768
  v_fmamk_f32 v221, v221, 0x3e0293ee, v23
  v_fmamk_f32 v222, v222, 0x3e0293ee, v23
  v_fmamk_f32 v223, v223, 0x3e0293ee, v23
  v_exp_f32 v216, v216
  v_exp_f32 v217, v217
  ds_read_b64_tr_b16 v[42:43], v14 offset:36864
  v_exp_f32 v218, v218
  v_exp_f32 v219, v219
  v_exp_f32 v220, v220
  v_exp_f32 v221, v221
  v_exp_f32 v222, v222
  ds_read_b64_tr_b16 v[44:45], v15 offset:32768
  v_exp_f32 v223, v223
  v_cvt_pk_bf16_f32 v140, v216, v217
  v_cvt_pk_bf16_f32 v141, v218, v219
  v_cvt_pk_bf16_f32 v142, v220, v221
  v_cvt_pk_bf16_f32 v143, v222, v223
  ds_read_b64_tr_b16 v[46:47], v15 offset:36864
  v_fmamk_f32 v224, v224, 0x3e0293ee, v24
  v_fmamk_f32 v225, v225, 0x3e0293ee, v24
  v_fmamk_f32 v226, v226, 0x3e0293ee, v24
  v_fmamk_f32 v227, v227, 0x3e0293ee, v24
  v_fmamk_f32 v228, v228, 0x3e0293ee, v24
  ds_read_b64_tr_b16 v[48:49], v16 offset:32768
  v_fmamk_f32 v229, v229, 0x3e0293ee, v24
  v_fmamk_f32 v230, v230, 0x3e0293ee, v24
  v_fmamk_f32 v231, v231, 0x3e0293ee, v24
  v_exp_f32 v224, v224
  v_exp_f32 v225, v225
  ds_read_b64_tr_b16 v[50:51], v16 offset:36864
  v_exp_f32 v226, v226
  v_exp_f32 v227, v227
  v_exp_f32 v228, v228
  v_exp_f32 v229, v229
  v_exp_f32 v230, v230
  ds_read_b64_tr_b16 v[52:53], v17 offset:32768
  v_exp_f32 v231, v231
  v_cvt_pk_bf16_f32 v144, v224, v225
  v_cvt_pk_bf16_f32 v145, v226, v227
  v_cvt_pk_bf16_f32 v146, v228, v229
  v_cvt_pk_bf16_f32 v147, v230, v231
  ds_read_b64_tr_b16 v[54:55], v17 offset:36864
  v_fmamk_f32 v232, v232, 0x3e0293ee, v22
  v_fmamk_f32 v233, v233, 0x3e0293ee, v22
  v_fmamk_f32 v234, v234, 0x3e0293ee, v22
  v_fmamk_f32 v235, v235, 0x3e0293ee, v22
  v_fmamk_f32 v236, v236, 0x3e0293ee, v22
  ds_read_b64_tr_b16 v[56:57], v18 offset:32768
  v_fmamk_f32 v237, v237, 0x3e0293ee, v22
  v_fmamk_f32 v238, v238, 0x3e0293ee, v22
  v_fmamk_f32 v239, v239, 0x3e0293ee, v22
  v_exp_f32 v232, v232
  v_exp_f32 v233, v233
  ds_read_b64_tr_b16 v[58:59], v18 offset:36864
  v_exp_f32 v234, v234
  v_exp_f32 v235, v235
  v_exp_f32 v236, v236
  v_exp_f32 v237, v237
  v_exp_f32 v238, v238
  ds_read_b64_tr_b16 v[60:61], v19 offset:32768
  v_exp_f32 v239, v239
  v_cvt_pk_bf16_f32 v148, v232, v233
  v_cvt_pk_bf16_f32 v149, v234, v235
  v_cvt_pk_bf16_f32 v150, v236, v237
  v_cvt_pk_bf16_f32 v151, v238, v239
  ds_read_b64_tr_b16 v[62:63], v19 offset:36864
  v_fmamk_f32 v240, v240, 0x3e0293ee, v23
  v_fmamk_f32 v241, v241, 0x3e0293ee, v23
  v_fmamk_f32 v242, v242, 0x3e0293ee, v23
  v_fmamk_f32 v243, v243, 0x3e0293ee, v23
  v_fmamk_f32 v244, v244, 0x3e0293ee, v23
  buffer_load_dwordx4 v5, s[16:19], s32 offen offset:2048 nt lds
  buffer_load_dwordx4 v6, s[16:19], s32 offen offset:3072 nt lds
  v_fmamk_f32 v245, v245, 0x3e0293ee, v23
  v_fmamk_f32 v246, v246, 0x3e0293ee, v23
  v_fmamk_f32 v247, v247, 0x3e0293ee, v23
  v_exp_f32 v240, v240
  v_exp_f32 v241, v241
  s_add_u32 m0, s34, 0x5000
  s_add_u32 s32, s34, 0x15000
  v_exp_f32 v242, v242
  v_exp_f32 v243, v243
  v_exp_f32 v244, v244
  v_exp_f32 v245, v245
  v_exp_f32 v246, v246
  buffer_load_dwordx4 v5, s[16:19], s32 offen offset:0 nt lds
  buffer_load_dwordx4 v6, s[16:19], s32 offen offset:1024 nt lds
  v_exp_f32 v247, v247
  v_cvt_pk_bf16_f32 v152, v240, v241
  v_cvt_pk_bf16_f32 v153, v242, v243
  v_cvt_pk_bf16_f32 v154, v244, v245
  v_cvt_pk_bf16_f32 v155, v246, v247
  v_fmamk_f32 v248, v248, 0x3e0293ee, v24
  v_fmamk_f32 v249, v249, 0x3e0293ee, v24
  v_fmamk_f32 v250, v250, 0x3e0293ee, v24
  v_fmamk_f32 v251, v251, 0x3e0293ee, v24
  v_fmamk_f32 v252, v252, 0x3e0293ee, v24
  v_fmamk_f32 v253, v253, 0x3e0293ee, v24
  v_fmamk_f32 v254, v254, 0x3e0293ee, v24
  v_fmamk_f32 v255, v255, 0x3e0293ee, v24
  v_exp_f32 v248, v248
  v_exp_f32 v249, v249
  buffer_load_dwordx4 v5, s[16:19], s32 offen offset:2048 nt lds
  v_exp_f32 v250, v250
  v_exp_f32 v251, v251
  v_exp_f32 v252, v252
  v_exp_f32 v253, v253
  v_exp_f32 v254, v254
  v_exp_f32 v255, v255
  v_cvt_pk_bf16_f32 v156, v248, v249
  v_cvt_pk_bf16_f32 v157, v250, v251
  v_cvt_pk_bf16_f32 v158, v252, v253
  v_cvt_pk_bf16_f32 v159, v254, v255
  s_waitcnt lgkmcnt(12)
  v_mfma_f32_16x16x32_bf16 v[160:163], v[32:35], v[64:67], 0
  v_mfma_f32_16x16x32_bf16 v[164:167], v[32:35], v[68:71], 0
  v_mfma_f32_16x16x32_bf16 v[168:171], v[32:35], v[72:75], 0
  v_mfma_f32_16x16x32_bf16 v[172:175], v[36:39], v[64:67], 0
  buffer_load_dwordx4 v6, s[16:19], s32 offen offset:3072 nt lds
  v_mfma_f32_16x16x32_bf16 v[176:179], v[36:39], v[68:71], 0
  v_mfma_f32_16x16x32_bf16 v[180:183], v[36:39], v[72:75], 0
  s_waitcnt lgkmcnt(8)
  v_mfma_f32_16x16x32_bf16 v[184:187], v[40:43], v[64:67], 0
  v_mfma_f32_16x16x32_bf16 v[188:191], v[40:43], v[68:71], 0
  v_mfma_f32_16x16x32_bf16 v[192:195], v[40:43], v[72:75], 0
  v_mfma_f32_16x16x32_bf16 v[196:199], v[44:47], v[64:67], 0
  v_mfma_f32_16x16x32_bf16 v[200:203], v[44:47], v[68:71], 0
  v_mfma_f32_16x16x32_bf16 v[204:207], v[44:47], v[72:75], 0
  s_waitcnt lgkmcnt(0)
  v_mfma_f32_16x16x32_bf16 v[208:211], v[48:51], v[64:67], 0
  s_waitcnt vmcnt(32)
  s_barrier
  ds_read_b64_tr_b16 v[32:33], v12 offset:49152
  ds_read_b64_tr_b16 v[34:35], v12 offset:53248
  v_mfma_f32_16x16x32_bf16 v[212:215], v[48:51], v[68:71], 0
  ds_read_b64_tr_b16 v[36:37], v13 offset:49152
  ds_read_b64_tr_b16 v[38:39], v13 offset:53248
  v_mfma_f32_16x16x32_bf16 v[216:219], v[48:51], v[72:75], 0
  ds_read_b64_tr_b16 v[40:41], v14 offset:49152
  ds_read_b64_tr_b16 v[42:43], v14 offset:53248
  v_mfma_f32_16x16x32_bf16 v[220:223], v[52:55], v[64:67], 0
  ds_read_b64_tr_b16 v[44:45], v15 offset:49152
  ds_read_b64_tr_b16 v[46:47], v15 offset:53248
  v_mfma_f32_16x16x32_bf16 v[224:227], v[52:55], v[68:71], 0
  ds_read_b64_tr_b16 v[48:49], v16 offset:49152
  ds_read_b64_tr_b16 v[50:51], v16 offset:53248
  v_mfma_f32_16x16x32_bf16 v[228:231], v[52:55], v[72:75], 0
  ds_read_b64_tr_b16 v[52:53], v17 offset:49152
  ds_read_b64_tr_b16 v[54:55], v17 offset:53248
  v_mfma_f32_16x16x32_bf16 v[232:235], v[56:59], v[64:67], 0
  s_add_u32 m0, s34, 0x8000
  s_add_u32 s32, s34, 0x18000
  v_mfma_f32_16x16x32_bf16 v[236:239], v[56:59], v[68:71], 0
  buffer_load_dwordx4 v5, s[16:19], s32 offen offset:0 nt lds
  v_mfma_f32_16x16x32_bf16 v[240:243], v[56:59], v[72:75], 0
  ds_read_b64_tr_b16 v[56:57], v18 offset:49152
  ds_read_b64_tr_b16 v[58:59], v18 offset:53248
  v_mfma_f32_16x16x32_bf16 v[244:247], v[60:63], v[64:67], 0
  buffer_load_dwordx4 v6, s[16:19], s32 offen offset:1024 nt lds
  v_mfma_f32_16x16x32_bf16 v[248:251], v[60:63], v[68:71], 0
  v_mfma_f32_16x16x32_bf16 v[252:255], v[60:63], v[72:75], 0
  ds_read_b64_tr_b16 v[60:61], v19 offset:49152
  ds_read_b64_tr_b16 v[62:63], v19 offset:53248
  v_mfma_f32_16x16x32_bf16 a[240:243], a[252:255], v[64:67], 0
  v_mfma_f32_16x16x32_bf16 a[244:247], a[252:255], v[68:71], 0
  v_mfma_f32_16x16x32_bf16 a[248:251], a[252:255], v[72:75], 0
  s_waitcnt lgkmcnt(12)
  v_mfma_f32_16x16x32_bf16 v[160:163], v[32:35], v[76:79], v[160:163]
  v_mfma_f32_16x16x32_bf16 v[164:167], v[32:35], v[80:83], v[164:167]
  v_mfma_f32_16x16x32_bf16 v[168:171], v[32:35], v[84:87], v[168:171]
  v_mfma_f32_16x16x32_bf16 v[172:175], v[36:39], v[76:79], v[172:175]
  buffer_load_dwordx4 v5, s[16:19], s32 offen offset:2048 nt lds
  v_mfma_f32_16x16x32_bf16 v[176:179], v[36:39], v[80:83], v[176:179]
  v_mfma_f32_16x16x32_bf16 v[180:183], v[36:39], v[84:87], v[180:183]
  s_waitcnt lgkmcnt(8)
  v_mfma_f32_16x16x32_bf16 v[184:187], v[40:43], v[76:79], v[184:187]
  v_mfma_f32_16x16x32_bf16 v[188:191], v[40:43], v[80:83], v[188:191]
  v_mfma_f32_16x16x32_bf16 v[192:195], v[40:43], v[84:87], v[192:195]
  v_mfma_f32_16x16x32_bf16 v[196:199], v[44:47], v[76:79], v[196:199]
  v_mfma_f32_16x16x32_bf16 v[200:203], v[44:47], v[80:83], v[200:203]
  v_mfma_f32_16x16x32_bf16 v[204:207], v[44:47], v[84:87], v[204:207]
  buffer_load_dwordx4 v6, s[16:19], s32 offen offset:3072 nt lds
  s_waitcnt lgkmcnt(0)
  v_mfma_f32_16x16x32_bf16 v[208:211], v[48:51], v[76:79], v[208:211]
  s_waitcnt vmcnt(28)
  s_barrier
  v_add_u32 v12, 0x10000, v12
  ds_read_b64_tr_b16 v[32:33], v12 offset:0
  ds_read_b64_tr_b16 v[34:35], v12 offset:4096
  v_mfma_f32_16x16x32_bf16 v[212:215], v[48:51], v[80:83], v[212:215]
  v_add_u32 v13, 0x10000, v13
  ds_read_b64_tr_b16 v[36:37], v13 offset:0
  ds_read_b64_tr_b16 v[38:39], v13 offset:4096
  v_mfma_f32_16x16x32_bf16 v[216:219], v[48:51], v[84:87], v[216:219]
  v_add_u32 v14, 0x10000, v14
  ds_read_b64_tr_b16 v[40:41], v14 offset:0
  ds_read_b64_tr_b16 v[42:43], v14 offset:4096
  v_mfma_f32_16x16x32_bf16 v[220:223], v[52:55], v[76:79], v[220:223]
  v_add_u32 v15, 0x10000, v15
  ds_read_b64_tr_b16 v[44:45], v15 offset:0
  ds_read_b64_tr_b16 v[46:47], v15 offset:4096
  v_mfma_f32_16x16x32_bf16 v[224:227], v[52:55], v[80:83], v[224:227]
  v_add_u32 v16, 0x10000, v16
  ds_read_b64_tr_b16 v[48:49], v16 offset:0
  ds_read_b64_tr_b16 v[50:51], v16 offset:4096
  v_mfma_f32_16x16x32_bf16 v[228:231], v[52:55], v[84:87], v[228:231]
  v_add_u32 v17, 0x10000, v17
  ds_read_b64_tr_b16 v[52:53], v17 offset:0
  ds_read_b64_tr_b16 v[54:55], v17 offset:4096
  v_mfma_f32_16x16x32_bf16 v[232:235], v[56:59], v[76:79], v[232:235]
  v_mfma_f32_16x16x32_bf16 v[236:239], v[56:59], v[80:83], v[236:239]
  v_mfma_f32_16x16x32_bf16 v[240:243], v[56:59], v[84:87], v[240:243]
  v_add_u32 v18, 0x10000, v18
  ds_read_b64_tr_b16 v[56:57], v18 offset:0
  ds_read_b64_tr_b16 v[58:59], v18 offset:4096
  v_mfma_f32_16x16x32_bf16 v[244:247], v[60:63], v[76:79], v[244:247]
  s_add_u32 m0, s34, 0x9000
  s_add_u32 s32, s34, 0x19000
  v_mfma_f32_16x16x32_bf16 v[248:251], v[60:63], v[80:83], v[248:251]
  buffer_load_dwordx4 v5, s[16:19], s32 offen offset:0 nt lds
  v_mfma_f32_16x16x32_bf16 v[252:255], v[60:63], v[84:87], v[252:255]
  v_add_u32 v19, 0x10000, v19
  ds_read_b64_tr_b16 v[60:61], v19 offset:0
  ds_read_b64_tr_b16 v[62:63], v19 offset:4096
  v_mfma_f32_16x16x32_bf16 a[240:243], a[252:255], v[76:79], a[240:243]
  v_mfma_f32_16x16x32_bf16 a[244:247], a[252:255], v[80:83], a[244:247]
  v_mfma_f32_16x16x32_bf16 a[248:251], a[252:255], v[84:87], a[248:251]
  s_waitcnt lgkmcnt(12)
  v_mfma_f32_16x16x32_bf16 v[160:163], v[32:35], v[88:91], v[160:163]
  v_mfma_f32_16x16x32_bf16 v[164:167], v[32:35], v[92:95], v[164:167]
  buffer_load_dwordx4 v6, s[16:19], s32 offen offset:1024 nt lds
  v_mfma_f32_16x16x32_bf16 v[168:171], v[32:35], v[96:99], v[168:171]
  v_mfma_f32_16x16x32_bf16 v[172:175], v[36:39], v[88:91], v[172:175]
  v_mfma_f32_16x16x32_bf16 v[176:179], v[36:39], v[92:95], v[176:179]
  v_mfma_f32_16x16x32_bf16 v[180:183], v[36:39], v[96:99], v[180:183]
  s_waitcnt lgkmcnt(8)
  v_mfma_f32_16x16x32_bf16 v[184:187], v[40:43], v[88:91], v[184:187]
  v_mfma_f32_16x16x32_bf16 v[188:191], v[40:43], v[92:95], v[188:191]
  v_mfma_f32_16x16x32_bf16 v[192:195], v[40:43], v[96:99], v[192:195]
  v_mfma_f32_16x16x32_bf16 v[196:199], v[44:47], v[88:91], v[196:199]
  v_mfma_f32_16x16x32_bf16 v[200:203], v[44:47], v[92:95], v[200:203]
  buffer_load_dwordx4 v5, s[16:19], s32 offen offset:2048 nt lds
  v_mfma_f32_16x16x32_bf16 v[204:207], v[44:47], v[96:99], v[204:207]
  s_waitcnt lgkmcnt(0)
  v_mfma_f32_16x16x32_bf16 v[208:211], v[48:51], v[88:91], v[208:211]
  s_waitcnt vmcnt(23)
  s_barrier
  ds_read_b64_tr_b16 v[32:33], v12 offset:16384
  ds_read_b64_tr_b16 v[34:35], v12 offset:20480
  v_mfma_f32_16x16x32_bf16 v[212:215], v[48:51], v[92:95], v[212:215]
  ds_read_b64_tr_b16 v[36:37], v13 offset:16384
  ds_read_b64_tr_b16 v[38:39], v13 offset:20480
  v_mfma_f32_16x16x32_bf16 v[216:219], v[48:51], v[96:99], v[216:219]
  ds_read_b64_tr_b16 v[40:41], v14 offset:16384
  ds_read_b64_tr_b16 v[42:43], v14 offset:20480
  v_mfma_f32_16x16x32_bf16 v[220:223], v[52:55], v[88:91], v[220:223]
  ds_read_b64_tr_b16 v[44:45], v15 offset:16384
  ds_read_b64_tr_b16 v[46:47], v15 offset:20480
  v_mfma_f32_16x16x32_bf16 v[224:227], v[52:55], v[92:95], v[224:227]
  ds_read_b64_tr_b16 v[48:49], v16 offset:16384
  ds_read_b64_tr_b16 v[50:51], v16 offset:20480
  v_mfma_f32_16x16x32_bf16 v[228:231], v[52:55], v[96:99], v[228:231]
  ds_read_b64_tr_b16 v[52:53], v17 offset:16384
  ds_read_b64_tr_b16 v[54:55], v17 offset:20480
  v_mfma_f32_16x16x32_bf16 v[232:235], v[56:59], v[88:91], v[232:235]
  buffer_load_dwordx4 v6, s[16:19], s32 offen offset:3072 nt lds
  v_mfma_f32_16x16x32_bf16 v[236:239], v[56:59], v[92:95], v[236:239]
  v_mfma_f32_16x16x32_bf16 v[240:243], v[56:59], v[96:99], v[240:243]
  ds_read_b64_tr_b16 v[56:57], v18 offset:16384
  ds_read_b64_tr_b16 v[58:59], v18 offset:20480
  v_mfma_f32_16x16x32_bf16 v[244:247], v[60:63], v[88:91], v[244:247]
  v_mfma_f32_16x16x32_bf16 v[248:251], v[60:63], v[92:95], v[248:251]
  v_mfma_f32_16x16x32_bf16 v[252:255], v[60:63], v[96:99], v[252:255]
  ds_read_b64_tr_b16 v[60:61], v19 offset:16384
  ds_read_b64_tr_b16 v[62:63], v19 offset:20480
  v_mfma_f32_16x16x32_bf16 a[240:243], a[252:255], v[88:91], a[240:243]
  v_mfma_f32_16x16x32_bf16 a[244:247], a[252:255], v[92:95], a[244:247]
  v_mfma_f32_16x16x32_bf16 a[248:251], a[252:255], v[96:99], a[248:251]
  s_waitcnt lgkmcnt(12)
  v_mfma_f32_16x16x32_bf16 v[160:163], v[32:35], v[100:103], v[160:163]
  s_add_u32 m0, s34, 0xc000
  s_add_u32 s32, s34, 0x1c000
  v_mfma_f32_16x16x32_bf16 v[164:167], v[32:35], v[104:107], v[164:167]
  buffer_load_dwordx4 v5, s[16:19], s32 offen offset:0 nt lds
  v_mfma_f32_16x16x32_bf16 v[168:171], v[32:35], v[108:111], v[168:171]
  v_mfma_f32_16x16x32_bf16 v[172:175], v[36:39], v[100:103], v[172:175]
  v_mfma_f32_16x16x32_bf16 v[176:179], v[36:39], v[104:107], v[176:179]
  v_mfma_f32_16x16x32_bf16 v[180:183], v[36:39], v[108:111], v[180:183]
  s_waitcnt lgkmcnt(8)
  v_mfma_f32_16x16x32_bf16 v[184:187], v[40:43], v[100:103], v[184:187]
  v_mfma_f32_16x16x32_bf16 v[188:191], v[40:43], v[104:107], v[188:191]
  v_mfma_f32_16x16x32_bf16 v[192:195], v[40:43], v[108:111], v[192:195]
  buffer_load_dwordx4 v6, s[16:19], s32 offen offset:1024 nt lds
  v_mfma_f32_16x16x32_bf16 v[196:199], v[44:47], v[100:103], v[196:199]
  v_mfma_f32_16x16x32_bf16 v[200:203], v[44:47], v[104:107], v[200:203]
  v_mfma_f32_16x16x32_bf16 v[204:207], v[44:47], v[108:111], v[204:207]
  s_waitcnt lgkmcnt(0)
  v_mfma_f32_16x16x32_bf16 v[208:211], v[48:51], v[100:103], v[208:211]
  s_waitcnt vmcnt(18)
  s_barrier
  v_subrev_u32 v12, 0x10000, v12
  ds_read_b64_tr_b16 v[32:33], v12 offset:0
  ds_read_b64_tr_b16 v[34:35], v12 offset:4096
  v_mfma_f32_16x16x32_bf16 v[212:215], v[48:51], v[104:107], v[212:215]
  v_subrev_u32 v13, 0x10000, v13
  ds_read_b64_tr_b16 v[36:37], v13 offset:0
  ds_read_b64_tr_b16 v[38:39], v13 offset:4096
  v_mfma_f32_16x16x32_bf16 v[216:219], v[48:51], v[108:111], v[216:219]
  v_subrev_u32 v14, 0x10000, v14
  ds_read_b64_tr_b16 v[40:41], v14 offset:0
  ds_read_b64_tr_b16 v[42:43], v14 offset:4096
  v_mfma_f32_16x16x32_bf16 v[220:223], v[52:55], v[100:103], v[220:223]
  v_subrev_u32 v15, 0x10000, v15
  ds_read_b64_tr_b16 v[44:45], v15 offset:0
  ds_read_b64_tr_b16 v[46:47], v15 offset:4096
  v_mfma_f32_16x16x32_bf16 v[224:227], v[52:55], v[104:107], v[224:227]
  v_subrev_u32 v16, 0x10000, v16
  ds_read_b64_tr_b16 v[48:49], v16 offset:0
  ds_read_b64_tr_b16 v[50:51], v16 offset:4096
  v_mfma_f32_16x16x32_bf16 v[228:231], v[52:55], v[108:111], v[228:231]
  v_subrev_u32 v17, 0x10000, v17
  ds_read_b64_tr_b16 v[52:53], v17 offset:0
  ds_read_b64_tr_b16 v[54:55], v17 offset:4096
  v_mfma_f32_16x16x32_bf16 v[232:235], v[56:59], v[100:103], v[232:235]
  buffer_load_dwordx4 v5, s[16:19], s32 offen offset:2048 nt lds
  buffer_load_dwordx4 v6, s[16:19], s32 offen offset:3072 nt lds
  v_mfma_f32_16x16x32_bf16 v[236:239], v[56:59], v[104:107], v[236:239]
  s_add_u32 m0, s34, 0xd000
  s_add_u32 s32, s34, 0x1d000
  v_mfma_f32_16x16x32_bf16 v[240:243], v[56:59], v[108:111], v[240:243]
  v_subrev_u32 v18, 0x10000, v18
  ds_read_b64_tr_b16 v[56:57], v18 offset:0
  ds_read_b64_tr_b16 v[58:59], v18 offset:4096
  v_mfma_f32_16x16x32_bf16 v[244:247], v[60:63], v[100:103], v[244:247]
  buffer_load_dwordx4 v5, s[16:19], s32 offen offset:0 nt lds
  buffer_load_dwordx4 v6, s[16:19], s32 offen offset:1024 nt lds
  v_mfma_f32_16x16x32_bf16 v[248:251], v[60:63], v[104:107], v[248:251]
  buffer_load_dwordx4 v5, s[16:19], s32 offen offset:2048 nt lds
  v_mfma_f32_16x16x32_bf16 v[252:255], v[60:63], v[108:111], v[252:255]
  v_subrev_u32 v19, 0x10000, v19
  ds_read_b64_tr_b16 v[60:61], v19 offset:0
  ds_read_b64_tr_b16 v[62:63], v19 offset:4096
  v_mfma_f32_16x16x32_bf16 a[240:243], a[252:255], v[100:103], a[240:243]
  v_mfma_f32_16x16x32_bf16 a[244:247], a[252:255], v[104:107], a[244:247]
  v_mfma_f32_16x16x32_bf16 a[248:251], a[252:255], v[108:111], a[248:251]
  s_waitcnt lgkmcnt(12)
  v_mfma_f32_16x16x32_bf16 v[160:163], v[32:35], v[112:115], v[160:163]
  v_mfma_f32_16x16x32_bf16 v[164:167], v[32:35], v[116:119], v[164:167]
  v_mfma_f32_16x16x32_bf16 v[168:171], v[32:35], v[120:123], v[168:171]
  v_mfma_f32_16x16x32_bf16 v[172:175], v[36:39], v[112:115], v[172:175]
  v_mfma_f32_16x16x32_bf16 v[176:179], v[36:39], v[116:119], v[176:179]
  buffer_load_dwordx4 v6, s[16:19], s32 offen offset:3072 nt lds
  v_mfma_f32_16x16x32_bf16 v[180:183], v[36:39], v[120:123], v[180:183]
  s_waitcnt lgkmcnt(8)
  v_mfma_f32_16x16x32_bf16 v[184:187], v[40:43], v[112:115], v[184:187]
  v_mfma_f32_16x16x32_bf16 v[188:191], v[40:43], v[116:119], v[188:191]
  v_mfma_f32_16x16x32_bf16 v[192:195], v[40:43], v[120:123], v[192:195]
  v_mfma_f32_16x16x32_bf16 v[196:199], v[44:47], v[112:115], v[196:199]
  v_mfma_f32_16x16x32_bf16 v[200:203], v[44:47], v[116:119], v[200:203]
  v_mfma_f32_16x16x32_bf16 v[204:207], v[44:47], v[120:123], v[204:207]
  s_waitcnt lgkmcnt(0)
  v_mfma_f32_16x16x32_bf16 v[208:211], v[48:51], v[112:115], v[208:211]
  s_waitcnt vmcnt(16)
  s_barrier
  ds_read_b64_tr_b16 v[32:33], v12 offset:16384
  ds_read_b64_tr_b16 v[34:35], v12 offset:20480
  v_mfma_f32_16x16x32_bf16 v[212:215], v[48:51], v[116:119], v[212:215]
  ds_read_b64_tr_b16 v[36:37], v13 offset:16384
  ds_read_b64_tr_b16 v[38:39], v13 offset:20480
  v_mfma_f32_16x16x32_bf16 v[216:219], v[48:51], v[120:123], v[216:219]
  ds_read_b64_tr_b16 v[40:41], v14 offset:16384
  ds_read_b64_tr_b16 v[42:43], v14 offset:20480
  v_mfma_f32_16x16x32_bf16 v[220:223], v[52:55], v[112:115], v[220:223]
  ds_read_b64_tr_b16 v[44:45], v15 offset:16384
  ds_read_b64_tr_b16 v[46:47], v15 offset:20480
  v_mfma_f32_16x16x32_bf16 v[224:227], v[52:55], v[116:119], v[224:227]
  ds_read_b64_tr_b16 v[48:49], v16 offset:16384
  ds_read_b64_tr_b16 v[50:51], v16 offset:20480
  v_mfma_f32_16x16x32_bf16 v[228:231], v[52:55], v[120:123], v[228:231]
  ds_read_b64_tr_b16 v[52:53], v17 offset:16384
  ds_read_b64_tr_b16 v[54:55], v17 offset:20480
  v_mfma_f32_16x16x32_bf16 v[232:235], v[56:59], v[112:115], v[232:235]
  s_add_u32 m0, s34, 0x10000
  s_add_u32 s32, s34, 0x20000
  v_mfma_f32_16x16x32_bf16 v[236:239], v[56:59], v[116:119], v[236:239]
  buffer_load_dwordx4 v1, s[12:15], s32 offen offset:0 nt lds
  buffer_load_dwordx4 v2, s[12:15], s32 offen offset:1024 nt lds
  v_mfma_f32_16x16x32_bf16 v[240:243], v[56:59], v[120:123], v[240:243]
  ds_read_b64_tr_b16 v[56:57], v18 offset:16384
  ds_read_b64_tr_b16 v[58:59], v18 offset:20480
  v_mfma_f32_16x16x32_bf16 v[244:247], v[60:63], v[112:115], v[244:247]
  buffer_load_dwordx4 v3, s[12:15], s32 offen offset:2048 nt lds
  buffer_load_dwordx4 v4, s[12:15], s32 offen offset:3072 nt lds
  v_mfma_f32_16x16x32_bf16 v[248:251], v[60:63], v[116:119], v[248:251]
  s_add_u32 m0, s34, 0x11000
  s_add_u32 s32, s34, 0x21000
  v_mfma_f32_16x16x32_bf16 v[252:255], v[60:63], v[120:123], v[252:255]
  ds_read_b64_tr_b16 v[60:61], v19 offset:16384
  ds_read_b64_tr_b16 v[62:63], v19 offset:20480
  v_mfma_f32_16x16x32_bf16 a[240:243], a[252:255], v[112:115], a[240:243]
  buffer_load_dwordx4 v1, s[12:15], s32 offen offset:0 nt lds
  buffer_load_dwordx4 v2, s[12:15], s32 offen offset:1024 nt lds
  v_mfma_f32_16x16x32_bf16 a[244:247], a[252:255], v[116:119], a[244:247]
  buffer_load_dwordx4 v3, s[12:15], s32 offen offset:2048 nt lds
  v_mfma_f32_16x16x32_bf16 a[248:251], a[252:255], v[120:123], a[248:251]
  s_waitcnt lgkmcnt(12)
  v_mfma_f32_16x16x32_bf16 v[160:163], v[32:35], v[124:127], v[160:163]
  v_mfma_f32_16x16x32_bf16 v[164:167], v[32:35], v[128:131], v[164:167]
  v_mfma_f32_16x16x32_bf16 v[168:171], v[32:35], v[132:135], v[168:171]
  v_mfma_f32_16x16x32_bf16 v[172:175], v[36:39], v[124:127], v[172:175]
  v_mfma_f32_16x16x32_bf16 v[176:179], v[36:39], v[128:131], v[176:179]
  buffer_load_dwordx4 v4, s[12:15], s32 offen offset:3072 nt lds
  v_mfma_f32_16x16x32_bf16 v[180:183], v[36:39], v[132:135], v[180:183]
  s_waitcnt lgkmcnt(8)
  v_mfma_f32_16x16x32_bf16 v[184:187], v[40:43], v[124:127], v[184:187]
  v_mfma_f32_16x16x32_bf16 v[188:191], v[40:43], v[128:131], v[188:191]
  v_mfma_f32_16x16x32_bf16 v[192:195], v[40:43], v[132:135], v[192:195]
  v_mfma_f32_16x16x32_bf16 v[196:199], v[44:47], v[124:127], v[196:199]
  v_mfma_f32_16x16x32_bf16 v[200:203], v[44:47], v[128:131], v[200:203]
  v_mfma_f32_16x16x32_bf16 v[204:207], v[44:47], v[132:135], v[204:207]
  s_waitcnt lgkmcnt(0)
  v_mfma_f32_16x16x32_bf16 v[208:211], v[48:51], v[124:127], v[208:211]
  s_waitcnt vmcnt(16)
  s_barrier
  ds_read_b64_tr_b16 v[32:33], v12 offset:32768
  ds_read_b64_tr_b16 v[34:35], v12 offset:36864
  v_mfma_f32_16x16x32_bf16 v[212:215], v[48:51], v[128:131], v[212:215]
  ds_read_b64_tr_b16 v[36:37], v13 offset:32768
  ds_read_b64_tr_b16 v[38:39], v13 offset:36864
  v_mfma_f32_16x16x32_bf16 v[216:219], v[48:51], v[132:135], v[216:219]
  ds_read_b64_tr_b16 v[40:41], v14 offset:32768
  ds_read_b64_tr_b16 v[42:43], v14 offset:36864
  v_mfma_f32_16x16x32_bf16 v[220:223], v[52:55], v[124:127], v[220:223]
  ds_read_b64_tr_b16 v[44:45], v15 offset:32768
  ds_read_b64_tr_b16 v[46:47], v15 offset:36864
  v_mfma_f32_16x16x32_bf16 v[224:227], v[52:55], v[128:131], v[224:227]
  ds_read_b64_tr_b16 v[48:49], v16 offset:32768
  ds_read_b64_tr_b16 v[50:51], v16 offset:36864
  v_mfma_f32_16x16x32_bf16 v[228:231], v[52:55], v[132:135], v[228:231]
  ds_read_b64_tr_b16 v[52:53], v17 offset:32768
  ds_read_b64_tr_b16 v[54:55], v17 offset:36864
  v_mfma_f32_16x16x32_bf16 v[232:235], v[56:59], v[124:127], v[232:235]
  s_add_u32 m0, s34, 0x14000
  s_add_u32 s32, s34, 0x24000
  v_mfma_f32_16x16x32_bf16 v[236:239], v[56:59], v[128:131], v[236:239]
  buffer_load_dwordx4 v1, s[12:15], s32 offen offset:0 nt lds
  buffer_load_dwordx4 v2, s[12:15], s32 offen offset:1024 nt lds
  v_mfma_f32_16x16x32_bf16 v[240:243], v[56:59], v[132:135], v[240:243]
  ds_read_b64_tr_b16 v[56:57], v18 offset:32768
  ds_read_b64_tr_b16 v[58:59], v18 offset:36864
  v_mfma_f32_16x16x32_bf16 v[244:247], v[60:63], v[124:127], v[244:247]
  buffer_load_dwordx4 v3, s[12:15], s32 offen offset:2048 nt lds
  buffer_load_dwordx4 v4, s[12:15], s32 offen offset:3072 nt lds
  v_mfma_f32_16x16x32_bf16 v[248:251], v[60:63], v[128:131], v[248:251]
  s_add_u32 m0, s34, 0x15000
  s_add_u32 s32, s34, 0x25000
  v_mfma_f32_16x16x32_bf16 v[252:255], v[60:63], v[132:135], v[252:255]
  ds_read_b64_tr_b16 v[60:61], v19 offset:32768
  ds_read_b64_tr_b16 v[62:63], v19 offset:36864
  v_mfma_f32_16x16x32_bf16 a[240:243], a[252:255], v[124:127], a[240:243]
  buffer_load_dwordx4 v1, s[12:15], s32 offen offset:0 nt lds
  buffer_load_dwordx4 v2, s[12:15], s32 offen offset:1024 nt lds
  v_mfma_f32_16x16x32_bf16 a[244:247], a[252:255], v[128:131], a[244:247]
  buffer_load_dwordx4 v3, s[12:15], s32 offen offset:2048 nt lds
  v_mfma_f32_16x16x32_bf16 a[248:251], a[252:255], v[132:135], a[248:251]
  s_waitcnt lgkmcnt(12)
  v_mfma_f32_16x16x32_bf16 v[160:163], v[32:35], v[136:139], v[160:163]
  v_mfma_f32_16x16x32_bf16 v[164:167], v[32:35], v[140:143], v[164:167]
  v_mfma_f32_16x16x32_bf16 v[168:171], v[32:35], v[144:147], v[168:171]
  v_mfma_f32_16x16x32_bf16 v[172:175], v[36:39], v[136:139], v[172:175]
  buffer_load_dwordx4 v4, s[12:15], s32 offen offset:3072 nt lds
  v_mfma_f32_16x16x32_bf16 v[176:179], v[36:39], v[140:143], v[176:179]
  v_mfma_f32_16x16x32_bf16 v[180:183], v[36:39], v[144:147], v[180:183]
  s_waitcnt lgkmcnt(8)
  v_mfma_f32_16x16x32_bf16 v[184:187], v[40:43], v[136:139], v[184:187]
  v_mfma_f32_16x16x32_bf16 v[188:191], v[40:43], v[140:143], v[188:191]
  v_mfma_f32_16x16x32_bf16 v[192:195], v[40:43], v[144:147], v[192:195]
  v_mfma_f32_16x16x32_bf16 v[196:199], v[44:47], v[136:139], v[196:199]
  v_mfma_f32_16x16x32_bf16 v[200:203], v[44:47], v[140:143], v[200:203]
  v_mfma_f32_16x16x32_bf16 v[204:207], v[44:47], v[144:147], v[204:207]
  s_waitcnt lgkmcnt(0)
  v_mfma_f32_16x16x32_bf16 v[208:211], v[48:51], v[136:139], v[208:211]
  s_waitcnt vmcnt(16)
  s_barrier
  ds_read_b64_tr_b16 v[32:33], v12 offset:49152
  ds_read_b64_tr_b16 v[34:35], v12 offset:53248
  v_mfma_f32_16x16x32_bf16 v[212:215], v[48:51], v[140:143], v[212:215]
  ds_read_b64_tr_b16 v[36:37], v13 offset:49152
  ds_read_b64_tr_b16 v[38:39], v13 offset:53248
  v_mfma_f32_16x16x32_bf16 v[216:219], v[48:51], v[144:147], v[216:219]
  ds_read_b64_tr_b16 v[40:41], v14 offset:49152
  ds_read_b64_tr_b16 v[42:43], v14 offset:53248
  v_mfma_f32_16x16x32_bf16 v[220:223], v[52:55], v[136:139], v[220:223]
  ds_read_b64_tr_b16 v[44:45], v15 offset:49152
  ds_read_b64_tr_b16 v[46:47], v15 offset:53248
  v_mfma_f32_16x16x32_bf16 v[224:227], v[52:55], v[140:143], v[224:227]
  ds_read_b64_tr_b16 v[48:49], v16 offset:49152
  ds_read_b64_tr_b16 v[50:51], v16 offset:53248
  v_mfma_f32_16x16x32_bf16 v[228:231], v[52:55], v[144:147], v[228:231]
  ds_read_b64_tr_b16 v[52:53], v17 offset:49152
  ds_read_b64_tr_b16 v[54:55], v17 offset:53248
  v_mfma_f32_16x16x32_bf16 v[232:235], v[56:59], v[136:139], v[232:235]
  s_add_u32 m0, s34, 0x0
  s_add_u32 s32, s34, 0x28000
  v_mfma_f32_16x16x32_bf16 v[236:239], v[56:59], v[140:143], v[236:239]
  buffer_load_dwordx4 v1, s[12:15], s32 offen offset:0 nt lds
  buffer_load_dwordx4 v2, s[12:15], s32 offen offset:1024 nt lds
  v_mfma_f32_16x16x32_bf16 v[240:243], v[56:59], v[144:147], v[240:243]
  ds_read_b64_tr_b16 v[56:57], v18 offset:49152
  ds_read_b64_tr_b16 v[58:59], v18 offset:53248
  v_mfma_f32_16x16x32_bf16 v[244:247], v[60:63], v[136:139], v[244:247]
  buffer_load_dwordx4 v3, s[12:15], s32 offen offset:2048 nt lds
  buffer_load_dwordx4 v4, s[12:15], s32 offen offset:3072 nt lds
  v_mfma_f32_16x16x32_bf16 v[248:251], v[60:63], v[140:143], v[248:251]
  s_add_u32 m0, s34, 0x1000
  s_add_u32 s32, s34, 0x29000
  v_mfma_f32_16x16x32_bf16 v[252:255], v[60:63], v[144:147], v[252:255]
  ds_read_b64_tr_b16 v[60:61], v19 offset:49152
  ds_read_b64_tr_b16 v[62:63], v19 offset:53248
  v_mfma_f32_16x16x32_bf16 a[240:243], a[252:255], v[136:139], a[240:243]
  buffer_load_dwordx4 v1, s[12:15], s32 offen offset:0 nt lds
  buffer_load_dwordx4 v2, s[12:15], s32 offen offset:1024 nt lds
  v_mfma_f32_16x16x32_bf16 a[244:247], a[252:255], v[140:143], a[244:247]
  buffer_load_dwordx4 v3, s[12:15], s32 offen offset:2048 nt lds
  v_mfma_f32_16x16x32_bf16 a[248:251], a[252:255], v[144:147], a[248:251]
  s_waitcnt lgkmcnt(12)
  v_mfma_f32_16x16x32_bf16 v[160:163], v[32:35], v[148:151], v[160:163]
  v_mfma_f32_16x16x32_bf16 v[164:167], v[32:35], v[152:155], v[164:167]
  v_mfma_f32_16x16x32_bf16 v[168:171], v[32:35], v[156:159], v[168:171]
  v_mfma_f32_16x16x32_bf16 v[172:175], v[36:39], v[148:151], v[172:175]
  buffer_load_dwordx4 v4, s[12:15], s32 offen offset:3072 nt lds
  v_mfma_f32_16x16x32_bf16 v[176:179], v[36:39], v[152:155], v[176:179]
  v_mfma_f32_16x16x32_bf16 v[180:183], v[36:39], v[156:159], v[180:183]
  s_waitcnt lgkmcnt(8)
  v_mfma_f32_16x16x32_bf16 v[184:187], v[40:43], v[148:151], v[184:187]
  v_mfma_f32_16x16x32_bf16 v[188:191], v[40:43], v[152:155], v[188:191]
  v_mfma_f32_16x16x32_bf16 v[192:195], v[40:43], v[156:159], v[192:195]
  v_mfma_f32_16x16x32_bf16 v[196:199], v[44:47], v[148:151], v[196:199]
  v_mfma_f32_16x16x32_bf16 v[200:203], v[44:47], v[152:155], v[200:203]
  v_mfma_f32_16x16x32_bf16 v[204:207], v[44:47], v[156:159], v[204:207]
  s_waitcnt lgkmcnt(0)
  v_mfma_f32_16x16x32_bf16 v[208:211], v[48:51], v[148:151], v[208:211]
  s_barrier
  ds_read_b64_tr_b16 v[32:33], v20 offset:0
  ds_read_b64_tr_b16 v[34:35], v20 offset:512
  v_mfma_f32_16x16x32_bf16 v[212:215], v[48:51], v[152:155], v[212:215]
  ds_read_b64_tr_b16 v[36:37], v21 offset:0
  ds_read_b64_tr_b16 v[38:39], v21 offset:512
  v_mfma_f32_16x16x32_bf16 v[216:219], v[48:51], v[156:159], v[216:219]
  ds_read_b64_tr_b16 v[40:41], v20 offset:4096
  ds_read_b64_tr_b16 v[42:43], v20 offset:4608
  v_mfma_f32_16x16x32_bf16 v[220:223], v[52:55], v[148:151], v[220:223]
  ds_read_b64_tr_b16 v[44:45], v21 offset:4096
  ds_read_b64_tr_b16 v[46:47], v21 offset:4608
  v_mfma_f32_16x16x32_bf16 v[224:227], v[52:55], v[152:155], v[224:227]
  ds_read_b64_tr_b16 v[48:49], v20 offset:8192
  ds_read_b64_tr_b16 v[50:51], v20 offset:8704
  v_mfma_f32_16x16x32_bf16 v[228:231], v[52:55], v[156:159], v[228:231]
  ds_read_b64_tr_b16 v[52:53], v21 offset:8192
  ds_read_b64_tr_b16 v[54:55], v21 offset:8704
  v_mfma_f32_16x16x32_bf16 v[232:235], v[56:59], v[148:151], v[232:235]
  v_mfma_f32_16x16x32_bf16 v[236:239], v[56:59], v[152:155], v[236:239]
  v_mfma_f32_16x16x32_bf16 v[240:243], v[56:59], v[156:159], v[240:243]
  ds_read_b64_tr_b16 v[56:57], v20 offset:12288
  ds_read_b64_tr_b16 v[58:59], v20 offset:12800
  v_mfma_f32_16x16x32_bf16 v[244:247], v[60:63], v[148:151], v[244:247]
  v_mfma_f32_16x16x32_bf16 v[248:251], v[60:63], v[152:155], v[248:251]
  v_mfma_f32_16x16x32_bf16 v[252:255], v[60:63], v[156:159], v[252:255]
  ds_read_b64_tr_b16 v[60:61], v21 offset:12288
  ds_read_b64_tr_b16 v[62:63], v21 offset:12800
  v_mfma_f32_16x16x32_bf16 a[240:243], a[252:255], v[148:151], a[240:243]
  v_mfma_f32_16x16x32_bf16 a[244:247], a[252:255], v[152:155], a[244:247]
  v_mfma_f32_16x16x32_bf16 a[248:251], a[252:255], v[156:159], a[248:251]
  s_and_b32 s100, s100, 1
  s_xor_b32 s100, s100, 3
  s_cmp_eq_u32 s38, 0
  s_cbranch_scc0 FZ_NOE
  v_mov_b32 v158, s100
  v_mov_b32 v159, s101
  s_mov_b64 exec, 1
  global_store_byte v159, v158, s[98:99] sc1
  s_mov_b64 exec, -1
FZ_NOE:
  v_add_u32 v112, s47, v0
  v_add_u32 v113, s48, v0
  v_lshrrev_b32 v115, 1, v0
  v_add_u32 v114, s49, v115
  v_add_u32 v115, s50, v115
  ds_write_b128 v112, v[208:211] offset:0
  ds_write_b128 v112, v[212:215] offset:1024
  ds_write_b128 v112, v[216:219] offset:2048
  ds_write_b128 v112, v[220:223] offset:3072
  ds_write_b128 v112, v[224:227] offset:4096
  ds_write_b128 v112, v[228:231] offset:5120
  ds_write_b128 v112, v[232:235] offset:6144
  ds_write_b128 v112, v[236:239] offset:7168
  ds_write_b128 v112, v[240:243] offset:8192
  ds_write_b128 v112, v[244:247] offset:9216
  ds_write_b128 v112, v[248:251] offset:10240
  ds_write_b128 v112, v[252:255] offset:11264
  v_mov_b32 v116, v22
  v_accvgpr_read_b32 v117, a240
  v_mov_b32 v118, v23
  v_accvgpr_read_b32 v119, a244
  v_mov_b32 v120, v24
  v_accvgpr_read_b32 v121, a248
  ds_write_b64 v114, v[116:117] offset:0
  ds_write_b64 v114, v[118:119] offset:512
  ds_write_b64 v114, v[120:121] offset:1024
  v_bfe_u32 v128, v0, 4, 4
  v_lshrrev_b32 v129, 8, v0
  v_lshrrev_b32 v131, 1, v128
  v_lshrrev_b32 v132, 1, v129
  v_xor_b32 v132, v131, v132
  v_lshlrev_b32 v132, 4, v132
  v_lshl_add_u32 v130, v128, 7, v132
  v_and_b32 v132, 1, v129
  v_lshl_add_u32 v130, v132, 3, v130
  v_add_u32 v130, s48, v130
  v_xor_b32 v134, v129, v131
  v_lshlrev_b32 v134, 4, v134
  v_lshl_add_u32 v134, v128, 7, v134
  v_add_u32 v134, s51, v134
  v_xor_b32 v135, 64, v134
  v_xor_b32 v131, 32, v130
  v_xor_b32 v132, 64, v130
  v_xor_b32 v133, 96, v130
  s_waitcnt lgkmcnt(0)
  s_barrier
  ds_read_b64 v[122:123], v115 offset:0
  ds_read_b64 v[124:125], v115 offset:512
  ds_read_b64 v[126:127], v115 offset:1024
  ds_read_b128 v[64:67], v113 offset:0
  ds_read_b128 v[68:71], v113 offset:1024
  ds_read_b128 v[72:75], v113 offset:2048
  ds_read_b128 v[76:79], v113 offset:3072
  ds_read_b128 v[80:83], v113 offset:4096
  ds_read_b128 v[84:87], v113 offset:5120
  ds_read_b128 v[88:91], v113 offset:6144
  ds_read_b128 v[92:95], v113 offset:7168
  ds_read_b128 v[96:99], v113 offset:8192
  ds_read_b128 v[100:103], v113 offset:9216
  ds_read_b128 v[104:107], v113 offset:10240
  ds_read_b128 v[108:111], v113 offset:11264
  s_waitcnt lgkmcnt(12)
  v_min_f32 v142, v116, v122
  v_min_f32 v143, v118, v124
  v_min_f32 v144, v120, v126
  v_sub_f32 v136, v142, v116
  v_sub_f32 v137, v143, v118
  v_sub_f32 v138, v144, v120
  v_sub_f32 v139, v142, v122
  v_sub_f32 v140, v143, v124
  v_sub_f32 v141, v144, v126
  v_exp_f32 v136, v136
  v_exp_f32 v137, v137
  v_exp_f32 v138, v138
  v_exp_f32 v139, v139
  v_exp_f32 v140, v140
  v_exp_f32 v141, v141
  v_mul_f32 v142, v117, v136
  v_mul_f32 v143, v119, v137
  v_mul_f32 v144, v121, v138
  v_fmac_f32 v142, v123, v139
  v_fmac_f32 v143, v125, v140
  v_fmac_f32 v144, v127, v141
  v_rcp_f32 v142, v142
  v_rcp_f32 v143, v143
  v_rcp_f32 v144, v144
  v_mul_f32 v136, v136, v142
  v_mul_f32 v137, v137, v143
  v_mul_f32 v138, v138, v144
  v_mul_f32 v139, v139, v142
  v_mul_f32 v140, v140, v143
  v_mul_f32 v141, v141, v144
  v_mul_f32 v160, v160, v136
  v_mul_f32 v161, v161, v136
  v_mul_f32 v162, v162, v136
  v_mul_f32 v163, v163, v136
  s_waitcnt lgkmcnt(11)
  v_fmac_f32 v160, v64, v139
  v_fmac_f32 v161, v65, v139
  v_fmac_f32 v162, v66, v139
  v_fmac_f32 v163, v67, v139
  v_cvt_pk_bf16_f32 v160, v160, v161
  v_cvt_pk_bf16_f32 v161, v162, v163
  ds_write_b64 v130, v[160:161] offset:0
  v_mul_f32 v164, v164, v137
  v_mul_f32 v165, v165, v137
  v_mul_f32 v166, v166, v137
  v_mul_f32 v167, v167, v137
  s_waitcnt lgkmcnt(11)
  v_fmac_f32 v164, v68, v140
  v_fmac_f32 v165, v69, v140
  v_fmac_f32 v166, v70, v140
  v_fmac_f32 v167, v71, v140
  v_cvt_pk_bf16_f32 v164, v164, v165
  v_cvt_pk_bf16_f32 v165, v166, v167
  ds_write_b64 v130, v[164:165] offset:2048
  v_mul_f32 v168, v168, v138
  v_mul_f32 v169, v169, v138
  v_mul_f32 v170, v170, v138
  v_mul_f32 v171, v171, v138
  s_waitcnt lgkmcnt(11)
  v_fmac_f32 v168, v72, v141
  v_fmac_f32 v169, v73, v141
  v_fmac_f32 v170, v74, v141
  v_fmac_f32 v171, v75, v141
  v_cvt_pk_bf16_f32 v168, v168, v169
  v_cvt_pk_bf16_f32 v169, v170, v171
  ds_write_b64 v130, v[168:169] offset:4096
  v_mul_f32 v172, v172, v136
  v_mul_f32 v173, v173, v136
  v_mul_f32 v174, v174, v136
  v_mul_f32 v175, v175, v136
  s_waitcnt lgkmcnt(11)
  v_fmac_f32 v172, v76, v139
  v_fmac_f32 v173, v77, v139
  v_fmac_f32 v174, v78, v139
  v_fmac_f32 v175, v79, v139
  v_cvt_pk_bf16_f32 v172, v172, v173
  v_cvt_pk_bf16_f32 v173, v174, v175
  ds_write_b64 v131, v[172:173] offset:0
  v_mul_f32 v176, v176, v137
  v_mul_f32 v177, v177, v137
  v_mul_f32 v178, v178, v137
  v_mul_f32 v179, v179, v137
  s_waitcnt lgkmcnt(11)
  v_fmac_f32 v176, v80, v140
  v_fmac_f32 v177, v81, v140
  v_fmac_f32 v178, v82, v140
  v_fmac_f32 v179, v83, v140
  v_cvt_pk_bf16_f32 v176, v176, v177
  v_cvt_pk_bf16_f32 v177, v178, v179
  ds_write_b64 v131, v[176:177] offset:2048
  v_mul_f32 v180, v180, v138
  v_mul_f32 v181, v181, v138
  v_mul_f32 v182, v182, v138
  v_mul_f32 v183, v183, v138
  s_waitcnt lgkmcnt(11)
  v_fmac_f32 v180, v84, v141
  v_fmac_f32 v181, v85, v141
  v_fmac_f32 v182, v86, v141
  v_fmac_f32 v183, v87, v141
  v_cvt_pk_bf16_f32 v180, v180, v181
  v_cvt_pk_bf16_f32 v181, v182, v183
  ds_write_b64 v131, v[180:181] offset:4096
  v_mul_f32 v184, v184, v136
  v_mul_f32 v185, v185, v136
  v_mul_f32 v186, v186, v136
  v_mul_f32 v187, v187, v136
  s_waitcnt lgkmcnt(11)
  v_fmac_f32 v184, v88, v139
  v_fmac_f32 v185, v89, v139
  v_fmac_f32 v186, v90, v139
  v_fmac_f32 v187, v91, v139
  v_cvt_pk_bf16_f32 v184, v184, v185
  v_cvt_pk_bf16_f32 v185, v186, v187
  ds_write_b64 v132, v[184:185] offset:0
  v_mul_f32 v188, v188, v137
  v_mul_f32 v189, v189, v137
  v_mul_f32 v190, v190, v137
  v_mul_f32 v191, v191, v137
  s_waitcnt lgkmcnt(11)
  v_fmac_f32 v188, v92, v140
  v_fmac_f32 v189, v93, v140
  v_fmac_f32 v190, v94, v140
  v_fmac_f32 v191, v95, v140
  v_cvt_pk_bf16_f32 v188, v188, v189
  v_cvt_pk_bf16_f32 v189, v190, v191
  ds_write_b64 v132, v[188:189] offset:2048
  v_mul_f32 v192, v192, v138
  v_mul_f32 v193, v193, v138
  v_mul_f32 v194, v194, v138
  v_mul_f32 v195, v195, v138
  s_waitcnt lgkmcnt(11)
  v_fmac_f32 v192, v96, v141
  v_fmac_f32 v193, v97, v141
  v_fmac_f32 v194, v98, v141
  v_fmac_f32 v195, v99, v141
  v_cvt_pk_bf16_f32 v192, v192, v193
  v_cvt_pk_bf16_f32 v193, v194, v195
  ds_write_b64 v132, v[192:193] offset:4096
  v_mul_f32 v196, v196, v136
  v_mul_f32 v197, v197, v136
  v_mul_f32 v198, v198, v136
  v_mul_f32 v199, v199, v136
  s_waitcnt lgkmcnt(11)
  v_fmac_f32 v196, v100, v139
  v_fmac_f32 v197, v101, v139
  v_fmac_f32 v198, v102, v139
  v_fmac_f32 v199, v103, v139
  v_cvt_pk_bf16_f32 v196, v196, v197
  v_cvt_pk_bf16_f32 v197, v198, v199
  ds_write_b64 v133, v[196:197] offset:0
  v_mul_f32 v200, v200, v137
  v_mul_f32 v201, v201, v137
  v_mul_f32 v202, v202, v137
  v_mul_f32 v203, v203, v137
  s_waitcnt lgkmcnt(11)
  v_fmac_f32 v200, v104, v140
  v_fmac_f32 v201, v105, v140
  v_fmac_f32 v202, v106, v140
  v_fmac_f32 v203, v107, v140
  v_cvt_pk_bf16_f32 v200, v200, v201
  v_cvt_pk_bf16_f32 v201, v202, v203
  ds_write_b64 v133, v[200:201] offset:2048
  v_mul_f32 v204, v204, v138
  v_mul_f32 v205, v205, v138
  v_mul_f32 v206, v206, v138
  v_mul_f32 v207, v207, v138
  s_waitcnt lgkmcnt(11)
  v_fmac_f32 v204, v108, v141
  v_fmac_f32 v205, v109, v141
  v_fmac_f32 v206, v110, v141
  v_fmac_f32 v207, v111, v141
  v_cvt_pk_bf16_f32 v204, v204, v205
  v_cvt_pk_bf16_f32 v205, v206, v207
  ds_write_b64 v133, v[204:205] offset:4096
  s_waitcnt lgkmcnt(0)
  s_barrier
  ds_read_b128 v[64:67], v134 offset:12288
  ds_read_b128 v[80:83], v134 offset:14336
  ds_read_b128 v[96:99], v134 offset:16384
  ds_read_b128 v[68:71], v135 offset:12288
  ds_read_b128 v[84:87], v135 offset:14336
  ds_read_b128 v[100:103], v135 offset:16384
  ds_read_b128 v[72:75], v134 offset:0
  ds_read_b128 v[88:91], v134 offset:2048
  ds_read_b128 v[104:107], v134 offset:4096
  ds_read_b128 v[76:79], v135 offset:0
  ds_read_b128 v[92:95], v135 offset:2048
  ds_read_b128 v[108:111], v135 offset:4096
  s_waitcnt lgkmcnt(0)
  v_mfma_f32_16x16x32_bf16 a[0:3], v[32:35], v[64:67], 0
  v_mfma_f32_16x16x32_bf16 a[4:7], v[32:35], v[80:83], 0
  v_mfma_f32_16x16x32_bf16 a[8:11], v[32:35], v[96:99], 0
  v_mfma_f32_16x16x32_bf16 a[12:15], v[36:39], v[64:67], 0
  v_mfma_f32_16x16x32_bf16 a[16:19], v[36:39], v[80:83], 0
  v_mfma_f32_16x16x32_bf16 a[20:23], v[36:39], v[96:99], 0
  v_mfma_f32_16x16x32_bf16 a[0:3], v[40:43], v[68:71], a[0:3]
  v_mfma_f32_16x16x32_bf16 a[4:7], v[40:43], v[84:87], a[4:7]
  v_mfma_f32_16x16x32_bf16 a[8:11], v[40:43], v[100:103], a[8:11]
  v_mfma_f32_16x16x32_bf16 a[12:15], v[44:47], v[68:71], a[12:15]
  v_mfma_f32_16x16x32_bf16 a[16:19], v[44:47], v[84:87], a[16:19]
  v_mfma_f32_16x16x32_bf16 a[20:23], v[44:47], v[100:103], a[20:23]
  v_mfma_f32_16x16x32_bf16 a[0:3], v[48:51], v[72:75], a[0:3]
  s_barrier
  ds_read_b64_tr_b16 v[32:33], v20 offset:16384
  ds_read_b64_tr_b16 v[34:35], v20 offset:16896
  v_mfma_f32_16x16x32_bf16 a[4:7], v[48:51], v[88:91], a[4:7]
  ds_read_b64_tr_b16 v[36:37], v21 offset:16384
  ds_read_b64_tr_b16 v[38:39], v21 offset:16896
  v_mfma_f32_16x16x32_bf16 a[8:11], v[48:51], v[104:107], a[8:11]
  ds_read_b64_tr_b16 v[40:41], v20 offset:20480
  ds_read_b64_tr_b16 v[42:43], v20 offset:20992
  v_mfma_f32_16x16x32_bf16 a[12:15], v[52:55], v[72:75], a[12:15]
  ds_read_b64_tr_b16 v[44:45], v21 offset:20480
  ds_read_b64_tr_b16 v[46:47], v21 offset:20992
  v_mfma_f32_16x16x32_bf16 a[16:19], v[52:55], v[88:91], a[16:19]
  ds_read_b64_tr_b16 v[48:49], v20 offset:24576
  ds_read_b64_tr_b16 v[50:51], v20 offset:25088
  v_mfma_f32_16x16x32_bf16 a[20:23], v[52:55], v[104:107], a[20:23]
  ds_read_b64_tr_b16 v[52:53], v21 offset:24576
  ds_read_b64_tr_b16 v[54:55], v21 offset:25088
  v_mfma_f32_16x16x32_bf16 a[0:3], v[56:59], v[76:79], a[0:3]
  s_add_u32 m0, s34, 0x4000
  s_add_u32 s32, s34, 0x2c000
  v_mfma_f32_16x16x32_bf16 a[4:7], v[56:59], v[92:95], a[4:7]
  buffer_load_dwordx4 v1, s[12:15], s32 offen offset:0 nt lds
  v_mfma_f32_16x16x32_bf16 a[8:11], v[56:59], v[108:111], a[8:11]
  ds_read_b64_tr_b16 v[56:57], v20 offset:28672
  ds_read_b64_tr_b16 v[58:59], v20 offset:29184
  v_mfma_f32_16x16x32_bf16 a[12:15], v[60:63], v[76:79], a[12:15]
  buffer_load_dwordx4 v2, s[12:15], s32 offen offset:1024 nt lds
  v_mfma_f32_16x16x32_bf16 a[16:19], v[60:63], v[92:95], a[16:19]
  v_mfma_f32_16x16x32_bf16 a[20:23], v[60:63], v[108:111], a[20:23]
  ds_read_b64_tr_b16 v[60:61], v21 offset:28672
  ds_read_b64_tr_b16 v[62:63], v21 offset:29184
  s_waitcnt lgkmcnt(12)
  v_mfma_f32_16x16x32_bf16 a[24:27], v[32:35], v[64:67], 0
  v_mfma_f32_16x16x32_bf16 a[28:31], v[32:35], v[80:83], 0
  v_mfma_f32_16x16x32_bf16 a[32:35], v[32:35], v[96:99], 0
  v_mfma_f32_16x16x32_bf16 a[36:39], v[36:39], v[64:67], 0
  v_mfma_f32_16x16x32_bf16 a[40:43], v[36:39], v[80:83], 0
  buffer_load_dwordx4 v3, s[12:15], s32 offen offset:2048 nt lds
  v_mfma_f32_16x16x32_bf16 a[44:47], v[36:39], v[96:99], 0
  s_waitcnt lgkmcnt(8)
  v_mfma_f32_16x16x32_bf16 a[24:27], v[40:43], v[68:71], a[24:27]
  v_mfma_f32_16x16x32_bf16 a[28:31], v[40:43], v[84:87], a[28:31]
  v_mfma_f32_16x16x32_bf16 a[32:35], v[40:43], v[100:103], a[32:35]
  v_mfma_f32_16x16x32_bf16 a[36:39], v[44:47], v[68:71], a[36:39]
  v_mfma_f32_16x16x32_bf16 a[40:43], v[44:47], v[84:87], a[40:43]
  v_mfma_f32_16x16x32_bf16 a[44:47], v[44:47], v[100:103], a[44:47]
  s_waitcnt lgkmcnt(0)
  v_mfma_f32_16x16x32_bf16 a[24:27], v[48:51], v[72:75], a[24:27]
  s_barrier
  ds_read_b64_tr_b16 v[32:33], v20 offset:32768
  ds_read_b64_tr_b16 v[34:35], v20 offset:33280
  v_mfma_f32_16x16x32_bf16 a[28:31], v[48:51], v[88:91], a[28:31]
  ds_read_b64_tr_b16 v[36:37], v21 offset:32768
  ds_read_b64_tr_b16 v[38:39], v21 offset:33280
  v_mfma_f32_16x16x32_bf16 a[32:35], v[48:51], v[104:107], a[32:35]
  ds_read_b64_tr_b16 v[40:41], v20 offset:36864
  ds_read_b64_tr_b16 v[42:43], v20 offset:37376
  v_mfma_f32_16x16x32_bf16 a[36:39], v[52:55], v[72:75], a[36:39]
  ds_read_b64_tr_b16 v[44:45], v21 offset:36864
  ds_read_b64_tr_b16 v[46:47], v21 offset:37376
  v_mfma_f32_16x16x32_bf16 a[40:43], v[52:55], v[88:91], a[40:43]
  ds_read_b64_tr_b16 v[48:49], v20 offset:40960
  ds_read_b64_tr_b16 v[50:51], v20 offset:41472
  v_mfma_f32_16x16x32_bf16 a[44:47], v[52:55], v[104:107], a[44:47]
  ds_read_b64_tr_b16 v[52:53], v21 offset:40960
  ds_read_b64_tr_b16 v[54:55], v21 offset:41472
  v_mfma_f32_16x16x32_bf16 a[24:27], v[56:59], v[76:79], a[24:27]
  buffer_load_dwordx4 v4, s[12:15], s32 offen offset:3072 nt lds
  v_mfma_f32_16x16x32_bf16 a[28:31], v[56:59], v[92:95], a[28:31]
  s_add_u32 m0, s34, 0x5000
  s_add_u32 s32, s34, 0x2d000
  v_mfma_f32_16x16x32_bf16 a[32:35], v[56:59], v[108:111], a[32:35]
  ds_read_b64_tr_b16 v[56:57], v20 offset:45056
  ds_read_b64_tr_b16 v[58:59], v20 offset:45568
  v_mfma_f32_16x16x32_bf16 a[36:39], v[60:63], v[76:79], a[36:39]
  buffer_load_dwordx4 v1, s[12:15], s32 offen offset:0 nt lds
  v_mfma_f32_16x16x32_bf16 a[40:43], v[60:63], v[92:95], a[40:43]
  v_mfma_f32_16x16x32_bf16 a[44:47], v[60:63], v[108:111], a[44:47]
  ds_read_b64_tr_b16 v[60:61], v21 offset:45056
  ds_read_b64_tr_b16 v[62:63], v21 offset:45568
  s_waitcnt lgkmcnt(12)
  v_mfma_f32_16x16x32_bf16 a[48:51], v[32:35], v[64:67], 0
  v_mfma_f32_16x16x32_bf16 a[52:55], v[32:35], v[80:83], 0
  v_mfma_f32_16x16x32_bf16 a[56:59], v[32:35], v[96:99], 0
  v_mfma_f32_16x16x32_bf16 a[60:63], v[36:39], v[64:67], 0
  buffer_load_dwordx4 v2, s[12:15], s32 offen offset:1024 nt lds
  v_mfma_f32_16x16x32_bf16 a[64:67], v[36:39], v[80:83], 0
  v_mfma_f32_16x16x32_bf16 a[68:71], v[36:39], v[96:99], 0
  s_waitcnt lgkmcnt(8)
  v_mfma_f32_16x16x32_bf16 a[48:51], v[40:43], v[68:71], a[48:51]
  v_mfma_f32_16x16x32_bf16 a[52:55], v[40:43], v[84:87], a[52:55]
  v_mfma_f32_16x16x32_bf16 a[56:59], v[40:43], v[100:103], a[56:59]
  v_mfma_f32_16x16x32_bf16 a[60:63], v[44:47], v[68:71], a[60:63]
  v_mfma_f32_16x16x32_bf16 a[64:67], v[44:47], v[84:87], a[64:67]
  v_mfma_f32_16x16x32_bf16 a[68:71], v[44:47], v[100:103], a[68:71]
  buffer_load_dwordx4 v3, s[12:15], s32 offen offset:2048 nt lds
  s_waitcnt lgkmcnt(0)
  v_mfma_f32_16x16x32_bf16 a[48:51], v[48:51], v[72:75], a[48:51]
  s_barrier
  ds_read_b64_tr_b16 v[32:33], v20 offset:49152
  ds_read_b64_tr_b16 v[34:35], v20 offset:49664
  v_mfma_f32_16x16x32_bf16 a[52:55], v[48:51], v[88:91], a[52:55]
  ds_read_b64_tr_b16 v[36:37], v21 offset:49152
  ds_read_b64_tr_b16 v[38:39], v21 offset:49664
  v_mfma_f32_16x16x32_bf16 a[56:59], v[48:51], v[104:107], a[56:59]
  ds_read_b64_tr_b16 v[40:41], v20 offset:53248
  ds_read_b64_tr_b16 v[42:43], v20 offset:53760
  v_mfma_f32_16x16x32_bf16 a[60:63], v[52:55], v[72:75], a[60:63]
  ds_read_b64_tr_b16 v[44:45], v21 offset:53248
  ds_read_b64_tr_b16 v[46:47], v21 offset:53760
  v_mfma_f32_16x16x32_bf16 a[64:67], v[52:55], v[88:91], a[64:67]
  ds_read_b64_tr_b16 v[48:49], v20 offset:57344
  ds_read_b64_tr_b16 v[50:51], v20 offset:57856
  v_mfma_f32_16x16x32_bf16 a[68:71], v[52:55], v[104:107], a[68:71]
  ds_read_b64_tr_b16 v[52:53], v21 offset:57344
  ds_read_b64_tr_b16 v[54:55], v21 offset:57856
  v_mfma_f32_16x16x32_bf16 a[48:51], v[56:59], v[76:79], a[48:51]
  v_mfma_f32_16x16x32_bf16 a[52:55], v[56:59], v[92:95], a[52:55]
  buffer_load_dwordx4 v4, s[12:15], s32 offen offset:3072 nt lds
  v_mfma_f32_16x16x32_bf16 a[56:59], v[56:59], v[108:111], a[56:59]
  ds_read_b64_tr_b16 v[56:57], v20 offset:61440
  ds_read_b64_tr_b16 v[58:59], v20 offset:61952
  v_mfma_f32_16x16x32_bf16 a[60:63], v[60:63], v[76:79], a[60:63]
  v_mfma_f32_16x16x32_bf16 a[64:67], v[60:63], v[92:95], a[64:67]
  v_mfma_f32_16x16x32_bf16 a[68:71], v[60:63], v[108:111], a[68:71]
  ds_read_b64_tr_b16 v[60:61], v21 offset:61440
  ds_read_b64_tr_b16 v[62:63], v21 offset:61952
  s_waitcnt lgkmcnt(12)
  v_mfma_f32_16x16x32_bf16 a[72:75], v[32:35], v[64:67], 0
  v_mfma_f32_16x16x32_bf16 a[76:79], v[32:35], v[80:83], 0
  v_mfma_f32_16x16x32_bf16 a[80:83], v[32:35], v[96:99], 0
  s_add_u32 m0, s34, 0x8000
  s_add_u32 s32, s34, 0x30000
  v_mfma_f32_16x16x32_bf16 a[84:87], v[36:39], v[64:67], 0
  buffer_load_dwordx4 v1, s[12:15], s32 offen offset:0 nt lds
  v_mfma_f32_16x16x32_bf16 a[88:91], v[36:39], v[80:83], 0
  v_mfma_f32_16x16x32_bf16 a[92:95], v[36:39], v[96:99], 0
  s_waitcnt lgkmcnt(8)
  v_mfma_f32_16x16x32_bf16 a[72:75], v[40:43], v[68:71], a[72:75]
  v_mfma_f32_16x16x32_bf16 a[76:79], v[40:43], v[84:87], a[76:79]
  v_mfma_f32_16x16x32_bf16 a[80:83], v[40:43], v[100:103], a[80:83]
  v_mfma_f32_16x16x32_bf16 a[84:87], v[44:47], v[68:71], a[84:87]
  v_mfma_f32_16x16x32_bf16 a[88:91], v[44:47], v[84:87], a[88:91]
  buffer_load_dwordx4 v2, s[12:15], s32 offen offset:1024 nt lds
  v_mfma_f32_16x16x32_bf16 a[92:95], v[44:47], v[100:103], a[92:95]
  s_waitcnt lgkmcnt(0)
  v_mfma_f32_16x16x32_bf16 a[72:75], v[48:51], v[72:75], a[72:75]
  s_barrier
  ds_read_b64_tr_b16 v[32:33], v20 offset:0
  ds_read_b64_tr_b16 v[34:35], v20 offset:512
  v_mfma_f32_16x16x32_bf16 a[76:79], v[48:51], v[88:91], a[76:79]
  ds_read_b64_tr_b16 v[36:37], v21 offset:0
  ds_read_b64_tr_b16 v[38:39], v21 offset:512
  v_mfma_f32_16x16x32_bf16 a[80:83], v[48:51], v[104:107], a[80:83]
  ds_read_b64_tr_b16 v[40:41], v20 offset:4096
  ds_read_b64_tr_b16 v[42:43], v20 offset:4608
  v_mfma_f32_16x16x32_bf16 a[84:87], v[52:55], v[72:75], a[84:87]
  ds_read_b64_tr_b16 v[44:45], v21 offset:4096
  ds_read_b64_tr_b16 v[46:47], v21 offset:4608
  v_mfma_f32_16x16x32_bf16 a[88:91], v[52:55], v[88:91], a[88:91]
  ds_read_b64_tr_b16 v[48:49], v20 offset:8192
  ds_read_b64_tr_b16 v[50:51], v20 offset:8704
  v_mfma_f32_16x16x32_bf16 a[92:95], v[52:55], v[104:107], a[92:95]
  ds_read_b64_tr_b16 v[52:53], v21 offset:8192
  ds_read_b64_tr_b16 v[54:55], v21 offset:8704
  v_mfma_f32_16x16x32_bf16 a[72:75], v[56:59], v[76:79], a[72:75]
  buffer_load_dwordx4 v3, s[12:15], s32 offen offset:2048 nt lds
  v_mfma_f32_16x16x32_bf16 a[76:79], v[56:59], v[92:95], a[76:79]
  v_mfma_f32_16x16x32_bf16 a[80:83], v[56:59], v[108:111], a[80:83]
  ds_read_b64_tr_b16 v[56:57], v20 offset:12288
  ds_read_b64_tr_b16 v[58:59], v20 offset:12800
  v_mfma_f32_16x16x32_bf16 a[84:87], v[60:63], v[76:79], a[84:87]
  v_mfma_f32_16x16x32_bf16 a[88:91], v[60:63], v[92:95], a[88:91]
  v_mfma_f32_16x16x32_bf16 a[92:95], v[60:63], v[108:111], a[92:95]
  ds_read_b64_tr_b16 v[60:61], v21 offset:12288
  ds_read_b64_tr_b16 v[62:63], v21 offset:12800
  s_waitcnt lgkmcnt(12)
  v_mfma_f32_16x16x32_bf16 a[96:99], v[32:35], v[64:67], 0
  v_mfma_f32_16x16x32_bf16 a[100:103], v[32:35], v[80:83], 0
  v_mfma_f32_16x16x32_bf16 a[104:107], v[32:35], v[96:99], 0
  buffer_load_dwordx4 v4, s[12:15], s32 offen offset:3072 nt lds
  v_mfma_f32_16x16x32_bf16 a[108:111], v[36:39], v[64:67], 0
  v_mfma_f32_16x16x32_bf16 a[112:115], v[36:39], v[80:83], 0
  v_mfma_f32_16x16x32_bf16 a[116:119], v[36:39], v[96:99], 0
  s_waitcnt lgkmcnt(8)
  v_mfma_f32_16x16x32_bf16 a[96:99], v[40:43], v[68:71], a[96:99]
  v_mfma_f32_16x16x32_bf16 a[100:103], v[40:43], v[84:87], a[100:103]
  v_mfma_f32_16x16x32_bf16 a[104:107], v[40:43], v[100:103], a[104:107]
  v_mfma_f32_16x16x32_bf16 a[108:111], v[44:47], v[68:71], a[108:111]
  s_add_u32 m0, s34, 0x9000
  s_add_u32 s32, s34, 0x31000
  v_mfma_f32_16x16x32_bf16 a[112:115], v[44:47], v[84:87], a[112:115]
  buffer_load_dwordx4 v1, s[12:15], s32 offen offset:0 nt lds
  v_mfma_f32_16x16x32_bf16 a[116:119], v[44:47], v[100:103], a[116:119]
  s_waitcnt lgkmcnt(0)
  v_mfma_f32_16x16x32_bf16 a[96:99], v[48:51], v[72:75], a[96:99]
  s_barrier
  ds_read_b64_tr_b16 v[32:33], v20 offset:16384
  ds_read_b64_tr_b16 v[34:35], v20 offset:16896
  v_mfma_f32_16x16x32_bf16 a[100:103], v[48:51], v[88:91], a[100:103]
  ds_read_b64_tr_b16 v[36:37], v21 offset:16384
  ds_read_b64_tr_b16 v[38:39], v21 offset:16896
  v_mfma_f32_16x16x32_bf16 a[104:107], v[48:51], v[104:107], a[104:107]
  ds_read_b64_tr_b16 v[40:41], v20 offset:20480
  ds_read_b64_tr_b16 v[42:43], v20 offset:20992
  v_mfma_f32_16x16x32_bf16 a[108:111], v[52:55], v[72:75], a[108:111]
  ds_read_b64_tr_b16 v[44:45], v21 offset:20480
  ds_read_b64_tr_b16 v[46:47], v21 offset:20992
  v_mfma_f32_16x16x32_bf16 a[112:115], v[52:55], v[88:91], a[112:115]
  ds_read_b64_tr_b16 v[48:49], v20 offset:24576
  ds_read_b64_tr_b16 v[50:51], v20 offset:25088
  v_mfma_f32_16x16x32_bf16 a[116:119], v[52:55], v[104:107], a[116:119]
  ds_read_b64_tr_b16 v[52:53], v21 offset:24576
  ds_read_b64_tr_b16 v[54:55], v21 offset:25088
  v_mfma_f32_16x16x32_bf16 a[96:99], v[56:59], v[76:79], a[96:99]
  buffer_load_dwordx4 v2, s[12:15], s32 offen offset:1024 nt lds
  v_mfma_f32_16x16x32_bf16 a[100:103], v[56:59], v[92:95], a[100:103]
  v_mfma_f32_16x16x32_bf16 a[104:107], v[56:59], v[108:111], a[104:107]
  ds_read_b64_tr_b16 v[56:57], v20 offset:28672
  ds_read_b64_tr_b16 v[58:59], v20 offset:29184
  v_mfma_f32_16x16x32_bf16 a[108:111], v[60:63], v[76:79], a[108:111]
  v_mfma_f32_16x16x32_bf16 a[112:115], v[60:63], v[92:95], a[112:115]
  v_mfma_f32_16x16x32_bf16 a[116:119], v[60:63], v[108:111], a[116:119]
  ds_read_b64_tr_b16 v[60:61], v21 offset:28672
  ds_read_b64_tr_b16 v[62:63], v21 offset:29184
  s_waitcnt lgkmcnt(12)
  v_mfma_f32_16x16x32_bf16 a[120:123], v[32:35], v[64:67], 0
  v_mfma_f32_16x16x32_bf16 a[124:127], v[32:35], v[80:83], 0
  buffer_load_dwordx4 v3, s[12:15], s32 offen offset:2048 nt lds
  v_mfma_f32_16x16x32_bf16 a[128:131], v[32:35], v[96:99], 0
  v_mfma_f32_16x16x32_bf16 a[132:135], v[36:39], v[64:67], 0
  v_mfma_f32_16x16x32_bf16 a[136:139], v[36:39], v[80:83], 0
  v_mfma_f32_16x16x32_bf16 a[140:143], v[36:39], v[96:99], 0
  s_waitcnt lgkmcnt(8)
  v_mfma_f32_16x16x32_bf16 a[120:123], v[40:43], v[68:71], a[120:123]
  v_mfma_f32_16x16x32_bf16 a[124:127], v[40:43], v[84:87], a[124:127]
  v_mfma_f32_16x16x32_bf16 a[128:131], v[40:43], v[100:103], a[128:131]
  v_mfma_f32_16x16x32_bf16 a[132:135], v[44:47], v[68:71], a[132:135]
  buffer_load_dwordx4 v4, s[12:15], s32 offen offset:3072 nt lds
  v_mfma_f32_16x16x32_bf16 a[136:139], v[44:47], v[84:87], a[136:139]
  v_mfma_f32_16x16x32_bf16 a[140:143], v[44:47], v[100:103], a[140:143]
  s_waitcnt lgkmcnt(0)
  v_mfma_f32_16x16x32_bf16 a[120:123], v[48:51], v[72:75], a[120:123]
  s_barrier
  ds_read_b64_tr_b16 v[32:33], v20 offset:32768
  ds_read_b64_tr_b16 v[34:35], v20 offset:33280
  v_mfma_f32_16x16x32_bf16 a[124:127], v[48:51], v[88:91], a[124:127]
  ds_read_b64_tr_b16 v[36:37], v21 offset:32768
  ds_read_b64_tr_b16 v[38:39], v21 offset:33280
  v_mfma_f32_16x16x32_bf16 a[128:131], v[48:51], v[104:107], a[128:131]
  ds_read_b64_tr_b16 v[40:41], v20 offset:36864
  ds_read_b64_tr_b16 v[42:43], v20 offset:37376
  v_mfma_f32_16x16x32_bf16 a[132:135], v[52:55], v[72:75], a[132:135]
  ds_read_b64_tr_b16 v[44:45], v21 offset:36864
  ds_read_b64_tr_b16 v[46:47], v21 offset:37376
  v_mfma_f32_16x16x32_bf16 a[136:139], v[52:55], v[88:91], a[136:139]
  ds_read_b64_tr_b16 v[48:49], v20 offset:40960
  ds_read_b64_tr_b16 v[50:51], v20 offset:41472
  v_mfma_f32_16x16x32_bf16 a[140:143], v[52:55], v[104:107], a[140:143]
  ds_read_b64_tr_b16 v[52:53], v21 offset:40960
  ds_read_b64_tr_b16 v[54:55], v21 offset:41472
  v_mfma_f32_16x16x32_bf16 a[120:123], v[56:59], v[76:79], a[120:123]
  s_add_u32 m0, s34, 0xc000
  s_add_u32 s32, s34, 0x34000
  v_mfma_f32_16x16x32_bf16 a[124:127], v[56:59], v[92:95], a[124:127]
  buffer_load_dwordx4 v1, s[12:15], s32 offen offset:0 nt lds
  v_mfma_f32_16x16x32_bf16 a[128:131], v[56:59], v[108:111], a[128:131]
  ds_read_b64_tr_b16 v[56:57], v20 offset:45056
  ds_read_b64_tr_b16 v[58:59], v20 offset:45568
  v_mfma_f32_16x16x32_bf16 a[132:135], v[60:63], v[76:79], a[132:135]
  v_mfma_f32_16x16x32_bf16 a[136:139], v[60:63], v[92:95], a[136:139]
  v_mfma_f32_16x16x32_bf16 a[140:143], v[60:63], v[108:111], a[140:143]
  ds_read_b64_tr_b16 v[60:61], v21 offset:45056
  ds_read_b64_tr_b16 v[62:63], v21 offset:45568
  s_waitcnt lgkmcnt(12)
  v_mfma_f32_16x16x32_bf16 a[144:147], v[32:35], v[64:67], 0
  buffer_load_dwordx4 v2, s[12:15], s32 offen offset:1024 nt lds
  v_mfma_f32_16x16x32_bf16 a[148:151], v[32:35], v[80:83], 0
  v_mfma_f32_16x16x32_bf16 a[152:155], v[32:35], v[96:99], 0
  v_mfma_f32_16x16x32_bf16 a[156:159], v[36:39], v[64:67], 0
  v_mfma_f32_16x16x32_bf16 a[160:163], v[36:39], v[80:83], 0
  v_mfma_f32_16x16x32_bf16 a[164:167], v[36:39], v[96:99], 0
  s_waitcnt lgkmcnt(8)
  v_mfma_f32_16x16x32_bf16 a[144:147], v[40:43], v[68:71], a[144:147]
  v_mfma_f32_16x16x32_bf16 a[148:151], v[40:43], v[84:87], a[148:151]
  v_mfma_f32_16x16x32_bf16 a[152:155], v[40:43], v[100:103], a[152:155]
  buffer_load_dwordx4 v3, s[12:15], s32 offen offset:2048 nt lds
  v_mfma_f32_16x16x32_bf16 a[156:159], v[44:47], v[68:71], a[156:159]
  v_mfma_f32_16x16x32_bf16 a[160:163], v[44:47], v[84:87], a[160:163]
  v_mfma_f32_16x16x32_bf16 a[164:167], v[44:47], v[100:103], a[164:167]
  s_waitcnt lgkmcnt(0)
  v_mfma_f32_16x16x32_bf16 a[144:147], v[48:51], v[72:75], a[144:147]
  s_barrier
  ds_read_b64_tr_b16 v[32:33], v20 offset:49152
  ds_read_b64_tr_b16 v[34:35], v20 offset:49664
  v_mfma_f32_16x16x32_bf16 a[148:151], v[48:51], v[88:91], a[148:151]
  ds_read_b64_tr_b16 v[36:37], v21 offset:49152
  ds_read_b64_tr_b16 v[38:39], v21 offset:49664
  v_mfma_f32_16x16x32_bf16 a[152:155], v[48:51], v[104:107], a[152:155]
  ds_read_b64_tr_b16 v[40:41], v20 offset:53248
  ds_read_b64_tr_b16 v[42:43], v20 offset:53760
  v_mfma_f32_16x16x32_bf16 a[156:159], v[52:55], v[72:75], a[156:159]
  ds_read_b64_tr_b16 v[44:45], v21 offset:53248
  ds_read_b64_tr_b16 v[46:47], v21 offset:53760
  v_mfma_f32_16x16x32_bf16 a[160:163], v[52:55], v[88:91], a[160:163]
  ds_read_b64_tr_b16 v[48:49], v20 offset:57344
  ds_read_b64_tr_b16 v[50:51], v20 offset:57856
  v_mfma_f32_16x16x32_bf16 a[164:167], v[52:55], v[104:107], a[164:167]
  ds_read_b64_tr_b16 v[52:53], v21 offset:57344
  ds_read_b64_tr_b16 v[54:55], v21 offset:57856
  v_mfma_f32_16x16x32_bf16 a[144:147], v[56:59], v[76:79], a[144:147]
  buffer_load_dwordx4 v4, s[12:15], s32 offen offset:3072 nt lds
  v_mfma_f32_16x16x32_bf16 a[148:151], v[56:59], v[92:95], a[148:151]
  v_mfma_f32_16x16x32_bf16 a[152:155], v[56:59], v[108:111], a[152:155]
  ds_read_b64_tr_b16 v[56:57], v20 offset:61440
  ds_read_b64_tr_b16 v[58:59], v20 offset:61952
  v_mfma_f32_16x16x32_bf16 a[156:159], v[60:63], v[76:79], a[156:159]
  v_mfma_f32_16x16x32_bf16 a[160:163], v[60:63], v[92:95], a[160:163]
  v_mfma_f32_16x16x32_bf16 a[164:167], v[60:63], v[108:111], a[164:167]
  ds_read_b64_tr_b16 v[60:61], v21 offset:61440
  ds_read_b64_tr_b16 v[62:63], v21 offset:61952
  s_waitcnt lgkmcnt(12)
  v_mfma_f32_16x16x32_bf16 a[168:171], v[32:35], v[64:67], 0
  s_add_u32 m0, s34, 0xd000
  s_add_u32 s32, s34, 0x35000
  v_mfma_f32_16x16x32_bf16 a[172:175], v[32:35], v[80:83], 0
  buffer_load_dwordx4 v1, s[12:15], s32 offen offset:0 nt lds
  v_mfma_f32_16x16x32_bf16 a[176:179], v[32:35], v[96:99], 0
  v_mfma_f32_16x16x32_bf16 a[180:183], v[36:39], v[64:67], 0
  v_mfma_f32_16x16x32_bf16 a[184:187], v[36:39], v[80:83], 0
  v_mfma_f32_16x16x32_bf16 a[188:191], v[36:39], v[96:99], 0
  s_waitcnt lgkmcnt(8)
  v_mfma_f32_16x16x32_bf16 a[168:171], v[40:43], v[68:71], a[168:171]
  v_mfma_f32_16x16x32_bf16 a[172:175], v[40:43], v[84:87], a[172:175]
  buffer_load_dwordx4 v2, s[12:15], s32 offen offset:1024 nt lds
  v_mfma_f32_16x16x32_bf16 a[176:179], v[40:43], v[100:103], a[176:179]
  v_mfma_f32_16x16x32_bf16 a[180:183], v[44:47], v[68:71], a[180:183]
  v_mfma_f32_16x16x32_bf16 a[184:187], v[44:47], v[84:87], a[184:187]
  v_mfma_f32_16x16x32_bf16 a[188:191], v[44:47], v[100:103], a[188:191]
  s_waitcnt lgkmcnt(0)
  v_mfma_f32_16x16x32_bf16 a[168:171], v[48:51], v[72:75], a[168:171]
  s_waitcnt vmcnt(38)
  s_barrier
  v_add_u32 v8, 0x10000, v8
  ds_read_b128 v[32:35], v8 offset:0
  ds_read_b128 v[36:39], v8 offset:4096
  v_mfma_f32_16x16x32_bf16 a[172:175], v[48:51], v[88:91], a[172:175]
  v_add_u32 v9, 0x10000, v9
  ds_read_b128 v[40:43], v9 offset:0
  ds_read_b128 v[44:47], v9 offset:4096
  v_mfma_f32_16x16x32_bf16 a[176:179], v[48:51], v[104:107], a[176:179]
  v_add_u32 v10, 0x10000, v10
  ds_read_b128 v[48:51], v10 offset:0
  v_mfma_f32_16x16x32_bf16 a[180:183], v[52:55], v[72:75], a[180:183]
  buffer_load_dwordx4 v3, s[12:15], s32 offen offset:2048 nt lds
  v_mfma_f32_16x16x32_bf16 a[184:187], v[52:55], v[88:91], a[184:187]
  v_mfma_f32_16x16x32_bf16 a[188:191], v[52:55], v[104:107], a[188:191]
  ds_read_b128 v[52:55], v10 offset:4096
  v_mfma_f32_16x16x32_bf16 a[168:171], v[56:59], v[76:79], a[168:171]
  v_mfma_f32_16x16x32_bf16 a[172:175], v[56:59], v[92:95], a[172:175]
  v_mfma_f32_16x16x32_bf16 a[176:179], v[56:59], v[108:111], a[176:179]
  v_add_u32 v11, 0x10000, v11
  ds_read_b128 v[56:59], v11 offset:0
  v_mfma_f32_16x16x32_bf16 a[180:183], v[60:63], v[76:79], a[180:183]
  v_mfma_f32_16x16x32_bf16 a[184:187], v[60:63], v[92:95], a[184:187]
  buffer_load_dwordx4 v4, s[12:15], s32 offen offset:3072 nt lds
  v_mfma_f32_16x16x32_bf16 a[188:191], v[60:63], v[108:111], a[188:191]
  ds_read_b128 v[60:63], v11 offset:4096
  s_waitcnt lgkmcnt(6)
  v_mfma_f32_16x16x32_bf16 v[64:67], v[32:35], a[192:195], 0
  v_mfma_f32_16x16x32_bf16 v[72:75], v[32:35], a[208:211], 0
  v_mfma_f32_16x16x32_bf16 v[80:83], v[32:35], a[224:227], 0
  v_mfma_f32_16x16x32_bf16 v[68:71], v[36:39], a[192:195], 0
  v_mfma_f32_16x16x32_bf16 v[76:79], v[36:39], a[208:211], 0
  v_mfma_f32_16x16x32_bf16 v[84:87], v[36:39], a[224:227], 0
  s_waitcnt lgkmcnt(4)
  v_mfma_f32_16x16x32_bf16 v[64:67], v[40:43], a[196:199], v[64:67]
  v_mfma_f32_16x16x32_bf16 v[72:75], v[40:43], a[212:215], v[72:75]
  v_mfma_f32_16x16x32_bf16 v[80:83], v[40:43], a[228:231], v[80:83]
  v_mfma_f32_16x16x32_bf16 v[68:71], v[44:47], a[196:199], v[68:71]
  v_mfma_f32_16x16x32_bf16 v[76:79], v[44:47], a[212:215], v[76:79]
  v_mfma_f32_16x16x32_bf16 v[84:87], v[44:47], a[228:231], v[84:87]
  s_waitcnt lgkmcnt(0)
  v_mfma_f32_16x16x32_bf16 v[64:67], v[48:51], a[200:203], v[64:67]
  s_waitcnt vmcnt(32)
  s_barrier
  ds_read_b128 v[32:35], v8 offset:16384
  ds_read_b128 v[36:39], v8 offset:20480
  v_mfma_f32_16x16x32_bf16 v[72:75], v[48:51], a[216:219], v[72:75]
  ds_read_b128 v[40:43], v9 offset:16384
  ds_read_b128 v[44:47], v9 offset:20480
  v_mfma_f32_16x16x32_bf16 v[80:83], v[48:51], a[232:235], v[80:83]
  ds_read_b128 v[48:51], v10 offset:16384
  s_add_u32 m0, s34, 0x10000
  v_mfma_f32_16x16x32_bf16 v[68:71], v[52:55], a[200:203], v[68:71]
  s_add_u32 s32, s34, 0x38000
  buffer_load_dwordx4 v1, s[12:15], s32 offen offset:0 nt lds
  v_mfma_f32_16x16x32_bf16 v[76:79], v[52:55], a[216:219], v[76:79]
  v_mfma_f32_16x16x32_bf16 v[84:87], v[52:55], a[232:235], v[84:87]
  ds_read_b128 v[52:55], v10 offset:20480
  v_mfma_f32_16x16x32_bf16 v[64:67], v[56:59], a[204:207], v[64:67]
  v_mfma_f32_16x16x32_bf16 v[72:75], v[56:59], a[220:223], v[72:75]
  v_mfma_f32_16x16x32_bf16 v[80:83], v[56:59], a[236:239], v[80:83]
  ds_read_b128 v[56:59], v11 offset:16384
  v_mfma_f32_16x16x32_bf16 v[68:71], v[60:63], a[204:207], v[68:71]
  v_mfma_f32_16x16x32_bf16 v[76:79], v[60:63], a[220:223], v[76:79]
  buffer_load_dwordx4 v2, s[12:15], s32 offen offset:1024 nt lds
  v_mfma_f32_16x16x32_bf16 v[84:87], v[60:63], a[236:239], v[84:87]
  ds_read_b128 v[60:63], v11 offset:20480
  s_waitcnt lgkmcnt(6)
  v_mfma_f32_16x16x32_bf16 v[88:91], v[32:35], a[192:195], 0
  v_mfma_f32_16x16x32_bf16 v[96:99], v[32:35], a[208:211], 0
  v_mfma_f32_16x16x32_bf16 v[104:107], v[32:35], a[224:227], 0
  v_mfma_f32_16x16x32_bf16 v[92:95], v[36:39], a[192:195], 0
  v_mfma_f32_16x16x32_bf16 v[100:103], v[36:39], a[208:211], 0
  v_mfma_f32_16x16x32_bf16 v[108:111], v[36:39], a[224:227], 0
  s_waitcnt lgkmcnt(4)
  v_mfma_f32_16x16x32_bf16 v[88:91], v[40:43], a[196:199], v[88:91]
  v_mfma_f32_16x16x32_bf16 v[96:99], v[40:43], a[212:215], v[96:99]
  buffer_load_dwordx4 v3, s[12:15], s32 offen offset:2048 nt lds
  v_mfma_f32_16x16x32_bf16 v[104:107], v[40:43], a[228:231], v[104:107]
  v_mfma_f32_16x16x32_bf16 v[92:95], v[44:47], a[196:199], v[92:95]
  v_mfma_f32_16x16x32_bf16 v[100:103], v[44:47], a[212:215], v[100:103]
  v_mfma_f32_16x16x32_bf16 v[108:111], v[44:47], a[228:231], v[108:111]
  s_waitcnt lgkmcnt(0)
  v_mfma_f32_16x16x32_bf16 v[88:91], v[48:51], a[200:203], v[88:91]
  s_waitcnt vmcnt(27)
  s_barrier
  v_subrev_u32 v8, 0x10000, v8
  ds_read_b128 v[32:35], v8 offset:0
  ds_read_b128 v[36:39], v8 offset:4096
  v_mfma_f32_16x16x32_bf16 v[96:99], v[48:51], a[216:219], v[96:99]
  v_subrev_u32 v9, 0x10000, v9
  ds_read_b128 v[40:43], v9 offset:0
  ds_read_b128 v[44:47], v9 offset:4096
  v_mfma_f32_16x16x32_bf16 v[104:107], v[48:51], a[232:235], v[104:107]
  v_subrev_u32 v10, 0x10000, v10
  ds_read_b128 v[48:51], v10 offset:0
  v_mfma_f32_16x16x32_bf16 v[92:95], v[52:55], a[200:203], v[92:95]
  v_mfma_f32_16x16x32_bf16 v[100:103], v[52:55], a[216:219], v[100:103]
  buffer_load_dwordx4 v4, s[12:15], s32 offen offset:3072 nt lds
  v_mfma_f32_16x16x32_bf16 v[108:111], v[52:55], a[232:235], v[108:111]
  ds_read_b128 v[52:55], v10 offset:4096
  v_mfma_f32_16x16x32_bf16 v[88:91], v[56:59], a[204:207], v[88:91]
  v_mfma_f32_16x16x32_bf16 v[96:99], v[56:59], a[220:223], v[96:99]
  v_mfma_f32_16x16x32_bf16 v[104:107], v[56:59], a[236:239], v[104:107]
  v_subrev_u32 v11, 0x10000, v11
  ds_read_b128 v[56:59], v11 offset:0
  v_mfma_f32_16x16x32_bf16 v[92:95], v[60:63], a[204:207], v[92:95]
  v_mfma_f32_16x16x32_bf16 v[100:103], v[60:63], a[220:223], v[100:103]
  v_mfma_f32_16x16x32_bf16 v[108:111], v[60:63], a[236:239], v[108:111]
  ds_read_b128 v[60:63], v11 offset:4096
  s_waitcnt lgkmcnt(6)
  v_mfma_f32_16x16x32_bf16 v[112:115], v[32:35], a[192:195], 0
  v_mfma_f32_16x16x32_bf16 v[120:123], v[32:35], a[208:211], 0
  v_mfma_f32_16x16x32_bf16 v[128:131], v[32:35], a[224:227], 0
  s_add_u32 m0, s34, 0x11000
  s_add_u32 s32, s34, 0x39000
  v_mfma_f32_16x16x32_bf16 v[116:119], v[36:39], a[192:195], 0
  buffer_load_dwordx4 v1, s[12:15], s32 offen offset:0 nt lds
  v_mfma_f32_16x16x32_bf16 v[124:127], v[36:39], a[208:211], 0
  v_mfma_f32_16x16x32_bf16 v[132:135], v[36:39], a[224:227], 0
  s_waitcnt lgkmcnt(4)
  v_mfma_f32_16x16x32_bf16 v[112:115], v[40:43], a[196:199], v[112:115]
  v_mfma_f32_16x16x32_bf16 v[120:123], v[40:43], a[212:215], v[120:123]
  v_mfma_f32_16x16x32_bf16 v[128:131], v[40:43], a[228:231], v[128:131]
  v_mfma_f32_16x16x32_bf16 v[116:119], v[44:47], a[196:199], v[116:119]
  v_mfma_f32_16x16x32_bf16 v[124:127], v[44:47], a[212:215], v[124:127]
  v_mfma_f32_16x16x32_bf16 v[132:135], v[44:47], a[228:231], v[132:135]
  buffer_load_dwordx4 v2, s[12:15], s32 offen offset:1024 nt lds
  s_waitcnt lgkmcnt(0)
  v_mfma_f32_16x16x32_bf16 v[112:115], v[48:51], a[200:203], v[112:115]
  s_waitcnt vmcnt(22)
  s_barrier
  ds_read_b128 v[32:35], v8 offset:16384
  ds_read_b128 v[36:39], v8 offset:20480
  v_mfma_f32_16x16x32_bf16 v[120:123], v[48:51], a[216:219], v[120:123]
  ds_read_b128 v[40:43], v9 offset:16384
  ds_read_b128 v[44:47], v9 offset:20480
  v_mfma_f32_16x16x32_bf16 v[128:131], v[48:51], a[232:235], v[128:131]
  ds_read_b128 v[48:51], v10 offset:16384
  v_mfma_f32_16x16x32_bf16 v[116:119], v[52:55], a[200:203], v[116:119]
  v_mfma_f32_16x16x32_bf16 v[124:127], v[52:55], a[216:219], v[124:127]
  v_mfma_f32_16x16x32_bf16 v[132:135], v[52:55], a[232:235], v[132:135]
  ds_read_b128 v[52:55], v10 offset:20480
  v_mfma_f32_16x16x32_bf16 v[112:115], v[56:59], a[204:207], v[112:115]
  v_mfma_f32_16x16x32_bf16 v[120:123], v[56:59], a[220:223], v[120:123]
  v_mfma_f32_16x16x32_bf16 v[128:131], v[56:59], a[236:239], v[128:131]
  ds_read_b128 v[56:59], v11 offset:16384
  buffer_load_dwordx4 v3, s[12:15], s32 offen offset:2048 nt lds
  v_mfma_f32_16x16x32_bf16 v[116:119], v[60:63], a[204:207], v[116:119]
  v_mfma_f32_16x16x32_bf16 v[124:127], v[60:63], a[220:223], v[124:127]
  v_mfma_f32_16x16x32_bf16 v[132:135], v[60:63], a[236:239], v[132:135]
  ds_read_b128 v[60:63], v11 offset:20480
  s_waitcnt lgkmcnt(6)
  v_mfma_f32_16x16x32_bf16 v[136:139], v[32:35], a[192:195], 0
  v_mfma_f32_16x16x32_bf16 v[144:147], v[32:35], a[208:211], 0
  v_mfma_f32_16x16x32_bf16 v[152:155], v[32:35], a[224:227], 0
  v_mfma_f32_16x16x32_bf16 v[140:143], v[36:39], a[192:195], 0
  v_mfma_f32_16x16x32_bf16 v[148:151], v[36:39], a[208:211], 0
  v_mfma_f32_16x16x32_bf16 v[156:159], v[36:39], a[224:227], 0
  buffer_load_dwordx4 v4, s[12:15], s32 offen offset:3072 nt lds
  s_waitcnt lgkmcnt(4)
  v_mfma_f32_16x16x32_bf16 v[136:139], v[40:43], a[196:199], v[136:139]
  v_mfma_f32_16x16x32_bf16 v[144:147], v[40:43], a[212:215], v[144:147]
  v_mfma_f32_16x16x32_bf16 v[152:155], v[40:43], a[228:231], v[152:155]
  v_mfma_f32_16x16x32_bf16 v[140:143], v[44:47], a[196:199], v[140:143]
  v_mfma_f32_16x16x32_bf16 v[148:151], v[44:47], a[212:215], v[148:151]
  v_mfma_f32_16x16x32_bf16 v[156:159], v[44:47], a[228:231], v[156:159]
  s_waitcnt lgkmcnt(0)
  v_mfma_f32_16x16x32_bf16 v[136:139], v[48:51], a[200:203], v[136:139]
  s_waitcnt vmcnt(16)
  s_barrier
  ds_read_b128 v[32:35], v8 offset:32768
  ds_read_b128 v[36:39], v8 offset:36864
  v_mfma_f32_16x16x32_bf16 v[144:147], v[48:51], a[216:219], v[144:147]
  ds_read_b128 v[40:43], v9 offset:32768
  ds_read_b128 v[44:47], v9 offset:36864
  v_mfma_f32_16x16x32_bf16 v[152:155], v[48:51], a[232:235], v[152:155]
  ds_read_b128 v[48:51], v10 offset:32768
  s_add_u32 m0, s34, 0x14000
  v_mfma_f32_16x16x32_bf16 v[140:143], v[52:55], a[200:203], v[140:143]
  s_add_u32 s32, s34, 0x3c000
  buffer_load_dwordx4 v1, s[12:15], s32 offen offset:0 nt lds
  v_mfma_f32_16x16x32_bf16 v[148:151], v[52:55], a[216:219], v[148:151]
  buffer_load_dwordx4 v2, s[12:15], s32 offen offset:1024 nt lds
  buffer_load_dwordx4 v3, s[12:15], s32 offen offset:2048 nt lds
  v_mfma_f32_16x16x32_bf16 v[156:159], v[52:55], a[232:235], v[156:159]
  ds_read_b128 v[52:55], v10 offset:36864
  buffer_load_dwordx4 v4, s[12:15], s32 offen offset:3072 nt lds
  v_mfma_f32_16x16x32_bf16 v[136:139], v[56:59], a[204:207], v[136:139]
  s_add_u32 m0, s34, 0x15000
  s_add_u32 s32, s34, 0x3d000
  v_mfma_f32_16x16x32_bf16 v[144:147], v[56:59], a[220:223], v[144:147]
  buffer_load_dwordx4 v1, s[12:15], s32 offen offset:0 nt lds
  buffer_load_dwordx4 v2, s[12:15], s32 offen offset:1024 nt lds
  v_mfma_f32_16x16x32_bf16 v[152:155], v[56:59], a[236:239], v[152:155]
  ds_read_b128 v[56:59], v11 offset:32768
  v_mfma_f32_16x16x32_bf16 v[140:143], v[60:63], a[204:207], v[140:143]
  v_mfma_f32_16x16x32_bf16 v[148:151], v[60:63], a[220:223], v[148:151]
  v_mfma_f32_16x16x32_bf16 v[156:159], v[60:63], a[236:239], v[156:159]
  ds_read_b128 v[60:63], v11 offset:36864
  s_waitcnt lgkmcnt(6)
  v_mfma_f32_16x16x32_bf16 v[160:163], v[32:35], a[192:195], 0
  v_mfma_f32_16x16x32_bf16 v[168:171], v[32:35], a[208:211], 0
  v_mfma_f32_16x16x32_bf16 v[176:179], v[32:35], a[224:227], 0
  v_mfma_f32_16x16x32_bf16 v[164:167], v[36:39], a[192:195], 0
  buffer_load_dwordx4 v3, s[12:15], s32 offen offset:2048 nt lds
  v_mfma_f32_16x16x32_bf16 v[172:175], v[36:39], a[208:211], 0
  v_mfma_f32_16x16x32_bf16 v[180:183], v[36:39], a[224:227], 0
  s_waitcnt lgkmcnt(4)
  v_mfma_f32_16x16x32_bf16 v[160:163], v[40:43], a[196:199], v[160:163]
  v_mfma_f32_16x16x32_bf16 v[168:171], v[40:43], a[212:215], v[168:171]
  v_mfma_f32_16x16x32_bf16 v[176:179], v[40:43], a[228:231], v[176:179]
  v_mfma_f32_16x16x32_bf16 v[164:167], v[44:47], a[196:199], v[164:167]
  v_mfma_f32_16x16x32_bf16 v[172:175], v[44:47], a[212:215], v[172:175]
  v_mfma_f32_16x16x32_bf16 v[180:183], v[44:47], a[228:231], v[180:183]
  s_waitcnt lgkmcnt(0)
  v_mfma_f32_16x16x32_bf16 v[160:163], v[48:51], a[200:203], v[160:163]
  s_waitcnt vmcnt(15)
  s_barrier
  ds_read_b128 v[32:35], v8 offset:49152
  ds_read_b128 v[36:39], v8 offset:53248
  v_mfma_f32_16x16x32_bf16 v[168:171], v[48:51], a[216:219], v[168:171]
  ds_read_b128 v[40:43], v9 offset:49152
  ds_read_b128 v[44:47], v9 offset:53248
  v_mfma_f32_16x16x32_bf16 v[176:179], v[48:51], a[232:235], v[176:179]
  ds_read_b128 v[48:51], v10 offset:49152
  buffer_load_dwordx4 v4, s[12:15], s32 offen offset:3072 nt lds
  v_mfma_f32_16x16x32_bf16 v[164:167], v[52:55], a[200:203], v[164:167]
  s_add_u32 m0, s34, 0x0
  s_add_u32 s32, s34, 0x20000
  v_mfma_f32_16x16x32_bf16 v[172:175], v[52:55], a[216:219], v[172:175]
  buffer_load_dwordx4 v5, s[16:19], s32 offen offset:0 nt lds
  buffer_load_dwordx4 v6, s[16:19], s32 offen offset:1024 nt lds
  v_mfma_f32_16x16x32_bf16 v[180:183], v[52:55], a[232:235], v[180:183]
  ds_read_b128 v[52:55], v10 offset:53248
  buffer_load_dwordx4 v5, s[16:19], s32 offen offset:2048 nt lds
  v_mfma_f32_16x16x32_bf16 v[160:163], v[56:59], a[204:207], v[160:163]
  buffer_load_dwordx4 v6, s[16:19], s32 offen offset:3072 nt lds
  s_add_u32 m0, s34, 0x1000
  v_mfma_f32_16x16x32_bf16 v[168:171], v[56:59], a[220:223], v[168:171]
  s_add_u32 s32, s34, 0x21000
  buffer_load_dwordx4 v5, s[16:19], s32 offen offset:0 nt lds
  v_mfma_f32_16x16x32_bf16 v[176:179], v[56:59], a[236:239], v[176:179]
  ds_read_b128 v[56:59], v11 offset:49152
  buffer_load_dwordx4 v6, s[16:19], s32 offen offset:1024 nt lds
  v_mfma_f32_16x16x32_bf16 v[164:167], v[60:63], a[204:207], v[164:167]
  v_mfma_f32_16x16x32_bf16 v[172:175], v[60:63], a[220:223], v[172:175]
  v_mfma_f32_16x16x32_bf16 v[180:183], v[60:63], a[236:239], v[180:183]
  ds_read_b128 v[60:63], v11 offset:53248
  s_waitcnt lgkmcnt(6)
  v_mfma_f32_16x16x32_bf16 v[184:187], v[32:35], a[192:195], 0
  v_mfma_f32_16x16x32_bf16 v[192:195], v[32:35], a[208:211], 0
  v_mfma_f32_16x16x32_bf16 v[200:203], v[32:35], a[224:227], 0
  v_mfma_f32_16x16x32_bf16 v[188:191], v[36:39], a[192:195], 0
  buffer_load_dwordx4 v5, s[16:19], s32 offen offset:2048 nt lds
  v_mfma_f32_16x16x32_bf16 v[196:199], v[36:39], a[208:211], 0
  v_mfma_f32_16x16x32_bf16 v[204:207], v[36:39], a[224:227], 0
  s_waitcnt lgkmcnt(4)
  v_mfma_f32_16x16x32_bf16 v[184:187], v[40:43], a[196:199], v[184:187]
  v_mfma_f32_16x16x32_bf16 v[192:195], v[40:43], a[212:215], v[192:195]
  v_mfma_f32_16x16x32_bf16 v[200:203], v[40:43], a[228:231], v[200:203]
  v_mfma_f32_16x16x32_bf16 v[188:191], v[44:47], a[196:199], v[188:191]
  v_mfma_f32_16x16x32_bf16 v[196:199], v[44:47], a[212:215], v[196:199]
  v_mfma_f32_16x16x32_bf16 v[204:207], v[44:47], a[228:231], v[204:207]
  s_waitcnt lgkmcnt(0)
  v_mfma_f32_16x16x32_bf16 v[184:187], v[48:51], a[200:203], v[184:187]
  s_waitcnt vmcnt(15)
  s_barrier
  v_add_u32 v8, 0x10000, v8
  ds_read_b128 v[32:35], v8 offset:0
  ds_read_b128 v[36:39], v8 offset:4096
  v_mfma_f32_16x16x32_bf16 v[192:195], v[48:51], a[216:219], v[192:195]
  v_add_u32 v9, 0x10000, v9
  ds_read_b128 v[40:43], v9 offset:0
  ds_read_b128 v[44:47], v9 offset:4096
  v_mfma_f32_16x16x32_bf16 v[200:203], v[48:51], a[232:235], v[200:203]
  v_add_u32 v10, 0x10000, v10
  ds_read_b128 v[48:51], v10 offset:0
  buffer_load_dwordx4 v6, s[16:19], s32 offen offset:3072 nt lds
  v_mfma_f32_16x16x32_bf16 v[188:191], v[52:55], a[200:203], v[188:191]
  s_add_u32 m0, s34, 0x4000
  s_add_u32 s32, s34, 0x24000
  v_mfma_f32_16x16x32_bf16 v[196:199], v[52:55], a[216:219], v[196:199]
  buffer_load_dwordx4 v5, s[16:19], s32 offen offset:0 nt lds
  buffer_load_dwordx4 v6, s[16:19], s32 offen offset:1024 nt lds
  v_mfma_f32_16x16x32_bf16 v[204:207], v[52:55], a[232:235], v[204:207]
  ds_read_b128 v[52:55], v10 offset:4096
  buffer_load_dwordx4 v5, s[16:19], s32 offen offset:2048 nt lds
  v_mfma_f32_16x16x32_bf16 v[184:187], v[56:59], a[204:207], v[184:187]
  buffer_load_dwordx4 v6, s[16:19], s32 offen offset:3072 nt lds
  s_add_u32 m0, s34, 0x5000
  v_mfma_f32_16x16x32_bf16 v[192:195], v[56:59], a[220:223], v[192:195]
  s_add_u32 s32, s34, 0x25000
  buffer_load_dwordx4 v5, s[16:19], s32 offen offset:0 nt lds
  v_mfma_f32_16x16x32_bf16 v[200:203], v[56:59], a[236:239], v[200:203]
  v_add_u32 v11, 0x10000, v11
  ds_read_b128 v[56:59], v11 offset:0
  buffer_load_dwordx4 v6, s[16:19], s32 offen offset:1024 nt lds
  v_mfma_f32_16x16x32_bf16 v[188:191], v[60:63], a[204:207], v[188:191]
  v_mfma_f32_16x16x32_bf16 v[196:199], v[60:63], a[220:223], v[196:199]
  buffer_load_dwordx4 v5, s[16:19], s32 offen offset:2048 nt lds
  v_mfma_f32_16x16x32_bf16 v[204:207], v[60:63], a[236:239], v[204:207]
  ds_read_b128 v[60:63], v11 offset:4096
  s_waitcnt lgkmcnt(6)
  v_mfma_f32_16x16x32_bf16 v[208:211], v[32:35], a[192:195], 0
  v_mfma_f32_16x16x32_bf16 v[216:219], v[32:35], a[208:211], 0
  v_mfma_f32_16x16x32_bf16 v[224:227], v[32:35], a[224:227], 0
  v_mfma_f32_16x16x32_bf16 v[212:215], v[36:39], a[192:195], 0
  v_mfma_f32_16x16x32_bf16 v[220:223], v[36:39], a[208:211], 0
  v_mfma_f32_16x16x32_bf16 v[228:231], v[36:39], a[224:227], 0
  s_waitcnt lgkmcnt(4)
  v_mfma_f32_16x16x32_bf16 v[208:211], v[40:43], a[196:199], v[208:211]
  v_mfma_f32_16x16x32_bf16 v[216:219], v[40:43], a[212:215], v[216:219]
  v_mfma_f32_16x16x32_bf16 v[224:227], v[40:43], a[228:231], v[224:227]
  buffer_load_dwordx4 v6, s[16:19], s32 offen offset:3072 nt lds
  v_mfma_f32_16x16x32_bf16 v[212:215], v[44:47], a[196:199], v[212:215]
  v_mfma_f32_16x16x32_bf16 v[220:223], v[44:47], a[212:215], v[220:223]
  v_mfma_f32_16x16x32_bf16 v[228:231], v[44:47], a[228:231], v[228:231]
  s_waitcnt lgkmcnt(0)
  v_mfma_f32_16x16x32_bf16 v[208:211], v[48:51], a[200:203], v[208:211]
  s_waitcnt vmcnt(16)
  s_barrier
  ds_read_b128 v[32:35], v8 offset:16384
  ds_read_b128 v[36:39], v8 offset:20480
  v_mfma_f32_16x16x32_bf16 v[216:219], v[48:51], a[216:219], v[216:219]
  ds_read_b128 v[40:43], v9 offset:16384
  ds_read_b128 v[44:47], v9 offset:20480
  v_mfma_f32_16x16x32_bf16 v[224:227], v[48:51], a[232:235], v[224:227]
  ds_read_b128 v[48:51], v10 offset:16384
  s_add_u32 m0, s34, 0x8000
  v_mfma_f32_16x16x32_bf16 v[212:215], v[52:55], a[200:203], v[212:215]
  s_add_u32 s32, s34, 0x28000
  buffer_load_dwordx4 v5, s[16:19], s32 offen offset:0 nt lds
  v_mfma_f32_16x16x32_bf16 v[220:223], v[52:55], a[216:219], v[220:223]
  buffer_load_dwordx4 v6, s[16:19], s32 offen offset:1024 nt lds
  buffer_load_dwordx4 v5, s[16:19], s32 offen offset:2048 nt lds
  v_mfma_f32_16x16x32_bf16 v[228:231], v[52:55], a[232:235], v[228:231]
  ds_read_b128 v[52:55], v10 offset:20480
  buffer_load_dwordx4 v6, s[16:19], s32 offen offset:3072 nt lds
  v_mfma_f32_16x16x32_bf16 v[208:211], v[56:59], a[204:207], v[208:211]
  s_add_u32 m0, s34, 0x9000
  s_add_u32 s32, s34, 0x29000
  v_mfma_f32_16x16x32_bf16 v[216:219], v[56:59], a[220:223], v[216:219]
  buffer_load_dwordx4 v5, s[16:19], s32 offen offset:0 nt lds
  buffer_load_dwordx4 v6, s[16:19], s32 offen offset:1024 nt lds
  v_mfma_f32_16x16x32_bf16 v[224:227], v[56:59], a[236:239], v[224:227]
  ds_read_b128 v[56:59], v11 offset:16384
  v_mfma_f32_16x16x32_bf16 v[212:215], v[60:63], a[204:207], v[212:215]
  v_mfma_f32_16x16x32_bf16 v[220:223], v[60:63], a[220:223], v[220:223]
  buffer_load_dwordx4 v5, s[16:19], s32 offen offset:2048 nt lds
  v_mfma_f32_16x16x32_bf16 v[228:231], v[60:63], a[236:239], v[228:231]
  ds_read_b128 v[60:63], v11 offset:20480
  s_waitcnt lgkmcnt(6)
  v_mfma_f32_16x16x32_bf16 v[232:235], v[32:35], a[192:195], 0
  v_mfma_f32_16x16x32_bf16 v[240:243], v[32:35], a[208:211], 0
  v_mfma_f32_16x16x32_bf16 v[248:251], v[32:35], a[224:227], 0
  v_mfma_f32_16x16x32_bf16 v[236:239], v[36:39], a[192:195], 0
  v_mfma_f32_16x16x32_bf16 v[244:247], v[36:39], a[208:211], 0
  v_mfma_f32_16x16x32_bf16 v[252:255], v[36:39], a[224:227], 0
  s_waitcnt lgkmcnt(4)
  v_mfma_f32_16x16x32_bf16 v[232:235], v[40:43], a[196:199], v[232:235]
  v_mfma_f32_16x16x32_bf16 v[240:243], v[40:43], a[212:215], v[240:243]
  v_mfma_f32_16x16x32_bf16 v[248:251], v[40:43], a[228:231], v[248:251]
  buffer_load_dwordx4 v6, s[16:19], s32 offen offset:3072 nt lds
  v_mfma_f32_16x16x32_bf16 v[236:239], v[44:47], a[196:199], v[236:239]
  v_mfma_f32_16x16x32_bf16 v[244:247], v[44:47], a[212:215], v[244:247]
  v_mfma_f32_16x16x32_bf16 v[252:255], v[44:47], a[228:231], v[252:255]
  s_waitcnt lgkmcnt(0)
  v_mfma_f32_16x16x32_bf16 v[232:235], v[48:51], a[200:203], v[232:235]
  s_barrier
  v_mfma_f32_16x16x32_bf16 v[240:243], v[48:51], a[216:219], v[240:243]
  v_mfma_f32_16x16x32_bf16 v[248:251], v[48:51], a[232:235], v[248:251]
  v_mfma_f32_16x16x32_bf16 v[236:239], v[52:55], a[200:203], v[236:239]
  v_mfma_f32_16x16x32_bf16 v[244:247], v[52:55], a[216:219], v[244:247]
  v_mfma_f32_16x16x32_bf16 v[252:255], v[52:55], a[232:235], v[252:255]
  s_add_u32 m0, s34, 0xc000
  s_add_u32 s32, s34, 0x2c000
  v_mfma_f32_16x16x32_bf16 v[232:235], v[56:59], a[204:207], v[232:235]
  buffer_load_dwordx4 v5, s[16:19], s32 offen offset:0 nt lds
  v_mfma_f32_16x16x32_bf16 v[240:243], v[56:59], a[220:223], v[240:243]
  v_mfma_f32_16x16x32_bf16 v[248:251], v[56:59], a[236:239], v[248:251]
  v_mfma_f32_16x16x32_bf16 v[236:239], v[60:63], a[204:207], v[236:239]
  v_mfma_f32_16x16x32_bf16 v[244:247], v[60:63], a[220:223], v[244:247]
  v_mfma_f32_16x16x32_bf16 v[252:255], v[60:63], a[236:239], v[252:255]
  v_max3_f32 v22, v64, v65, v66
  v_max3_f32 v22, v22, v67, v68
  v_max3_f32 v22, v22, v69, v70
  v_max_f32 v22, v22, v71
  v_max3_f32 v23, v72, v73, v74
  v_max3_f32 v23, v23, v75, v76
  v_max3_f32 v23, v23, v77, v78
  v_max_f32 v23, v23, v79
  v_max3_f32 v24, v80, v81, v82
  v_max3_f32 v24, v24, v83, v84
  v_max3_f32 v24, v24, v85, v86
  v_max_f32 v24, v24, v87
  buffer_load_dwordx4 v6, s[16:19], s32 offen offset:1024 nt lds
  v_max3_f32 v22, v22, v88, v89
  v_max3_f32 v22, v22, v90, v91
  v_max3_f32 v22, v22, v92, v93
  v_max3_f32 v22, v22, v94, v95
  v_max3_f32 v23, v23, v96, v97
  v_max3_f32 v23, v23, v98, v99
  v_max3_f32 v23, v23, v100, v101
  v_max3_f32 v23, v23, v102, v103
  v_max3_f32 v24, v24, v104, v105
  v_max3_f32 v24, v24, v106, v107
  v_max3_f32 v24, v24, v108, v109
  v_max3_f32 v24, v24, v110, v111
  v_max3_f32 v22, v22, v112, v113
  v_max3_f32 v22, v22, v114, v115
  v_max3_f32 v22, v22, v116, v117
  v_max3_f32 v22, v22, v118, v119
  v_max3_f32 v23, v23, v120, v121
  v_max3_f32 v23, v23, v122, v123
  v_max3_f32 v23, v23, v124, v125
  v_max3_f32 v23, v23, v126, v127
  v_max3_f32 v24, v24, v128, v129
  v_max3_f32 v24, v24, v130, v131
  v_max3_f32 v24, v24, v132, v133
  v_max3_f32 v24, v24, v134, v135
  v_max3_f32 v22, v22, v136, v137
  v_max3_f32 v22, v22, v138, v139
  v_max3_f32 v22, v22, v140, v141
  v_max3_f32 v22, v22, v142, v143
  v_max3_f32 v23, v23, v144, v145
  v_max3_f32 v23, v23, v146, v147
  v_max3_f32 v23, v23, v148, v149
  v_max3_f32 v23, v23, v150, v151
  v_max3_f32 v24, v24, v152, v153
  v_max3_f32 v24, v24, v154, v155
  v_max3_f32 v24, v24, v156, v157
  v_max3_f32 v24, v24, v158, v159
  buffer_load_dwordx4 v5, s[16:19], s32 offen offset:2048 nt lds
  v_max3_f32 v22, v22, v160, v161
  v_max3_f32 v22, v22, v162, v163
  v_max3_f32 v22, v22, v164, v165
  v_max3_f32 v22, v22, v166, v167
  v_max3_f32 v23, v23, v168, v169
  v_max3_f32 v23, v23, v170, v171
  v_max3_f32 v23, v23, v172, v173
  v_max3_f32 v23, v23, v174, v175
  v_max3_f32 v24, v24, v176, v177
  v_max3_f32 v24, v24, v178, v179
  v_max3_f32 v24, v24, v180, v181
  v_max3_f32 v24, v24, v182, v183
  v_max3_f32 v22, v22, v184, v185
  v_max3_f32 v22, v22, v186, v187
  v_max3_f32 v22, v22, v188, v189
  v_max3_f32 v22, v22, v190, v191
  v_max3_f32 v23, v23, v192, v193
  v_max3_f32 v23, v23, v194, v195
  v_max3_f32 v23, v23, v196, v197
  v_max3_f32 v23, v23, v198, v199
  v_max3_f32 v24, v24, v200, v201
  v_max3_f32 v24, v24, v202, v203
  v_max3_f32 v24, v24, v204, v205
  v_max3_f32 v24, v24, v206, v207
  v_max3_f32 v22, v22, v208, v209
  v_max3_f32 v22, v22, v210, v211
  v_max3_f32 v22, v22, v212, v213
  v_max3_f32 v22, v22, v214, v215
  v_max3_f32 v23, v23, v216, v217
  v_max3_f32 v23, v23, v218, v219
  v_max3_f32 v23, v23, v220, v221
  v_max3_f32 v23, v23, v222, v223
  v_max3_f32 v24, v24, v224, v225
  v_max3_f32 v24, v24, v226, v227
  v_max3_f32 v24, v24, v228, v229
  v_max3_f32 v24, v24, v230, v231
  buffer_load_dwordx4 v6, s[16:19], s32 offen offset:3072 nt lds
  v_max3_f32 v22, v22, v232, v233
  v_max3_f32 v22, v22, v234, v235
  v_max3_f32 v22, v22, v236, v237
  v_max3_f32 v22, v22, v238, v239
  v_max3_f32 v23, v23, v240, v241
  v_max3_f32 v23, v23, v242, v243
  v_max3_f32 v23, v23, v244, v245
  v_max3_f32 v23, v23, v246, v247
  v_max3_f32 v24, v24, v248, v249
  v_max3_f32 v24, v24, v250, v251
  v_max3_f32 v24, v24, v252, v253
  v_max3_f32 v24, v24, v254, v255
  v_mov_b32 v25, v22
  v_mov_b32 v26, v23
  v_mov_b32 v27, v24
  v_permlane32_swap_b32 v22, v25
  v_permlane32_swap_b32 v23, v26
  v_permlane32_swap_b32 v24, v27
  v_max_f32 v22, v22, v25
  v_max_f32 v23, v23, v26
  v_max_f32 v24, v24, v27
  v_mov_b32 v25, v22
  v_mov_b32 v26, v23
  v_mov_b32 v27, v24
  v_permlane16_swap_b32 v22, v25
  v_permlane16_swap_b32 v23, v26
  v_permlane16_swap_b32 v24, v27
  v_max_f32 v22, v22, v25
  v_max_f32 v23, v23, v26
  v_max_f32 v24, v24, v27
  v_mul_f32 v22, 0xbe0293ee, v22
  v_mul_f32 v23, 0xbe0293ee, v23
  v_mul_f32 v24, 0xbe0293ee, v24
  v_fmamk_f32 v64, v64, 0x3e0293ee, v22
  v_fmamk_f32 v65, v65, 0x3e0293ee, v22
  v_fmamk_f32 v66, v66, 0x3e0293ee, v22
  v_fmamk_f32 v67, v67, 0x3e0293ee, v22
  v_fmamk_f32 v68, v68, 0x3e0293ee, v22
  s_add_u32 m0, s34, 0xd000
  s_add_u32 s32, s34, 0x2d000
  v_fmamk_f32 v69, v69, 0x3e0293ee, v22
  v_fmamk_f32 v70, v70, 0x3e0293ee, v22
  v_fmamk_f32 v71, v71, 0x3e0293ee, v22
  v_exp_f32 v64, v64
  v_exp_f32 v65, v65
  buffer_load_dwordx4 v5, s[16:19], s32 offen offset:0 nt lds
  v_exp_f32 v66, v66
  v_exp_f32 v67, v67
  v_exp_f32 v68, v68
  v_exp_f32 v69, v69
  v_exp_f32 v70, v70
  v_exp_f32 v71, v71
  v_cvt_pk_bf16_f32 v64, v64, v65
  v_cvt_pk_bf16_f32 v65, v66, v67
  v_cvt_pk_bf16_f32 v66, v68, v69
  v_cvt_pk_bf16_f32 v67, v70, v71
  v_fmamk_f32 v72, v72, 0x3e0293ee, v23
  v_fmamk_f32 v73, v73, 0x3e0293ee, v23
  v_fmamk_f32 v74, v74, 0x3e0293ee, v23
  v_fmamk_f32 v75, v75, 0x3e0293ee, v23
  v_fmamk_f32 v76, v76, 0x3e0293ee, v23
  v_fmamk_f32 v77, v77, 0x3e0293ee, v23
  v_fmamk_f32 v78, v78, 0x3e0293ee, v23
  v_fmamk_f32 v79, v79, 0x3e0293ee, v23
  v_exp_f32 v72, v72
  v_exp_f32 v73, v73
  buffer_load_dwordx4 v6, s[16:19], s32 offen offset:1024 nt lds
  v_exp_f32 v74, v74
  v_exp_f32 v75, v75
  v_exp_f32 v76, v76
  v_exp_f32 v77, v77
  v_exp_f32 v78, v78
  v_exp_f32 v79, v79
  v_cvt_pk_bf16_f32 v68, v72, v73
  v_cvt_pk_bf16_f32 v69, v74, v75
  v_cvt_pk_bf16_f32 v70, v76, v77
  v_cvt_pk_bf16_f32 v71, v78, v79
  v_fmamk_f32 v80, v80, 0x3e0293ee, v24
  v_fmamk_f32 v81, v81, 0x3e0293ee, v24
  v_fmamk_f32 v82, v82, 0x3e0293ee, v24
  v_fmamk_f32 v83, v83, 0x3e0293ee, v24
  v_fmamk_f32 v84, v84, 0x3e0293ee, v24
  v_fmamk_f32 v85, v85, 0x3e0293ee, v24
  v_fmamk_f32 v86, v86, 0x3e0293ee, v24
  v_fmamk_f32 v87, v87, 0x3e0293ee, v24
  v_exp_f32 v80, v80
  v_exp_f32 v81, v81
  v_exp_f32 v82, v82
  v_exp_f32 v83, v83
  v_exp_f32 v84, v84
  v_exp_f32 v85, v85
  v_exp_f32 v86, v86
  buffer_load_dwordx4 v5, s[16:19], s32 offen offset:2048 nt lds
  v_exp_f32 v87, v87
  v_cvt_pk_bf16_f32 v72, v80, v81
  v_cvt_pk_bf16_f32 v73, v82, v83
  v_cvt_pk_bf16_f32 v74, v84, v85
  v_cvt_pk_bf16_f32 v75, v86, v87
  v_fmamk_f32 v88, v88, 0x3e0293ee, v22
  v_fmamk_f32 v89, v89, 0x3e0293ee, v22
  v_fmamk_f32 v90, v90, 0x3e0293ee, v22
  v_fmamk_f32 v91, v91, 0x3e0293ee, v22
  v_fmamk_f32 v92, v92, 0x3e0293ee, v22
  v_fmamk_f32 v93, v93, 0x3e0293ee, v22
  v_fmamk_f32 v94, v94, 0x3e0293ee, v22
  v_fmamk_f32 v95, v95, 0x3e0293ee, v22
  v_exp_f32 v88, v88
  v_exp_f32 v89, v89
  v_exp_f32 v90, v90
  v_exp_f32 v91, v91
  v_exp_f32 v92, v92
  v_exp_f32 v93, v93
  v_exp_f32 v94, v94
  v_exp_f32 v95, v95
  v_cvt_pk_bf16_f32 v76, v88, v89
  v_cvt_pk_bf16_f32 v77, v90, v91
  v_cvt_pk_bf16_f32 v78, v92, v93
  v_cvt_pk_bf16_f32 v79, v94, v95
  buffer_load_dwordx4 v6, s[16:19], s32 offen offset:3072 nt lds
  v_fmamk_f32 v96, v96, 0x3e0293ee, v23
  v_fmamk_f32 v97, v97, 0x3e0293ee, v23
  v_fmamk_f32 v98, v98, 0x3e0293ee, v23
  v_fmamk_f32 v99, v99, 0x3e0293ee, v23
  v_fmamk_f32 v100, v100, 0x3e0293ee, v23
  v_fmamk_f32 v101, v101, 0x3e0293ee, v23
  v_fmamk_f32 v102, v102, 0x3e0293ee, v23
  v_fmamk_f32 v103, v103, 0x3e0293ee, v23
  v_exp_f32 v96, v96
  v_exp_f32 v97, v97
  v_exp_f32 v98, v98
  v_exp_f32 v99, v99
  v_exp_f32 v100, v100
  v_exp_f32 v101, v101
  v_exp_f32 v102, v102
  v_exp_f32 v103, v103
  v_cvt_pk_bf16_f32 v80, v96, v97
  v_cvt_pk_bf16_f32 v81, v98, v99
  v_cvt_pk_bf16_f32 v82, v100, v101
  v_cvt_pk_bf16_f32 v83, v102, v103
  v_fmamk_f32 v104, v104, 0x3e0293ee, v24
  v_fmamk_f32 v105, v105, 0x3e0293ee, v24
  v_fmamk_f32 v106, v106, 0x3e0293ee, v24
  v_fmamk_f32 v107, v107, 0x3e0293ee, v24
  v_fmamk_f32 v108, v108, 0x3e0293ee, v24
  s_add_u32 m0, s34, 0x10000
  s_add_u32 s32, s34, 0x30000
  v_fmamk_f32 v109, v109, 0x3e0293ee, v24
  v_fmamk_f32 v110, v110, 0x3e0293ee, v24
  v_fmamk_f32 v111, v111, 0x3e0293ee, v24
  v_exp_f32 v104, v104
  v_exp_f32 v105, v105
  buffer_load_dwordx4 v5, s[16:19], s32 offen offset:0 nt lds
  v_exp_f32 v106, v106
  v_exp_f32 v107, v107
  v_exp_f32 v108, v108
  v_exp_f32 v109, v109
  v_exp_f32 v110, v110
  v_exp_f32 v111, v111
  v_cvt_pk_bf16_f32 v84, v104, v105
  v_cvt_pk_bf16_f32 v85, v106, v107
  v_cvt_pk_bf16_f32 v86, v108, v109
  v_cvt_pk_bf16_f32 v87, v110, v111
  v_fmamk_f32 v112, v112, 0x3e0293ee, v22
  v_fmamk_f32 v113, v113, 0x3e0293ee, v22
  v_fmamk_f32 v114, v114, 0x3e0293ee, v22
  v_fmamk_f32 v115, v115, 0x3e0293ee, v22
  v_fmamk_f32 v116, v116, 0x3e0293ee, v22
  v_fmamk_f32 v117, v117, 0x3e0293ee, v22
  v_fmamk_f32 v118, v118, 0x3e0293ee, v22
  v_fmamk_f32 v119, v119, 0x3e0293ee, v22
  v_exp_f32 v112, v112
  v_exp_f32 v113, v113
  v_exp_f32 v114, v114
  v_exp_f32 v115, v115
  v_exp_f32 v116, v116
  v_exp_f32 v117, v117
  v_exp_f32 v118, v118
  buffer_load_dwordx4 v6, s[16:19], s32 offen offset:1024 nt lds
  v_exp_f32 v119, v119
  v_cvt_pk_bf16_f32 v88, v112, v113
  v_cvt_pk_bf16_f32 v89, v114, v115
  v_cvt_pk_bf16_f32 v90, v116, v117
  v_cvt_pk_bf16_f32 v91, v118, v119
  v_fmamk_f32 v120, v120, 0x3e0293ee, v23
  v_fmamk_f32 v121, v121, 0x3e0293ee, v23
  v_fmamk_f32 v122, v122, 0x3e0293ee, v23
  v_fmamk_f32 v123, v123, 0x3e0293ee, v23
  v_fmamk_f32 v124, v124, 0x3e0293ee, v23
  v_fmamk_f32 v125, v125, 0x3e0293ee, v23
  v_fmamk_f32 v126, v126, 0x3e0293ee, v23
  v_fmamk_f32 v127, v127, 0x3e0293ee, v23
  v_exp_f32 v120, v120
  v_exp_f32 v121, v121
  v_exp_f32 v122, v122
  v_exp_f32 v123, v123
  v_exp_f32 v124, v124
  v_exp_f32 v125, v125
  v_exp_f32 v126, v126
  v_exp_f32 v127, v127
  v_cvt_pk_bf16_f32 v92, v120, v121
  v_cvt_pk_bf16_f32 v93, v122, v123
  v_cvt_pk_bf16_f32 v94, v124, v125
  v_cvt_pk_bf16_f32 v95, v126, v127
  buffer_load_dwordx4 v5, s[16:19], s32 offen offset:2048 nt lds
  v_fmamk_f32 v128, v128, 0x3e0293ee, v24
  v_fmamk_f32 v129, v129, 0x3e0293ee, v24
  v_fmamk_f32 v130, v130, 0x3e0293ee, v24
  v_fmamk_f32 v131, v131, 0x3e0293ee, v24
  v_fmamk_f32 v132, v132, 0x3e0293ee, v24
  v_fmamk_f32 v133, v133, 0x3e0293ee, v24
  v_fmamk_f32 v134, v134, 0x3e0293ee, v24
  v_fmamk_f32 v135, v135, 0x3e0293ee, v24
  v_exp_f32 v128, v128
  v_exp_f32 v129, v129
  v_exp_f32 v130, v130
  v_exp_f32 v131, v131
  v_exp_f32 v132, v132
  v_exp_f32 v133, v133
  v_exp_f32 v134, v134
  v_exp_f32 v135, v135
  v_cvt_pk_bf16_f32 v96, v128, v129
  v_cvt_pk_bf16_f32 v97, v130, v131
  v_cvt_pk_bf16_f32 v98, v132, v133
  v_cvt_pk_bf16_f32 v99, v134, v135
  v_fmamk_f32 v136, v136, 0x3e0293ee, v22
  v_fmamk_f32 v137, v137, 0x3e0293ee, v22
  v_fmamk_f32 v138, v138, 0x3e0293ee, v22
  v_fmamk_f32 v139, v139, 0x3e0293ee, v22
  v_fmamk_f32 v140, v140, 0x3e0293ee, v22
  buffer_load_dwordx4 v6, s[16:19], s32 offen offset:3072 nt lds
  v_fmamk_f32 v141, v141, 0x3e0293ee, v22
  v_fmamk_f32 v142, v142, 0x3e0293ee, v22
  v_fmamk_f32 v143, v143, 0x3e0293ee, v22
  v_exp_f32 v136, v136
  v_exp_f32 v137, v137
  v_exp_f32 v138, v138
  v_exp_f32 v139, v139
  v_exp_f32 v140, v140
  v_exp_f32 v141, v141
  v_exp_f32 v142, v142
  v_exp_f32 v143, v143
  v_cvt_pk_bf16_f32 v100, v136, v137
  v_cvt_pk_bf16_f32 v101, v138, v139
  v_cvt_pk_bf16_f32 v102, v140, v141
  v_cvt_pk_bf16_f32 v103, v142, v143
  v_fmamk_f32 v144, v144, 0x3e0293ee, v23
  v_fmamk_f32 v145, v145, 0x3e0293ee, v23
  v_fmamk_f32 v146, v146, 0x3e0293ee, v23
  v_fmamk_f32 v147, v147, 0x3e0293ee, v23
  v_fmamk_f32 v148, v148, 0x3e0293ee, v23
  v_fmamk_f32 v149, v149, 0x3e0293ee, v23
  v_fmamk_f32 v150, v150, 0x3e0293ee, v23
  v_fmamk_f32 v151, v151, 0x3e0293ee, v23
  v_exp_f32 v144, v144
  v_exp_f32 v145, v145
  s_add_u32 m0, s34, 0x11000
  s_add_u32 s32, s34, 0x31000
  v_exp_f32 v146, v146
  v_exp_f32 v147, v147
  v_exp_f32 v148, v148
  v_exp_f32 v149, v149
  v_exp_f32 v150, v150
  buffer_load_dwordx4 v5, s[16:19], s32 offen offset:0 nt lds
  v_exp_f32 v151, v151
  v_cvt_pk_bf16_f32 v104, v144, v145
  v_cvt_pk_bf16_f32 v105, v146, v147
  v_cvt_pk_bf16_f32 v106, v148, v149
  v_cvt_pk_bf16_f32 v107, v150, v151
  v_fmamk_f32 v152, v152, 0x3e0293ee, v24
  v_fmamk_f32 v153, v153, 0x3e0293ee, v24
  v_fmamk_f32 v154, v154, 0x3e0293ee, v24
  v_fmamk_f32 v155, v155, 0x3e0293ee, v24
  v_fmamk_f32 v156, v156, 0x3e0293ee, v24
  v_fmamk_f32 v157, v157, 0x3e0293ee, v24
  v_fmamk_f32 v158, v158, 0x3e0293ee, v24
  v_fmamk_f32 v159, v159, 0x3e0293ee, v24
  v_exp_f32 v152, v152
  v_exp_f32 v153, v153
  v_exp_f32 v154, v154
  v_exp_f32 v155, v155
  v_exp_f32 v156, v156
  v_exp_f32 v157, v157
  v_exp_f32 v158, v158
  buffer_load_dwordx4 v6, s[16:19], s32 offen offset:1024 nt lds
  v_exp_f32 v159, v159
  v_cvt_pk_bf16_f32 v108, v152, v153
  v_cvt_pk_bf16_f32 v109, v154, v155
  v_cvt_pk_bf16_f32 v110, v156, v157
  v_cvt_pk_bf16_f32 v111, v158, v159
  v_fmamk_f32 v160, v160, 0x3e0293ee, v22
  v_fmamk_f32 v161, v161, 0x3e0293ee, v22
  v_fmamk_f32 v162, v162, 0x3e0293ee, v22
  v_fmamk_f32 v163, v163, 0x3e0293ee, v22
  v_fmamk_f32 v164, v164, 0x3e0293ee, v22
  v_fmamk_f32 v165, v165, 0x3e0293ee, v22
  v_fmamk_f32 v166, v166, 0x3e0293ee, v22
  v_fmamk_f32 v167, v167, 0x3e0293ee, v22
  v_exp_f32 v160, v160
  v_exp_f32 v161, v161
  v_exp_f32 v162, v162
  v_exp_f32 v163, v163
  v_exp_f32 v164, v164
  v_exp_f32 v165, v165
  v_exp_f32 v166, v166
  v_exp_f32 v167, v167
  v_cvt_pk_bf16_f32 v112, v160, v161
  v_cvt_pk_bf16_f32 v113, v162, v163
  v_cvt_pk_bf16_f32 v114, v164, v165
  v_cvt_pk_bf16_f32 v115, v166, v167
  buffer_load_dwordx4 v5, s[16:19], s32 offen offset:2048 nt lds
  v_fmamk_f32 v168, v168, 0x3e0293ee, v23
  v_fmamk_f32 v169, v169, 0x3e0293ee, v23
  v_fmamk_f32 v170, v170, 0x3e0293ee, v23
  v_fmamk_f32 v171, v171, 0x3e0293ee, v23
  v_fmamk_f32 v172, v172, 0x3e0293ee, v23
  v_fmamk_f32 v173, v173, 0x3e0293ee, v23
  v_fmamk_f32 v174, v174, 0x3e0293ee, v23
  v_fmamk_f32 v175, v175, 0x3e0293ee, v23
  v_exp_f32 v168, v168
  v_exp_f32 v169, v169
  v_exp_f32 v170, v170
  v_exp_f32 v171, v171
  v_exp_f32 v172, v172
  v_exp_f32 v173, v173
  v_exp_f32 v174, v174
  v_exp_f32 v175, v175
  v_cvt_pk_bf16_f32 v116, v168, v169
  v_cvt_pk_bf16_f32 v117, v170, v171
  v_cvt_pk_bf16_f32 v118, v172, v173
  v_cvt_pk_bf16_f32 v119, v174, v175
  v_fmamk_f32 v176, v176, 0x3e0293ee, v24
  v_fmamk_f32 v177, v177, 0x3e0293ee, v24
  v_fmamk_f32 v178, v178, 0x3e0293ee, v24
  v_fmamk_f32 v179, v179, 0x3e0293ee, v24
  v_fmamk_f32 v180, v180, 0x3e0293ee, v24
  v_fmamk_f32 v181, v181, 0x3e0293ee, v24
  v_fmamk_f32 v182, v182, 0x3e0293ee, v24
  v_fmamk_f32 v183, v183, 0x3e0293ee, v24
  v_exp_f32 v176, v176
  v_exp_f32 v177, v177
  buffer_load_dwordx4 v6, s[16:19], s32 offen offset:3072 nt lds
  v_exp_f32 v178, v178
  v_exp_f32 v179, v179
  v_exp_f32 v180, v180
  v_exp_f32 v181, v181
  v_exp_f32 v182, v182
  v_exp_f32 v183, v183
  v_cvt_pk_bf16_f32 v120, v176, v177
  v_cvt_pk_bf16_f32 v121, v178, v179
  v_cvt_pk_bf16_f32 v122, v180, v181
  v_cvt_pk_bf16_f32 v123, v182, v183
  v_fmamk_f32 v184, v184, 0x3e0293ee, v22
  v_fmamk_f32 v185, v185, 0x3e0293ee, v22
  v_fmamk_f32 v186, v186, 0x3e0293ee, v22
  v_fmamk_f32 v187, v187, 0x3e0293ee, v22
  v_fmamk_f32 v188, v188, 0x3e0293ee, v22
  v_fmamk_f32 v189, v189, 0x3e0293ee, v22
  v_fmamk_f32 v190, v190, 0x3e0293ee, v22
  v_fmamk_f32 v191, v191, 0x3e0293ee, v22
  v_exp_f32 v184, v184
  v_exp_f32 v185, v185
  v_exp_f32 v186, v186
  v_exp_f32 v187, v187
  v_exp_f32 v188, v188
  v_exp_f32 v189, v189
  v_exp_f32 v190, v190
  s_add_u32 m0, s34, 0x14000
  s_add_u32 s32, s34, 0x34000
  v_exp_f32 v191, v191
  v_cvt_pk_bf16_f32 v124, v184, v185
  v_cvt_pk_bf16_f32 v125, v186, v187
  v_cvt_pk_bf16_f32 v126, v188, v189
  v_cvt_pk_bf16_f32 v127, v190, v191
  buffer_load_dwordx4 v5, s[16:19], s32 offen offset:0 nt lds
  v_fmamk_f32 v192, v192, 0x3e0293ee, v23
  v_fmamk_f32 v193, v193, 0x3e0293ee, v23
  v_fmamk_f32 v194, v194, 0x3e0293ee, v23
  v_fmamk_f32 v195, v195, 0x3e0293ee, v23
  v_fmamk_f32 v196, v196, 0x3e0293ee, v23
  v_fmamk_f32 v197, v197, 0x3e0293ee, v23
  v_fmamk_f32 v198, v198, 0x3e0293ee, v23
  v_fmamk_f32 v199, v199, 0x3e0293ee, v23
  v_exp_f32 v192, v192
  v_exp_f32 v193, v193
  v_exp_f32 v194, v194
  v_exp_f32 v195, v195
  v_exp_f32 v196, v196
  v_exp_f32 v197, v197
  v_exp_f32 v198, v198
  v_exp_f32 v199, v199
  v_cvt_pk_bf16_f32 v128, v192, v193
  v_cvt_pk_bf16_f32 v129, v194, v195
  v_cvt_pk_bf16_f32 v130, v196, v197
  v_cvt_pk_bf16_f32 v131, v198, v199
  buffer_load_dwordx4 v6, s[16:19], s32 offen offset:1024 nt lds
  v_fmamk_f32 v200, v200, 0x3e0293ee, v24
  v_fmamk_f32 v201, v201, 0x3e0293ee, v24
  v_fmamk_f32 v202, v202, 0x3e0293ee, v24
  v_fmamk_f32 v203, v203, 0x3e0293ee, v24
  v_fmamk_f32 v204, v204, 0x3e0293ee, v24
  v_fmamk_f32 v205, v205, 0x3e0293ee, v24
  v_fmamk_f32 v206, v206, 0x3e0293ee, v24
  v_fmamk_f32 v207, v207, 0x3e0293ee, v24
  v_exp_f32 v200, v200
  v_exp_f32 v201, v201
  v_exp_f32 v202, v202
  v_exp_f32 v203, v203
  v_exp_f32 v204, v204
  v_exp_f32 v205, v205
  v_exp_f32 v206, v206
  v_exp_f32 v207, v207
  v_cvt_pk_bf16_f32 v132, v200, v201
  v_cvt_pk_bf16_f32 v133, v202, v203
  v_cvt_pk_bf16_f32 v134, v204, v205
  v_cvt_pk_bf16_f32 v135, v206, v207
  s_waitcnt vmcnt(34)
  s_barrier
  v_fmamk_f32 v208, v208, 0x3e0293ee, v22
  v_fmamk_f32 v209, v209, 0x3e0293ee, v22
  v_fmamk_f32 v210, v210, 0x3e0293ee, v22
  v_fmamk_f32 v211, v211, 0x3e0293ee, v22
  v_fmamk_f32 v212, v212, 0x3e0293ee, v22
  ds_read_b64_tr_b16 v[32:33], v12 offset:0
  v_fmamk_f32 v213, v213, 0x3e0293ee, v22
  v_fmamk_f32 v214, v214, 0x3e0293ee, v22
  v_fmamk_f32 v215, v215, 0x3e0293ee, v22
  v_exp_f32 v208, v208
  v_exp_f32 v209, v209
  ds_read_b64_tr_b16 v[34:35], v12 offset:4096
  v_exp_f32 v210, v210
  v_exp_f32 v211, v211
  v_exp_f32 v212, v212
  v_exp_f32 v213, v213
  v_exp_f32 v214, v214
  ds_read_b64_tr_b16 v[36:37], v13 offset:0
  v_exp_f32 v215, v215
  v_cvt_pk_bf16_f32 v136, v208, v209
  v_cvt_pk_bf16_f32 v137, v210, v211
  v_cvt_pk_bf16_f32 v138, v212, v213
  v_cvt_pk_bf16_f32 v139, v214, v215
  ds_read_b64_tr_b16 v[38:39], v13 offset:4096
  v_fmamk_f32 v216, v216, 0x3e0293ee, v23
  v_fmamk_f32 v217, v217, 0x3e0293ee, v23
  v_fmamk_f32 v218, v218, 0x3e0293ee, v23
  v_fmamk_f32 v219, v219, 0x3e0293ee, v23
  v_fmamk_f32 v220, v220, 0x3e0293ee, v23
  ds_read_b64_tr_b16 v[40:41], v14 offset:0
  v_fmamk_f32 v221, v221, 0x3e0293ee, v23
  v_fmamk_f32 v222, v222, 0x3e0293ee, v23
  v_fmamk_f32 v223, v223, 0x3e0293ee, v23
  v_exp_f32 v216, v216
  v_exp_f32 v217, v217
  ds_read_b64_tr_b16 v[42:43], v14 offset:4096
  v_exp_f32 v218, v218
  v_exp_f32 v219, v219
  v_exp_f32 v220, v220
  v_exp_f32 v221, v221
  v_exp_f32 v222, v222
  ds_read_b64_tr_b16 v[44:45], v15 offset:0
  v_exp_f32 v223, v223
  v_cvt_pk_bf16_f32 v140, v216, v217
  v_cvt_pk_bf16_f32 v141, v218, v219
  v_cvt_pk_bf16_f32 v142, v220, v221
  v_cvt_pk_bf16_f32 v143, v222, v223
  ds_read_b64_tr_b16 v[46:47], v15 offset:4096
  v_fmamk_f32 v224, v224, 0x3e0293ee, v24
  v_fmamk_f32 v225, v225, 0x3e0293ee, v24
  v_fmamk_f32 v226, v226, 0x3e0293ee, v24
  v_fmamk_f32 v227, v227, 0x3e0293ee, v24
  v_fmamk_f32 v228, v228, 0x3e0293ee, v24
  ds_read_b64_tr_b16 v[48:49], v16 offset:0
  v_fmamk_f32 v229, v229, 0x3e0293ee, v24
  v_fmamk_f32 v230, v230, 0x3e0293ee, v24
  v_fmamk_f32 v231, v231, 0x3e0293ee, v24
  v_exp_f32 v224, v224
  v_exp_f32 v225, v225
  ds_read_b64_tr_b16 v[50:51], v16 offset:4096
  v_exp_f32 v226, v226
  v_exp_f32 v227, v227
  v_exp_f32 v228, v228
  v_exp_f32 v229, v229
  v_exp_f32 v230, v230
  ds_read_b64_tr_b16 v[52:53], v17 offset:0
  v_exp_f32 v231, v231
  v_cvt_pk_bf16_f32 v144, v224, v225
  v_cvt_pk_bf16_f32 v145, v226, v227
  v_cvt_pk_bf16_f32 v146, v228, v229
  v_cvt_pk_bf16_f32 v147, v230, v231
  ds_read_b64_tr_b16 v[54:55], v17 offset:4096
  v_fmamk_f32 v232, v232, 0x3e0293ee, v22
  v_fmamk_f32 v233, v233, 0x3e0293ee, v22
  v_fmamk_f32 v234, v234, 0x3e0293ee, v22
  v_fmamk_f32 v235, v235, 0x3e0293ee, v22
  v_fmamk_f32 v236, v236, 0x3e0293ee, v22
  ds_read_b64_tr_b16 v[56:57], v18 offset:0
  v_fmamk_f32 v237, v237, 0x3e0293ee, v22
  v_fmamk_f32 v238, v238, 0x3e0293ee, v22
  v_fmamk_f32 v239, v239, 0x3e0293ee, v22
  v_exp_f32 v232, v232
  v_exp_f32 v233, v233
  ds_read_b64_tr_b16 v[58:59], v18 offset:4096
  v_exp_f32 v234, v234
  v_exp_f32 v235, v235
  v_exp_f32 v236, v236
  v_exp_f32 v237, v237
  v_exp_f32 v238, v238
  ds_read_b64_tr_b16 v[60:61], v19 offset:0
  v_exp_f32 v239, v239
  v_cvt_pk_bf16_f32 v148, v232, v233
  v_cvt_pk_bf16_f32 v149, v234, v235
  v_cvt_pk_bf16_f32 v150, v236, v237
  v_cvt_pk_bf16_f32 v151, v238, v239
  ds_read_b64_tr_b16 v[62:63], v19 offset:4096
  v_fmamk_f32 v240, v240, 0x3e0293ee, v23
  v_fmamk_f32 v241, v241, 0x3e0293ee, v23
  v_fmamk_f32 v242, v242, 0x3e0293ee, v23
  v_fmamk_f32 v243, v243, 0x3e0293ee, v23
  v_fmamk_f32 v244, v244, 0x3e0293ee, v23
  buffer_load_dwordx4 v5, s[16:19], s32 offen offset:2048 nt lds
  buffer_load_dwordx4 v6, s[16:19], s32 offen offset:3072 nt lds
  v_fmamk_f32 v245, v245, 0x3e0293ee, v23
  v_fmamk_f32 v246, v246, 0x3e0293ee, v23
  v_fmamk_f32 v247, v247, 0x3e0293ee, v23
  v_exp_f32 v240, v240
  v_exp_f32 v241, v241
  s_add_u32 m0, s34, 0x15000
  s_add_u32 s32, s34, 0x35000
  v_exp_f32 v242, v242
  v_exp_f32 v243, v243
  v_exp_f32 v244, v244
  v_exp_f32 v245, v245
  v_exp_f32 v246, v246
  buffer_load_dwordx4 v5, s[16:19], s32 offen offset:0 nt lds
  buffer_load_dwordx4 v6, s[16:19], s32 offen offset:1024 nt lds
  v_exp_f32 v247, v247
  v_cvt_pk_bf16_f32 v152, v240, v241
  v_cvt_pk_bf16_f32 v153, v242, v243
  v_cvt_pk_bf16_f32 v154, v244, v245
  v_cvt_pk_bf16_f32 v155, v246, v247
  v_fmamk_f32 v248, v248, 0x3e0293ee, v24
  v_fmamk_f32 v249, v249, 0x3e0293ee, v24
  v_fmamk_f32 v250, v250, 0x3e0293ee, v24
  v_fmamk_f32 v251, v251, 0x3e0293ee, v24
  v_fmamk_f32 v252, v252, 0x3e0293ee, v24
  v_fmamk_f32 v253, v253, 0x3e0293ee, v24
  v_fmamk_f32 v254, v254, 0x3e0293ee, v24
  v_fmamk_f32 v255, v255, 0x3e0293ee, v24
  v_exp_f32 v248, v248
  v_exp_f32 v249, v249
  buffer_load_dwordx4 v5, s[16:19], s32 offen offset:2048 nt lds
  v_exp_f32 v250, v250
  v_exp_f32 v251, v251
  v_exp_f32 v252, v252
  v_exp_f32 v253, v253
  v_exp_f32 v254, v254
  v_exp_f32 v255, v255
  v_cvt_pk_bf16_f32 v156, v248, v249
  v_cvt_pk_bf16_f32 v157, v250, v251
  v_cvt_pk_bf16_f32 v158, v252, v253
  v_cvt_pk_bf16_f32 v159, v254, v255
  s_waitcnt lgkmcnt(12)
  v_mfma_f32_16x16x32_bf16 v[160:163], v[32:35], v[64:67], 0
  v_mfma_f32_16x16x32_bf16 v[164:167], v[32:35], v[68:71], 0
  v_mfma_f32_16x16x32_bf16 v[168:171], v[32:35], v[72:75], 0
  v_mfma_f32_16x16x32_bf16 v[172:175], v[36:39], v[64:67], 0
  buffer_load_dwordx4 v6, s[16:19], s32 offen offset:3072 nt lds
  v_mfma_f32_16x16x32_bf16 v[176:179], v[36:39], v[68:71], 0
  v_mfma_f32_16x16x32_bf16 v[180:183], v[36:39], v[72:75], 0
  s_waitcnt lgkmcnt(8)
  v_mfma_f32_16x16x32_bf16 v[184:187], v[40:43], v[64:67], 0
  v_mfma_f32_16x16x32_bf16 v[188:191], v[40:43], v[68:71], 0
  v_mfma_f32_16x16x32_bf16 v[192:195], v[40:43], v[72:75], 0
  v_mfma_f32_16x16x32_bf16 v[196:199], v[44:47], v[64:67], 0
  v_mfma_f32_16x16x32_bf16 v[200:203], v[44:47], v[68:71], 0
  v_mfma_f32_16x16x32_bf16 v[204:207], v[44:47], v[72:75], 0
  s_waitcnt lgkmcnt(0)
  v_mfma_f32_16x16x32_bf16 v[208:211], v[48:51], v[64:67], 0
  s_waitcnt vmcnt(32)
  s_barrier
  ds_read_b64_tr_b16 v[32:33], v12 offset:16384
  ds_read_b64_tr_b16 v[34:35], v12 offset:20480
  v_mfma_f32_16x16x32_bf16 v[212:215], v[48:51], v[68:71], 0
  ds_read_b64_tr_b16 v[36:37], v13 offset:16384
  ds_read_b64_tr_b16 v[38:39], v13 offset:20480
  v_mfma_f32_16x16x32_bf16 v[216:219], v[48:51], v[72:75], 0
  ds_read_b64_tr_b16 v[40:41], v14 offset:16384
  ds_read_b64_tr_b16 v[42:43], v14 offset:20480
  v_mfma_f32_16x16x32_bf16 v[220:223], v[52:55], v[64:67], 0
  ds_read_b64_tr_b16 v[44:45], v15 offset:16384
  ds_read_b64_tr_b16 v[46:47], v15 offset:20480
  v_mfma_f32_16x16x32_bf16 v[224:227], v[52:55], v[68:71], 0
  ds_read_b64_tr_b16 v[48:49], v16 offset:16384
  ds_read_b64_tr_b16 v[50:51], v16 offset:20480
  v_mfma_f32_16x16x32_bf16 v[228:231], v[52:55], v[72:75], 0
  ds_read_b64_tr_b16 v[52:53], v17 offset:16384
  ds_read_b64_tr_b16 v[54:55], v17 offset:20480
  v_mfma_f32_16x16x32_bf16 v[232:235], v[56:59], v[64:67], 0
  s_add_u32 m0, s34, 0x0
  s_add_u32 s32, s34, 0x38000
  v_mfma_f32_16x16x32_bf16 v[236:239], v[56:59], v[68:71], 0
  buffer_load_dwordx4 v5, s[16:19], s32 offen offset:0 nt lds
  v_mfma_f32_16x16x32_bf16 v[240:243], v[56:59], v[72:75], 0
  ds_read_b64_tr_b16 v[56:57], v18 offset:16384
  ds_read_b64_tr_b16 v[58:59], v18 offset:20480
  v_mfma_f32_16x16x32_bf16 v[244:247], v[60:63], v[64:67], 0
  buffer_load_dwordx4 v6, s[16:19], s32 offen offset:1024 nt lds
  v_mfma_f32_16x16x32_bf16 v[248:251], v[60:63], v[68:71], 0
  v_mfma_f32_16x16x32_bf16 v[252:255], v[60:63], v[72:75], 0
  ds_read_b64_tr_b16 v[60:61], v19 offset:16384
  ds_read_b64_tr_b16 v[62:63], v19 offset:20480
  v_mfma_f32_16x16x32_bf16 a[240:243], a[252:255], v[64:67], 0
  v_mfma_f32_16x16x32_bf16 a[244:247], a[252:255], v[68:71], 0
  v_mfma_f32_16x16x32_bf16 a[248:251], a[252:255], v[72:75], 0
  s_waitcnt lgkmcnt(12)
  v_mfma_f32_16x16x32_bf16 v[160:163], v[32:35], v[76:79], v[160:163]
  v_mfma_f32_16x16x32_bf16 v[164:167], v[32:35], v[80:83], v[164:167]
  v_mfma_f32_16x16x32_bf16 v[168:171], v[32:35], v[84:87], v[168:171]
  v_mfma_f32_16x16x32_bf16 v[172:175], v[36:39], v[76:79], v[172:175]
  buffer_load_dwordx4 v5, s[16:19], s32 offen offset:2048 nt lds
  v_mfma_f32_16x16x32_bf16 v[176:179], v[36:39], v[80:83], v[176:179]
  v_mfma_f32_16x16x32_bf16 v[180:183], v[36:39], v[84:87], v[180:183]
  s_waitcnt lgkmcnt(8)
  v_mfma_f32_16x16x32_bf16 v[184:187], v[40:43], v[76:79], v[184:187]
  v_mfma_f32_16x16x32_bf16 v[188:191], v[40:43], v[80:83], v[188:191]
  v_mfma_f32_16x16x32_bf16 v[192:195], v[40:43], v[84:87], v[192:195]
  v_mfma_f32_16x16x32_bf16 v[196:199], v[44:47], v[76:79], v[196:199]
  v_mfma_f32_16x16x32_bf16 v[200:203], v[44:47], v[80:83], v[200:203]
  v_mfma_f32_16x16x32_bf16 v[204:207], v[44:47], v[84:87], v[204:207]
  buffer_load_dwordx4 v6, s[16:19], s32 offen offset:3072 nt lds
  s_waitcnt lgkmcnt(0)
  v_mfma_f32_16x16x32_bf16 v[208:211], v[48:51], v[76:79], v[208:211]
  s_waitcnt vmcnt(28)
  s_barrier
  ds_read_b64_tr_b16 v[32:33], v12 offset:32768
  ds_read_b64_tr_b16 v[34:35], v12 offset:36864
  v_mfma_f32_16x16x32_bf16 v[212:215], v[48:51], v[80:83], v[212:215]
  ds_read_b64_tr_b16 v[36:37], v13 offset:32768
  ds_read_b64_tr_b16 v[38:39], v13 offset:36864
  v_mfma_f32_16x16x32_bf16 v[216:219], v[48:51], v[84:87], v[216:219]
  ds_read_b64_tr_b16 v[40:41], v14 offset:32768
  ds_read_b64_tr_b16 v[42:43], v14 offset:36864
  v_mfma_f32_16x16x32_bf16 v[220:223], v[52:55], v[76:79], v[220:223]
  ds_read_b64_tr_b16 v[44:45], v15 offset:32768
  ds_read_b64_tr_b16 v[46:47], v15 offset:36864
  v_mfma_f32_16x16x32_bf16 v[224:227], v[52:55], v[80:83], v[224:227]
  ds_read_b64_tr_b16 v[48:49], v16 offset:32768
  ds_read_b64_tr_b16 v[50:51], v16 offset:36864
  v_mfma_f32_16x16x32_bf16 v[228:231], v[52:55], v[84:87], v[228:231]
  ds_read_b64_tr_b16 v[52:53], v17 offset:32768
  ds_read_b64_tr_b16 v[54:55], v17 offset:36864
  v_mfma_f32_16x16x32_bf16 v[232:235], v[56:59], v[76:79], v[232:235]
  v_mfma_f32_16x16x32_bf16 v[236:239], v[56:59], v[80:83], v[236:239]
  v_mfma_f32_16x16x32_bf16 v[240:243], v[56:59], v[84:87], v[240:243]
  ds_read_b64_tr_b16 v[56:57], v18 offset:32768
  ds_read_b64_tr_b16 v[58:59], v18 offset:36864
  v_mfma_f32_16x16x32_bf16 v[244:247], v[60:63], v[76:79], v[244:247]
  s_add_u32 m0, s34, 0x1000
  s_add_u32 s32, s34, 0x39000
  v_mfma_f32_16x16x32_bf16 v[248:251], v[60:63], v[80:83], v[248:251]
  buffer_load_dwordx4 v5, s[16:19], s32 offen offset:0 nt lds
  v_mfma_f32_16x16x32_bf16 v[252:255], v[60:63], v[84:87], v[252:255]
  ds_read_b64_tr_b16 v[60:61], v19 offset:32768
  ds_read_b64_tr_b16 v[62:63], v19 offset:36864
  v_mfma_f32_16x16x32_bf16 a[240:243], a[252:255], v[76:79], a[240:243]
  v_mfma_f32_16x16x32_bf16 a[244:247], a[252:255], v[80:83], a[244:247]
  v_mfma_f32_16x16x32_bf16 a[248:251], a[252:255], v[84:87], a[248:251]
  s_waitcnt lgkmcnt(12)
  v_mfma_f32_16x16x32_bf16 v[160:163], v[32:35], v[88:91], v[160:163]
  v_mfma_f32_16x16x32_bf16 v[164:167], v[32:35], v[92:95], v[164:167]
  buffer_load_dwordx4 v6, s[16:19], s32 offen offset:1024 nt lds
  v_mfma_f32_16x16x32_bf16 v[168:171], v[32:35], v[96:99], v[168:171]
  v_mfma_f32_16x16x32_bf16 v[172:175], v[36:39], v[88:91], v[172:175]
  v_mfma_f32_16x16x32_bf16 v[176:179], v[36:39], v[92:95], v[176:179]
  v_mfma_f32_16x16x32_bf16 v[180:183], v[36:39], v[96:99], v[180:183]
  s_waitcnt lgkmcnt(8)
  v_mfma_f32_16x16x32_bf16 v[184:187], v[40:43], v[88:91], v[184:187]
  v_mfma_f32_16x16x32_bf16 v[188:191], v[40:43], v[92:95], v[188:191]
  v_mfma_f32_16x16x32_bf16 v[192:195], v[40:43], v[96:99], v[192:195]
  v_mfma_f32_16x16x32_bf16 v[196:199], v[44:47], v[88:91], v[196:199]
  v_mfma_f32_16x16x32_bf16 v[200:203], v[44:47], v[92:95], v[200:203]
  buffer_load_dwordx4 v5, s[16:19], s32 offen offset:2048 nt lds
  v_mfma_f32_16x16x32_bf16 v[204:207], v[44:47], v[96:99], v[204:207]
  s_waitcnt lgkmcnt(0)
  v_mfma_f32_16x16x32_bf16 v[208:211], v[48:51], v[88:91], v[208:211]
  s_waitcnt vmcnt(23)
  s_barrier
  ds_read_b64_tr_b16 v[32:33], v12 offset:49152
  ds_read_b64_tr_b16 v[34:35], v12 offset:53248
  v_mfma_f32_16x16x32_bf16 v[212:215], v[48:51], v[92:95], v[212:215]
  ds_read_b64_tr_b16 v[36:37], v13 offset:49152
  ds_read_b64_tr_b16 v[38:39], v13 offset:53248
  v_mfma_f32_16x16x32_bf16 v[216:219], v[48:51], v[96:99], v[216:219]
  ds_read_b64_tr_b16 v[40:41], v14 offset:49152
  ds_read_b64_tr_b16 v[42:43], v14 offset:53248
  v_mfma_f32_16x16x32_bf16 v[220:223], v[52:55], v[88:91], v[220:223]
  ds_read_b64_tr_b16 v[44:45], v15 offset:49152
  ds_read_b64_tr_b16 v[46:47], v15 offset:53248
  v_mfma_f32_16x16x32_bf16 v[224:227], v[52:55], v[92:95], v[224:227]
  ds_read_b64_tr_b16 v[48:49], v16 offset:49152
  ds_read_b64_tr_b16 v[50:51], v16 offset:53248
  v_mfma_f32_16x16x32_bf16 v[228:231], v[52:55], v[96:99], v[228:231]
  ds_read_b64_tr_b16 v[52:53], v17 offset:49152
  ds_read_b64_tr_b16 v[54:55], v17 offset:53248
  v_mfma_f32_16x16x32_bf16 v[232:235], v[56:59], v[88:91], v[232:235]
  buffer_load_dwordx4 v6, s[16:19], s32 offen offset:3072 nt lds
  v_mfma_f32_16x16x32_bf16 v[236:239], v[56:59], v[92:95], v[236:239]
  v_mfma_f32_16x16x32_bf16 v[240:243], v[56:59], v[96:99], v[240:243]
  ds_read_b64_tr_b16 v[56:57], v18 offset:49152
  ds_read_b64_tr_b16 v[58:59], v18 offset:53248
  v_mfma_f32_16x16x32_bf16 v[244:247], v[60:63], v[88:91], v[244:247]
  v_mfma_f32_16x16x32_bf16 v[248:251], v[60:63], v[92:95], v[248:251]
  v_mfma_f32_16x16x32_bf16 v[252:255], v[60:63], v[96:99], v[252:255]
  ds_read_b64_tr_b16 v[60:61], v19 offset:49152
  ds_read_b64_tr_b16 v[62:63], v19 offset:53248
  v_mfma_f32_16x16x32_bf16 a[240:243], a[252:255], v[88:91], a[240:243]
  v_mfma_f32_16x16x32_bf16 a[244:247], a[252:255], v[92:95], a[244:247]
  v_mfma_f32_16x16x32_bf16 a[248:251], a[252:255], v[96:99], a[248:251]
  s_waitcnt lgkmcnt(12)
  v_mfma_f32_16x16x32_bf16 v[160:163], v[32:35], v[100:103], v[160:163]
  s_add_u32 m0, s34, 0x4000
  s_add_u32 s32, s34, 0x3c000
  v_mfma_f32_16x16x32_bf16 v[164:167], v[32:35], v[104:107], v[164:167]
  buffer_load_dwordx4 v5, s[16:19], s32 offen offset:0 nt lds
  v_mfma_f32_16x16x32_bf16 v[168:171], v[32:35], v[108:111], v[168:171]
  v_mfma_f32_16x16x32_bf16 v[172:175], v[36:39], v[100:103], v[172:175]
  v_mfma_f32_16x16x32_bf16 v[176:179], v[36:39], v[104:107], v[176:179]
  v_mfma_f32_16x16x32_bf16 v[180:183], v[36:39], v[108:111], v[180:183]
  s_waitcnt lgkmcnt(8)
  v_mfma_f32_16x16x32_bf16 v[184:187], v[40:43], v[100:103], v[184:187]
  v_mfma_f32_16x16x32_bf16 v[188:191], v[40:43], v[104:107], v[188:191]
  v_mfma_f32_16x16x32_bf16 v[192:195], v[40:43], v[108:111], v[192:195]
  buffer_load_dwordx4 v6, s[16:19], s32 offen offset:1024 nt lds
  v_mfma_f32_16x16x32_bf16 v[196:199], v[44:47], v[100:103], v[196:199]
  v_mfma_f32_16x16x32_bf16 v[200:203], v[44:47], v[104:107], v[200:203]
  v_mfma_f32_16x16x32_bf16 v[204:207], v[44:47], v[108:111], v[204:207]
  s_waitcnt lgkmcnt(0)
  v_mfma_f32_16x16x32_bf16 v[208:211], v[48:51], v[100:103], v[208:211]
  s_waitcnt vmcnt(18)
  s_barrier
  v_add_u32 v12, 0x10000, v12
  ds_read_b64_tr_b16 v[32:33], v12 offset:0
  ds_read_b64_tr_b16 v[34:35], v12 offset:4096
  v_mfma_f32_16x16x32_bf16 v[212:215], v[48:51], v[104:107], v[212:215]
  v_add_u32 v13, 0x10000, v13
  ds_read_b64_tr_b16 v[36:37], v13 offset:0
  ds_read_b64_tr_b16 v[38:39], v13 offset:4096
  v_mfma_f32_16x16x32_bf16 v[216:219], v[48:51], v[108:111], v[216:219]
  v_add_u32 v14, 0x10000, v14
  ds_read_b64_tr_b16 v[40:41], v14 offset:0
  ds_read_b64_tr_b16 v[42:43], v14 offset:4096
  v_mfma_f32_16x16x32_bf16 v[220:223], v[52:55], v[100:103], v[220:223]
  v_add_u32 v15, 0x10000, v15
  ds_read_b64_tr_b16 v[44:45], v15 offset:0
  ds_read_b64_tr_b16 v[46:47], v15 offset:4096
  v_mfma_f32_16x16x32_bf16 v[224:227], v[52:55], v[104:107], v[224:227]
  v_add_u32 v16, 0x10000, v16
  ds_read_b64_tr_b16 v[48:49], v16 offset:0
  ds_read_b64_tr_b16 v[50:51], v16 offset:4096
  v_mfma_f32_16x16x32_bf16 v[228:231], v[52:55], v[108:111], v[228:231]
  v_add_u32 v17, 0x10000, v17
  ds_read_b64_tr_b16 v[52:53], v17 offset:0
  ds_read_b64_tr_b16 v[54:55], v17 offset:4096
  v_mfma_f32_16x16x32_bf16 v[232:235], v[56:59], v[100:103], v[232:235]
  buffer_load_dwordx4 v5, s[16:19], s32 offen offset:2048 nt lds
  buffer_load_dwordx4 v6, s[16:19], s32 offen offset:3072 nt lds
  v_mfma_f32_16x16x32_bf16 v[236:239], v[56:59], v[104:107], v[236:239]
  s_add_u32 m0, s34, 0x5000
  s_add_u32 s32, s34, 0x3d000
  v_mfma_f32_16x16x32_bf16 v[240:243], v[56:59], v[108:111], v[240:243]
  v_add_u32 v18, 0x10000, v18
  ds_read_b64_tr_b16 v[56:57], v18 offset:0
  ds_read_b64_tr_b16 v[58:59], v18 offset:4096
  v_mfma_f32_16x16x32_bf16 v[244:247], v[60:63], v[100:103], v[244:247]
  buffer_load_dwordx4 v5, s[16:19], s32 offen offset:0 nt lds
  buffer_load_dwordx4 v6, s[16:19], s32 offen offset:1024 nt lds
  v_mfma_f32_16x16x32_bf16 v[248:251], v[60:63], v[104:107], v[248:251]
  buffer_load_dwordx4 v5, s[16:19], s32 offen offset:2048 nt lds
  v_mfma_f32_16x16x32_bf16 v[252:255], v[60:63], v[108:111], v[252:255]
  v_add_u32 v19, 0x10000, v19
  ds_read_b64_tr_b16 v[60:61], v19 offset:0
  ds_read_b64_tr_b16 v[62:63], v19 offset:4096
  v_mfma_f32_16x16x32_bf16 a[240:243], a[252:255], v[100:103], a[240:243]
  v_mfma_f32_16x16x32_bf16 a[244:247], a[252:255], v[104:107], a[244:247]
  v_mfma_f32_16x16x32_bf16 a[248:251], a[252:255], v[108:111], a[248:251]
  s_waitcnt lgkmcnt(12)
  v_mfma_f32_16x16x32_bf16 v[160:163], v[32:35], v[112:115], v[160:163]
  v_mfma_f32_16x16x32_bf16 v[164:167], v[32:35], v[116:119], v[164:167]
  v_mfma_f32_16x16x32_bf16 v[168:171], v[32:35], v[120:123], v[168:171]
  v_mfma_f32_16x16x32_bf16 v[172:175], v[36:39], v[112:115], v[172:175]
  v_mfma_f32_16x16x32_bf16 v[176:179], v[36:39], v[116:119], v[176:179]
  buffer_load_dwordx4 v6, s[16:19], s32 offen offset:3072 nt lds
  v_mfma_f32_16x16x32_bf16 v[180:183], v[36:39], v[120:123], v[180:183]
  s_waitcnt lgkmcnt(8)
  v_mfma_f32_16x16x32_bf16 v[184:187], v[40:43], v[112:115], v[184:187]
  v_mfma_f32_16x16x32_bf16 v[188:191], v[40:43], v[116:119], v[188:191]
  v_mfma_f32_16x16x32_bf16 v[192:195], v[40:43], v[120:123], v[192:195]
  v_mfma_f32_16x16x32_bf16 v[196:199], v[44:47], v[112:115], v[196:199]
  v_mfma_f32_16x16x32_bf16 v[200:203], v[44:47], v[116:119], v[200:203]
  v_mfma_f32_16x16x32_bf16 v[204:207], v[44:47], v[120:123], v[204:207]
  s_waitcnt lgkmcnt(0)
  v_mfma_f32_16x16x32_bf16 v[208:211], v[48:51], v[112:115], v[208:211]
  s_waitcnt vmcnt(16)
  s_barrier
  ds_read_b64_tr_b16 v[32:33], v12 offset:16384
  ds_read_b64_tr_b16 v[34:35], v12 offset:20480
  v_mfma_f32_16x16x32_bf16 v[212:215], v[48:51], v[116:119], v[212:215]
  ds_read_b64_tr_b16 v[36:37], v13 offset:16384
  ds_read_b64_tr_b16 v[38:39], v13 offset:20480
  v_mfma_f32_16x16x32_bf16 v[216:219], v[48:51], v[120:123], v[216:219]
  ds_read_b64_tr_b16 v[40:41], v14 offset:16384
  ds_read_b64_tr_b16 v[42:43], v14 offset:20480
  v_mfma_f32_16x16x32_bf16 v[220:223], v[52:55], v[112:115], v[220:223]
  ds_read_b64_tr_b16 v[44:45], v15 offset:16384
  ds_read_b64_tr_b16 v[46:47], v15 offset:20480
  v_mfma_f32_16x16x32_bf16 v[224:227], v[52:55], v[116:119], v[224:227]
  ds_read_b64_tr_b16 v[48:49], v16 offset:16384
  ds_read_b64_tr_b16 v[50:51], v16 offset:20480
  v_mfma_f32_16x16x32_bf16 v[228:231], v[52:55], v[120:123], v[228:231]
  ds_read_b64_tr_b16 v[52:53], v17 offset:16384
  ds_read_b64_tr_b16 v[54:55], v17 offset:20480
  v_mfma_f32_16x16x32_bf16 v[232:235], v[56:59], v[112:115], v[232:235]
  v_mfma_f32_16x16x32_bf16 v[236:239], v[56:59], v[116:119], v[236:239]
  v_mfma_f32_16x16x32_bf16 v[240:243], v[56:59], v[120:123], v[240:243]
  ds_read_b64_tr_b16 v[56:57], v18 offset:16384
  ds_read_b64_tr_b16 v[58:59], v18 offset:20480
  v_mfma_f32_16x16x32_bf16 v[244:247], v[60:63], v[112:115], v[244:247]
  v_mfma_f32_16x16x32_bf16 v[248:251], v[60:63], v[116:119], v[248:251]
  v_mfma_f32_16x16x32_bf16 v[252:255], v[60:63], v[120:123], v[252:255]
  ds_read_b64_tr_b16 v[60:61], v19 offset:16384
  ds_read_b64_tr_b16 v[62:63], v19 offset:20480
  v_mfma_f32_16x16x32_bf16 a[240:243], a[252:255], v[112:115], a[240:243]
  v_mfma_f32_16x16x32_bf16 a[244:247], a[252:255], v[116:119], a[244:247]
  v_mfma_f32_16x16x32_bf16 a[248:251], a[252:255], v[120:123], a[248:251]
  s_waitcnt lgkmcnt(12)
  v_mfma_f32_16x16x32_bf16 v[160:163], v[32:35], v[124:127], v[160:163]
  v_mfma_f32_16x16x32_bf16 v[164:167], v[32:35], v[128:131], v[164:167]
  v_mfma_f32_16x16x32_bf16 v[168:171], v[32:35], v[132:135], v[168:171]
  v_mfma_f32_16x16x32_bf16 v[172:175], v[36:39], v[124:127], v[172:175]
  v_mfma_f32_16x16x32_bf16 v[176:179], v[36:39], v[128:131], v[176:179]
  v_mfma_f32_16x16x32_bf16 v[180:183], v[36:39], v[132:135], v[180:183]
  s_waitcnt lgkmcnt(8)
  v_mfma_f32_16x16x32_bf16 v[184:187], v[40:43], v[124:127], v[184:187]
  v_mfma_f32_16x16x32_bf16 v[188:191], v[40:43], v[128:131], v[188:191]
  v_mfma_f32_16x16x32_bf16 v[192:195], v[40:43], v[132:135], v[192:195]
  v_mfma_f32_16x16x32_bf16 v[196:199], v[44:47], v[124:127], v[196:199]
  v_mfma_f32_16x16x32_bf16 v[200:203], v[44:47], v[128:131], v[200:203]
  v_mfma_f32_16x16x32_bf16 v[204:207], v[44:47], v[132:135], v[204:207]
  s_waitcnt lgkmcnt(0)
  v_mfma_f32_16x16x32_bf16 v[208:211], v[48:51], v[124:127], v[208:211]
  s_waitcnt vmcnt(8)
  s_barrier
  v_subrev_u32 v12, 0x10000, v12
  ds_read_b64_tr_b16 v[32:33], v12 offset:0
  ds_read_b64_tr_b16 v[34:35], v12 offset:4096
  v_mfma_f32_16x16x32_bf16 v[212:215], v[48:51], v[128:131], v[212:215]
  v_subrev_u32 v13, 0x10000, v13
  ds_read_b64_tr_b16 v[36:37], v13 offset:0
  ds_read_b64_tr_b16 v[38:39], v13 offset:4096
  v_mfma_f32_16x16x32_bf16 v[216:219], v[48:51], v[132:135], v[216:219]
  v_subrev_u32 v14, 0x10000, v14
  ds_read_b64_tr_b16 v[40:41], v14 offset:0
  ds_read_b64_tr_b16 v[42:43], v14 offset:4096
  v_mfma_f32_16x16x32_bf16 v[220:223], v[52:55], v[124:127], v[220:223]
  v_subrev_u32 v15, 0x10000, v15
  ds_read_b64_tr_b16 v[44:45], v15 offset:0
  ds_read_b64_tr_b16 v[46:47], v15 offset:4096
  v_mfma_f32_16x16x32_bf16 v[224:227], v[52:55], v[128:131], v[224:227]
  v_subrev_u32 v16, 0x10000, v16
  ds_read_b64_tr_b16 v[48:49], v16 offset:0
  ds_read_b64_tr_b16 v[50:51], v16 offset:4096
  v_mfma_f32_16x16x32_bf16 v[228:231], v[52:55], v[132:135], v[228:231]
  v_subrev_u32 v17, 0x10000, v17
  ds_read_b64_tr_b16 v[52:53], v17 offset:0
  ds_read_b64_tr_b16 v[54:55], v17 offset:4096
  v_mfma_f32_16x16x32_bf16 v[232:235], v[56:59], v[124:127], v[232:235]
  v_mfma_f32_16x16x32_bf16 v[236:239], v[56:59], v[128:131], v[236:239]
  v_mfma_f32_16x16x32_bf16 v[240:243], v[56:59], v[132:135], v[240:243]
  v_subrev_u32 v18, 0x10000, v18
  ds_read_b64_tr_b16 v[56:57], v18 offset:0
  ds_read_b64_tr_b16 v[58:59], v18 offset:4096
  v_mfma_f32_16x16x32_bf16 v[244:247], v[60:63], v[124:127], v[244:247]
  v_mfma_f32_16x16x32_bf16 v[248:251], v[60:63], v[128:131], v[248:251]
  v_mfma_f32_16x16x32_bf16 v[252:255], v[60:63], v[132:135], v[252:255]
  v_subrev_u32 v19, 0x10000, v19
  ds_read_b64_tr_b16 v[60:61], v19 offset:0
  ds_read_b64_tr_b16 v[62:63], v19 offset:4096
  v_mfma_f32_16x16x32_bf16 a[240:243], a[252:255], v[124:127], a[240:243]
  v_mfma_f32_16x16x32_bf16 a[244:247], a[252:255], v[128:131], a[244:247]
  v_mfma_f32_16x16x32_bf16 a[248:251], a[252:255], v[132:135], a[248:251]
  s_waitcnt lgkmcnt(12)
  v_mfma_f32_16x16x32_bf16 v[160:163], v[32:35], v[136:139], v[160:163]
  v_mfma_f32_16x16x32_bf16 v[164:167], v[32:35], v[140:143], v[164:167]
  v_mfma_f32_16x16x32_bf16 v[168:171], v[32:35], v[144:147], v[168:171]
  v_mfma_f32_16x16x32_bf16 v[172:175], v[36:39], v[136:139], v[172:175]
  v_mfma_f32_16x16x32_bf16 v[176:179], v[36:39], v[140:143], v[176:179]
  v_mfma_f32_16x16x32_bf16 v[180:183], v[36:39], v[144:147], v[180:183]
  s_waitcnt lgkmcnt(8)
  v_mfma_f32_16x16x32_bf16 v[184:187], v[40:43], v[136:139], v[184:187]
  v_mfma_f32_16x16x32_bf16 v[188:191], v[40:43], v[140:143], v[188:191]
  v_mfma_f32_16x16x32_bf16 v[192:195], v[40:43], v[144:147], v[192:195]
  v_mfma_f32_16x16x32_bf16 v[196:199], v[44:47], v[136:139], v[196:199]
  v_mfma_f32_16x16x32_bf16 v[200:203], v[44:47], v[140:143], v[200:203]
  v_mfma_f32_16x16x32_bf16 v[204:207], v[44:47], v[144:147], v[204:207]
  s_waitcnt lgkmcnt(0)
  v_mfma_f32_16x16x32_bf16 v[208:211], v[48:51], v[136:139], v[208:211]
  s_waitcnt vmcnt(0)
  s_barrier
  ds_read_b64_tr_b16 v[32:33], v12 offset:16384
  ds_read_b64_tr_b16 v[34:35], v12 offset:20480
  v_mfma_f32_16x16x32_bf16 v[212:215], v[48:51], v[140:143], v[212:215]
  ds_read_b64_tr_b16 v[36:37], v13 offset:16384
  ds_read_b64_tr_b16 v[38:39], v13 offset:20480
  v_mfma_f32_16x16x32_bf16 v[216:219], v[48:51], v[144:147], v[216:219]
  ds_read_b64_tr_b16 v[40:41], v14 offset:16384
  ds_read_b64_tr_b16 v[42:43], v14 offset:20480
  v_mfma_f32_16x16x32_bf16 v[220:223], v[52:55], v[136:139], v[220:223]
  ds_read_b64_tr_b16 v[44:45], v15 offset:16384
  ds_read_b64_tr_b16 v[46:47], v15 offset:20480
  v_mfma_f32_16x16x32_bf16 v[224:227], v[52:55], v[140:143], v[224:227]
  ds_read_b64_tr_b16 v[48:49], v16 offset:16384
  ds_read_b64_tr_b16 v[50:51], v16 offset:20480
  v_mfma_f32_16x16x32_bf16 v[228:231], v[52:55], v[144:147], v[228:231]
  ds_read_b64_tr_b16 v[52:53], v17 offset:16384
  ds_read_b64_tr_b16 v[54:55], v17 offset:20480
  v_mfma_f32_16x16x32_bf16 v[232:235], v[56:59], v[136:139], v[232:235]
  v_mfma_f32_16x16x32_bf16 v[236:239], v[56:59], v[140:143], v[236:239]
  v_mfma_f32_16x16x32_bf16 v[240:243], v[56:59], v[144:147], v[240:243]
  ds_read_b64_tr_b16 v[56:57], v18 offset:16384
  ds_read_b64_tr_b16 v[58:59], v18 offset:20480
  v_mfma_f32_16x16x32_bf16 v[244:247], v[60:63], v[136:139], v[244:247]
  v_mfma_f32_16x16x32_bf16 v[248:251], v[60:63], v[140:143], v[248:251]
  v_mfma_f32_16x16x32_bf16 v[252:255], v[60:63], v[144:147], v[252:255]
  ds_read_b64_tr_b16 v[60:61], v19 offset:16384
  ds_read_b64_tr_b16 v[62:63], v19 offset:20480
  v_mfma_f32_16x16x32_bf16 a[240:243], a[252:255], v[136:139], a[240:243]
  v_mfma_f32_16x16x32_bf16 a[244:247], a[252:255], v[140:143], a[244:247]
  v_mfma_f32_16x16x32_bf16 a[248:251], a[252:255], v[144:147], a[248:251]
  s_waitcnt lgkmcnt(12)
  v_mfma_f32_16x16x32_bf16 v[160:163], v[32:35], v[148:151], v[160:163]
  v_mfma_f32_16x16x32_bf16 v[164:167], v[32:35], v[152:155], v[164:167]
  v_mfma_f32_16x16x32_bf16 v[168:171], v[32:35], v[156:159], v[168:171]
  v_mfma_f32_16x16x32_bf16 v[172:175], v[36:39], v[148:151], v[172:175]
  v_mfma_f32_16x16x32_bf16 v[176:179], v[36:39], v[152:155], v[176:179]
  v_mfma_f32_16x16x32_bf16 v[180:183], v[36:39], v[156:159], v[180:183]
  s_waitcnt lgkmcnt(8)
  v_mfma_f32_16x16x32_bf16 v[184:187], v[40:43], v[148:151], v[184:187]
  v_mfma_f32_16x16x32_bf16 v[188:191], v[40:43], v[152:155], v[188:191]
  v_mfma_f32_16x16x32_bf16 v[192:195], v[40:43], v[156:159], v[192:195]
  v_mfma_f32_16x16x32_bf16 v[196:199], v[44:47], v[148:151], v[196:199]
  v_mfma_f32_16x16x32_bf16 v[200:203], v[44:47], v[152:155], v[200:203]
  v_mfma_f32_16x16x32_bf16 v[204:207], v[44:47], v[156:159], v[204:207]
  s_waitcnt lgkmcnt(0)
  v_mfma_f32_16x16x32_bf16 v[208:211], v[48:51], v[148:151], v[208:211]
  s_barrier
  ds_read_b64_tr_b16 v[32:33], v20 offset:0
  ds_read_b64_tr_b16 v[34:35], v20 offset:512
  v_mfma_f32_16x16x32_bf16 v[212:215], v[48:51], v[152:155], v[212:215]
  ds_read_b64_tr_b16 v[36:37], v21 offset:0
  ds_read_b64_tr_b16 v[38:39], v21 offset:512
  v_mfma_f32_16x16x32_bf16 v[216:219], v[48:51], v[156:159], v[216:219]
  ds_read_b64_tr_b16 v[40:41], v20 offset:4096
  ds_read_b64_tr_b16 v[42:43], v20 offset:4608
  v_mfma_f32_16x16x32_bf16 v[220:223], v[52:55], v[148:151], v[220:223]
  ds_read_b64_tr_b16 v[44:45], v21 offset:4096
  ds_read_b64_tr_b16 v[46:47], v21 offset:4608
  v_mfma_f32_16x16x32_bf16 v[224:227], v[52:55], v[152:155], v[224:227]
  ds_read_b64_tr_b16 v[48:49], v20 offset:8192
  ds_read_b64_tr_b16 v[50:51], v20 offset:8704
  v_mfma_f32_16x16x32_bf16 v[228:231], v[52:55], v[156:159], v[228:231]
  ds_read_b64_tr_b16 v[52:53], v21 offset:8192
  ds_read_b64_tr_b16 v[54:55], v21 offset:8704
  v_mfma_f32_16x16x32_bf16 v[232:235], v[56:59], v[148:151], v[232:235]
  v_mfma_f32_16x16x32_bf16 v[236:239], v[56:59], v[152:155], v[236:239]
  v_mfma_f32_16x16x32_bf16 v[240:243], v[56:59], v[156:159], v[240:243]
  ds_read_b64_tr_b16 v[56:57], v20 offset:12288
  ds_read_b64_tr_b16 v[58:59], v20 offset:12800
  v_mfma_f32_16x16x32_bf16 v[244:247], v[60:63], v[148:151], v[244:247]
  v_mfma_f32_16x16x32_bf16 v[248:251], v[60:63], v[152:155], v[248:251]
  v_mfma_f32_16x16x32_bf16 v[252:255], v[60:63], v[156:159], v[252:255]
  ds_read_b64_tr_b16 v[60:61], v21 offset:12288
  ds_read_b64_tr_b16 v[62:63], v21 offset:12800
  v_mfma_f32_16x16x32_bf16 a[240:243], a[252:255], v[148:151], a[240:243]
  v_mfma_f32_16x16x32_bf16 a[244:247], a[252:255], v[152:155], a[244:247]
  v_mfma_f32_16x16x32_bf16 a[248:251], a[252:255], v[156:159], a[248:251]
  v_add_u32 v112, s47, v0
  v_add_u32 v113, s48, v0
  v_lshrrev_b32 v115, 1, v0
  v_add_u32 v114, s49, v115
  v_add_u32 v115, s50, v115
  ds_write_b128 v112, v[208:211] offset:0
  ds_write_b128 v112, v[212:215] offset:1024
  ds_write_b128 v112, v[216:219] offset:2048
  ds_write_b128 v112, v[220:223] offset:3072
  ds_write_b128 v112, v[224:227] offset:4096
  ds_write_b128 v112, v[228:231] offset:5120
  ds_write_b128 v112, v[232:235] offset:6144
  ds_write_b128 v112, v[236:239] offset:7168
  ds_write_b128 v112, v[240:243] offset:8192
  ds_write_b128 v112, v[244:247] offset:9216
  ds_write_b128 v112, v[248:251] offset:10240
  ds_write_b128 v112, v[252:255] offset:11264
  v_mov_b32 v116, v22
  v_accvgpr_read_b32 v117, a240
  v_mov_b32 v118, v23
  v_accvgpr_read_b32 v119, a244
  v_mov_b32 v120, v24
  v_accvgpr_read_b32 v121, a248
  ds_write_b64 v114, v[116:117] offset:0
  ds_write_b64 v114, v[118:119] offset:512
  ds_write_b64 v114, v[120:121] offset:1024
  v_bfe_u32 v128, v0, 4, 4
  v_lshrrev_b32 v129, 8, v0
  v_lshrrev_b32 v131, 1, v128
  v_lshrrev_b32 v132, 1, v129
  v_xor_b32 v132, v131, v132
  v_lshlrev_b32 v132, 4, v132
  v_lshl_add_u32 v130, v128, 7, v132
  v_and_b32 v132, 1, v129
  v_lshl_add_u32 v130, v132, 3, v130
  v_add_u32 v130, s48, v130
  v_xor_b32 v134, v129, v131
  v_lshlrev_b32 v134, 4, v134
  v_lshl_add_u32 v134, v128, 7, v134
  v_add_u32 v134, s51, v134
  v_xor_b32 v135, 64, v134
  v_xor_b32 v131, 32, v130
  v_xor_b32 v132, 64, v130
  v_xor_b32 v133, 96, v130
  s_waitcnt lgkmcnt(0)
  s_barrier
  ds_read_b64 v[122:123], v115 offset:0
  ds_read_b64 v[124:125], v115 offset:512
  ds_read_b64 v[126:127], v115 offset:1024
  ds_read_b128 v[64:67], v113 offset:0
  ds_read_b128 v[68:71], v113 offset:1024
  ds_read_b128 v[72:75], v113 offset:2048
  ds_read_b128 v[76:79], v113 offset:3072
  ds_read_b128 v[80:83], v113 offset:4096
  ds_read_b128 v[84:87], v113 offset:5120
  ds_read_b128 v[88:91], v113 offset:6144
  ds_read_b128 v[92:95], v113 offset:7168
  ds_read_b128 v[96:99], v113 offset:8192
  ds_read_b128 v[100:103], v113 offset:9216
  ds_read_b128 v[104:107], v113 offset:10240
  ds_read_b128 v[108:111], v113 offset:11264
  s_waitcnt lgkmcnt(12)
  v_min_f32 v142, v116, v122
  v_min_f32 v143, v118, v124
  v_min_f32 v144, v120, v126
  v_sub_f32 v136, v142, v116
  v_sub_f32 v137, v143, v118
  v_sub_f32 v138, v144, v120
  v_sub_f32 v139, v142, v122
  v_sub_f32 v140, v143, v124
  v_sub_f32 v141, v144, v126
  v_exp_f32 v136, v136
  v_exp_f32 v137, v137
  v_exp_f32 v138, v138
  v_exp_f32 v139, v139
  v_exp_f32 v140, v140
  v_exp_f32 v141, v141
  v_mul_f32 v142, v117, v136
  v_mul_f32 v143, v119, v137
  v_mul_f32 v144, v121, v138
  v_fmac_f32 v142, v123, v139
  v_fmac_f32 v143, v125, v140
  v_fmac_f32 v144, v127, v141
  v_rcp_f32 v142, v142
  v_rcp_f32 v143, v143
  v_rcp_f32 v144, v144
  v_mul_f32 v136, v136, v142
  v_mul_f32 v137, v137, v143
  v_mul_f32 v138, v138, v144
  v_mul_f32 v139, v139, v142
  v_mul_f32 v140, v140, v143
  v_mul_f32 v141, v141, v144
  v_mul_f32 v160, v160, v136
  v_mul_f32 v161, v161, v136
  v_mul_f32 v162, v162, v136
  v_mul_f32 v163, v163, v136
  s_waitcnt lgkmcnt(11)
  v_fmac_f32 v160, v64, v139
  v_fmac_f32 v161, v65, v139
  v_fmac_f32 v162, v66, v139
  v_fmac_f32 v163, v67, v139
  v_cvt_pk_bf16_f32 v160, v160, v161
  v_cvt_pk_bf16_f32 v161, v162, v163
  ds_write_b64 v130, v[160:161] offset:0
  v_mul_f32 v164, v164, v137
  v_mul_f32 v165, v165, v137
  v_mul_f32 v166, v166, v137
  v_mul_f32 v167, v167, v137
  s_waitcnt lgkmcnt(11)
  v_fmac_f32 v164, v68, v140
  v_fmac_f32 v165, v69, v140
  v_fmac_f32 v166, v70, v140
  v_fmac_f32 v167, v71, v140
  v_cvt_pk_bf16_f32 v164, v164, v165
  v_cvt_pk_bf16_f32 v165, v166, v167
  ds_write_b64 v130, v[164:165] offset:2048
  v_mul_f32 v168, v168, v138
  v_mul_f32 v169, v169, v138
  v_mul_f32 v170, v170, v138
  v_mul_f32 v171, v171, v138
  s_waitcnt lgkmcnt(11)
  v_fmac_f32 v168, v72, v141
  v_fmac_f32 v169, v73, v141
  v_fmac_f32 v170, v74, v141
  v_fmac_f32 v171, v75, v141
  v_cvt_pk_bf16_f32 v168, v168, v169
  v_cvt_pk_bf16_f32 v169, v170, v171
  ds_write_b64 v130, v[168:169] offset:4096
  v_mul_f32 v172, v172, v136
  v_mul_f32 v173, v173, v136
  v_mul_f32 v174, v174, v136
  v_mul_f32 v175, v175, v136
  s_waitcnt lgkmcnt(11)
  v_fmac_f32 v172, v76, v139
  v_fmac_f32 v173, v77, v139
  v_fmac_f32 v174, v78, v139
  v_fmac_f32 v175, v79, v139
  v_cvt_pk_bf16_f32 v172, v172, v173
  v_cvt_pk_bf16_f32 v173, v174, v175
  ds_write_b64 v131, v[172:173] offset:0
  v_mul_f32 v176, v176, v137
  v_mul_f32 v177, v177, v137
  v_mul_f32 v178, v178, v137
  v_mul_f32 v179, v179, v137
  s_waitcnt lgkmcnt(11)
  v_fmac_f32 v176, v80, v140
  v_fmac_f32 v177, v81, v140
  v_fmac_f32 v178, v82, v140
  v_fmac_f32 v179, v83, v140
  v_cvt_pk_bf16_f32 v176, v176, v177
  v_cvt_pk_bf16_f32 v177, v178, v179
  ds_write_b64 v131, v[176:177] offset:2048
  v_mul_f32 v180, v180, v138
  v_mul_f32 v181, v181, v138
  v_mul_f32 v182, v182, v138
  v_mul_f32 v183, v183, v138
  s_waitcnt lgkmcnt(11)
  v_fmac_f32 v180, v84, v141
  v_fmac_f32 v181, v85, v141
  v_fmac_f32 v182, v86, v141
  v_fmac_f32 v183, v87, v141
  v_cvt_pk_bf16_f32 v180, v180, v181
  v_cvt_pk_bf16_f32 v181, v182, v183
  ds_write_b64 v131, v[180:181] offset:4096
  v_mul_f32 v184, v184, v136
  v_mul_f32 v185, v185, v136
  v_mul_f32 v186, v186, v136
  v_mul_f32 v187, v187, v136
  s_waitcnt lgkmcnt(11)
  v_fmac_f32 v184, v88, v139
  v_fmac_f32 v185, v89, v139
  v_fmac_f32 v186, v90, v139
  v_fmac_f32 v187, v91, v139
  v_cvt_pk_bf16_f32 v184, v184, v185
  v_cvt_pk_bf16_f32 v185, v186, v187
  ds_write_b64 v132, v[184:185] offset:0
  v_mul_f32 v188, v188, v137
  v_mul_f32 v189, v189, v137
  v_mul_f32 v190, v190, v137
  v_mul_f32 v191, v191, v137
  s_waitcnt lgkmcnt(11)
  v_fmac_f32 v188, v92, v140
  v_fmac_f32 v189, v93, v140
  v_fmac_f32 v190, v94, v140
  v_fmac_f32 v191, v95, v140
  v_cvt_pk_bf16_f32 v188, v188, v189
  v_cvt_pk_bf16_f32 v189, v190, v191
  ds_write_b64 v132, v[188:189] offset:2048
  v_mul_f32 v192, v192, v138
  v_mul_f32 v193, v193, v138
  v_mul_f32 v194, v194, v138
  v_mul_f32 v195, v195, v138
  s_waitcnt lgkmcnt(11)
  v_fmac_f32 v192, v96, v141
  v_fmac_f32 v193, v97, v141
  v_fmac_f32 v194, v98, v141
  v_fmac_f32 v195, v99, v141
  v_cvt_pk_bf16_f32 v192, v192, v193
  v_cvt_pk_bf16_f32 v193, v194, v195
  ds_write_b64 v132, v[192:193] offset:4096
  v_mul_f32 v196, v196, v136
  v_mul_f32 v197, v197, v136
  v_mul_f32 v198, v198, v136
  v_mul_f32 v199, v199, v136
  s_waitcnt lgkmcnt(11)
  v_fmac_f32 v196, v100, v139
  v_fmac_f32 v197, v101, v139
  v_fmac_f32 v198, v102, v139
  v_fmac_f32 v199, v103, v139
  v_cvt_pk_bf16_f32 v196, v196, v197
  v_cvt_pk_bf16_f32 v197, v198, v199
  ds_write_b64 v133, v[196:197] offset:0
  v_mul_f32 v200, v200, v137
  v_mul_f32 v201, v201, v137
  v_mul_f32 v202, v202, v137
  v_mul_f32 v203, v203, v137
  s_waitcnt lgkmcnt(11)
  v_fmac_f32 v200, v104, v140
  v_fmac_f32 v201, v105, v140
  v_fmac_f32 v202, v106, v140
  v_fmac_f32 v203, v107, v140
  v_cvt_pk_bf16_f32 v200, v200, v201
  v_cvt_pk_bf16_f32 v201, v202, v203
  ds_write_b64 v133, v[200:201] offset:2048
  v_mul_f32 v204, v204, v138
  v_mul_f32 v205, v205, v138
  v_mul_f32 v206, v206, v138
  v_mul_f32 v207, v207, v138
  s_waitcnt lgkmcnt(11)
  v_fmac_f32 v204, v108, v141
  v_fmac_f32 v205, v109, v141
  v_fmac_f32 v206, v110, v141
  v_fmac_f32 v207, v111, v141
  v_cvt_pk_bf16_f32 v204, v204, v205
  v_cvt_pk_bf16_f32 v205, v206, v207
  ds_write_b64 v133, v[204:205] offset:4096
  s_waitcnt lgkmcnt(0)
  s_barrier
  ds_read_b128 v[64:67], v134 offset:12288
  ds_read_b128 v[80:83], v134 offset:14336
  ds_read_b128 v[96:99], v134 offset:16384
  ds_read_b128 v[68:71], v135 offset:12288
  ds_read_b128 v[84:87], v135 offset:14336
  ds_read_b128 v[100:103], v135 offset:16384
  ds_read_b128 v[72:75], v134 offset:0
  ds_read_b128 v[88:91], v134 offset:2048
  ds_read_b128 v[104:107], v134 offset:4096
  ds_read_b128 v[76:79], v135 offset:0
  ds_read_b128 v[92:95], v135 offset:2048
  ds_read_b128 v[108:111], v135 offset:4096
  s_waitcnt lgkmcnt(0)
  v_mfma_f32_16x16x32_bf16 a[0:3], v[32:35], v[64:67], a[0:3]
  v_mfma_f32_16x16x32_bf16 a[4:7], v[32:35], v[80:83], a[4:7]
  v_mfma_f32_16x16x32_bf16 a[8:11], v[32:35], v[96:99], a[8:11]
  v_mfma_f32_16x16x32_bf16 a[12:15], v[36:39], v[64:67], a[12:15]
  v_mfma_f32_16x16x32_bf16 a[16:19], v[36:39], v[80:83], a[16:19]
  v_mfma_f32_16x16x32_bf16 a[20:23], v[36:39], v[96:99], a[20:23]
  v_mfma_f32_16x16x32_bf16 a[0:3], v[40:43], v[68:71], a[0:3]
  v_mfma_f32_16x16x32_bf16 a[4:7], v[40:43], v[84:87], a[4:7]
  v_mfma_f32_16x16x32_bf16 a[8:11], v[40:43], v[100:103], a[8:11]
  v_mfma_f32_16x16x32_bf16 a[12:15], v[44:47], v[68:71], a[12:15]
  v_mfma_f32_16x16x32_bf16 a[16:19], v[44:47], v[84:87], a[16:19]
  v_mfma_f32_16x16x32_bf16 a[20:23], v[44:47], v[100:103], a[20:23]
  v_mfma_f32_16x16x32_bf16 a[0:3], v[48:51], v[72:75], a[0:3]
  s_barrier
  ds_read_b64_tr_b16 v[32:33], v20 offset:16384
  ds_read_b64_tr_b16 v[34:35], v20 offset:16896
  v_mfma_f32_16x16x32_bf16 a[4:7], v[48:51], v[88:91], a[4:7]
  ds_read_b64_tr_b16 v[36:37], v21 offset:16384
  ds_read_b64_tr_b16 v[38:39], v21 offset:16896
  v_mfma_f32_16x16x32_bf16 a[8:11], v[48:51], v[104:107], a[8:11]
  ds_read_b64_tr_b16 v[40:41], v20 offset:20480
  ds_read_b64_tr_b16 v[42:43], v20 offset:20992
  v_mfma_f32_16x16x32_bf16 a[12:15], v[52:55], v[72:75], a[12:15]
  ds_read_b64_tr_b16 v[44:45], v21 offset:20480
  ds_read_b64_tr_b16 v[46:47], v21 offset:20992
  v_mfma_f32_16x16x32_bf16 a[16:19], v[52:55], v[88:91], a[16:19]
  ds_read_b64_tr_b16 v[48:49], v20 offset:24576
  ds_read_b64_tr_b16 v[50:51], v20 offset:25088
  v_mfma_f32_16x16x32_bf16 a[20:23], v[52:55], v[104:107], a[20:23]
  ds_read_b64_tr_b16 v[52:53], v21 offset:24576
  ds_read_b64_tr_b16 v[54:55], v21 offset:25088
  v_mfma_f32_16x16x32_bf16 a[0:3], v[56:59], v[76:79], a[0:3]
  v_mfma_f32_16x16x32_bf16 a[4:7], v[56:59], v[92:95], a[4:7]
  v_mfma_f32_16x16x32_bf16 a[8:11], v[56:59], v[108:111], a[8:11]
  ds_read_b64_tr_b16 v[56:57], v20 offset:28672
  ds_read_b64_tr_b16 v[58:59], v20 offset:29184
  v_mfma_f32_16x16x32_bf16 a[12:15], v[60:63], v[76:79], a[12:15]
  v_mfma_f32_16x16x32_bf16 a[16:19], v[60:63], v[92:95], a[16:19]
  v_mfma_f32_16x16x32_bf16 a[20:23], v[60:63], v[108:111], a[20:23]
  ds_read_b64_tr_b16 v[60:61], v21 offset:28672
  ds_read_b64_tr_b16 v[62:63], v21 offset:29184
  s_waitcnt lgkmcnt(12)
  v_mfma_f32_16x16x32_bf16 a[24:27], v[32:35], v[64:67], a[24:27]
  v_mfma_f32_16x16x32_bf16 a[28:31], v[32:35], v[80:83], a[28:31]
  v_mfma_f32_16x16x32_bf16 a[32:35], v[32:35], v[96:99], a[32:35]
  v_mfma_f32_16x16x32_bf16 a[36:39], v[36:39], v[64:67], a[36:39]
  v_mfma_f32_16x16x32_bf16 a[40:43], v[36:39], v[80:83], a[40:43]
  s_add_u32 s33, s41, 0
  s_and_b32 s33, s33, 7
  v_mfma_f32_16x16x32_bf16 a[44:47], v[36:39], v[96:99], a[44:47]
  s_mul_i32 s33, s33, 3072
  v_accvgpr_read_b32 v112, a0
  s_waitcnt lgkmcnt(8)
  v_mfma_f32_16x16x32_bf16 a[24:27], v[40:43], v[68:71], a[24:27]
  v_accvgpr_read_b32 v113, a1
  v_accvgpr_read_b32 v114, a2
  v_mfma_f32_16x16x32_bf16 a[28:31], v[40:43], v[84:87], a[28:31]
  v_accvgpr_read_b32 v115, a3
  v_accvgpr_read_b32 v116, a12
  v_mfma_f32_16x16x32_bf16 a[32:35], v[40:43], v[100:103], a[32:35]
  v_accvgpr_read_b32 v117, a13
  v_accvgpr_read_b32 v118, a14
  v_mfma_f32_16x16x32_bf16 a[36:39], v[44:47], v[68:71], a[36:39]
  v_accvgpr_read_b32 v119, a15
  v_cvt_pk_bf16_f32 v136, v112, v113
  v_mfma_f32_16x16x32_bf16 a[40:43], v[44:47], v[84:87], a[40:43]
  v_cvt_pk_bf16_f32 v137, v114, v115
  v_cvt_pk_bf16_f32 v138, v116, v117
  v_mfma_f32_16x16x32_bf16 a[44:47], v[44:47], v[100:103], a[44:47]
  v_cvt_pk_bf16_f32 v139, v118, v119
  v_accvgpr_read_b32 v120, a4
  s_waitcnt lgkmcnt(0)
  v_mfma_f32_16x16x32_bf16 a[24:27], v[48:51], v[72:75], a[24:27]
  s_barrier
  ds_read_b64_tr_b16 v[32:33], v20 offset:32768
  ds_read_b64_tr_b16 v[34:35], v20 offset:33280
  v_mfma_f32_16x16x32_bf16 a[28:31], v[48:51], v[88:91], a[28:31]
  ds_read_b64_tr_b16 v[36:37], v21 offset:32768
  ds_read_b64_tr_b16 v[38:39], v21 offset:33280
  v_mfma_f32_16x16x32_bf16 a[32:35], v[48:51], v[104:107], a[32:35]
  ds_read_b64_tr_b16 v[40:41], v20 offset:36864
  ds_read_b64_tr_b16 v[42:43], v20 offset:37376
  v_mfma_f32_16x16x32_bf16 a[36:39], v[52:55], v[72:75], a[36:39]
  ds_read_b64_tr_b16 v[44:45], v21 offset:36864
  ds_read_b64_tr_b16 v[46:47], v21 offset:37376
  v_mfma_f32_16x16x32_bf16 a[40:43], v[52:55], v[88:91], a[40:43]
  ds_read_b64_tr_b16 v[48:49], v20 offset:40960
  ds_read_b64_tr_b16 v[50:51], v20 offset:41472
  v_mfma_f32_16x16x32_bf16 a[44:47], v[52:55], v[104:107], a[44:47]
  ds_read_b64_tr_b16 v[52:53], v21 offset:40960
  ds_read_b64_tr_b16 v[54:55], v21 offset:41472
  v_mfma_f32_16x16x32_bf16 a[24:27], v[56:59], v[76:79], a[24:27]
  v_accvgpr_read_b32 v121, a5
  v_accvgpr_read_b32 v122, a6
  v_mfma_f32_16x16x32_bf16 a[28:31], v[56:59], v[92:95], a[28:31]
  v_accvgpr_read_b32 v123, a7
  v_accvgpr_read_b32 v124, a16
  v_mfma_f32_16x16x32_bf16 a[32:35], v[56:59], v[108:111], a[32:35]
  ds_read_b64_tr_b16 v[56:57], v20 offset:45056
  ds_read_b64_tr_b16 v[58:59], v20 offset:45568
  v_mfma_f32_16x16x32_bf16 a[36:39], v[60:63], v[76:79], a[36:39]
  v_accvgpr_read_b32 v125, a17
  v_accvgpr_read_b32 v126, a18
  v_mfma_f32_16x16x32_bf16 a[40:43], v[60:63], v[92:95], a[40:43]
  v_accvgpr_read_b32 v127, a19
  v_permlane16_swap_b32 v136, v138
  v_mfma_f32_16x16x32_bf16 a[44:47], v[60:63], v[108:111], a[44:47]
  ds_read_b64_tr_b16 v[60:61], v21 offset:45056
  ds_read_b64_tr_b16 v[62:63], v21 offset:45568
  v_permlane16_swap_b32 v137, v139
  v_cvt_pk_bf16_f32 v140, v120, v121
  v_cvt_pk_bf16_f32 v141, v122, v123
  v_cvt_pk_bf16_f32 v142, v124, v125
  v_cvt_pk_bf16_f32 v143, v126, v127
  v_accvgpr_read_b32 v128, a8
  v_accvgpr_read_b32 v129, a9
  v_accvgpr_read_b32 v130, a10
  v_accvgpr_read_b32 v131, a11
  v_accvgpr_read_b32 v132, a20
  v_accvgpr_read_b32 v133, a21
  v_accvgpr_read_b32 v134, a22
  v_accvgpr_read_b32 v135, a23
  buffer_store_dwordx4 v[136:139], v0, s[28:31], s33 offen offset:0 sc1
  v_permlane16_swap_b32 v140, v142
  v_permlane16_swap_b32 v141, v143
  v_cvt_pk_bf16_f32 v144, v128, v129
  v_cvt_pk_bf16_f32 v145, v130, v131
  v_cvt_pk_bf16_f32 v146, v132, v133
  v_cvt_pk_bf16_f32 v147, v134, v135
  buffer_store_dwordx4 v[140:143], v0, s[28:31], s33 offen offset:1024 sc1
  s_nop 0
  v_permlane16_swap_b32 v144, v146
  v_permlane16_swap_b32 v145, v147
  buffer_store_dwordx4 v[144:147], v0, s[28:31], s33 offen offset:2048 sc1
  s_waitcnt lgkmcnt(12)
  v_mfma_f32_16x16x32_bf16 a[48:51], v[32:35], v[64:67], a[48:51]
  v_mfma_f32_16x16x32_bf16 a[52:55], v[32:35], v[80:83], a[52:55]
  v_mfma_f32_16x16x32_bf16 a[56:59], v[32:35], v[96:99], a[56:59]
  v_mfma_f32_16x16x32_bf16 a[60:63], v[36:39], v[64:67], a[60:63]
  v_mfma_f32_16x16x32_bf16 a[64:67], v[36:39], v[80:83], a[64:67]
  s_add_u32 s33, s41, 1
  s_and_b32 s33, s33, 7
  v_mfma_f32_16x16x32_bf16 a[68:71], v[36:39], v[96:99], a[68:71]
  s_mul_i32 s33, s33, 3072
  v_accvgpr_read_b32 v112, a24
  s_waitcnt lgkmcnt(8)
  v_mfma_f32_16x16x32_bf16 a[48:51], v[40:43], v[68:71], a[48:51]
  v_accvgpr_read_b32 v113, a25
  v_accvgpr_read_b32 v114, a26
  v_mfma_f32_16x16x32_bf16 a[52:55], v[40:43], v[84:87], a[52:55]
  v_accvgpr_read_b32 v115, a27
  v_accvgpr_read_b32 v116, a36
  v_mfma_f32_16x16x32_bf16 a[56:59], v[40:43], v[100:103], a[56:59]
  v_accvgpr_read_b32 v117, a37
  v_accvgpr_read_b32 v118, a38
  v_mfma_f32_16x16x32_bf16 a[60:63], v[44:47], v[68:71], a[60:63]
  v_accvgpr_read_b32 v119, a39
  v_cvt_pk_bf16_f32 v136, v112, v113
  v_mfma_f32_16x16x32_bf16 a[64:67], v[44:47], v[84:87], a[64:67]
  v_cvt_pk_bf16_f32 v137, v114, v115
  v_cvt_pk_bf16_f32 v138, v116, v117
  v_mfma_f32_16x16x32_bf16 a[68:71], v[44:47], v[100:103], a[68:71]
  v_cvt_pk_bf16_f32 v139, v118, v119
  v_accvgpr_read_b32 v120, a28
  s_waitcnt lgkmcnt(0)
  v_mfma_f32_16x16x32_bf16 a[48:51], v[48:51], v[72:75], a[48:51]
  s_barrier
  ds_read_b64_tr_b16 v[32:33], v20 offset:49152
  ds_read_b64_tr_b16 v[34:35], v20 offset:49664
  v_mfma_f32_16x16x32_bf16 a[52:55], v[48:51], v[88:91], a[52:55]
  ds_read_b64_tr_b16 v[36:37], v21 offset:49152
  ds_read_b64_tr_b16 v[38:39], v21 offset:49664
  v_mfma_f32_16x16x32_bf16 a[56:59], v[48:51], v[104:107], a[56:59]
  ds_read_b64_tr_b16 v[40:41], v20 offset:53248
  ds_read_b64_tr_b16 v[42:43], v20 offset:53760
  v_mfma_f32_16x16x32_bf16 a[60:63], v[52:55], v[72:75], a[60:63]
  ds_read_b64_tr_b16 v[44:45], v21 offset:53248
  ds_read_b64_tr_b16 v[46:47], v21 offset:53760
  v_mfma_f32_16x16x32_bf16 a[64:67], v[52:55], v[88:91], a[64:67]
  ds_read_b64_tr_b16 v[48:49], v20 offset:57344
  ds_read_b64_tr_b16 v[50:51], v20 offset:57856
  v_mfma_f32_16x16x32_bf16 a[68:71], v[52:55], v[104:107], a[68:71]
  ds_read_b64_tr_b16 v[52:53], v21 offset:57344
  ds_read_b64_tr_b16 v[54:55], v21 offset:57856
  v_mfma_f32_16x16x32_bf16 a[48:51], v[56:59], v[76:79], a[48:51]
  v_accvgpr_read_b32 v121, a29
  v_accvgpr_read_b32 v122, a30
  v_mfma_f32_16x16x32_bf16 a[52:55], v[56:59], v[92:95], a[52:55]
  v_accvgpr_read_b32 v123, a31
  v_accvgpr_read_b32 v124, a40
  v_mfma_f32_16x16x32_bf16 a[56:59], v[56:59], v[108:111], a[56:59]
  ds_read_b64_tr_b16 v[56:57], v20 offset:61440
  ds_read_b64_tr_b16 v[58:59], v20 offset:61952
  v_mfma_f32_16x16x32_bf16 a[60:63], v[60:63], v[76:79], a[60:63]
  v_accvgpr_read_b32 v125, a41
  v_accvgpr_read_b32 v126, a42
  v_mfma_f32_16x16x32_bf16 a[64:67], v[60:63], v[92:95], a[64:67]
  v_accvgpr_read_b32 v127, a43
  v_permlane16_swap_b32 v136, v138
  v_mfma_f32_16x16x32_bf16 a[68:71], v[60:63], v[108:111], a[68:71]
  ds_read_b64_tr_b16 v[60:61], v21 offset:61440
  ds_read_b64_tr_b16 v[62:63], v21 offset:61952
  v_permlane16_swap_b32 v137, v139
  v_cvt_pk_bf16_f32 v140, v120, v121
  v_cvt_pk_bf16_f32 v141, v122, v123
  v_cvt_pk_bf16_f32 v142, v124, v125
  v_cvt_pk_bf16_f32 v143, v126, v127
  v_accvgpr_read_b32 v128, a32
  v_accvgpr_read_b32 v129, a33
  v_accvgpr_read_b32 v130, a34
  v_accvgpr_read_b32 v131, a35
  v_accvgpr_read_b32 v132, a44
  v_accvgpr_read_b32 v133, a45
  v_accvgpr_read_b32 v134, a46
  v_accvgpr_read_b32 v135, a47
  buffer_store_dwordx4 v[136:139], v0, s[28:31], s33 offen offset:0 sc1
  v_permlane16_swap_b32 v140, v142
  v_permlane16_swap_b32 v141, v143
  v_cvt_pk_bf16_f32 v144, v128, v129
  v_cvt_pk_bf16_f32 v145, v130, v131
  v_cvt_pk_bf16_f32 v146, v132, v133
  v_cvt_pk_bf16_f32 v147, v134, v135
  buffer_store_dwordx4 v[140:143], v0, s[28:31], s33 offen offset:1024 sc1
  s_nop 0
  v_permlane16_swap_b32 v144, v146
  v_permlane16_swap_b32 v145, v147
  buffer_store_dwordx4 v[144:147], v0, s[28:31], s33 offen offset:2048 sc1
  s_waitcnt lgkmcnt(12)
  v_mfma_f32_16x16x32_bf16 a[72:75], v[32:35], v[64:67], a[72:75]
  v_mfma_f32_16x16x32_bf16 a[76:79], v[32:35], v[80:83], a[76:79]
  v_mfma_f32_16x16x32_bf16 a[80:83], v[32:35], v[96:99], a[80:83]
  v_mfma_f32_16x16x32_bf16 a[84:87], v[36:39], v[64:67], a[84:87]
  v_mfma_f32_16x16x32_bf16 a[88:91], v[36:39], v[80:83], a[88:91]
  s_add_u32 s33, s41, 2
  s_and_b32 s33, s33, 7
  v_mfma_f32_16x16x32_bf16 a[92:95], v[36:39], v[96:99], a[92:95]
  s_mul_i32 s33, s33, 3072
  v_accvgpr_read_b32 v112, a48
  s_waitcnt lgkmcnt(8)
  v_mfma_f32_16x16x32_bf16 a[72:75], v[40:43], v[68:71], a[72:75]
  v_accvgpr_read_b32 v113, a49
  v_accvgpr_read_b32 v114, a50
  v_mfma_f32_16x16x32_bf16 a[76:79], v[40:43], v[84:87], a[76:79]
  v_accvgpr_read_b32 v115, a51
  v_accvgpr_read_b32 v116, a60
  v_mfma_f32_16x16x32_bf16 a[80:83], v[40:43], v[100:103], a[80:83]
  v_accvgpr_read_b32 v117, a61
  v_accvgpr_read_b32 v118, a62
  v_mfma_f32_16x16x32_bf16 a[84:87], v[44:47], v[68:71], a[84:87]
  v_accvgpr_read_b32 v119, a63
  v_cvt_pk_bf16_f32 v136, v112, v113
  v_mfma_f32_16x16x32_bf16 a[88:91], v[44:47], v[84:87], a[88:91]
  v_cvt_pk_bf16_f32 v137, v114, v115
  v_cvt_pk_bf16_f32 v138, v116, v117
  v_mfma_f32_16x16x32_bf16 a[92:95], v[44:47], v[100:103], a[92:95]
  v_cvt_pk_bf16_f32 v139, v118, v119
  v_accvgpr_read_b32 v120, a52
  s_waitcnt lgkmcnt(0)
  v_mfma_f32_16x16x32_bf16 a[72:75], v[48:51], v[72:75], a[72:75]
  s_barrier
  v_subrev_u32 v20, 0x8000, v20
  ds_read_b64_tr_b16 v[32:33], v20 offset:0
  ds_read_b64_tr_b16 v[34:35], v20 offset:512
  v_mfma_f32_16x16x32_bf16 a[76:79], v[48:51], v[88:91], a[76:79]
  v_subrev_u32 v21, 0x8000, v21
  ds_read_b64_tr_b16 v[36:37], v21 offset:0
  ds_read_b64_tr_b16 v[38:39], v21 offset:512
  v_mfma_f32_16x16x32_bf16 a[80:83], v[48:51], v[104:107], a[80:83]
  ds_read_b64_tr_b16 v[40:41], v20 offset:4096
  ds_read_b64_tr_b16 v[42:43], v20 offset:4608
  v_mfma_f32_16x16x32_bf16 a[84:87], v[52:55], v[72:75], a[84:87]
  ds_read_b64_tr_b16 v[44:45], v21 offset:4096
  ds_read_b64_tr_b16 v[46:47], v21 offset:4608
  v_mfma_f32_16x16x32_bf16 a[88:91], v[52:55], v[88:91], a[88:91]
  ds_read_b64_tr_b16 v[48:49], v20 offset:8192
  ds_read_b64_tr_b16 v[50:51], v20 offset:8704
  v_mfma_f32_16x16x32_bf16 a[92:95], v[52:55], v[104:107], a[92:95]
  ds_read_b64_tr_b16 v[52:53], v21 offset:8192
  ds_read_b64_tr_b16 v[54:55], v21 offset:8704
  v_mfma_f32_16x16x32_bf16 a[72:75], v[56:59], v[76:79], a[72:75]
  v_accvgpr_read_b32 v121, a53
  v_accvgpr_read_b32 v122, a54
  v_mfma_f32_16x16x32_bf16 a[76:79], v[56:59], v[92:95], a[76:79]
  v_accvgpr_read_b32 v123, a55
  v_accvgpr_read_b32 v124, a64
  v_mfma_f32_16x16x32_bf16 a[80:83], v[56:59], v[108:111], a[80:83]
  ds_read_b64_tr_b16 v[56:57], v20 offset:12288
  ds_read_b64_tr_b16 v[58:59], v20 offset:12800
  v_mfma_f32_16x16x32_bf16 a[84:87], v[60:63], v[76:79], a[84:87]
  v_accvgpr_read_b32 v125, a65
  v_accvgpr_read_b32 v126, a66
  v_mfma_f32_16x16x32_bf16 a[88:91], v[60:63], v[92:95], a[88:91]
  v_accvgpr_read_b32 v127, a67
  v_permlane16_swap_b32 v136, v138
  v_mfma_f32_16x16x32_bf16 a[92:95], v[60:63], v[108:111], a[92:95]
  ds_read_b64_tr_b16 v[60:61], v21 offset:12288
  ds_read_b64_tr_b16 v[62:63], v21 offset:12800
  v_permlane16_swap_b32 v137, v139
  v_cvt_pk_bf16_f32 v140, v120, v121
  v_cvt_pk_bf16_f32 v141, v122, v123
  v_cvt_pk_bf16_f32 v142, v124, v125
  v_cvt_pk_bf16_f32 v143, v126, v127
  v_accvgpr_read_b32 v128, a56
  v_accvgpr_read_b32 v129, a57
  v_accvgpr_read_b32 v130, a58
  v_accvgpr_read_b32 v131, a59
  v_accvgpr_read_b32 v132, a68
  v_accvgpr_read_b32 v133, a69
  v_accvgpr_read_b32 v134, a70
  v_accvgpr_read_b32 v135, a71
  buffer_store_dwordx4 v[136:139], v0, s[28:31], s33 offen offset:0 sc1
  v_permlane16_swap_b32 v140, v142
  v_permlane16_swap_b32 v141, v143
  v_cvt_pk_bf16_f32 v144, v128, v129
  v_cvt_pk_bf16_f32 v145, v130, v131
  v_cvt_pk_bf16_f32 v146, v132, v133
  v_cvt_pk_bf16_f32 v147, v134, v135
  buffer_store_dwordx4 v[140:143], v0, s[28:31], s33 offen offset:1024 sc1
  s_nop 0
  v_permlane16_swap_b32 v144, v146
  v_permlane16_swap_b32 v145, v147
  buffer_store_dwordx4 v[144:147], v0, s[28:31], s33 offen offset:2048 sc1
  s_waitcnt lgkmcnt(12)
  v_mfma_f32_16x16x32_bf16 a[96:99], v[32:35], v[64:67], a[96:99]
  v_mfma_f32_16x16x32_bf16 a[100:103], v[32:35], v[80:83], a[100:103]
  v_mfma_f32_16x16x32_bf16 a[104:107], v[32:35], v[96:99], a[104:107]
  v_mfma_f32_16x16x32_bf16 a[108:111], v[36:39], v[64:67], a[108:111]
  v_mfma_f32_16x16x32_bf16 a[112:115], v[36:39], v[80:83], a[112:115]
  s_add_u32 s33, s41, 3
  s_and_b32 s33, s33, 7
  v_mfma_f32_16x16x32_bf16 a[116:119], v[36:39], v[96:99], a[116:119]
  s_mul_i32 s33, s33, 3072
  v_accvgpr_read_b32 v112, a72
  s_waitcnt lgkmcnt(8)
  v_mfma_f32_16x16x32_bf16 a[96:99], v[40:43], v[68:71], a[96:99]
  v_accvgpr_read_b32 v113, a73
  v_accvgpr_read_b32 v114, a74
  v_mfma_f32_16x16x32_bf16 a[100:103], v[40:43], v[84:87], a[100:103]
  v_accvgpr_read_b32 v115, a75
  v_accvgpr_read_b32 v116, a84
  v_mfma_f32_16x16x32_bf16 a[104:107], v[40:43], v[100:103], a[104:107]
  v_accvgpr_read_b32 v117, a85
  v_accvgpr_read_b32 v118, a86
  v_mfma_f32_16x16x32_bf16 a[108:111], v[44:47], v[68:71], a[108:111]
  v_accvgpr_read_b32 v119, a87
  v_cvt_pk_bf16_f32 v136, v112, v113
  v_mfma_f32_16x16x32_bf16 a[112:115], v[44:47], v[84:87], a[112:115]
  v_cvt_pk_bf16_f32 v137, v114, v115
  v_cvt_pk_bf16_f32 v138, v116, v117
  v_mfma_f32_16x16x32_bf16 a[116:119], v[44:47], v[100:103], a[116:119]
  v_cvt_pk_bf16_f32 v139, v118, v119
  v_accvgpr_read_b32 v120, a76
  s_waitcnt lgkmcnt(0)
  v_mfma_f32_16x16x32_bf16 a[96:99], v[48:51], v[72:75], a[96:99]
  s_barrier
  ds_read_b64_tr_b16 v[32:33], v20 offset:16384
  ds_read_b64_tr_b16 v[34:35], v20 offset:16896
  v_mfma_f32_16x16x32_bf16 a[100:103], v[48:51], v[88:91], a[100:103]
  ds_read_b64_tr_b16 v[36:37], v21 offset:16384
  ds_read_b64_tr_b16 v[38:39], v21 offset:16896
  v_mfma_f32_16x16x32_bf16 a[104:107], v[48:51], v[104:107], a[104:107]
  ds_read_b64_tr_b16 v[40:41], v20 offset:20480
  ds_read_b64_tr_b16 v[42:43], v20 offset:20992
  v_mfma_f32_16x16x32_bf16 a[108:111], v[52:55], v[72:75], a[108:111]
  ds_read_b64_tr_b16 v[44:45], v21 offset:20480
  ds_read_b64_tr_b16 v[46:47], v21 offset:20992
  v_mfma_f32_16x16x32_bf16 a[112:115], v[52:55], v[88:91], a[112:115]
  ds_read_b64_tr_b16 v[48:49], v20 offset:24576
  ds_read_b64_tr_b16 v[50:51], v20 offset:25088
  v_mfma_f32_16x16x32_bf16 a[116:119], v[52:55], v[104:107], a[116:119]
  ds_read_b64_tr_b16 v[52:53], v21 offset:24576
  ds_read_b64_tr_b16 v[54:55], v21 offset:25088
  v_mfma_f32_16x16x32_bf16 a[96:99], v[56:59], v[76:79], a[96:99]
  v_accvgpr_read_b32 v121, a77
  v_accvgpr_read_b32 v122, a78
  v_mfma_f32_16x16x32_bf16 a[100:103], v[56:59], v[92:95], a[100:103]
  v_accvgpr_read_b32 v123, a79
  v_accvgpr_read_b32 v124, a88
  v_mfma_f32_16x16x32_bf16 a[104:107], v[56:59], v[108:111], a[104:107]
  ds_read_b64_tr_b16 v[56:57], v20 offset:28672
  ds_read_b64_tr_b16 v[58:59], v20 offset:29184
  v_mfma_f32_16x16x32_bf16 a[108:111], v[60:63], v[76:79], a[108:111]
  v_accvgpr_read_b32 v125, a89
  v_accvgpr_read_b32 v126, a90
  v_mfma_f32_16x16x32_bf16 a[112:115], v[60:63], v[92:95], a[112:115]
  v_accvgpr_read_b32 v127, a91
  v_permlane16_swap_b32 v136, v138
  v_mfma_f32_16x16x32_bf16 a[116:119], v[60:63], v[108:111], a[116:119]
  ds_read_b64_tr_b16 v[60:61], v21 offset:28672
  ds_read_b64_tr_b16 v[62:63], v21 offset:29184
  v_permlane16_swap_b32 v137, v139
  v_cvt_pk_bf16_f32 v140, v120, v121
  v_cvt_pk_bf16_f32 v141, v122, v123
  v_cvt_pk_bf16_f32 v142, v124, v125
  v_cvt_pk_bf16_f32 v143, v126, v127
  v_accvgpr_read_b32 v128, a80
  v_accvgpr_read_b32 v129, a81
  v_accvgpr_read_b32 v130, a82
  v_accvgpr_read_b32 v131, a83
  v_accvgpr_read_b32 v132, a92
  v_accvgpr_read_b32 v133, a93
  v_accvgpr_read_b32 v134, a94
  v_accvgpr_read_b32 v135, a95
  buffer_store_dwordx4 v[136:139], v0, s[28:31], s33 offen offset:0 sc1
  v_permlane16_swap_b32 v140, v142
  v_permlane16_swap_b32 v141, v143
  v_cvt_pk_bf16_f32 v144, v128, v129
  v_cvt_pk_bf16_f32 v145, v130, v131
  v_cvt_pk_bf16_f32 v146, v132, v133
  v_cvt_pk_bf16_f32 v147, v134, v135
  buffer_store_dwordx4 v[140:143], v0, s[28:31], s33 offen offset:1024 sc1
  s_nop 0
  v_permlane16_swap_b32 v144, v146
  v_permlane16_swap_b32 v145, v147
  buffer_store_dwordx4 v[144:147], v0, s[28:31], s33 offen offset:2048 sc1
  s_waitcnt lgkmcnt(12)
  v_mfma_f32_16x16x32_bf16 a[120:123], v[32:35], v[64:67], a[120:123]
  v_mfma_f32_16x16x32_bf16 a[124:127], v[32:35], v[80:83], a[124:127]
  v_mfma_f32_16x16x32_bf16 a[128:131], v[32:35], v[96:99], a[128:131]
  v_mfma_f32_16x16x32_bf16 a[132:135], v[36:39], v[64:67], a[132:135]
  v_mfma_f32_16x16x32_bf16 a[136:139], v[36:39], v[80:83], a[136:139]
  s_add_u32 s33, s41, 4
  s_and_b32 s33, s33, 7
  v_mfma_f32_16x16x32_bf16 a[140:143], v[36:39], v[96:99], a[140:143]
  s_mul_i32 s33, s33, 3072
  v_accvgpr_read_b32 v112, a96
  s_waitcnt lgkmcnt(8)
  v_mfma_f32_16x16x32_bf16 a[120:123], v[40:43], v[68:71], a[120:123]
  v_accvgpr_read_b32 v113, a97
  v_accvgpr_read_b32 v114, a98
  v_mfma_f32_16x16x32_bf16 a[124:127], v[40:43], v[84:87], a[124:127]
  v_accvgpr_read_b32 v115, a99
  v_accvgpr_read_b32 v116, a108
  v_mfma_f32_16x16x32_bf16 a[128:131], v[40:43], v[100:103], a[128:131]
  v_accvgpr_read_b32 v117, a109
  v_accvgpr_read_b32 v118, a110
  v_mfma_f32_16x16x32_bf16 a[132:135], v[44:47], v[68:71], a[132:135]
  v_accvgpr_read_b32 v119, a111
  v_cvt_pk_bf16_f32 v136, v112, v113
  v_mfma_f32_16x16x32_bf16 a[136:139], v[44:47], v[84:87], a[136:139]
  v_cvt_pk_bf16_f32 v137, v114, v115
  v_cvt_pk_bf16_f32 v138, v116, v117
  v_mfma_f32_16x16x32_bf16 a[140:143], v[44:47], v[100:103], a[140:143]
  v_cvt_pk_bf16_f32 v139, v118, v119
  v_accvgpr_read_b32 v120, a100
  s_waitcnt lgkmcnt(0)
  v_mfma_f32_16x16x32_bf16 a[120:123], v[48:51], v[72:75], a[120:123]
  s_barrier
  v_subrev_u32 v20, 0x10000, v20
  ds_read_b64_tr_b16 v[32:33], v20 offset:0
  ds_read_b64_tr_b16 v[34:35], v20 offset:512
  v_mfma_f32_16x16x32_bf16 a[124:127], v[48:51], v[88:91], a[124:127]
  v_subrev_u32 v21, 0x10000, v21
  ds_read_b64_tr_b16 v[36:37], v21 offset:0
  ds_read_b64_tr_b16 v[38:39], v21 offset:512
  v_mfma_f32_16x16x32_bf16 a[128:131], v[48:51], v[104:107], a[128:131]
  ds_read_b64_tr_b16 v[40:41], v20 offset:4096
  ds_read_b64_tr_b16 v[42:43], v20 offset:4608
  v_mfma_f32_16x16x32_bf16 a[132:135], v[52:55], v[72:75], a[132:135]
  ds_read_b64_tr_b16 v[44:45], v21 offset:4096
  ds_read_b64_tr_b16 v[46:47], v21 offset:4608
  v_mfma_f32_16x16x32_bf16 a[136:139], v[52:55], v[88:91], a[136:139]
  ds_read_b64_tr_b16 v[48:49], v20 offset:8192
  ds_read_b64_tr_b16 v[50:51], v20 offset:8704
  v_mfma_f32_16x16x32_bf16 a[140:143], v[52:55], v[104:107], a[140:143]
  ds_read_b64_tr_b16 v[52:53], v21 offset:8192
  ds_read_b64_tr_b16 v[54:55], v21 offset:8704
  v_mfma_f32_16x16x32_bf16 a[120:123], v[56:59], v[76:79], a[120:123]
  v_accvgpr_read_b32 v121, a101
  v_accvgpr_read_b32 v122, a102
  v_mfma_f32_16x16x32_bf16 a[124:127], v[56:59], v[92:95], a[124:127]
  v_accvgpr_read_b32 v123, a103
  v_accvgpr_read_b32 v124, a112
  v_mfma_f32_16x16x32_bf16 a[128:131], v[56:59], v[108:111], a[128:131]
  ds_read_b64_tr_b16 v[56:57], v20 offset:12288
  ds_read_b64_tr_b16 v[58:59], v20 offset:12800
  v_mfma_f32_16x16x32_bf16 a[132:135], v[60:63], v[76:79], a[132:135]
  v_accvgpr_read_b32 v125, a113
  v_accvgpr_read_b32 v126, a114
  v_mfma_f32_16x16x32_bf16 a[136:139], v[60:63], v[92:95], a[136:139]
  v_accvgpr_read_b32 v127, a115
  v_permlane16_swap_b32 v136, v138
  v_mfma_f32_16x16x32_bf16 a[140:143], v[60:63], v[108:111], a[140:143]
  ds_read_b64_tr_b16 v[60:61], v21 offset:12288
  ds_read_b64_tr_b16 v[62:63], v21 offset:12800
  v_permlane16_swap_b32 v137, v139
  v_cvt_pk_bf16_f32 v140, v120, v121
  v_cvt_pk_bf16_f32 v141, v122, v123
  v_cvt_pk_bf16_f32 v142, v124, v125
  v_cvt_pk_bf16_f32 v143, v126, v127
  v_accvgpr_read_b32 v128, a104
  v_accvgpr_read_b32 v129, a105
  v_accvgpr_read_b32 v130, a106
  v_accvgpr_read_b32 v131, a107
  v_accvgpr_read_b32 v132, a116
  v_accvgpr_read_b32 v133, a117
  v_accvgpr_read_b32 v134, a118
  v_accvgpr_read_b32 v135, a119
  buffer_store_dwordx4 v[136:139], v0, s[28:31], s33 offen offset:0 sc1
  v_permlane16_swap_b32 v140, v142
  v_permlane16_swap_b32 v141, v143
  v_cvt_pk_bf16_f32 v144, v128, v129
  v_cvt_pk_bf16_f32 v145, v130, v131
  v_cvt_pk_bf16_f32 v146, v132, v133
  v_cvt_pk_bf16_f32 v147, v134, v135
  buffer_store_dwordx4 v[140:143], v0, s[28:31], s33 offen offset:1024 sc1
  s_nop 0
  v_permlane16_swap_b32 v144, v146
  v_permlane16_swap_b32 v145, v147
  buffer_store_dwordx4 v[144:147], v0, s[28:31], s33 offen offset:2048 sc1
  s_waitcnt lgkmcnt(12)
  v_mfma_f32_16x16x32_bf16 a[144:147], v[32:35], v[64:67], a[144:147]
  v_mfma_f32_16x16x32_bf16 a[148:151], v[32:35], v[80:83], a[148:151]
  v_mfma_f32_16x16x32_bf16 a[152:155], v[32:35], v[96:99], a[152:155]
  v_mfma_f32_16x16x32_bf16 a[156:159], v[36:39], v[64:67], a[156:159]
  v_mfma_f32_16x16x32_bf16 a[160:163], v[36:39], v[80:83], a[160:163]
  s_add_u32 s33, s41, 5
  s_and_b32 s33, s33, 7
  v_mfma_f32_16x16x32_bf16 a[164:167], v[36:39], v[96:99], a[164:167]
  s_mul_i32 s33, s33, 3072
  v_accvgpr_read_b32 v112, a120
  s_waitcnt lgkmcnt(8)
  v_mfma_f32_16x16x32_bf16 a[144:147], v[40:43], v[68:71], a[144:147]
  v_accvgpr_read_b32 v113, a121
  v_accvgpr_read_b32 v114, a122
  v_mfma_f32_16x16x32_bf16 a[148:151], v[40:43], v[84:87], a[148:151]
  v_accvgpr_read_b32 v115, a123
  v_accvgpr_read_b32 v116, a132
  v_mfma_f32_16x16x32_bf16 a[152:155], v[40:43], v[100:103], a[152:155]
  v_accvgpr_read_b32 v117, a133
  v_accvgpr_read_b32 v118, a134
  v_mfma_f32_16x16x32_bf16 a[156:159], v[44:47], v[68:71], a[156:159]
  v_accvgpr_read_b32 v119, a135
  v_cvt_pk_bf16_f32 v136, v112, v113
  v_mfma_f32_16x16x32_bf16 a[160:163], v[44:47], v[84:87], a[160:163]
  v_cvt_pk_bf16_f32 v137, v114, v115
  v_cvt_pk_bf16_f32 v138, v116, v117
  v_mfma_f32_16x16x32_bf16 a[164:167], v[44:47], v[100:103], a[164:167]
  v_cvt_pk_bf16_f32 v139, v118, v119
  v_accvgpr_read_b32 v120, a124
  s_waitcnt lgkmcnt(0)
  v_mfma_f32_16x16x32_bf16 a[144:147], v[48:51], v[72:75], a[144:147]
  s_barrier
  v_add_u32 v20, 0x18000, v20
  ds_read_b64_tr_b16 v[32:33], v20 offset:0
  ds_read_b64_tr_b16 v[34:35], v20 offset:512
  v_mfma_f32_16x16x32_bf16 a[148:151], v[48:51], v[88:91], a[148:151]
  v_add_u32 v21, 0x18000, v21
  ds_read_b64_tr_b16 v[36:37], v21 offset:0
  ds_read_b64_tr_b16 v[38:39], v21 offset:512
  v_mfma_f32_16x16x32_bf16 a[152:155], v[48:51], v[104:107], a[152:155]
  ds_read_b64_tr_b16 v[40:41], v20 offset:4096
  ds_read_b64_tr_b16 v[42:43], v20 offset:4608
  v_mfma_f32_16x16x32_bf16 a[156:159], v[52:55], v[72:75], a[156:159]
  ds_read_b64_tr_b16 v[44:45], v21 offset:4096
  ds_read_b64_tr_b16 v[46:47], v21 offset:4608
  v_mfma_f32_16x16x32_bf16 a[160:163], v[52:55], v[88:91], a[160:163]
  ds_read_b64_tr_b16 v[48:49], v20 offset:8192
  ds_read_b64_tr_b16 v[50:51], v20 offset:8704
  v_mfma_f32_16x16x32_bf16 a[164:167], v[52:55], v[104:107], a[164:167]
  ds_read_b64_tr_b16 v[52:53], v21 offset:8192
  ds_read_b64_tr_b16 v[54:55], v21 offset:8704
  v_mfma_f32_16x16x32_bf16 a[144:147], v[56:59], v[76:79], a[144:147]
  v_accvgpr_read_b32 v121, a125
  v_accvgpr_read_b32 v122, a126
  v_mfma_f32_16x16x32_bf16 a[148:151], v[56:59], v[92:95], a[148:151]
  v_accvgpr_read_b32 v123, a127
  v_accvgpr_read_b32 v124, a136
  v_mfma_f32_16x16x32_bf16 a[152:155], v[56:59], v[108:111], a[152:155]
  ds_read_b64_tr_b16 v[56:57], v20 offset:12288
  ds_read_b64_tr_b16 v[58:59], v20 offset:12800
  v_mfma_f32_16x16x32_bf16 a[156:159], v[60:63], v[76:79], a[156:159]
  v_accvgpr_read_b32 v125, a137
  v_accvgpr_read_b32 v126, a138
  v_mfma_f32_16x16x32_bf16 a[160:163], v[60:63], v[92:95], a[160:163]
  v_accvgpr_read_b32 v127, a139
  v_permlane16_swap_b32 v136, v138
  v_mfma_f32_16x16x32_bf16 a[164:167], v[60:63], v[108:111], a[164:167]
  ds_read_b64_tr_b16 v[60:61], v21 offset:12288
  ds_read_b64_tr_b16 v[62:63], v21 offset:12800
  v_permlane16_swap_b32 v137, v139
  v_cvt_pk_bf16_f32 v140, v120, v121
  v_cvt_pk_bf16_f32 v141, v122, v123
  v_cvt_pk_bf16_f32 v142, v124, v125
  v_cvt_pk_bf16_f32 v143, v126, v127
  v_accvgpr_read_b32 v128, a128
  v_accvgpr_read_b32 v129, a129
  v_accvgpr_read_b32 v130, a130
  v_accvgpr_read_b32 v131, a131
  v_accvgpr_read_b32 v132, a140
  v_accvgpr_read_b32 v133, a141
  v_accvgpr_read_b32 v134, a142
  v_accvgpr_read_b32 v135, a143
  buffer_store_dwordx4 v[136:139], v0, s[28:31], s33 offen offset:0 sc1
  v_permlane16_swap_b32 v140, v142
  v_permlane16_swap_b32 v141, v143
  v_cvt_pk_bf16_f32 v144, v128, v129
  v_cvt_pk_bf16_f32 v145, v130, v131
  v_cvt_pk_bf16_f32 v146, v132, v133
  v_cvt_pk_bf16_f32 v147, v134, v135
  buffer_store_dwordx4 v[140:143], v0, s[28:31], s33 offen offset:1024 sc1
  s_nop 0
  v_permlane16_swap_b32 v144, v146
  v_permlane16_swap_b32 v145, v147
  buffer_store_dwordx4 v[144:147], v0, s[28:31], s33 offen offset:2048 sc1
  s_waitcnt lgkmcnt(12)
  v_mfma_f32_16x16x32_bf16 a[168:171], v[32:35], v[64:67], a[168:171]
  v_mfma_f32_16x16x32_bf16 a[172:175], v[32:35], v[80:83], a[172:175]
  v_mfma_f32_16x16x32_bf16 a[176:179], v[32:35], v[96:99], a[176:179]
  v_mfma_f32_16x16x32_bf16 a[180:183], v[36:39], v[64:67], a[180:183]
  v_mfma_f32_16x16x32_bf16 a[184:187], v[36:39], v[80:83], a[184:187]
  s_add_u32 s33, s41, 6
  s_and_b32 s33, s33, 7
  v_mfma_f32_16x16x32_bf16 a[188:191], v[36:39], v[96:99], a[188:191]
  s_mul_i32 s33, s33, 3072
  v_accvgpr_read_b32 v112, a144
  s_waitcnt lgkmcnt(8)
  v_mfma_f32_16x16x32_bf16 a[168:171], v[40:43], v[68:71], a[168:171]
  v_accvgpr_read_b32 v113, a145
  v_accvgpr_read_b32 v114, a146
  v_mfma_f32_16x16x32_bf16 a[172:175], v[40:43], v[84:87], a[172:175]
  v_accvgpr_read_b32 v115, a147
  v_accvgpr_read_b32 v116, a156
  v_mfma_f32_16x16x32_bf16 a[176:179], v[40:43], v[100:103], a[176:179]
  v_accvgpr_read_b32 v117, a157
  v_accvgpr_read_b32 v118, a158
  v_mfma_f32_16x16x32_bf16 a[180:183], v[44:47], v[68:71], a[180:183]
  v_accvgpr_read_b32 v119, a159
  v_cvt_pk_bf16_f32 v136, v112, v113
  v_mfma_f32_16x16x32_bf16 a[184:187], v[44:47], v[84:87], a[184:187]
  v_cvt_pk_bf16_f32 v137, v114, v115
  v_cvt_pk_bf16_f32 v138, v116, v117
  v_mfma_f32_16x16x32_bf16 a[188:191], v[44:47], v[100:103], a[188:191]
  v_cvt_pk_bf16_f32 v139, v118, v119
  v_accvgpr_read_b32 v120, a148
  s_waitcnt lgkmcnt(0)
  v_mfma_f32_16x16x32_bf16 a[168:171], v[48:51], v[72:75], a[168:171]
  s_barrier
  v_accvgpr_read_b32 v121, a149
  v_accvgpr_read_b32 v122, a150
  v_mfma_f32_16x16x32_bf16 a[172:175], v[48:51], v[88:91], a[172:175]
  v_accvgpr_read_b32 v123, a151
  v_accvgpr_read_b32 v124, a160
  v_mfma_f32_16x16x32_bf16 a[176:179], v[48:51], v[104:107], a[176:179]
  v_accvgpr_read_b32 v125, a161
  v_accvgpr_read_b32 v126, a162
  v_mfma_f32_16x16x32_bf16 a[180:183], v[52:55], v[72:75], a[180:183]
  v_accvgpr_read_b32 v127, a163
  v_permlane16_swap_b32 v136, v138
  v_mfma_f32_16x16x32_bf16 a[184:187], v[52:55], v[88:91], a[184:187]
  v_permlane16_swap_b32 v137, v139
  v_cvt_pk_bf16_f32 v140, v120, v121
  v_mfma_f32_16x16x32_bf16 a[188:191], v[52:55], v[104:107], a[188:191]
  v_cvt_pk_bf16_f32 v141, v122, v123
  v_cvt_pk_bf16_f32 v142, v124, v125
  v_mfma_f32_16x16x32_bf16 a[168:171], v[56:59], v[76:79], a[168:171]
  v_cvt_pk_bf16_f32 v143, v126, v127
  v_accvgpr_read_b32 v128, a152
  v_mfma_f32_16x16x32_bf16 a[172:175], v[56:59], v[92:95], a[172:175]
  v_accvgpr_read_b32 v129, a153
  v_accvgpr_read_b32 v130, a154
  v_mfma_f32_16x16x32_bf16 a[176:179], v[56:59], v[108:111], a[176:179]
  v_accvgpr_read_b32 v131, a155
  v_accvgpr_read_b32 v132, a164
  v_mfma_f32_16x16x32_bf16 a[180:183], v[60:63], v[76:79], a[180:183]
  v_accvgpr_read_b32 v133, a165
  v_accvgpr_read_b32 v134, a166
  v_mfma_f32_16x16x32_bf16 a[184:187], v[60:63], v[92:95], a[184:187]
  v_accvgpr_read_b32 v135, a167
  buffer_store_dwordx4 v[136:139], v0, s[28:31], s33 offen offset:0 sc1
  v_mfma_f32_16x16x32_bf16 a[188:191], v[60:63], v[108:111], a[188:191]
  v_permlane16_swap_b32 v140, v142
  v_permlane16_swap_b32 v141, v143
  v_cvt_pk_bf16_f32 v144, v128, v129
  v_cvt_pk_bf16_f32 v145, v130, v131
  v_cvt_pk_bf16_f32 v146, v132, v133
  v_cvt_pk_bf16_f32 v147, v134, v135
  buffer_store_dwordx4 v[140:143], v0, s[28:31], s33 offen offset:1024 sc1
  s_nop 0
  v_permlane16_swap_b32 v144, v146
  v_permlane16_swap_b32 v145, v147
  buffer_store_dwordx4 v[144:147], v0, s[28:31], s33 offen offset:2048 sc1
  s_nop 7
  s_and_b32 s3, s2, 3
  s_lshl_b32 s3, s3, 2
  s_lshr_b32 s22, s2, 6
  s_add_u32 s22, s22, s3
  s_lshr_b32 s3, s2, 3
  s_and_b32 s23, s3, 7
  s_lshr_b32 s3, s2, 2
  s_and_b32 s24, s3, 1
  s_lshl_b32 s25, s24, 3
  s_add_u32 s25, s25, s23
  v_lshrrev_b32 v2, 4, v0
  v_lshrrev_b32 v172, 2, v0
  v_mov_b32 v1, 0
  v_mov_b32 v5, 0x27100
  s_mov_b32 s16, s98
  s_mov_b32 s17, s99
  s_mov_b32 s18, 256
  s_mov_b32 s19, 0x20000
  s_lshl_b32 s36, s25, 4
  s_lshl_b32 s3, s25, 7
  s_add_u32 s3, s3, 0x2000000
  s_add_u32 s56, s62, s3
  s_addc_u32 s57, s63, 0
  s_mov_b32 s58, 64
  s_mov_b32 s59, 0x20000
  s_lshl_b32 s37, 1, s22
  s_cmp_eq_u32 s38, 0
  s_cbranch_scc0 FZ_AR0
  s_mov_b64 exec, 0xffff
  buffer_load_ubyte v169, v2, s[16:19], s36 offen sc1
  buffer_load_dword v168, v172, s[56:59], 0 offen sc1
  s_mov_b64 exec, -1
FZ_AR0:
  s_add_u32 s33, s41, 7
  s_and_b32 s33, s33, 7
  s_mul_i32 s33, s33, 3072
  v_accvgpr_read_b32 v112, a168
  v_accvgpr_read_b32 v113, a169
  v_accvgpr_read_b32 v114, a170
  v_accvgpr_read_b32 v115, a171
  v_accvgpr_read_b32 v116, a180
  v_accvgpr_read_b32 v117, a181
  v_accvgpr_read_b32 v118, a182
  v_accvgpr_read_b32 v119, a183
  v_cvt_pk_bf16_f32 v136, v112, v113
  v_cvt_pk_bf16_f32 v137, v114, v115
  v_cvt_pk_bf16_f32 v138, v116, v117
  v_cvt_pk_bf16_f32 v139, v118, v119
  v_accvgpr_read_b32 v120, a172
  v_accvgpr_read_b32 v121, a173
  v_accvgpr_read_b32 v122, a174
  v_accvgpr_read_b32 v123, a175
  v_accvgpr_read_b32 v124, a184
  v_accvgpr_read_b32 v125, a185
  v_accvgpr_read_b32 v126, a186
  v_accvgpr_read_b32 v127, a187
  v_permlane16_swap_b32 v136, v138
  v_permlane16_swap_b32 v137, v139
  v_cvt_pk_bf16_f32 v140, v120, v121
  v_cvt_pk_bf16_f32 v141, v122, v123
  v_cvt_pk_bf16_f32 v142, v124, v125
  v_cvt_pk_bf16_f32 v143, v126, v127
  v_accvgpr_read_b32 v128, a176
  v_accvgpr_read_b32 v129, a177
  v_accvgpr_read_b32 v130, a178
  v_accvgpr_read_b32 v131, a179
  v_accvgpr_read_b32 v132, a188
  v_accvgpr_read_b32 v133, a189
  v_accvgpr_read_b32 v134, a190
  v_accvgpr_read_b32 v135, a191
  buffer_store_dwordx4 v[136:139], v0, s[28:31], s33 offen offset:0 sc1
  v_permlane16_swap_b32 v140, v142
  v_permlane16_swap_b32 v141, v143
  v_cvt_pk_bf16_f32 v144, v128, v129
  v_cvt_pk_bf16_f32 v145, v130, v131
  v_cvt_pk_bf16_f32 v146, v132, v133
  v_cvt_pk_bf16_f32 v147, v134, v135
  buffer_store_dwordx4 v[140:143], v0, s[28:31], s33 offen offset:1024 sc1
  s_nop 0
  v_permlane16_swap_b32 v144, v146
  v_permlane16_swap_b32 v145, v147
  buffer_store_dwordx4 v[144:147], v0, s[28:31], s33 offen offset:2048 sc1
  s_load_dwordx2 s[4:5], s[0:1], 80
  s_mul_i32 s26, s22, 6
  s_lshl_b32 s3, s38, 1
  s_add_u32 s26, s26, s3
  s_max_u32 s26, s26, 2
  s_sub_u32 s26, s26, 2
  s_mul_i32 s3, s25, 1572864
  s_lshl_b32 s27, s26, 10
  s_add_u32 s3, s3, s27
  s_add_u32 s8, s62, s3
  s_addc_u32 s9, s63, 0
  s_mov_b32 s10, 1476608
  s_mov_b32 s11, 0x20000
  s_mul_i32 s44, s26, 2731
  s_lshr_b32 s44, s44, 16
  s_mul_i32 s45, s44, 24
  s_sub_u32 s45, s26, s45
  s_mul_i32 s46, s45, 21846
  s_lshr_b32 s46, s46, 16
  s_mul_i32 s47, s46, 3
  s_sub_u32 s47, s45, s47
  s_mul_i32 s52, s23, 96
  s_lshr_b32 s48, s44, 1
  s_mul_i32 s48, s48, 48
  s_add_u32 s52, s52, s48
  s_lshl_b32 s48, s47, 4
  s_add_u32 s52, s52, s48
  s_lshl_b32 s52, s52, 11
  s_lshl_b32 s48, s24, 10
  s_add_u32 s52, s52, s48
  s_lshl_b32 s48, s46, 7
  s_add_u32 s52, s52, s48
  s_and_b32 s48, s44, 1
  s_lshl_b32 s48, s48, 6
  s_add_u32 s52, s52, s48
  s_add_u32 s27, s26, 1
  s_mul_i32 s44, s27, 2731
  s_lshr_b32 s44, s44, 16
  s_mul_i32 s45, s44, 24
  s_sub_u32 s45, s27, s45
  s_mul_i32 s46, s45, 21846
  s_lshr_b32 s46, s46, 16
  s_mul_i32 s47, s46, 3
  s_sub_u32 s47, s45, s47
  s_mul_i32 s53, s23, 96
  s_lshr_b32 s48, s44, 1
  s_mul_i32 s48, s48, 48
  s_add_u32 s53, s53, s48
  s_lshl_b32 s48, s47, 4
  s_add_u32 s53, s53, s48
  s_lshl_b32 s53, s53, 11
  s_lshl_b32 s48, s24, 10
  s_add_u32 s53, s53, s48
  s_lshl_b32 s48, s46, 7
  s_add_u32 s53, s53, s48
  s_and_b32 s48, s44, 1
  s_lshl_b32 s48, s48, 6
  s_add_u32 s53, s53, s48
  v_and_b32 v4, 15, v2
  v_lshlrev_b32 v4, 11, v4
  v_bfe_u32 v6, v2, 4, 1
  v_lshl_add_u32 v4, v6, 5, v4
  v_lshrrev_b32 v6, 5, v2
  v_lshl_add_u32 v4, v6, 4, v4
  s_mov_b32 s40, 0
  s_mov_b32 s41, 0
  s_waitcnt vmcnt(0) lgkmcnt(0)
  s_mov_b32 s28, s4
  s_mov_b32 s29, s5
  s_mov_b32 s30, 1572864
  s_mov_b32 s31, 0x20000
  s_cmp_eq_u32 s38, 0
  s_cbranch_scc0 FZ_BR0
  s_mov_b64 exec, 0xffff
  v_cmp_lt_u32 vcc, 1, v169
  v_and_b32 v168, 1, v168
  s_and_b32 s60, vcc_lo, 0xffff
  v_xor_b32 v168, v168, v169
  v_and_b32 v168, 3, v168
  v_cmp_eq_u32 vcc, 2, v168
  s_nop 3
  s_and_b32 s61, vcc_lo, 0xffff
  s_or_b32 s61, s61, s37
  s_mov_b64 exec, -1
  v_mov_b32 v6, s61
  ds_write_b32 v5, v6
  s_waitcnt lgkmcnt(0)
FZ_BR0:
  s_barrier
  s_cmp_eq_u32 s38, 0
  s_cbranch_scc0 FZ_POLLR0
  s_and_b32 s55, s100, 1
  s_lshl_b32 s54, s22, 2
  v_mov_b32 v6, s55
  s_mov_b64 exec, 1
  buffer_store_dword v6, v1, s[56:59], s54 offen sc1
FZ_PR0:
  s_cmp_eq_u32 s61, 0xffff
  s_cbranch_scc1 FZ_ENDR0
  s_add_u32 s41, s41, 1
  s_cmp_ge_u32 s41, 200000
  s_cbranch_scc1 FZ_ENDR0
  s_mov_b64 exec, 0xffff
  s_cmp_eq_u32 s60, 0xffff
  s_cbranch_scc1 FZ_E1R0
  buffer_load_ubyte v169, v2, s[16:19], s36 offen sc1
FZ_E1R0:
  buffer_load_dword v168, v172, s[56:59], 0 offen sc1
  s_waitcnt vmcnt(0)
  v_cmp_lt_u32 vcc, 1, v169
  v_and_b32 v168, 1, v168
  s_and_b32 s60, vcc_lo, 0xffff
  v_xor_b32 v168, v168, v169
  v_and_b32 v168, 3, v168
  v_cmp_eq_u32 vcc, 2, v168
  s_nop 3
  s_and_b32 s61, vcc_lo, 0xffff
  s_or_b32 s61, s61, s37
  s_mov_b64 exec, -1
  v_mov_b32 v6, s61
  ds_write_b32 v5, v6
  s_branch FZ_PR0
FZ_POLLR0:
  ds_read_b32 v6, v5
  s_waitcnt lgkmcnt(0)
  v_readfirstlane_b32 s42, v6
  s_nop 3
  s_andn2_b32 s43, s42, s40
  s_or_b32 s40, s40, s43
  s_cmp_eq_u32 s43, 0
  s_cbranch_scc1 FZ_NONER0
  s_bitcmp1_b32 s43, 0
  s_cbranch_scc0 FZ_S0R0
  s_mov_b32 s49, 0
  buffer_load_dwordx4 v[8:11], v0, s[8:11], s49 offen sc1
  buffer_load_dwordx4 v[72:75], v0, s[8:11], s49 offen offset:1024 sc1
FZ_S0R0:
  s_bitcmp1_b32 s43, 1
  s_cbranch_scc0 FZ_S1R0
  s_mov_b32 s49, 98304
  buffer_load_dwordx4 v[12:15], v0, s[8:11], s49 offen sc1
  buffer_load_dwordx4 v[76:79], v0, s[8:11], s49 offen offset:1024 sc1
FZ_S1R0:
  s_bitcmp1_b32 s43, 2
  s_cbranch_scc0 FZ_S2R0
  s_mov_b32 s49, 196608
  buffer_load_dwordx4 v[16:19], v0, s[8:11], s49 offen sc1
  buffer_load_dwordx4 v[80:83], v0, s[8:11], s49 offen offset:1024 sc1
FZ_S2R0:
  s_bitcmp1_b32 s43, 3
  s_cbranch_scc0 FZ_S3R0
  s_mov_b32 s49, 294912
  buffer_load_dwordx4 v[20:23], v0, s[8:11], s49 offen sc1
  buffer_load_dwordx4 v[84:87], v0, s[8:11], s49 offen offset:1024 sc1
FZ_S3R0:
  s_bitcmp1_b32 s43, 4
  s_cbranch_scc0 FZ_S4R0
  s_mov_b32 s49, 393216
  buffer_load_dwordx4 v[24:27], v0, s[8:11], s49 offen sc1
  buffer_load_dwordx4 v[88:91], v0, s[8:11], s49 offen offset:1024 sc1
FZ_S4R0:
  s_bitcmp1_b32 s43, 5
  s_cbranch_scc0 FZ_S5R0
  s_mov_b32 s49, 491520
  buffer_load_dwordx4 v[28:31], v0, s[8:11], s49 offen sc1
  buffer_load_dwordx4 v[92:95], v0, s[8:11], s49 offen offset:1024 sc1
FZ_S5R0:
  s_bitcmp1_b32 s43, 6
  s_cbranch_scc0 FZ_S6R0
  s_mov_b32 s49, 589824
  buffer_load_dwordx4 v[32:35], v0, s[8:11], s49 offen sc1
  buffer_load_dwordx4 v[96:99], v0, s[8:11], s49 offen offset:1024 sc1
FZ_S6R0:
  s_bitcmp1_b32 s43, 7
  s_cbranch_scc0 FZ_S7R0
  s_mov_b32 s49, 688128
  buffer_load_dwordx4 v[36:39], v0, s[8:11], s49 offen sc1
  buffer_load_dwordx4 v[100:103], v0, s[8:11], s49 offen offset:1024 sc1
FZ_S7R0:
  s_bitcmp1_b32 s43, 8
  s_cbranch_scc0 FZ_S8R0
  s_mov_b32 s49, 786432
  buffer_load_dwordx4 v[40:43], v0, s[8:11], s49 offen sc1
  buffer_load_dwordx4 v[104:107], v0, s[8:11], s49 offen offset:1024 sc1
FZ_S8R0:
  s_bitcmp1_b32 s43, 9
  s_cbranch_scc0 FZ_S9R0
  s_mov_b32 s49, 884736
  buffer_load_dwordx4 v[44:47], v0, s[8:11], s49 offen sc1
  buffer_load_dwordx4 v[108:111], v0, s[8:11], s49 offen offset:1024 sc1
FZ_S9R0:
  s_bitcmp1_b32 s43, 10
  s_cbranch_scc0 FZ_S10R0
  s_mov_b32 s49, 983040
  buffer_load_dwordx4 v[48:51], v0, s[8:11], s49 offen sc1
  buffer_load_dwordx4 v[112:115], v0, s[8:11], s49 offen offset:1024 sc1
FZ_S10R0:
  s_bitcmp1_b32 s43, 11
  s_cbranch_scc0 FZ_S11R0
  s_mov_b32 s49, 1081344
  buffer_load_dwordx4 v[52:55], v0, s[8:11], s49 offen sc1
  buffer_load_dwordx4 v[116:119], v0, s[8:11], s49 offen offset:1024 sc1
FZ_S11R0:
  s_bitcmp1_b32 s43, 12
  s_cbranch_scc0 FZ_S12R0
  s_mov_b32 s49, 1179648
  buffer_load_dwordx4 v[56:59], v0, s[8:11], s49 offen sc1
  buffer_load_dwordx4 v[120:123], v0, s[8:11], s49 offen offset:1024 sc1
FZ_S12R0:
  s_bitcmp1_b32 s43, 13
  s_cbranch_scc0 FZ_S13R0
  s_mov_b32 s49, 1277952
  buffer_load_dwordx4 v[60:63], v0, s[8:11], s49 offen sc1
  buffer_load_dwordx4 v[124:127], v0, s[8:11], s49 offen offset:1024 sc1
FZ_S13R0:
  s_bitcmp1_b32 s43, 14
  s_cbranch_scc0 FZ_S14R0
  s_mov_b32 s49, 1376256
  buffer_load_dwordx4 v[64:67], v0, s[8:11], s49 offen sc1
  buffer_load_dwordx4 v[128:131], v0, s[8:11], s49 offen offset:1024 sc1
FZ_S14R0:
  s_bitcmp1_b32 s43, 15
  s_cbranch_scc0 FZ_S15R0
  s_mov_b32 s49, 1474560
  buffer_load_dwordx4 v[68:71], v0, s[8:11], s49 offen sc1
  buffer_load_dwordx4 v[132:135], v0, s[8:11], s49 offen offset:1024 sc1
FZ_S15R0:
FZ_NONER0:
  s_add_u32 s41, s41, 1
  s_cmp_ge_u32 s41, 3200000
  s_cbranch_scc1 FZ_DONER0
  s_cmp_eq_u32 s40, 0xffff
  s_cbranch_scc0 FZ_POLLR0
FZ_DONER0:
  s_mov_b32 s27, 0xffff0000
  s_waitcnt vmcnt(0)
  v_lshlrev_b32 v140, 16, v8
  v_and_b32 v141, s27, v8
  v_lshlrev_b32 v142, 16, v9
  v_and_b32 v143, s27, v9
  v_lshlrev_b32 v144, 16, v10
  v_and_b32 v145, s27, v10
  v_lshlrev_b32 v146, 16, v11
  v_and_b32 v147, s27, v11
  v_lshlrev_b32 v174, 16, v12
  v_and_b32 v175, s27, v12
  v_pk_add_f32 v[140:141], v[140:141], v[174:175]
  v_lshlrev_b32 v176, 16, v13
  v_and_b32 v177, s27, v13
  v_pk_add_f32 v[142:143], v[142:143], v[176:177]
  v_lshlrev_b32 v174, 16, v14
  v_and_b32 v175, s27, v14
  v_pk_add_f32 v[144:145], v[144:145], v[174:175]
  v_lshlrev_b32 v176, 16, v15
  v_and_b32 v177, s27, v15
  v_pk_add_f32 v[146:147], v[146:147], v[176:177]
  v_lshlrev_b32 v174, 16, v16
  v_and_b32 v175, s27, v16
  v_pk_add_f32 v[140:141], v[140:141], v[174:175]
  v_lshlrev_b32 v176, 16, v17
  v_and_b32 v177, s27, v17
  v_pk_add_f32 v[142:143], v[142:143], v[176:177]
  v_lshlrev_b32 v174, 16, v18
  v_and_b32 v175, s27, v18
  v_pk_add_f32 v[144:145], v[144:145], v[174:175]
  v_lshlrev_b32 v176, 16, v19
  v_and_b32 v177, s27, v19
  v_pk_add_f32 v[146:147], v[146:147], v[176:177]
  v_lshlrev_b32 v174, 16, v20
  v_and_b32 v175, s27, v20
  v_pk_add_f32 v[140:141], v[140:141], v[174:175]
  v_lshlrev_b32 v176, 16, v21
  v_and_b32 v177, s27, v21
  v_pk_add_f32 v[142:143], v[142:143], v[176:177]
  v_lshlrev_b32 v174, 16, v22
  v_and_b32 v175, s27, v22
  v_pk_add_f32 v[144:145], v[144:145], v[174:175]
  v_lshlrev_b32 v176, 16, v23
  v_and_b32 v177, s27, v23
  v_pk_add_f32 v[146:147], v[146:147], v[176:177]
  v_lshlrev_b32 v174, 16, v24
  v_and_b32 v175, s27, v24
  v_pk_add_f32 v[140:141], v[140:141], v[174:175]
  v_lshlrev_b32 v176, 16, v25
  v_and_b32 v177, s27, v25
  v_pk_add_f32 v[142:143], v[142:143], v[176:177]
  v_lshlrev_b32 v174, 16, v26
  v_and_b32 v175, s27, v26
  v_pk_add_f32 v[144:145], v[144:145], v[174:175]
  v_lshlrev_b32 v176, 16, v27
  v_and_b32 v177, s27, v27
  v_pk_add_f32 v[146:147], v[146:147], v[176:177]
  v_lshlrev_b32 v174, 16, v28
  v_and_b32 v175, s27, v28
  v_pk_add_f32 v[140:141], v[140:141], v[174:175]
  v_lshlrev_b32 v176, 16, v29
  v_and_b32 v177, s27, v29
  v_pk_add_f32 v[142:143], v[142:143], v[176:177]
  v_lshlrev_b32 v174, 16, v30
  v_and_b32 v175, s27, v30
  v_pk_add_f32 v[144:145], v[144:145], v[174:175]
  v_lshlrev_b32 v176, 16, v31
  v_and_b32 v177, s27, v31
  v_pk_add_f32 v[146:147], v[146:147], v[176:177]
  v_lshlrev_b32 v174, 16, v32
  v_and_b32 v175, s27, v32
  v_pk_add_f32 v[140:141], v[140:141], v[174:175]
  v_lshlrev_b32 v176, 16, v33
  v_and_b32 v177, s27, v33
  v_pk_add_f32 v[142:143], v[142:143], v[176:177]
  v_lshlrev_b32 v174, 16, v34
  v_and_b32 v175, s27, v34
  v_pk_add_f32 v[144:145], v[144:145], v[174:175]
  v_lshlrev_b32 v176, 16, v35
  v_and_b32 v177, s27, v35
  v_pk_add_f32 v[146:147], v[146:147], v[176:177]
  v_lshlrev_b32 v174, 16, v36
  v_and_b32 v175, s27, v36
  v_pk_add_f32 v[140:141], v[140:141], v[174:175]
  v_lshlrev_b32 v176, 16, v37
  v_and_b32 v177, s27, v37
  v_pk_add_f32 v[142:143], v[142:143], v[176:177]
  v_lshlrev_b32 v174, 16, v38
  v_and_b32 v175, s27, v38
  v_pk_add_f32 v[144:145], v[144:145], v[174:175]
  v_lshlrev_b32 v176, 16, v39
  v_and_b32 v177, s27, v39
  v_pk_add_f32 v[146:147], v[146:147], v[176:177]
  v_lshlrev_b32 v174, 16, v40
  v_and_b32 v175, s27, v40
  v_pk_add_f32 v[140:141], v[140:141], v[174:175]
  v_lshlrev_b32 v176, 16, v41
  v_and_b32 v177, s27, v41
  v_pk_add_f32 v[142:143], v[142:143], v[176:177]
  v_lshlrev_b32 v174, 16, v42
  v_and_b32 v175, s27, v42
  v_pk_add_f32 v[144:145], v[144:145], v[174:175]
  v_lshlrev_b32 v176, 16, v43
  v_and_b32 v177, s27, v43
  v_pk_add_f32 v[146:147], v[146:147], v[176:177]
  v_lshlrev_b32 v174, 16, v44
  v_and_b32 v175, s27, v44
  v_pk_add_f32 v[140:141], v[140:141], v[174:175]
  v_lshlrev_b32 v176, 16, v45
  v_and_b32 v177, s27, v45
  v_pk_add_f32 v[142:143], v[142:143], v[176:177]
  v_lshlrev_b32 v174, 16, v46
  v_and_b32 v175, s27, v46
  v_pk_add_f32 v[144:145], v[144:145], v[174:175]
  v_lshlrev_b32 v176, 16, v47
  v_and_b32 v177, s27, v47
  v_pk_add_f32 v[146:147], v[146:147], v[176:177]
  v_lshlrev_b32 v174, 16, v48
  v_and_b32 v175, s27, v48
  v_pk_add_f32 v[140:141], v[140:141], v[174:175]
  v_lshlrev_b32 v176, 16, v49
  v_and_b32 v177, s27, v49
  v_pk_add_f32 v[142:143], v[142:143], v[176:177]
  v_lshlrev_b32 v174, 16, v50
  v_and_b32 v175, s27, v50
  v_pk_add_f32 v[144:145], v[144:145], v[174:175]
  v_lshlrev_b32 v176, 16, v51
  v_and_b32 v177, s27, v51
  v_pk_add_f32 v[146:147], v[146:147], v[176:177]
  v_lshlrev_b32 v174, 16, v52
  v_and_b32 v175, s27, v52
  v_pk_add_f32 v[140:141], v[140:141], v[174:175]
  v_lshlrev_b32 v176, 16, v53
  v_and_b32 v177, s27, v53
  v_pk_add_f32 v[142:143], v[142:143], v[176:177]
  v_lshlrev_b32 v174, 16, v54
  v_and_b32 v175, s27, v54
  v_pk_add_f32 v[144:145], v[144:145], v[174:175]
  v_lshlrev_b32 v176, 16, v55
  v_and_b32 v177, s27, v55
  v_pk_add_f32 v[146:147], v[146:147], v[176:177]
  v_lshlrev_b32 v174, 16, v56
  v_and_b32 v175, s27, v56
  v_pk_add_f32 v[140:141], v[140:141], v[174:175]
  v_lshlrev_b32 v176, 16, v57
  v_and_b32 v177, s27, v57
  v_pk_add_f32 v[142:143], v[142:143], v[176:177]
  v_lshlrev_b32 v174, 16, v58
  v_and_b32 v175, s27, v58
  v_pk_add_f32 v[144:145], v[144:145], v[174:175]
  v_lshlrev_b32 v176, 16, v59
  v_and_b32 v177, s27, v59
  v_pk_add_f32 v[146:147], v[146:147], v[176:177]
  v_lshlrev_b32 v174, 16, v60
  v_and_b32 v175, s27, v60
  v_pk_add_f32 v[140:141], v[140:141], v[174:175]
  v_lshlrev_b32 v176, 16, v61
  v_and_b32 v177, s27, v61
  v_pk_add_f32 v[142:143], v[142:143], v[176:177]
  v_lshlrev_b32 v174, 16, v62
  v_and_b32 v175, s27, v62
  v_pk_add_f32 v[144:145], v[144:145], v[174:175]
  v_lshlrev_b32 v176, 16, v63
  v_and_b32 v177, s27, v63
  v_pk_add_f32 v[146:147], v[146:147], v[176:177]
  v_lshlrev_b32 v174, 16, v64
  v_and_b32 v175, s27, v64
  v_pk_add_f32 v[140:141], v[140:141], v[174:175]
  v_lshlrev_b32 v176, 16, v65
  v_and_b32 v177, s27, v65
  v_pk_add_f32 v[142:143], v[142:143], v[176:177]
  v_lshlrev_b32 v174, 16, v66
  v_and_b32 v175, s27, v66
  v_pk_add_f32 v[144:145], v[144:145], v[174:175]
  v_lshlrev_b32 v176, 16, v67
  v_and_b32 v177, s27, v67
  v_pk_add_f32 v[146:147], v[146:147], v[176:177]
  v_lshlrev_b32 v174, 16, v68
  v_and_b32 v175, s27, v68
  v_pk_add_f32 v[140:141], v[140:141], v[174:175]
  v_lshlrev_b32 v176, 16, v69
  v_and_b32 v177, s27, v69
  v_pk_add_f32 v[142:143], v[142:143], v[176:177]
  v_lshlrev_b32 v174, 16, v70
  v_and_b32 v175, s27, v70
  v_pk_add_f32 v[144:145], v[144:145], v[174:175]
  v_lshlrev_b32 v176, 16, v71
  v_and_b32 v177, s27, v71
  v_pk_add_f32 v[146:147], v[146:147], v[176:177]
  v_cvt_pk_bf16_f32 v160, v140, v141
  v_cvt_pk_bf16_f32 v161, v142, v143
  v_cvt_pk_bf16_f32 v162, v144, v145
  v_cvt_pk_bf16_f32 v163, v146, v147
  buffer_store_dwordx4 v[160:163], v4, s[28:31], s52 offen
  v_lshlrev_b32 v150, 16, v72
  v_and_b32 v151, s27, v72
  v_lshlrev_b32 v152, 16, v73
  v_and_b32 v153, s27, v73
  v_lshlrev_b32 v154, 16, v74
  v_and_b32 v155, s27, v74
  v_lshlrev_b32 v156, 16, v75
  v_and_b32 v157, s27, v75
  v_lshlrev_b32 v174, 16, v76
  v_and_b32 v175, s27, v76
  v_pk_add_f32 v[150:151], v[150:151], v[174:175]
  v_lshlrev_b32 v176, 16, v77
  v_and_b32 v177, s27, v77
  v_pk_add_f32 v[152:153], v[152:153], v[176:177]
  v_lshlrev_b32 v174, 16, v78
  v_and_b32 v175, s27, v78
  v_pk_add_f32 v[154:155], v[154:155], v[174:175]
  v_lshlrev_b32 v176, 16, v79
  v_and_b32 v177, s27, v79
  v_pk_add_f32 v[156:157], v[156:157], v[176:177]
  v_lshlrev_b32 v174, 16, v80
  v_and_b32 v175, s27, v80
  v_pk_add_f32 v[150:151], v[150:151], v[174:175]
  v_lshlrev_b32 v176, 16, v81
  v_and_b32 v177, s27, v81
  v_pk_add_f32 v[152:153], v[152:153], v[176:177]
  v_lshlrev_b32 v174, 16, v82
  v_and_b32 v175, s27, v82
  v_pk_add_f32 v[154:155], v[154:155], v[174:175]
  v_lshlrev_b32 v176, 16, v83
  v_and_b32 v177, s27, v83
  v_pk_add_f32 v[156:157], v[156:157], v[176:177]
  v_lshlrev_b32 v174, 16, v84
  v_and_b32 v175, s27, v84
  v_pk_add_f32 v[150:151], v[150:151], v[174:175]
  v_lshlrev_b32 v176, 16, v85
  v_and_b32 v177, s27, v85
  v_pk_add_f32 v[152:153], v[152:153], v[176:177]
  v_lshlrev_b32 v174, 16, v86
  v_and_b32 v175, s27, v86
  v_pk_add_f32 v[154:155], v[154:155], v[174:175]
  v_lshlrev_b32 v176, 16, v87
  v_and_b32 v177, s27, v87
  v_pk_add_f32 v[156:157], v[156:157], v[176:177]
  v_lshlrev_b32 v174, 16, v88
  v_and_b32 v175, s27, v88
  v_pk_add_f32 v[150:151], v[150:151], v[174:175]
  v_lshlrev_b32 v176, 16, v89
  v_and_b32 v177, s27, v89
  v_pk_add_f32 v[152:153], v[152:153], v[176:177]
  v_lshlrev_b32 v174, 16, v90
  v_and_b32 v175, s27, v90
  v_pk_add_f32 v[154:155], v[154:155], v[174:175]
  v_lshlrev_b32 v176, 16, v91
  v_and_b32 v177, s27, v91
  v_pk_add_f32 v[156:157], v[156:157], v[176:177]
  v_lshlrev_b32 v174, 16, v92
  v_and_b32 v175, s27, v92
  v_pk_add_f32 v[150:151], v[150:151], v[174:175]
  v_lshlrev_b32 v176, 16, v93
  v_and_b32 v177, s27, v93
  v_pk_add_f32 v[152:153], v[152:153], v[176:177]
  v_lshlrev_b32 v174, 16, v94
  v_and_b32 v175, s27, v94
  v_pk_add_f32 v[154:155], v[154:155], v[174:175]
  v_lshlrev_b32 v176, 16, v95
  v_and_b32 v177, s27, v95
  v_pk_add_f32 v[156:157], v[156:157], v[176:177]
  v_lshlrev_b32 v174, 16, v96
  v_and_b32 v175, s27, v96
  v_pk_add_f32 v[150:151], v[150:151], v[174:175]
  v_lshlrev_b32 v176, 16, v97
  v_and_b32 v177, s27, v97
  v_pk_add_f32 v[152:153], v[152:153], v[176:177]
  v_lshlrev_b32 v174, 16, v98
  v_and_b32 v175, s27, v98
  v_pk_add_f32 v[154:155], v[154:155], v[174:175]
  v_lshlrev_b32 v176, 16, v99
  v_and_b32 v177, s27, v99
  v_pk_add_f32 v[156:157], v[156:157], v[176:177]
  v_lshlrev_b32 v174, 16, v100
  v_and_b32 v175, s27, v100
  v_pk_add_f32 v[150:151], v[150:151], v[174:175]
  v_lshlrev_b32 v176, 16, v101
  v_and_b32 v177, s27, v101
  v_pk_add_f32 v[152:153], v[152:153], v[176:177]
  v_lshlrev_b32 v174, 16, v102
  v_and_b32 v175, s27, v102
  v_pk_add_f32 v[154:155], v[154:155], v[174:175]
  v_lshlrev_b32 v176, 16, v103
  v_and_b32 v177, s27, v103
  v_pk_add_f32 v[156:157], v[156:157], v[176:177]
  v_lshlrev_b32 v174, 16, v104
  v_and_b32 v175, s27, v104
  v_pk_add_f32 v[150:151], v[150:151], v[174:175]
  v_lshlrev_b32 v176, 16, v105
  v_and_b32 v177, s27, v105
  v_pk_add_f32 v[152:153], v[152:153], v[176:177]
  v_lshlrev_b32 v174, 16, v106
  v_and_b32 v175, s27, v106
  v_pk_add_f32 v[154:155], v[154:155], v[174:175]
  v_lshlrev_b32 v176, 16, v107
  v_and_b32 v177, s27, v107
  v_pk_add_f32 v[156:157], v[156:157], v[176:177]
  v_lshlrev_b32 v174, 16, v108
  v_and_b32 v175, s27, v108
  v_pk_add_f32 v[150:151], v[150:151], v[174:175]
  v_lshlrev_b32 v176, 16, v109
  v_and_b32 v177, s27, v109
  v_pk_add_f32 v[152:153], v[152:153], v[176:177]
  v_lshlrev_b32 v174, 16, v110
  v_and_b32 v175, s27, v110
  v_pk_add_f32 v[154:155], v[154:155], v[174:175]
  v_lshlrev_b32 v176, 16, v111
  v_and_b32 v177, s27, v111
  v_pk_add_f32 v[156:157], v[156:157], v[176:177]
  v_lshlrev_b32 v174, 16, v112
  v_and_b32 v175, s27, v112
  v_pk_add_f32 v[150:151], v[150:151], v[174:175]
  v_lshlrev_b32 v176, 16, v113
  v_and_b32 v177, s27, v113
  v_pk_add_f32 v[152:153], v[152:153], v[176:177]
  v_lshlrev_b32 v174, 16, v114
  v_and_b32 v175, s27, v114
  v_pk_add_f32 v[154:155], v[154:155], v[174:175]
  v_lshlrev_b32 v176, 16, v115
  v_and_b32 v177, s27, v115
  v_pk_add_f32 v[156:157], v[156:157], v[176:177]
  v_lshlrev_b32 v174, 16, v116
  v_and_b32 v175, s27, v116
  v_pk_add_f32 v[150:151], v[150:151], v[174:175]
  v_lshlrev_b32 v176, 16, v117
  v_and_b32 v177, s27, v117
  v_pk_add_f32 v[152:153], v[152:153], v[176:177]
  v_lshlrev_b32 v174, 16, v118
  v_and_b32 v175, s27, v118
  v_pk_add_f32 v[154:155], v[154:155], v[174:175]
  v_lshlrev_b32 v176, 16, v119
  v_and_b32 v177, s27, v119
  v_pk_add_f32 v[156:157], v[156:157], v[176:177]
  v_lshlrev_b32 v174, 16, v120
  v_and_b32 v175, s27, v120
  v_pk_add_f32 v[150:151], v[150:151], v[174:175]
  v_lshlrev_b32 v176, 16, v121
  v_and_b32 v177, s27, v121
  v_pk_add_f32 v[152:153], v[152:153], v[176:177]
  v_lshlrev_b32 v174, 16, v122
  v_and_b32 v175, s27, v122
  v_pk_add_f32 v[154:155], v[154:155], v[174:175]
  v_lshlrev_b32 v176, 16, v123
  v_and_b32 v177, s27, v123
  v_pk_add_f32 v[156:157], v[156:157], v[176:177]
  v_lshlrev_b32 v174, 16, v124
  v_and_b32 v175, s27, v124
  v_pk_add_f32 v[150:151], v[150:151], v[174:175]
  v_lshlrev_b32 v176, 16, v125
  v_and_b32 v177, s27, v125
  v_pk_add_f32 v[152:153], v[152:153], v[176:177]
  v_lshlrev_b32 v174, 16, v126
  v_and_b32 v175, s27, v126
  v_pk_add_f32 v[154:155], v[154:155], v[174:175]
  v_lshlrev_b32 v176, 16, v127
  v_and_b32 v177, s27, v127
  v_pk_add_f32 v[156:157], v[156:157], v[176:177]
  v_lshlrev_b32 v174, 16, v128
  v_and_b32 v175, s27, v128
  v_pk_add_f32 v[150:151], v[150:151], v[174:175]
  v_lshlrev_b32 v176, 16, v129
  v_and_b32 v177, s27, v129
  v_pk_add_f32 v[152:153], v[152:153], v[176:177]
  v_lshlrev_b32 v174, 16, v130
  v_and_b32 v175, s27, v130
  v_pk_add_f32 v[154:155], v[154:155], v[174:175]
  v_lshlrev_b32 v176, 16, v131
  v_and_b32 v177, s27, v131
  v_pk_add_f32 v[156:157], v[156:157], v[176:177]
  v_lshlrev_b32 v174, 16, v132
  v_and_b32 v175, s27, v132
  v_pk_add_f32 v[150:151], v[150:151], v[174:175]
  v_lshlrev_b32 v176, 16, v133
  v_and_b32 v177, s27, v133
  v_pk_add_f32 v[152:153], v[152:153], v[176:177]
  v_lshlrev_b32 v174, 16, v134
  v_and_b32 v175, s27, v134
  v_pk_add_f32 v[154:155], v[154:155], v[174:175]
  v_lshlrev_b32 v176, 16, v135
  v_and_b32 v177, s27, v135
  v_pk_add_f32 v[156:157], v[156:157], v[176:177]
  v_cvt_pk_bf16_f32 v164, v150, v151
  v_cvt_pk_bf16_f32 v165, v152, v153
  v_cvt_pk_bf16_f32 v166, v154, v155
  v_cvt_pk_bf16_f32 v167, v156, v157
  buffer_store_dwordx4 v[164:167], v4, s[28:31], s53 offen
FZ_ENDR0:
  s_mov_b64 exec, -1
  s_endpgm
K1_ROLE1:
  v_and_b32 v200, 63, v0
  v_and_b32 v201, 15, v0
  v_lshrrev_b32 v202, 4, v200
  v_bfe_u32 v203, v0, 2, 2
  v_and_b32 v204, 3, v0
  v_lshlrev_b32 v0, 4, v200
  v_xor_b32 v205, v202, v201
  v_lshlrev_b32 v205, 4, v205
  v_lshl_add_u32 v205, v201, 8, v205
  v_add_u32 v8, s34, v205
  v_xor_b32 v9, 64, v8
  v_xor_b32 v10, 128, v8
  v_xor_b32 v11, 192, v8
  v_lshl_add_u32 v205, v202, 2, v203
  v_and_b32 v206, 7, v205
  s_lshl_b32 s42, s40, 2
  v_xor_b32 v206, s42, v206
  v_lshlrev_b32 v206, 5, v206
  v_lshl_add_u32 v206, v205, 8, v206
  v_lshl_add_u32 v206, v204, 3, v206
  v_add_u32 v12, s34, v206
  v_xor_b32 v13, 32, v12
  v_xor_b32 v14, 64, v12
  v_xor_b32 v15, 96, v12
  v_xor_b32 v16, 128, v12
  v_xor_b32 v17, 160, v12
  v_xor_b32 v18, 192, v12
  v_xor_b32 v19, 224, v12
  v_and_b32 v207, 1, v202
  v_lshl_or_b32 v206, v207, 2, v203
  v_xor_b32 v206, s42, v206
  v_lshlrev_b32 v206, 5, v206
  v_lshl_add_u32 v205, v202, 3, v203
  v_lshl_add_u32 v206, v205, 9, v206
  v_lshl_add_u32 v206, v204, 3, v206
  v_add_u32 v192, 0x18000, v206
  v_xor_b32 v193, 32, v192
  v_xor_b32 v194, 64, v192
  v_xor_b32 v195, 96, v192
  v_lshrrev_b32 v206, 1, v203
  v_lshl_or_b32 v206, v207, 1, v206
  s_lshl_b32 s43, s40, 1
  v_xor_b32 v206, s43, v206
  v_lshlrev_b32 v206, 5, v206
  v_lshl_add_u32 v206, v205, 7, v206
  v_lshl_add_u32 v206, v204, 3, v206
  v_add_u32 v20, 0x18000, v206
  v_xor_b32 v21, 32, v20
  v_lshrrev_b32 v206, 1, v201
  v_xor_b32 v206, v202, v206
  v_lshlrev_b32 v206, 4, v206
  v_lshl_add_u32 v206, v201, 7, v206
  s_mul_i32 s43, s39, 6144
  v_add_u32 v196, s43, v206
  v_xor_b32 v197, 64, v196
  v_mov_b32 v206, 0x3f803f80
  v_accvgpr_write_b32 a252, v206
  v_accvgpr_write_b32 a253, v206
  v_accvgpr_write_b32 a254, v206
  v_accvgpr_write_b32 a255, v206
  v_lshrrev_b32 v206, 5, v200
  v_and_b32 v205, 31, v200
  v_lshlrev_b32 v207, 1, v206
  v_xor_b32 v205, v207, v205
  v_lshlrev_b32 v205, 4, v205
  v_lshl_add_u32 v205, v206, 13, v205
  v_mov_b32 v184, v205
  v_xor_b32 v185, 0x40, v205
  v_add_u32 v185, 0x3c00, v185
  v_mov_b32 v186, v205
  v_add_u32 v186, 0x7800, v186
  v_xor_b32 v187, 0x40, v205
  v_add_u32 v187, 0xb400, v187
  v_xor_b32 v188, 0x80, v205
  v_add_u32 v188, 0x10000, v188
  v_xor_b32 v189, 0xc0, v205
  v_add_u32 v189, 0x13c00, v189
  v_xor_b32 v190, 0x80, v205
  v_add_u32 v190, 0x17800, v190
  v_xor_b32 v191, 0xc0, v205
  v_add_u32 v191, 0x1b400, v191
  v_and_b32 v206, 1, v202
  v_lshlrev_b32 v206, 1, v206
  v_and_b32 v205, 7, v200
  v_xor_b32 v205, v206, v205
  v_lshlrev_b32 v205, 4, v205
  v_lshrrev_b32 v206, 3, v200
  v_lshl_add_u32 v1, v206, 10, v205
  v_xor_b32 v2, 64, v1
  v_add_u32 v2, 0x1c00, v2
  v_add_u32 v3, 0x3800, v1
  v_xor_b32 v4, 64, v1
  v_add_u32 v4, 0x5400, v4
  s_add_u32 m0, s34, 0x18000
  s_add_u32 s32, s36, 0x0
  buffer_load_dwordx4 v184, s[20:23], s32 offen offset:0 nt lds
  buffer_load_dwordx4 v185, s[20:23], s32 offen offset:1024 nt lds
  buffer_load_dwordx4 v186, s[20:23], s32 offen offset:2048 nt lds
  buffer_load_dwordx4 v187, s[20:23], s32 offen offset:3072 nt lds
  s_add_u32 m0, s34, 0x19000
  s_add_u32 s32, s36, 0x0
  buffer_load_dwordx4 v188, s[20:23], s32 offen offset:0 nt lds
  buffer_load_dwordx4 v189, s[20:23], s32 offen offset:1024 nt lds
  buffer_load_dwordx4 v190, s[20:23], s32 offen offset:2048 nt lds
  buffer_load_dwordx4 v191, s[20:23], s32 offen offset:3072 nt lds
  s_add_u32 m0, s34, 0x1c000
  s_add_u32 s32, s36, 0x40000
  buffer_load_dwordx4 v184, s[20:23], s32 offen offset:0 nt lds
  buffer_load_dwordx4 v185, s[20:23], s32 offen offset:1024 nt lds
  buffer_load_dwordx4 v186, s[20:23], s32 offen offset:2048 nt lds
  buffer_load_dwordx4 v187, s[20:23], s32 offen offset:3072 nt lds
  s_add_u32 m0, s34, 0x1d000
  s_add_u32 s32, s36, 0x40000
  buffer_load_dwordx4 v188, s[20:23], s32 offen offset:0 nt lds
  buffer_load_dwordx4 v189, s[20:23], s32 offen offset:1024 nt lds
  buffer_load_dwordx4 v190, s[20:23], s32 offen offset:2048 nt lds
  buffer_load_dwordx4 v191, s[20:23], s32 offen offset:3072 nt lds
  s_waitcnt lgkmcnt(0)
  s_waitcnt vmcnt(8)
  s_barrier
  ds_read_b128 v[160:163], v196 offset:0
  ds_read_b128 v[164:167], v196 offset:2048
  ds_read_b128 v[168:171], v196 offset:4096
  ds_read_b64_tr_b16 v[32:33], v192 offset:0
  ds_read_b64_tr_b16 v[34:35], v192 offset:2048
  ds_read_b64_tr_b16 v[36:37], v193 offset:0
  ds_read_b64_tr_b16 v[38:39], v193 offset:2048
  ds_read_b64_tr_b16 v[40:41], v194 offset:0
  ds_read_b64_tr_b16 v[42:43], v194 offset:2048
  ds_read_b64_tr_b16 v[44:45], v195 offset:0
  ds_read_b64_tr_b16 v[46:47], v195 offset:2048
  ds_read_b64_tr_b16 v[48:49], v192 offset:256
  ds_read_b64_tr_b16 v[50:51], v192 offset:2304
  ds_read_b64_tr_b16 v[52:53], v193 offset:256
  ds_read_b64_tr_b16 v[54:55], v193 offset:2304
  ds_read_b64_tr_b16 v[56:57], v194 offset:256
  ds_read_b64_tr_b16 v[58:59], v194 offset:2304
  ds_read_b64_tr_b16 v[60:61], v195 offset:256
  ds_read_b64_tr_b16 v[62:63], v195 offset:2304
  s_waitcnt lgkmcnt(15)
  s_waitcnt lgkmcnt(12)
  v_mfma_f32_16x16x32_bf16 v[64:67], v[32:35], v[160:163], 0
  s_add_u32 m0, s34, 0x20000
  s_add_u32 s32, s36, 0x80000
  v_mfma_f32_16x16x32_bf16 v[68:71], v[32:35], v[164:167], 0
  buffer_load_dwordx4 v184, s[20:23], s32 offen offset:0 nt lds
  buffer_load_dwordx4 v185, s[20:23], s32 offen offset:1024 nt lds
  v_mfma_f32_16x16x32_bf16 v[72:75], v[32:35], v[168:171], 0
  buffer_load_dwordx4 v186, s[20:23], s32 offen offset:2048 nt lds
  buffer_load_dwordx4 v187, s[20:23], s32 offen offset:3072 nt lds
  v_mfma_f32_16x16x32_bf16 v[76:79], v[36:39], v[160:163], 0
  s_add_u32 m0, s34, 0x21000
  s_add_u32 s32, s36, 0x80000
  v_mfma_f32_16x16x32_bf16 v[80:83], v[36:39], v[164:167], 0
  buffer_load_dwordx4 v188, s[20:23], s32 offen offset:0 nt lds
  buffer_load_dwordx4 v189, s[20:23], s32 offen offset:1024 nt lds
  v_mfma_f32_16x16x32_bf16 v[84:87], v[36:39], v[168:171], 0
  buffer_load_dwordx4 v190, s[20:23], s32 offen offset:2048 nt lds
  buffer_load_dwordx4 v191, s[20:23], s32 offen offset:3072 nt lds
  s_waitcnt lgkmcnt(8)
  v_mfma_f32_16x16x32_bf16 v[88:91], v[40:43], v[160:163], 0
  s_add_u32 m0, s34, 0x24000
  s_add_u32 s32, s36, 0xc0000
  v_mfma_f32_16x16x32_bf16 v[92:95], v[40:43], v[164:167], 0
  buffer_load_dwordx4 v184, s[20:23], s32 offen offset:0 nt lds
  buffer_load_dwordx4 v185, s[20:23], s32 offen offset:1024 nt lds
  v_mfma_f32_16x16x32_bf16 v[96:99], v[40:43], v[168:171], 0
  buffer_load_dwordx4 v186, s[20:23], s32 offen offset:2048 nt lds
  buffer_load_dwordx4 v187, s[20:23], s32 offen offset:3072 nt lds
  v_mfma_f32_16x16x32_bf16 v[100:103], v[44:47], v[160:163], 0
  s_add_u32 m0, s34, 0x25000
  s_add_u32 s32, s36, 0xc0000
  v_mfma_f32_16x16x32_bf16 v[104:107], v[44:47], v[164:167], 0
  buffer_load_dwordx4 v188, s[20:23], s32 offen offset:0 nt lds
  buffer_load_dwordx4 v189, s[20:23], s32 offen offset:1024 nt lds
  v_mfma_f32_16x16x32_bf16 v[108:111], v[44:47], v[168:171], 0
  buffer_load_dwordx4 v190, s[20:23], s32 offen offset:2048 nt lds
  buffer_load_dwordx4 v191, s[20:23], s32 offen offset:3072 nt lds
  s_waitcnt lgkmcnt(0)
  v_mfma_f32_16x16x32_bf16 v[112:115], v[48:51], v[160:163], 0
  s_waitcnt vmcnt(16)
  s_barrier
  ds_read_b128 v[172:175], v197 offset:0
  ds_read_b128 v[176:179], v197 offset:2048
  v_mfma_f32_16x16x32_bf16 v[116:119], v[48:51], v[164:167], 0
  ds_read_b128 v[180:183], v197 offset:4096
  ds_read_b64_tr_b16 v[32:33], v192 offset:16384
  v_mfma_f32_16x16x32_bf16 v[120:123], v[48:51], v[168:171], 0
  ds_read_b64_tr_b16 v[34:35], v192 offset:18432
  ds_read_b64_tr_b16 v[36:37], v193 offset:16384
  v_mfma_f32_16x16x32_bf16 v[124:127], v[52:55], v[160:163], 0
  ds_read_b64_tr_b16 v[38:39], v193 offset:18432
  ds_read_b64_tr_b16 v[40:41], v194 offset:16384
  v_mfma_f32_16x16x32_bf16 v[128:131], v[52:55], v[164:167], 0
  ds_read_b64_tr_b16 v[42:43], v194 offset:18432
  ds_read_b64_tr_b16 v[44:45], v195 offset:16384
  v_mfma_f32_16x16x32_bf16 v[132:135], v[52:55], v[168:171], 0
  ds_read_b64_tr_b16 v[46:47], v195 offset:18432
  ds_read_b64_tr_b16 v[48:49], v192 offset:16640
  v_mfma_f32_16x16x32_bf16 v[136:139], v[56:59], v[160:163], 0
  ds_read_b64_tr_b16 v[50:51], v192 offset:18688
  ds_read_b64_tr_b16 v[52:53], v193 offset:16640
  v_mfma_f32_16x16x32_bf16 v[140:143], v[56:59], v[164:167], 0
  ds_read_b64_tr_b16 v[54:55], v193 offset:18688
  s_add_u32 m0, s34, 0x18000
  v_mfma_f32_16x16x32_bf16 v[144:147], v[56:59], v[168:171], 0
  ds_read_b64_tr_b16 v[56:57], v194 offset:16640
  ds_read_b64_tr_b16 v[58:59], v194 offset:18688
  v_mfma_f32_16x16x32_bf16 v[148:151], v[60:63], v[160:163], 0
  s_add_u32 s32, s36, 0x100000
  buffer_load_dwordx4 v184, s[20:23], s32 offen offset:0 nt lds
  v_mfma_f32_16x16x32_bf16 v[152:155], v[60:63], v[164:167], 0
  buffer_load_dwordx4 v185, s[20:23], s32 offen offset:1024 nt lds
  buffer_load_dwordx4 v186, s[20:23], s32 offen offset:2048 nt lds
  v_mfma_f32_16x16x32_bf16 v[156:159], v[60:63], v[168:171], 0
  ds_read_b64_tr_b16 v[60:61], v195 offset:16640
  ds_read_b64_tr_b16 v[62:63], v195 offset:18688
  s_waitcnt lgkmcnt(15)
  s_waitcnt lgkmcnt(12)
  v_mfma_f32_16x16x32_bf16 v[64:67], v[32:35], v[172:175], v[64:67]
  buffer_load_dwordx4 v187, s[20:23], s32 offen offset:3072 nt lds
  s_add_u32 m0, s34, 0x19000
  v_mfma_f32_16x16x32_bf16 v[68:71], v[32:35], v[176:179], v[68:71]
  s_add_u32 s32, s36, 0x100000
  buffer_load_dwordx4 v188, s[20:23], s32 offen offset:0 nt lds
  v_mfma_f32_16x16x32_bf16 v[72:75], v[32:35], v[180:183], v[72:75]
  buffer_load_dwordx4 v189, s[20:23], s32 offen offset:1024 nt lds
  buffer_load_dwordx4 v190, s[20:23], s32 offen offset:2048 nt lds
  v_mfma_f32_16x16x32_bf16 v[76:79], v[36:39], v[172:175], v[76:79]
  buffer_load_dwordx4 v191, s[20:23], s32 offen offset:3072 nt lds
  v_mfma_f32_16x16x32_bf16 v[80:83], v[36:39], v[176:179], v[80:83]
  v_mfma_f32_16x16x32_bf16 v[84:87], v[36:39], v[180:183], v[84:87]
  s_waitcnt lgkmcnt(8)
  v_mfma_f32_16x16x32_bf16 v[88:91], v[40:43], v[172:175], v[88:91]
  v_mfma_f32_16x16x32_bf16 v[92:95], v[40:43], v[176:179], v[92:95]
  v_mfma_f32_16x16x32_bf16 v[96:99], v[40:43], v[180:183], v[96:99]
  v_mfma_f32_16x16x32_bf16 v[100:103], v[44:47], v[172:175], v[100:103]
  v_mfma_f32_16x16x32_bf16 v[104:107], v[44:47], v[176:179], v[104:107]
  v_mfma_f32_16x16x32_bf16 v[108:111], v[44:47], v[180:183], v[108:111]
  s_waitcnt lgkmcnt(0)
  v_mfma_f32_16x16x32_bf16 v[112:115], v[48:51], v[172:175], v[112:115]
  s_waitcnt vmcnt(16)
  s_barrier
  ds_read_b128 v[160:163], v196 offset:12288
  ds_read_b128 v[164:167], v196 offset:14336
  v_mfma_f32_16x16x32_bf16 v[116:119], v[48:51], v[176:179], v[116:119]
  ds_read_b128 v[168:171], v196 offset:16384
  ds_read_b64_tr_b16 v[32:33], v192 offset:32768
  v_mfma_f32_16x16x32_bf16 v[120:123], v[48:51], v[180:183], v[120:123]
  ds_read_b64_tr_b16 v[34:35], v192 offset:34816
  ds_read_b64_tr_b16 v[36:37], v193 offset:32768
  v_mfma_f32_16x16x32_bf16 v[124:127], v[52:55], v[172:175], v[124:127]
  ds_read_b64_tr_b16 v[38:39], v193 offset:34816
  ds_read_b64_tr_b16 v[40:41], v194 offset:32768
  v_mfma_f32_16x16x32_bf16 v[128:131], v[52:55], v[176:179], v[128:131]
  ds_read_b64_tr_b16 v[42:43], v194 offset:34816
  ds_read_b64_tr_b16 v[44:45], v195 offset:32768
  v_mfma_f32_16x16x32_bf16 v[132:135], v[52:55], v[180:183], v[132:135]
  ds_read_b64_tr_b16 v[46:47], v195 offset:34816
  ds_read_b64_tr_b16 v[48:49], v192 offset:33024
  v_mfma_f32_16x16x32_bf16 v[136:139], v[56:59], v[172:175], v[136:139]
  ds_read_b64_tr_b16 v[50:51], v192 offset:35072
  ds_read_b64_tr_b16 v[52:53], v193 offset:33024
  v_mfma_f32_16x16x32_bf16 v[140:143], v[56:59], v[176:179], v[140:143]
  ds_read_b64_tr_b16 v[54:55], v193 offset:35072
  s_add_u32 m0, s34, 0x1c000
  v_mfma_f32_16x16x32_bf16 v[144:147], v[56:59], v[180:183], v[144:147]
  ds_read_b64_tr_b16 v[56:57], v194 offset:33024
  ds_read_b64_tr_b16 v[58:59], v194 offset:35072
  v_mfma_f32_16x16x32_bf16 v[148:151], v[60:63], v[172:175], v[148:151]
  s_add_u32 s32, s36, 0x140000
  buffer_load_dwordx4 v184, s[20:23], s32 offen offset:0 nt lds
  v_mfma_f32_16x16x32_bf16 v[152:155], v[60:63], v[176:179], v[152:155]
  buffer_load_dwordx4 v185, s[20:23], s32 offen offset:1024 nt lds
  buffer_load_dwordx4 v186, s[20:23], s32 offen offset:2048 nt lds
  v_mfma_f32_16x16x32_bf16 v[156:159], v[60:63], v[180:183], v[156:159]
  ds_read_b64_tr_b16 v[60:61], v195 offset:33024
  ds_read_b64_tr_b16 v[62:63], v195 offset:35072
  s_waitcnt lgkmcnt(15)
  s_waitcnt lgkmcnt(12)
  v_mfma_f32_16x16x32_bf16 v[64:67], v[32:35], v[160:163], v[64:67]
  buffer_load_dwordx4 v187, s[20:23], s32 offen offset:3072 nt lds
  s_add_u32 m0, s34, 0x1d000
  v_mfma_f32_16x16x32_bf16 v[68:71], v[32:35], v[164:167], v[68:71]
  s_add_u32 s32, s36, 0x140000
  buffer_load_dwordx4 v188, s[20:23], s32 offen offset:0 nt lds
  v_mfma_f32_16x16x32_bf16 v[72:75], v[32:35], v[168:171], v[72:75]
  buffer_load_dwordx4 v189, s[20:23], s32 offen offset:1024 nt lds
  buffer_load_dwordx4 v190, s[20:23], s32 offen offset:2048 nt lds
  v_mfma_f32_16x16x32_bf16 v[76:79], v[36:39], v[160:163], v[76:79]
  buffer_load_dwordx4 v191, s[20:23], s32 offen offset:3072 nt lds
  v_mfma_f32_16x16x32_bf16 v[80:83], v[36:39], v[164:167], v[80:83]
  v_mfma_f32_16x16x32_bf16 v[84:87], v[36:39], v[168:171], v[84:87]
  s_waitcnt lgkmcnt(8)
  v_mfma_f32_16x16x32_bf16 v[88:91], v[40:43], v[160:163], v[88:91]
  v_mfma_f32_16x16x32_bf16 v[92:95], v[40:43], v[164:167], v[92:95]
  v_mfma_f32_16x16x32_bf16 v[96:99], v[40:43], v[168:171], v[96:99]
  v_mfma_f32_16x16x32_bf16 v[100:103], v[44:47], v[160:163], v[100:103]
  v_mfma_f32_16x16x32_bf16 v[104:107], v[44:47], v[164:167], v[104:107]
  v_mfma_f32_16x16x32_bf16 v[108:111], v[44:47], v[168:171], v[108:111]
  s_waitcnt lgkmcnt(0)
  v_mfma_f32_16x16x32_bf16 v[112:115], v[48:51], v[160:163], v[112:115]
  s_waitcnt vmcnt(16)
  s_barrier
  ds_read_b128 v[172:175], v197 offset:12288
  ds_read_b128 v[176:179], v197 offset:14336
  v_mfma_f32_16x16x32_bf16 v[116:119], v[48:51], v[164:167], v[116:119]
  ds_read_b128 v[180:183], v197 offset:16384
  ds_read_b64_tr_b16 v[32:33], v192 offset:49152
  v_mfma_f32_16x16x32_bf16 v[120:123], v[48:51], v[168:171], v[120:123]
  ds_read_b64_tr_b16 v[34:35], v192 offset:51200
  ds_read_b64_tr_b16 v[36:37], v193 offset:49152
  v_mfma_f32_16x16x32_bf16 v[124:127], v[52:55], v[160:163], v[124:127]
  ds_read_b64_tr_b16 v[38:39], v193 offset:51200
  ds_read_b64_tr_b16 v[40:41], v194 offset:49152
  v_mfma_f32_16x16x32_bf16 v[128:131], v[52:55], v[164:167], v[128:131]
  ds_read_b64_tr_b16 v[42:43], v194 offset:51200
  ds_read_b64_tr_b16 v[44:45], v195 offset:49152
  v_mfma_f32_16x16x32_bf16 v[132:135], v[52:55], v[168:171], v[132:135]
  ds_read_b64_tr_b16 v[46:47], v195 offset:51200
  ds_read_b64_tr_b16 v[48:49], v192 offset:49408
  v_mfma_f32_16x16x32_bf16 v[136:139], v[56:59], v[160:163], v[136:139]
  ds_read_b64_tr_b16 v[50:51], v192 offset:51456
  ds_read_b64_tr_b16 v[52:53], v193 offset:49408
  v_mfma_f32_16x16x32_bf16 v[140:143], v[56:59], v[164:167], v[140:143]
  ds_read_b64_tr_b16 v[54:55], v193 offset:51456
  s_add_u32 m0, s34, 0x20000
  v_mfma_f32_16x16x32_bf16 v[144:147], v[56:59], v[168:171], v[144:147]
  ds_read_b64_tr_b16 v[56:57], v194 offset:49408
  ds_read_b64_tr_b16 v[58:59], v194 offset:51456
  v_mfma_f32_16x16x32_bf16 v[148:151], v[60:63], v[160:163], v[148:151]
  s_add_u32 s32, s36, 0x180000
  buffer_load_dwordx4 v184, s[20:23], s32 offen offset:0 nt lds
  v_mfma_f32_16x16x32_bf16 v[152:155], v[60:63], v[164:167], v[152:155]
  buffer_load_dwordx4 v185, s[20:23], s32 offen offset:1024 nt lds
  buffer_load_dwordx4 v186, s[20:23], s32 offen offset:2048 nt lds
  v_mfma_f32_16x16x32_bf16 v[156:159], v[60:63], v[168:171], v[156:159]
  ds_read_b64_tr_b16 v[60:61], v195 offset:49408
  ds_read_b64_tr_b16 v[62:63], v195 offset:51456
  s_waitcnt lgkmcnt(15)
  s_waitcnt lgkmcnt(12)
  v_mfma_f32_16x16x32_bf16 v[64:67], v[32:35], v[172:175], v[64:67]
  buffer_load_dwordx4 v187, s[20:23], s32 offen offset:3072 nt lds
  s_add_u32 m0, s34, 0x21000
  v_mfma_f32_16x16x32_bf16 v[68:71], v[32:35], v[176:179], v[68:71]
  s_add_u32 s32, s36, 0x180000
  buffer_load_dwordx4 v188, s[20:23], s32 offen offset:0 nt lds
  v_mfma_f32_16x16x32_bf16 v[72:75], v[32:35], v[180:183], v[72:75]
  buffer_load_dwordx4 v189, s[20:23], s32 offen offset:1024 nt lds
  buffer_load_dwordx4 v190, s[20:23], s32 offen offset:2048 nt lds
  v_mfma_f32_16x16x32_bf16 v[76:79], v[36:39], v[172:175], v[76:79]
  buffer_load_dwordx4 v191, s[20:23], s32 offen offset:3072 nt lds
  v_mfma_f32_16x16x32_bf16 v[80:83], v[36:39], v[176:179], v[80:83]
  v_mfma_f32_16x16x32_bf16 v[84:87], v[36:39], v[180:183], v[84:87]
  s_waitcnt lgkmcnt(8)
  v_mfma_f32_16x16x32_bf16 v[88:91], v[40:43], v[172:175], v[88:91]
  v_mfma_f32_16x16x32_bf16 v[92:95], v[40:43], v[176:179], v[92:95]
  v_mfma_f32_16x16x32_bf16 v[96:99], v[40:43], v[180:183], v[96:99]
  v_mfma_f32_16x16x32_bf16 v[100:103], v[44:47], v[172:175], v[100:103]
  v_mfma_f32_16x16x32_bf16 v[104:107], v[44:47], v[176:179], v[104:107]
  v_mfma_f32_16x16x32_bf16 v[108:111], v[44:47], v[180:183], v[108:111]
  s_waitcnt lgkmcnt(0)
  v_mfma_f32_16x16x32_bf16 v[112:115], v[48:51], v[172:175], v[112:115]
  s_waitcnt vmcnt(16)
  s_barrier
  ds_read_b128 v[160:163], v196 offset:24576
  ds_read_b128 v[164:167], v196 offset:26624
  v_mfma_f32_16x16x32_bf16 v[116:119], v[48:51], v[176:179], v[116:119]
  ds_read_b128 v[168:171], v196 offset:28672
  ds_read_b64_tr_b16 v[32:33], v192 offset:0
  v_mfma_f32_16x16x32_bf16 v[120:123], v[48:51], v[180:183], v[120:123]
  ds_read_b64_tr_b16 v[34:35], v192 offset:2048
  ds_read_b64_tr_b16 v[36:37], v193 offset:0
  v_mfma_f32_16x16x32_bf16 v[124:127], v[52:55], v[172:175], v[124:127]
  ds_read_b64_tr_b16 v[38:39], v193 offset:2048
  ds_read_b64_tr_b16 v[40:41], v194 offset:0
  v_mfma_f32_16x16x32_bf16 v[128:131], v[52:55], v[176:179], v[128:131]
  ds_read_b64_tr_b16 v[42:43], v194 offset:2048
  ds_read_b64_tr_b16 v[44:45], v195 offset:0
  v_mfma_f32_16x16x32_bf16 v[132:135], v[52:55], v[180:183], v[132:135]
  ds_read_b64_tr_b16 v[46:47], v195 offset:2048
  ds_read_b64_tr_b16 v[48:49], v192 offset:256
  v_mfma_f32_16x16x32_bf16 v[136:139], v[56:59], v[172:175], v[136:139]
  ds_read_b64_tr_b16 v[50:51], v192 offset:2304
  ds_read_b64_tr_b16 v[52:53], v193 offset:256
  v_mfma_f32_16x16x32_bf16 v[140:143], v[56:59], v[176:179], v[140:143]
  ds_read_b64_tr_b16 v[54:55], v193 offset:2304
  s_add_u32 m0, s34, 0x24000
  v_mfma_f32_16x16x32_bf16 v[144:147], v[56:59], v[180:183], v[144:147]
  ds_read_b64_tr_b16 v[56:57], v194 offset:256
  ds_read_b64_tr_b16 v[58:59], v194 offset:2304
  v_mfma_f32_16x16x32_bf16 v[148:151], v[60:63], v[172:175], v[148:151]
  s_add_u32 s32, s36, 0x1c0000
  buffer_load_dwordx4 v184, s[20:23], s32 offen offset:0 nt lds
  v_mfma_f32_16x16x32_bf16 v[152:155], v[60:63], v[176:179], v[152:155]
  buffer_load_dwordx4 v185, s[20:23], s32 offen offset:1024 nt lds
  buffer_load_dwordx4 v186, s[20:23], s32 offen offset:2048 nt lds
  v_mfma_f32_16x16x32_bf16 v[156:159], v[60:63], v[180:183], v[156:159]
  ds_read_b64_tr_b16 v[60:61], v195 offset:256
  ds_read_b64_tr_b16 v[62:63], v195 offset:2304
  s_waitcnt lgkmcnt(15)
  s_waitcnt lgkmcnt(12)
  v_mfma_f32_16x16x32_bf16 v[64:67], v[32:35], v[160:163], v[64:67]
  buffer_load_dwordx4 v187, s[20:23], s32 offen offset:3072 nt lds
  s_add_u32 m0, s34, 0x25000
  v_mfma_f32_16x16x32_bf16 v[68:71], v[32:35], v[164:167], v[68:71]
  s_add_u32 s32, s36, 0x1c0000
  buffer_load_dwordx4 v188, s[20:23], s32 offen offset:0 nt lds
  v_mfma_f32_16x16x32_bf16 v[72:75], v[32:35], v[168:171], v[72:75]
  buffer_load_dwordx4 v189, s[20:23], s32 offen offset:1024 nt lds
  buffer_load_dwordx4 v190, s[20:23], s32 offen offset:2048 nt lds
  v_mfma_f32_16x16x32_bf16 v[76:79], v[36:39], v[160:163], v[76:79]
  buffer_load_dwordx4 v191, s[20:23], s32 offen offset:3072 nt lds
  v_mfma_f32_16x16x32_bf16 v[80:83], v[36:39], v[164:167], v[80:83]
  v_mfma_f32_16x16x32_bf16 v[84:87], v[36:39], v[168:171], v[84:87]
  s_waitcnt lgkmcnt(8)
  v_mfma_f32_16x16x32_bf16 v[88:91], v[40:43], v[160:163], v[88:91]
  v_mfma_f32_16x16x32_bf16 v[92:95], v[40:43], v[164:167], v[92:95]
  v_mfma_f32_16x16x32_bf16 v[96:99], v[40:43], v[168:171], v[96:99]
  v_mfma_f32_16x16x32_bf16 v[100:103], v[44:47], v[160:163], v[100:103]
  v_mfma_f32_16x16x32_bf16 v[104:107], v[44:47], v[164:167], v[104:107]
  v_mfma_f32_16x16x32_bf16 v[108:111], v[44:47], v[168:171], v[108:111]
  s_waitcnt lgkmcnt(0)
  v_mfma_f32_16x16x32_bf16 v[112:115], v[48:51], v[160:163], v[112:115]
  s_waitcnt vmcnt(16)
  s_barrier
  ds_read_b128 v[172:175], v197 offset:24576
  ds_read_b128 v[176:179], v197 offset:26624
  v_mfma_f32_16x16x32_bf16 v[116:119], v[48:51], v[164:167], v[116:119]
  ds_read_b128 v[180:183], v197 offset:28672
  ds_read_b64_tr_b16 v[32:33], v192 offset:16384
  v_mfma_f32_16x16x32_bf16 v[120:123], v[48:51], v[168:171], v[120:123]
  ds_read_b64_tr_b16 v[34:35], v192 offset:18432
  ds_read_b64_tr_b16 v[36:37], v193 offset:16384
  v_mfma_f32_16x16x32_bf16 v[124:127], v[52:55], v[160:163], v[124:127]
  ds_read_b64_tr_b16 v[38:39], v193 offset:18432
  ds_read_b64_tr_b16 v[40:41], v194 offset:16384
  v_mfma_f32_16x16x32_bf16 v[128:131], v[52:55], v[164:167], v[128:131]
  ds_read_b64_tr_b16 v[42:43], v194 offset:18432
  ds_read_b64_tr_b16 v[44:45], v195 offset:16384
  v_mfma_f32_16x16x32_bf16 v[132:135], v[52:55], v[168:171], v[132:135]
  ds_read_b64_tr_b16 v[46:47], v195 offset:18432
  ds_read_b64_tr_b16 v[48:49], v192 offset:16640
  v_mfma_f32_16x16x32_bf16 v[136:139], v[56:59], v[160:163], v[136:139]
  ds_read_b64_tr_b16 v[50:51], v192 offset:18688
  ds_read_b64_tr_b16 v[52:53], v193 offset:16640
  v_mfma_f32_16x16x32_bf16 v[140:143], v[56:59], v[164:167], v[140:143]
  ds_read_b64_tr_b16 v[54:55], v193 offset:18688
  s_add_u32 m0, s34, 0x18000
  v_mfma_f32_16x16x32_bf16 v[144:147], v[56:59], v[168:171], v[144:147]
  ds_read_b64_tr_b16 v[56:57], v194 offset:16640
  ds_read_b64_tr_b16 v[58:59], v194 offset:18688
  v_mfma_f32_16x16x32_bf16 v[148:151], v[60:63], v[160:163], v[148:151]
  s_add_u32 s32, s36, 0x200000
  buffer_load_dwordx4 v184, s[20:23], s32 offen offset:0 nt lds
  v_mfma_f32_16x16x32_bf16 v[152:155], v[60:63], v[164:167], v[152:155]
  buffer_load_dwordx4 v185, s[20:23], s32 offen offset:1024 nt lds
  buffer_load_dwordx4 v186, s[20:23], s32 offen offset:2048 nt lds
  v_mfma_f32_16x16x32_bf16 v[156:159], v[60:63], v[168:171], v[156:159]
  ds_read_b64_tr_b16 v[60:61], v195 offset:16640
  ds_read_b64_tr_b16 v[62:63], v195 offset:18688
  s_waitcnt lgkmcnt(15)
  s_waitcnt lgkmcnt(12)
  v_mfma_f32_16x16x32_bf16 v[64:67], v[32:35], v[172:175], v[64:67]
  buffer_load_dwordx4 v187, s[20:23], s32 offen offset:3072 nt lds
  s_add_u32 m0, s34, 0x19000
  v_mfma_f32_16x16x32_bf16 v[68:71], v[32:35], v[176:179], v[68:71]
  s_add_u32 s32, s36, 0x200000
  buffer_load_dwordx4 v188, s[20:23], s32 offen offset:0 nt lds
  v_mfma_f32_16x16x32_bf16 v[72:75], v[32:35], v[180:183], v[72:75]
  buffer_load_dwordx4 v189, s[20:23], s32 offen offset:1024 nt lds
  buffer_load_dwordx4 v190, s[20:23], s32 offen offset:2048 nt lds
  v_mfma_f32_16x16x32_bf16 v[76:79], v[36:39], v[172:175], v[76:79]
  buffer_load_dwordx4 v191, s[20:23], s32 offen offset:3072 nt lds
  v_mfma_f32_16x16x32_bf16 v[80:83], v[36:39], v[176:179], v[80:83]
  v_mfma_f32_16x16x32_bf16 v[84:87], v[36:39], v[180:183], v[84:87]
  s_waitcnt lgkmcnt(8)
  v_mfma_f32_16x16x32_bf16 v[88:91], v[40:43], v[172:175], v[88:91]
  v_mfma_f32_16x16x32_bf16 v[92:95], v[40:43], v[176:179], v[92:95]
  v_mfma_f32_16x16x32_bf16 v[96:99], v[40:43], v[180:183], v[96:99]
  v_mfma_f32_16x16x32_bf16 v[100:103], v[44:47], v[172:175], v[100:103]
  v_mfma_f32_16x16x32_bf16 v[104:107], v[44:47], v[176:179], v[104:107]
  v_mfma_f32_16x16x32_bf16 v[108:111], v[44:47], v[180:183], v[108:111]
  s_waitcnt lgkmcnt(0)
  v_mfma_f32_16x16x32_bf16 v[112:115], v[48:51], v[172:175], v[112:115]
  s_waitcnt vmcnt(16)
  s_barrier
  ds_read_b128 v[160:163], v196 offset:36864
  ds_read_b128 v[164:167], v196 offset:38912
  v_mfma_f32_16x16x32_bf16 v[116:119], v[48:51], v[176:179], v[116:119]
  ds_read_b128 v[168:171], v196 offset:40960
  ds_read_b64_tr_b16 v[32:33], v192 offset:32768
  v_mfma_f32_16x16x32_bf16 v[120:123], v[48:51], v[180:183], v[120:123]
  ds_read_b64_tr_b16 v[34:35], v192 offset:34816
  ds_read_b64_tr_b16 v[36:37], v193 offset:32768
  v_mfma_f32_16x16x32_bf16 v[124:127], v[52:55], v[172:175], v[124:127]
  ds_read_b64_tr_b16 v[38:39], v193 offset:34816
  ds_read_b64_tr_b16 v[40:41], v194 offset:32768
  v_mfma_f32_16x16x32_bf16 v[128:131], v[52:55], v[176:179], v[128:131]
  ds_read_b64_tr_b16 v[42:43], v194 offset:34816
  ds_read_b64_tr_b16 v[44:45], v195 offset:32768
  v_mfma_f32_16x16x32_bf16 v[132:135], v[52:55], v[180:183], v[132:135]
  ds_read_b64_tr_b16 v[46:47], v195 offset:34816
  ds_read_b64_tr_b16 v[48:49], v192 offset:33024
  v_mfma_f32_16x16x32_bf16 v[136:139], v[56:59], v[172:175], v[136:139]
  ds_read_b64_tr_b16 v[50:51], v192 offset:35072
  ds_read_b64_tr_b16 v[52:53], v193 offset:33024
  v_mfma_f32_16x16x32_bf16 v[140:143], v[56:59], v[176:179], v[140:143]
  ds_read_b64_tr_b16 v[54:55], v193 offset:35072
  s_add_u32 m0, s34, 0x1c000
  v_mfma_f32_16x16x32_bf16 v[144:147], v[56:59], v[180:183], v[144:147]
  ds_read_b64_tr_b16 v[56:57], v194 offset:33024
  ds_read_b64_tr_b16 v[58:59], v194 offset:35072
  v_mfma_f32_16x16x32_bf16 v[148:151], v[60:63], v[172:175], v[148:151]
  s_add_u32 s32, s36, 0x240000
  buffer_load_dwordx4 v184, s[20:23], s32 offen offset:0 nt lds
  v_mfma_f32_16x16x32_bf16 v[152:155], v[60:63], v[176:179], v[152:155]
  buffer_load_dwordx4 v185, s[20:23], s32 offen offset:1024 nt lds
  buffer_load_dwordx4 v186, s[20:23], s32 offen offset:2048 nt lds
  v_mfma_f32_16x16x32_bf16 v[156:159], v[60:63], v[180:183], v[156:159]
  ds_read_b64_tr_b16 v[60:61], v195 offset:33024
  ds_read_b64_tr_b16 v[62:63], v195 offset:35072
  s_waitcnt lgkmcnt(15)
  s_waitcnt lgkmcnt(12)
  v_mfma_f32_16x16x32_bf16 v[64:67], v[32:35], v[160:163], v[64:67]
  buffer_load_dwordx4 v187, s[20:23], s32 offen offset:3072 nt lds
  s_add_u32 m0, s34, 0x1d000
  v_mfma_f32_16x16x32_bf16 v[68:71], v[32:35], v[164:167], v[68:71]
  s_add_u32 s32, s36, 0x240000
  buffer_load_dwordx4 v188, s[20:23], s32 offen offset:0 nt lds
  v_mfma_f32_16x16x32_bf16 v[72:75], v[32:35], v[168:171], v[72:75]
  buffer_load_dwordx4 v189, s[20:23], s32 offen offset:1024 nt lds
  buffer_load_dwordx4 v190, s[20:23], s32 offen offset:2048 nt lds
  v_mfma_f32_16x16x32_bf16 v[76:79], v[36:39], v[160:163], v[76:79]
  buffer_load_dwordx4 v191, s[20:23], s32 offen offset:3072 nt lds
  v_mfma_f32_16x16x32_bf16 v[80:83], v[36:39], v[164:167], v[80:83]
  v_mfma_f32_16x16x32_bf16 v[84:87], v[36:39], v[168:171], v[84:87]
  s_waitcnt lgkmcnt(8)
  v_mfma_f32_16x16x32_bf16 v[88:91], v[40:43], v[160:163], v[88:91]
  v_mfma_f32_16x16x32_bf16 v[92:95], v[40:43], v[164:167], v[92:95]
  v_mfma_f32_16x16x32_bf16 v[96:99], v[40:43], v[168:171], v[96:99]
  v_mfma_f32_16x16x32_bf16 v[100:103], v[44:47], v[160:163], v[100:103]
  v_mfma_f32_16x16x32_bf16 v[104:107], v[44:47], v[164:167], v[104:107]
  v_mfma_f32_16x16x32_bf16 v[108:111], v[44:47], v[168:171], v[108:111]
  s_waitcnt lgkmcnt(0)
  v_mfma_f32_16x16x32_bf16 v[112:115], v[48:51], v[160:163], v[112:115]
  s_waitcnt vmcnt(16)
  s_barrier
  ds_read_b128 v[172:175], v197 offset:36864
  ds_read_b128 v[176:179], v197 offset:38912
  v_mfma_f32_16x16x32_bf16 v[116:119], v[48:51], v[164:167], v[116:119]
  ds_read_b128 v[180:183], v197 offset:40960
  ds_read_b64_tr_b16 v[32:33], v192 offset:49152
  v_mfma_f32_16x16x32_bf16 v[120:123], v[48:51], v[168:171], v[120:123]
  ds_read_b64_tr_b16 v[34:35], v192 offset:51200
  ds_read_b64_tr_b16 v[36:37], v193 offset:49152
  v_mfma_f32_16x16x32_bf16 v[124:127], v[52:55], v[160:163], v[124:127]
  ds_read_b64_tr_b16 v[38:39], v193 offset:51200
  ds_read_b64_tr_b16 v[40:41], v194 offset:49152
  v_mfma_f32_16x16x32_bf16 v[128:131], v[52:55], v[164:167], v[128:131]
  ds_read_b64_tr_b16 v[42:43], v194 offset:51200
  ds_read_b64_tr_b16 v[44:45], v195 offset:49152
  v_mfma_f32_16x16x32_bf16 v[132:135], v[52:55], v[168:171], v[132:135]
  ds_read_b64_tr_b16 v[46:47], v195 offset:51200
  ds_read_b64_tr_b16 v[48:49], v192 offset:49408
  v_mfma_f32_16x16x32_bf16 v[136:139], v[56:59], v[160:163], v[136:139]
  ds_read_b64_tr_b16 v[50:51], v192 offset:51456
  ds_read_b64_tr_b16 v[52:53], v193 offset:49408
  v_mfma_f32_16x16x32_bf16 v[140:143], v[56:59], v[164:167], v[140:143]
  ds_read_b64_tr_b16 v[54:55], v193 offset:51456
  s_add_u32 m0, s34, 0x20000
  v_mfma_f32_16x16x32_bf16 v[144:147], v[56:59], v[168:171], v[144:147]
  ds_read_b64_tr_b16 v[56:57], v194 offset:49408
  ds_read_b64_tr_b16 v[58:59], v194 offset:51456
  v_mfma_f32_16x16x32_bf16 v[148:151], v[60:63], v[160:163], v[148:151]
  s_add_u32 s32, s36, 0x280000
  buffer_load_dwordx4 v184, s[20:23], s32 offen offset:0 nt lds
  v_mfma_f32_16x16x32_bf16 v[152:155], v[60:63], v[164:167], v[152:155]
  buffer_load_dwordx4 v185, s[20:23], s32 offen offset:1024 nt lds
  buffer_load_dwordx4 v186, s[20:23], s32 offen offset:2048 nt lds
  v_mfma_f32_16x16x32_bf16 v[156:159], v[60:63], v[168:171], v[156:159]
  ds_read_b64_tr_b16 v[60:61], v195 offset:49408
  ds_read_b64_tr_b16 v[62:63], v195 offset:51456
  s_waitcnt lgkmcnt(15)
  s_waitcnt lgkmcnt(12)
  v_mfma_f32_16x16x32_bf16 v[64:67], v[32:35], v[172:175], v[64:67]
  buffer_load_dwordx4 v187, s[20:23], s32 offen offset:3072 nt lds
  s_add_u32 m0, s34, 0x21000
  v_mfma_f32_16x16x32_bf16 v[68:71], v[32:35], v[176:179], v[68:71]
  s_add_u32 s32, s36, 0x280000
  buffer_load_dwordx4 v188, s[20:23], s32 offen offset:0 nt lds
  v_mfma_f32_16x16x32_bf16 v[72:75], v[32:35], v[180:183], v[72:75]
  buffer_load_dwordx4 v189, s[20:23], s32 offen offset:1024 nt lds
  buffer_load_dwordx4 v190, s[20:23], s32 offen offset:2048 nt lds
  v_mfma_f32_16x16x32_bf16 v[76:79], v[36:39], v[172:175], v[76:79]
  buffer_load_dwordx4 v191, s[20:23], s32 offen offset:3072 nt lds
  v_mfma_f32_16x16x32_bf16 v[80:83], v[36:39], v[176:179], v[80:83]
  v_mfma_f32_16x16x32_bf16 v[84:87], v[36:39], v[180:183], v[84:87]
  s_waitcnt lgkmcnt(8)
  v_mfma_f32_16x16x32_bf16 v[88:91], v[40:43], v[172:175], v[88:91]
  v_mfma_f32_16x16x32_bf16 v[92:95], v[40:43], v[176:179], v[92:95]
  v_mfma_f32_16x16x32_bf16 v[96:99], v[40:43], v[180:183], v[96:99]
  v_mfma_f32_16x16x32_bf16 v[100:103], v[44:47], v[172:175], v[100:103]
  v_mfma_f32_16x16x32_bf16 v[104:107], v[44:47], v[176:179], v[104:107]
  v_mfma_f32_16x16x32_bf16 v[108:111], v[44:47], v[180:183], v[108:111]
  s_waitcnt lgkmcnt(0)
  v_mfma_f32_16x16x32_bf16 v[112:115], v[48:51], v[172:175], v[112:115]
  s_waitcnt vmcnt(16)
  s_barrier
  ds_read_b128 v[160:163], v196 offset:49152
  ds_read_b128 v[164:167], v196 offset:51200
  v_mfma_f32_16x16x32_bf16 v[116:119], v[48:51], v[176:179], v[116:119]
  ds_read_b128 v[168:171], v196 offset:53248
  ds_read_b64_tr_b16 v[32:33], v192 offset:0
  v_mfma_f32_16x16x32_bf16 v[120:123], v[48:51], v[180:183], v[120:123]
  ds_read_b64_tr_b16 v[34:35], v192 offset:2048
  ds_read_b64_tr_b16 v[36:37], v193 offset:0
  v_mfma_f32_16x16x32_bf16 v[124:127], v[52:55], v[172:175], v[124:127]
  ds_read_b64_tr_b16 v[38:39], v193 offset:2048
  ds_read_b64_tr_b16 v[40:41], v194 offset:0
  v_mfma_f32_16x16x32_bf16 v[128:131], v[52:55], v[176:179], v[128:131]
  ds_read_b64_tr_b16 v[42:43], v194 offset:2048
  ds_read_b64_tr_b16 v[44:45], v195 offset:0
  v_mfma_f32_16x16x32_bf16 v[132:135], v[52:55], v[180:183], v[132:135]
  ds_read_b64_tr_b16 v[46:47], v195 offset:2048
  ds_read_b64_tr_b16 v[48:49], v192 offset:256
  v_mfma_f32_16x16x32_bf16 v[136:139], v[56:59], v[172:175], v[136:139]
  ds_read_b64_tr_b16 v[50:51], v192 offset:2304
  ds_read_b64_tr_b16 v[52:53], v193 offset:256
  v_mfma_f32_16x16x32_bf16 v[140:143], v[56:59], v[176:179], v[140:143]
  ds_read_b64_tr_b16 v[54:55], v193 offset:2304
  s_add_u32 m0, s34, 0x24000
  v_mfma_f32_16x16x32_bf16 v[144:147], v[56:59], v[180:183], v[144:147]
  ds_read_b64_tr_b16 v[56:57], v194 offset:256
  ds_read_b64_tr_b16 v[58:59], v194 offset:2304
  v_mfma_f32_16x16x32_bf16 v[148:151], v[60:63], v[172:175], v[148:151]
  s_add_u32 s32, s36, 0x2c0000
  buffer_load_dwordx4 v184, s[20:23], s32 offen offset:0 nt lds
  v_mfma_f32_16x16x32_bf16 v[152:155], v[60:63], v[176:179], v[152:155]
  buffer_load_dwordx4 v185, s[20:23], s32 offen offset:1024 nt lds
  buffer_load_dwordx4 v186, s[20:23], s32 offen offset:2048 nt lds
  v_mfma_f32_16x16x32_bf16 v[156:159], v[60:63], v[180:183], v[156:159]
  ds_read_b64_tr_b16 v[60:61], v195 offset:256
  ds_read_b64_tr_b16 v[62:63], v195 offset:2304
  s_waitcnt lgkmcnt(15)
  s_waitcnt lgkmcnt(12)
  v_mfma_f32_16x16x32_bf16 v[64:67], v[32:35], v[160:163], v[64:67]
  buffer_load_dwordx4 v187, s[20:23], s32 offen offset:3072 nt lds
  s_add_u32 m0, s34, 0x25000
  v_mfma_f32_16x16x32_bf16 v[68:71], v[32:35], v[164:167], v[68:71]
  s_add_u32 s32, s36, 0x2c0000
  buffer_load_dwordx4 v188, s[20:23], s32 offen offset:0 nt lds
  v_mfma_f32_16x16x32_bf16 v[72:75], v[32:35], v[168:171], v[72:75]
  buffer_load_dwordx4 v189, s[20:23], s32 offen offset:1024 nt lds
  buffer_load_dwordx4 v190, s[20:23], s32 offen offset:2048 nt lds
  v_mfma_f32_16x16x32_bf16 v[76:79], v[36:39], v[160:163], v[76:79]
  buffer_load_dwordx4 v191, s[20:23], s32 offen offset:3072 nt lds
  v_mfma_f32_16x16x32_bf16 v[80:83], v[36:39], v[164:167], v[80:83]
  v_mfma_f32_16x16x32_bf16 v[84:87], v[36:39], v[168:171], v[84:87]
  s_waitcnt lgkmcnt(8)
  v_mfma_f32_16x16x32_bf16 v[88:91], v[40:43], v[160:163], v[88:91]
  v_mfma_f32_16x16x32_bf16 v[92:95], v[40:43], v[164:167], v[92:95]
  v_mfma_f32_16x16x32_bf16 v[96:99], v[40:43], v[168:171], v[96:99]
  v_mfma_f32_16x16x32_bf16 v[100:103], v[44:47], v[160:163], v[100:103]
  v_mfma_f32_16x16x32_bf16 v[104:107], v[44:47], v[164:167], v[104:107]
  v_mfma_f32_16x16x32_bf16 v[108:111], v[44:47], v[168:171], v[108:111]
  s_waitcnt lgkmcnt(0)
  v_mfma_f32_16x16x32_bf16 v[112:115], v[48:51], v[160:163], v[112:115]
  s_waitcnt vmcnt(16)
  s_barrier
  ds_read_b128 v[172:175], v197 offset:49152
  ds_read_b128 v[176:179], v197 offset:51200
  v_mfma_f32_16x16x32_bf16 v[116:119], v[48:51], v[164:167], v[116:119]
  ds_read_b128 v[180:183], v197 offset:53248
  ds_read_b64_tr_b16 v[32:33], v192 offset:16384
  v_mfma_f32_16x16x32_bf16 v[120:123], v[48:51], v[168:171], v[120:123]
  ds_read_b64_tr_b16 v[34:35], v192 offset:18432
  ds_read_b64_tr_b16 v[36:37], v193 offset:16384
  v_mfma_f32_16x16x32_bf16 v[124:127], v[52:55], v[160:163], v[124:127]
  ds_read_b64_tr_b16 v[38:39], v193 offset:18432
  ds_read_b64_tr_b16 v[40:41], v194 offset:16384
  v_mfma_f32_16x16x32_bf16 v[128:131], v[52:55], v[164:167], v[128:131]
  ds_read_b64_tr_b16 v[42:43], v194 offset:18432
  ds_read_b64_tr_b16 v[44:45], v195 offset:16384
  v_mfma_f32_16x16x32_bf16 v[132:135], v[52:55], v[168:171], v[132:135]
  ds_read_b64_tr_b16 v[46:47], v195 offset:18432
  ds_read_b64_tr_b16 v[48:49], v192 offset:16640
  v_mfma_f32_16x16x32_bf16 v[136:139], v[56:59], v[160:163], v[136:139]
  ds_read_b64_tr_b16 v[50:51], v192 offset:18688
  ds_read_b64_tr_b16 v[52:53], v193 offset:16640
  v_mfma_f32_16x16x32_bf16 v[140:143], v[56:59], v[164:167], v[140:143]
  ds_read_b64_tr_b16 v[54:55], v193 offset:18688
  s_add_u32 m0, s34, 0x18000
  v_mfma_f32_16x16x32_bf16 v[144:147], v[56:59], v[168:171], v[144:147]
  ds_read_b64_tr_b16 v[56:57], v194 offset:16640
  ds_read_b64_tr_b16 v[58:59], v194 offset:18688
  v_mfma_f32_16x16x32_bf16 v[148:151], v[60:63], v[160:163], v[148:151]
  s_add_u32 s32, s36, 0x300000
  buffer_load_dwordx4 v184, s[20:23], s32 offen offset:0 nt lds
  v_mfma_f32_16x16x32_bf16 v[152:155], v[60:63], v[164:167], v[152:155]
  buffer_load_dwordx4 v185, s[20:23], s32 offen offset:1024 nt lds
  buffer_load_dwordx4 v186, s[20:23], s32 offen offset:2048 nt lds
  v_mfma_f32_16x16x32_bf16 v[156:159], v[60:63], v[168:171], v[156:159]
  ds_read_b64_tr_b16 v[60:61], v195 offset:16640
  ds_read_b64_tr_b16 v[62:63], v195 offset:18688
  s_waitcnt lgkmcnt(15)
  s_waitcnt lgkmcnt(12)
  v_mfma_f32_16x16x32_bf16 v[64:67], v[32:35], v[172:175], v[64:67]
  buffer_load_dwordx4 v187, s[20:23], s32 offen offset:3072 nt lds
  s_add_u32 m0, s34, 0x19000
  v_mfma_f32_16x16x32_bf16 v[68:71], v[32:35], v[176:179], v[68:71]
  s_add_u32 s32, s36, 0x300000
  buffer_load_dwordx4 v188, s[20:23], s32 offen offset:0 nt lds
  v_mfma_f32_16x16x32_bf16 v[72:75], v[32:35], v[180:183], v[72:75]
  buffer_load_dwordx4 v189, s[20:23], s32 offen offset:1024 nt lds
  buffer_load_dwordx4 v190, s[20:23], s32 offen offset:2048 nt lds
  v_mfma_f32_16x16x32_bf16 v[76:79], v[36:39], v[172:175], v[76:79]
  buffer_load_dwordx4 v191, s[20:23], s32 offen offset:3072 nt lds
  v_mfma_f32_16x16x32_bf16 v[80:83], v[36:39], v[176:179], v[80:83]
  v_mfma_f32_16x16x32_bf16 v[84:87], v[36:39], v[180:183], v[84:87]
  s_waitcnt lgkmcnt(8)
  v_mfma_f32_16x16x32_bf16 v[88:91], v[40:43], v[172:175], v[88:91]
  v_mfma_f32_16x16x32_bf16 v[92:95], v[40:43], v[176:179], v[92:95]
  v_mfma_f32_16x16x32_bf16 v[96:99], v[40:43], v[180:183], v[96:99]
  v_mfma_f32_16x16x32_bf16 v[100:103], v[44:47], v[172:175], v[100:103]
  v_mfma_f32_16x16x32_bf16 v[104:107], v[44:47], v[176:179], v[104:107]
  v_mfma_f32_16x16x32_bf16 v[108:111], v[44:47], v[180:183], v[108:111]
  s_waitcnt lgkmcnt(0)
  v_mfma_f32_16x16x32_bf16 v[112:115], v[48:51], v[172:175], v[112:115]
  s_waitcnt vmcnt(16)
  s_barrier
  ds_read_b128 v[160:163], v196 offset:61440
  ds_read_b128 v[164:167], v196 offset:63488
  v_mfma_f32_16x16x32_bf16 v[116:119], v[48:51], v[176:179], v[116:119]
  v_add_u32 v196, 0x10000, v196
  ds_read_b128 v[168:171], v196 offset:0
  ds_read_b64_tr_b16 v[32:33], v192 offset:32768
  v_mfma_f32_16x16x32_bf16 v[120:123], v[48:51], v[180:183], v[120:123]
  ds_read_b64_tr_b16 v[34:35], v192 offset:34816
  ds_read_b64_tr_b16 v[36:37], v193 offset:32768
  v_mfma_f32_16x16x32_bf16 v[124:127], v[52:55], v[172:175], v[124:127]
  ds_read_b64_tr_b16 v[38:39], v193 offset:34816
  ds_read_b64_tr_b16 v[40:41], v194 offset:32768
  v_mfma_f32_16x16x32_bf16 v[128:131], v[52:55], v[176:179], v[128:131]
  ds_read_b64_tr_b16 v[42:43], v194 offset:34816
  ds_read_b64_tr_b16 v[44:45], v195 offset:32768
  v_mfma_f32_16x16x32_bf16 v[132:135], v[52:55], v[180:183], v[132:135]
  ds_read_b64_tr_b16 v[46:47], v195 offset:34816
  ds_read_b64_tr_b16 v[48:49], v192 offset:33024
  v_mfma_f32_16x16x32_bf16 v[136:139], v[56:59], v[172:175], v[136:139]
  ds_read_b64_tr_b16 v[50:51], v192 offset:35072
  ds_read_b64_tr_b16 v[52:53], v193 offset:33024
  v_mfma_f32_16x16x32_bf16 v[140:143], v[56:59], v[176:179], v[140:143]
  ds_read_b64_tr_b16 v[54:55], v193 offset:35072
  s_add_u32 m0, s34, 0x1c000
  v_mfma_f32_16x16x32_bf16 v[144:147], v[56:59], v[180:183], v[144:147]
  ds_read_b64_tr_b16 v[56:57], v194 offset:33024
  ds_read_b64_tr_b16 v[58:59], v194 offset:35072
  v_mfma_f32_16x16x32_bf16 v[148:151], v[60:63], v[172:175], v[148:151]
  s_add_u32 s32, s36, 0x340000
  buffer_load_dwordx4 v184, s[20:23], s32 offen offset:0 nt lds
  v_mfma_f32_16x16x32_bf16 v[152:155], v[60:63], v[176:179], v[152:155]
  buffer_load_dwordx4 v185, s[20:23], s32 offen offset:1024 nt lds
  buffer_load_dwordx4 v186, s[20:23], s32 offen offset:2048 nt lds
  v_mfma_f32_16x16x32_bf16 v[156:159], v[60:63], v[180:183], v[156:159]
  ds_read_b64_tr_b16 v[60:61], v195 offset:33024
  ds_read_b64_tr_b16 v[62:63], v195 offset:35072
  s_waitcnt lgkmcnt(15)
  s_waitcnt lgkmcnt(12)
  v_mfma_f32_16x16x32_bf16 v[64:67], v[32:35], v[160:163], v[64:67]
  buffer_load_dwordx4 v187, s[20:23], s32 offen offset:3072 nt lds
  s_add_u32 m0, s34, 0x1d000
  v_mfma_f32_16x16x32_bf16 v[68:71], v[32:35], v[164:167], v[68:71]
  s_add_u32 s32, s36, 0x340000
  buffer_load_dwordx4 v188, s[20:23], s32 offen offset:0 nt lds
  v_mfma_f32_16x16x32_bf16 v[72:75], v[32:35], v[168:171], v[72:75]
  buffer_load_dwordx4 v189, s[20:23], s32 offen offset:1024 nt lds
  buffer_load_dwordx4 v190, s[20:23], s32 offen offset:2048 nt lds
  v_mfma_f32_16x16x32_bf16 v[76:79], v[36:39], v[160:163], v[76:79]
  buffer_load_dwordx4 v191, s[20:23], s32 offen offset:3072 nt lds
  v_mfma_f32_16x16x32_bf16 v[80:83], v[36:39], v[164:167], v[80:83]
  v_mfma_f32_16x16x32_bf16 v[84:87], v[36:39], v[168:171], v[84:87]
  s_waitcnt lgkmcnt(8)
  v_mfma_f32_16x16x32_bf16 v[88:91], v[40:43], v[160:163], v[88:91]
  v_mfma_f32_16x16x32_bf16 v[92:95], v[40:43], v[164:167], v[92:95]
  v_mfma_f32_16x16x32_bf16 v[96:99], v[40:43], v[168:171], v[96:99]
  v_mfma_f32_16x16x32_bf16 v[100:103], v[44:47], v[160:163], v[100:103]
  v_mfma_f32_16x16x32_bf16 v[104:107], v[44:47], v[164:167], v[104:107]
  v_mfma_f32_16x16x32_bf16 v[108:111], v[44:47], v[168:171], v[108:111]
  s_waitcnt lgkmcnt(0)
  v_mfma_f32_16x16x32_bf16 v[112:115], v[48:51], v[160:163], v[112:115]
  s_waitcnt vmcnt(16)
  s_barrier
  ds_read_b128 v[172:175], v197 offset:61440
  ds_read_b128 v[176:179], v197 offset:63488
  v_mfma_f32_16x16x32_bf16 v[116:119], v[48:51], v[164:167], v[116:119]
  v_add_u32 v197, 0x10000, v197
  ds_read_b128 v[180:183], v197 offset:0
  ds_read_b64_tr_b16 v[32:33], v192 offset:49152
  v_mfma_f32_16x16x32_bf16 v[120:123], v[48:51], v[168:171], v[120:123]
  ds_read_b64_tr_b16 v[34:35], v192 offset:51200
  ds_read_b64_tr_b16 v[36:37], v193 offset:49152
  v_mfma_f32_16x16x32_bf16 v[124:127], v[52:55], v[160:163], v[124:127]
  ds_read_b64_tr_b16 v[38:39], v193 offset:51200
  ds_read_b64_tr_b16 v[40:41], v194 offset:49152
  v_mfma_f32_16x16x32_bf16 v[128:131], v[52:55], v[164:167], v[128:131]
  ds_read_b64_tr_b16 v[42:43], v194 offset:51200
  ds_read_b64_tr_b16 v[44:45], v195 offset:49152
  v_mfma_f32_16x16x32_bf16 v[132:135], v[52:55], v[168:171], v[132:135]
  ds_read_b64_tr_b16 v[46:47], v195 offset:51200
  ds_read_b64_tr_b16 v[48:49], v192 offset:49408
  v_mfma_f32_16x16x32_bf16 v[136:139], v[56:59], v[160:163], v[136:139]
  ds_read_b64_tr_b16 v[50:51], v192 offset:51456
  ds_read_b64_tr_b16 v[52:53], v193 offset:49408
  v_mfma_f32_16x16x32_bf16 v[140:143], v[56:59], v[164:167], v[140:143]
  ds_read_b64_tr_b16 v[54:55], v193 offset:51456
  s_add_u32 m0, s34, 0x20000
  v_mfma_f32_16x16x32_bf16 v[144:147], v[56:59], v[168:171], v[144:147]
  ds_read_b64_tr_b16 v[56:57], v194 offset:49408
  ds_read_b64_tr_b16 v[58:59], v194 offset:51456
  v_mfma_f32_16x16x32_bf16 v[148:151], v[60:63], v[160:163], v[148:151]
  s_add_u32 s32, s36, 0x380000
  buffer_load_dwordx4 v184, s[20:23], s32 offen offset:0 nt lds
  v_mfma_f32_16x16x32_bf16 v[152:155], v[60:63], v[164:167], v[152:155]
  buffer_load_dwordx4 v185, s[20:23], s32 offen offset:1024 nt lds
  buffer_load_dwordx4 v186, s[20:23], s32 offen offset:2048 nt lds
  v_mfma_f32_16x16x32_bf16 v[156:159], v[60:63], v[168:171], v[156:159]
  ds_read_b64_tr_b16 v[60:61], v195 offset:49408
  ds_read_b64_tr_b16 v[62:63], v195 offset:51456
  s_waitcnt lgkmcnt(15)
  s_waitcnt lgkmcnt(12)
  v_mfma_f32_16x16x32_bf16 v[64:67], v[32:35], v[172:175], v[64:67]
  buffer_load_dwordx4 v187, s[20:23], s32 offen offset:3072 nt lds
  s_add_u32 m0, s34, 0x21000
  v_mfma_f32_16x16x32_bf16 v[68:71], v[32:35], v[176:179], v[68:71]
  s_add_u32 s32, s36, 0x380000
  buffer_load_dwordx4 v188, s[20:23], s32 offen offset:0 nt lds
  v_mfma_f32_16x16x32_bf16 v[72:75], v[32:35], v[180:183], v[72:75]
  buffer_load_dwordx4 v189, s[20:23], s32 offen offset:1024 nt lds
  buffer_load_dwordx4 v190, s[20:23], s32 offen offset:2048 nt lds
  v_mfma_f32_16x16x32_bf16 v[76:79], v[36:39], v[172:175], v[76:79]
  buffer_load_dwordx4 v191, s[20:23], s32 offen offset:3072 nt lds
  v_mfma_f32_16x16x32_bf16 v[80:83], v[36:39], v[176:179], v[80:83]
  v_mfma_f32_16x16x32_bf16 v[84:87], v[36:39], v[180:183], v[84:87]
  s_waitcnt lgkmcnt(8)
  v_mfma_f32_16x16x32_bf16 v[88:91], v[40:43], v[172:175], v[88:91]
  v_mfma_f32_16x16x32_bf16 v[92:95], v[40:43], v[176:179], v[92:95]
  v_mfma_f32_16x16x32_bf16 v[96:99], v[40:43], v[180:183], v[96:99]
  v_mfma_f32_16x16x32_bf16 v[100:103], v[44:47], v[172:175], v[100:103]
  v_mfma_f32_16x16x32_bf16 v[104:107], v[44:47], v[176:179], v[104:107]
  v_mfma_f32_16x16x32_bf16 v[108:111], v[44:47], v[180:183], v[108:111]
  s_waitcnt lgkmcnt(0)
  v_mfma_f32_16x16x32_bf16 v[112:115], v[48:51], v[172:175], v[112:115]
  s_waitcnt vmcnt(16)
  s_barrier
  ds_read_b128 v[160:163], v196 offset:8192
  ds_read_b128 v[164:167], v196 offset:10240
  v_mfma_f32_16x16x32_bf16 v[116:119], v[48:51], v[176:179], v[116:119]
  ds_read_b128 v[168:171], v196 offset:12288
  ds_read_b64_tr_b16 v[32:33], v192 offset:0
  v_mfma_f32_16x16x32_bf16 v[120:123], v[48:51], v[180:183], v[120:123]
  ds_read_b64_tr_b16 v[34:35], v192 offset:2048
  ds_read_b64_tr_b16 v[36:37], v193 offset:0
  v_mfma_f32_16x16x32_bf16 v[124:127], v[52:55], v[172:175], v[124:127]
  ds_read_b64_tr_b16 v[38:39], v193 offset:2048
  ds_read_b64_tr_b16 v[40:41], v194 offset:0
  v_mfma_f32_16x16x32_bf16 v[128:131], v[52:55], v[176:179], v[128:131]
  ds_read_b64_tr_b16 v[42:43], v194 offset:2048
  ds_read_b64_tr_b16 v[44:45], v195 offset:0
  v_mfma_f32_16x16x32_bf16 v[132:135], v[52:55], v[180:183], v[132:135]
  ds_read_b64_tr_b16 v[46:47], v195 offset:2048
  ds_read_b64_tr_b16 v[48:49], v192 offset:256
  v_mfma_f32_16x16x32_bf16 v[136:139], v[56:59], v[172:175], v[136:139]
  ds_read_b64_tr_b16 v[50:51], v192 offset:2304
  ds_read_b64_tr_b16 v[52:53], v193 offset:256
  v_mfma_f32_16x16x32_bf16 v[140:143], v[56:59], v[176:179], v[140:143]
  ds_read_b64_tr_b16 v[54:55], v193 offset:2304
  s_add_u32 m0, s34, 0x24000
  v_mfma_f32_16x16x32_bf16 v[144:147], v[56:59], v[180:183], v[144:147]
  ds_read_b64_tr_b16 v[56:57], v194 offset:256
  ds_read_b64_tr_b16 v[58:59], v194 offset:2304
  v_mfma_f32_16x16x32_bf16 v[148:151], v[60:63], v[172:175], v[148:151]
  s_add_u32 s32, s36, 0x3c0000
  buffer_load_dwordx4 v184, s[20:23], s32 offen offset:0 nt lds
  v_mfma_f32_16x16x32_bf16 v[152:155], v[60:63], v[176:179], v[152:155]
  buffer_load_dwordx4 v185, s[20:23], s32 offen offset:1024 nt lds
  buffer_load_dwordx4 v186, s[20:23], s32 offen offset:2048 nt lds
  v_mfma_f32_16x16x32_bf16 v[156:159], v[60:63], v[180:183], v[156:159]
  ds_read_b64_tr_b16 v[60:61], v195 offset:256
  ds_read_b64_tr_b16 v[62:63], v195 offset:2304
  s_waitcnt lgkmcnt(15)
  s_waitcnt lgkmcnt(12)
  v_mfma_f32_16x16x32_bf16 v[64:67], v[32:35], v[160:163], v[64:67]
  buffer_load_dwordx4 v187, s[20:23], s32 offen offset:3072 nt lds
  s_add_u32 m0, s34, 0x25000
  v_mfma_f32_16x16x32_bf16 v[68:71], v[32:35], v[164:167], v[68:71]
  s_add_u32 s32, s36, 0x3c0000
  buffer_load_dwordx4 v188, s[20:23], s32 offen offset:0 nt lds
  v_mfma_f32_16x16x32_bf16 v[72:75], v[32:35], v[168:171], v[72:75]
  buffer_load_dwordx4 v189, s[20:23], s32 offen offset:1024 nt lds
  buffer_load_dwordx4 v190, s[20:23], s32 offen offset:2048 nt lds
  v_mfma_f32_16x16x32_bf16 v[76:79], v[36:39], v[160:163], v[76:79]
  buffer_load_dwordx4 v191, s[20:23], s32 offen offset:3072 nt lds
  v_mfma_f32_16x16x32_bf16 v[80:83], v[36:39], v[164:167], v[80:83]
  v_mfma_f32_16x16x32_bf16 v[84:87], v[36:39], v[168:171], v[84:87]
  s_waitcnt lgkmcnt(8)
  v_mfma_f32_16x16x32_bf16 v[88:91], v[40:43], v[160:163], v[88:91]
  v_mfma_f32_16x16x32_bf16 v[92:95], v[40:43], v[164:167], v[92:95]
  v_mfma_f32_16x16x32_bf16 v[96:99], v[40:43], v[168:171], v[96:99]
  v_mfma_f32_16x16x32_bf16 v[100:103], v[44:47], v[160:163], v[100:103]
  v_mfma_f32_16x16x32_bf16 v[104:107], v[44:47], v[164:167], v[104:107]
  v_mfma_f32_16x16x32_bf16 v[108:111], v[44:47], v[168:171], v[108:111]
  s_waitcnt lgkmcnt(0)
  v_mfma_f32_16x16x32_bf16 v[112:115], v[48:51], v[160:163], v[112:115]
  s_waitcnt vmcnt(16)
  s_barrier
  ds_read_b128 v[172:175], v197 offset:8192
  ds_read_b128 v[176:179], v197 offset:10240
  v_mfma_f32_16x16x32_bf16 v[116:119], v[48:51], v[164:167], v[116:119]
  ds_read_b128 v[180:183], v197 offset:12288
  ds_read_b64_tr_b16 v[32:33], v192 offset:16384
  v_mfma_f32_16x16x32_bf16 v[120:123], v[48:51], v[168:171], v[120:123]
  ds_read_b64_tr_b16 v[34:35], v192 offset:18432
  ds_read_b64_tr_b16 v[36:37], v193 offset:16384
  v_mfma_f32_16x16x32_bf16 v[124:127], v[52:55], v[160:163], v[124:127]
  ds_read_b64_tr_b16 v[38:39], v193 offset:18432
  ds_read_b64_tr_b16 v[40:41], v194 offset:16384
  v_mfma_f32_16x16x32_bf16 v[128:131], v[52:55], v[164:167], v[128:131]
  ds_read_b64_tr_b16 v[42:43], v194 offset:18432
  ds_read_b64_tr_b16 v[44:45], v195 offset:16384
  v_mfma_f32_16x16x32_bf16 v[132:135], v[52:55], v[168:171], v[132:135]
  ds_read_b64_tr_b16 v[46:47], v195 offset:18432
  ds_read_b64_tr_b16 v[48:49], v192 offset:16640
  v_mfma_f32_16x16x32_bf16 v[136:139], v[56:59], v[160:163], v[136:139]
  ds_read_b64_tr_b16 v[50:51], v192 offset:18688
  ds_read_b64_tr_b16 v[52:53], v193 offset:16640
  v_mfma_f32_16x16x32_bf16 v[140:143], v[56:59], v[164:167], v[140:143]
  ds_read_b64_tr_b16 v[54:55], v193 offset:18688
  v_mfma_f32_16x16x32_bf16 v[144:147], v[56:59], v[168:171], v[144:147]
  ds_read_b64_tr_b16 v[56:57], v194 offset:16640
  ds_read_b64_tr_b16 v[58:59], v194 offset:18688
  v_mfma_f32_16x16x32_bf16 v[148:151], v[60:63], v[160:163], v[148:151]
  v_mfma_f32_16x16x32_bf16 v[152:155], v[60:63], v[164:167], v[152:155]
  v_mfma_f32_16x16x32_bf16 v[156:159], v[60:63], v[168:171], v[156:159]
  ds_read_b64_tr_b16 v[60:61], v195 offset:16640
  ds_read_b64_tr_b16 v[62:63], v195 offset:18688
  s_waitcnt lgkmcnt(15)
  s_waitcnt lgkmcnt(12)
  v_mfma_f32_16x16x32_bf16 v[64:67], v[32:35], v[172:175], v[64:67]
  v_mfma_f32_16x16x32_bf16 v[68:71], v[32:35], v[176:179], v[68:71]
  v_mfma_f32_16x16x32_bf16 v[72:75], v[32:35], v[180:183], v[72:75]
  v_mfma_f32_16x16x32_bf16 v[76:79], v[36:39], v[172:175], v[76:79]
  v_mfma_f32_16x16x32_bf16 v[80:83], v[36:39], v[176:179], v[80:83]
  v_mfma_f32_16x16x32_bf16 v[84:87], v[36:39], v[180:183], v[84:87]
  s_waitcnt lgkmcnt(8)
  v_mfma_f32_16x16x32_bf16 v[88:91], v[40:43], v[172:175], v[88:91]
  v_mfma_f32_16x16x32_bf16 v[92:95], v[40:43], v[176:179], v[92:95]
  v_mfma_f32_16x16x32_bf16 v[96:99], v[40:43], v[180:183], v[96:99]
  v_mfma_f32_16x16x32_bf16 v[100:103], v[44:47], v[172:175], v[100:103]
  v_mfma_f32_16x16x32_bf16 v[104:107], v[44:47], v[176:179], v[104:107]
  v_mfma_f32_16x16x32_bf16 v[108:111], v[44:47], v[180:183], v[108:111]
  s_waitcnt lgkmcnt(0)
  v_mfma_f32_16x16x32_bf16 v[112:115], v[48:51], v[172:175], v[112:115]
  s_waitcnt vmcnt(8)
  s_barrier
  ds_read_b128 v[160:163], v196 offset:20480
  ds_read_b128 v[164:167], v196 offset:22528
  v_mfma_f32_16x16x32_bf16 v[116:119], v[48:51], v[176:179], v[116:119]
  ds_read_b128 v[168:171], v196 offset:24576
  ds_read_b64_tr_b16 v[32:33], v192 offset:32768
  v_mfma_f32_16x16x32_bf16 v[120:123], v[48:51], v[180:183], v[120:123]
  ds_read_b64_tr_b16 v[34:35], v192 offset:34816
  ds_read_b64_tr_b16 v[36:37], v193 offset:32768
  v_mfma_f32_16x16x32_bf16 v[124:127], v[52:55], v[172:175], v[124:127]
  ds_read_b64_tr_b16 v[38:39], v193 offset:34816
  ds_read_b64_tr_b16 v[40:41], v194 offset:32768
  v_mfma_f32_16x16x32_bf16 v[128:131], v[52:55], v[176:179], v[128:131]
  ds_read_b64_tr_b16 v[42:43], v194 offset:34816
  ds_read_b64_tr_b16 v[44:45], v195 offset:32768
  v_mfma_f32_16x16x32_bf16 v[132:135], v[52:55], v[180:183], v[132:135]
  ds_read_b64_tr_b16 v[46:47], v195 offset:34816
  ds_read_b64_tr_b16 v[48:49], v192 offset:33024
  v_mfma_f32_16x16x32_bf16 v[136:139], v[56:59], v[172:175], v[136:139]
  ds_read_b64_tr_b16 v[50:51], v192 offset:35072
  ds_read_b64_tr_b16 v[52:53], v193 offset:33024
  v_mfma_f32_16x16x32_bf16 v[140:143], v[56:59], v[176:179], v[140:143]
  ds_read_b64_tr_b16 v[54:55], v193 offset:35072
  v_mfma_f32_16x16x32_bf16 v[144:147], v[56:59], v[180:183], v[144:147]
  ds_read_b64_tr_b16 v[56:57], v194 offset:33024
  ds_read_b64_tr_b16 v[58:59], v194 offset:35072
  v_mfma_f32_16x16x32_bf16 v[148:151], v[60:63], v[172:175], v[148:151]
  v_mfma_f32_16x16x32_bf16 v[152:155], v[60:63], v[176:179], v[152:155]
  v_mfma_f32_16x16x32_bf16 v[156:159], v[60:63], v[180:183], v[156:159]
  ds_read_b64_tr_b16 v[60:61], v195 offset:33024
  ds_read_b64_tr_b16 v[62:63], v195 offset:35072
  s_waitcnt lgkmcnt(15)
  s_waitcnt lgkmcnt(12)
  v_mfma_f32_16x16x32_bf16 v[64:67], v[32:35], v[160:163], v[64:67]
  v_mfma_f32_16x16x32_bf16 v[68:71], v[32:35], v[164:167], v[68:71]
  v_mfma_f32_16x16x32_bf16 v[72:75], v[32:35], v[168:171], v[72:75]
  v_mfma_f32_16x16x32_bf16 v[76:79], v[36:39], v[160:163], v[76:79]
  v_mfma_f32_16x16x32_bf16 v[80:83], v[36:39], v[164:167], v[80:83]
  v_mfma_f32_16x16x32_bf16 v[84:87], v[36:39], v[168:171], v[84:87]
  s_waitcnt lgkmcnt(8)
  v_mfma_f32_16x16x32_bf16 v[88:91], v[40:43], v[160:163], v[88:91]
  v_mfma_f32_16x16x32_bf16 v[92:95], v[40:43], v[164:167], v[92:95]
  v_mfma_f32_16x16x32_bf16 v[96:99], v[40:43], v[168:171], v[96:99]
  v_mfma_f32_16x16x32_bf16 v[100:103], v[44:47], v[160:163], v[100:103]
  v_mfma_f32_16x16x32_bf16 v[104:107], v[44:47], v[164:167], v[104:107]
  v_mfma_f32_16x16x32_bf16 v[108:111], v[44:47], v[168:171], v[108:111]
  s_waitcnt lgkmcnt(0)
  v_mfma_f32_16x16x32_bf16 v[112:115], v[48:51], v[160:163], v[112:115]
  s_waitcnt vmcnt(0)
  s_barrier
  ds_read_b128 v[172:175], v197 offset:20480
  ds_read_b128 v[176:179], v197 offset:22528
  v_mfma_f32_16x16x32_bf16 v[116:119], v[48:51], v[164:167], v[116:119]
  ds_read_b128 v[180:183], v197 offset:24576
  ds_read_b64_tr_b16 v[32:33], v192 offset:49152
  v_mfma_f32_16x16x32_bf16 v[120:123], v[48:51], v[168:171], v[120:123]
  ds_read_b64_tr_b16 v[34:35], v192 offset:51200
  ds_read_b64_tr_b16 v[36:37], v193 offset:49152
  v_mfma_f32_16x16x32_bf16 v[124:127], v[52:55], v[160:163], v[124:127]
  ds_read_b64_tr_b16 v[38:39], v193 offset:51200
  ds_read_b64_tr_b16 v[40:41], v194 offset:49152
  v_mfma_f32_16x16x32_bf16 v[128:131], v[52:55], v[164:167], v[128:131]
  ds_read_b64_tr_b16 v[42:43], v194 offset:51200
  ds_read_b64_tr_b16 v[44:45], v195 offset:49152
  v_mfma_f32_16x16x32_bf16 v[132:135], v[52:55], v[168:171], v[132:135]
  ds_read_b64_tr_b16 v[46:47], v195 offset:51200
  ds_read_b64_tr_b16 v[48:49], v192 offset:49408
  v_mfma_f32_16x16x32_bf16 v[136:139], v[56:59], v[160:163], v[136:139]
  ds_read_b64_tr_b16 v[50:51], v192 offset:51456
  ds_read_b64_tr_b16 v[52:53], v193 offset:49408
  v_mfma_f32_16x16x32_bf16 v[140:143], v[56:59], v[164:167], v[140:143]
  ds_read_b64_tr_b16 v[54:55], v193 offset:51456
  v_mfma_f32_16x16x32_bf16 v[144:147], v[56:59], v[168:171], v[144:147]
  ds_read_b64_tr_b16 v[56:57], v194 offset:49408
  ds_read_b64_tr_b16 v[58:59], v194 offset:51456
  v_mfma_f32_16x16x32_bf16 v[148:151], v[60:63], v[160:163], v[148:151]
  v_mfma_f32_16x16x32_bf16 v[152:155], v[60:63], v[164:167], v[152:155]
  v_mfma_f32_16x16x32_bf16 v[156:159], v[60:63], v[168:171], v[156:159]
  ds_read_b64_tr_b16 v[60:61], v195 offset:49408
  ds_read_b64_tr_b16 v[62:63], v195 offset:51456
  s_waitcnt lgkmcnt(15)
  s_waitcnt lgkmcnt(12)
  v_mfma_f32_16x16x32_bf16 v[64:67], v[32:35], v[172:175], v[64:67]
  v_mfma_f32_16x16x32_bf16 v[68:71], v[32:35], v[176:179], v[68:71]
  v_mfma_f32_16x16x32_bf16 v[72:75], v[32:35], v[180:183], v[72:75]
  v_mfma_f32_16x16x32_bf16 v[76:79], v[36:39], v[172:175], v[76:79]
  v_mfma_f32_16x16x32_bf16 v[80:83], v[36:39], v[176:179], v[80:83]
  v_mfma_f32_16x16x32_bf16 v[84:87], v[36:39], v[180:183], v[84:87]
  s_waitcnt lgkmcnt(8)
  v_mfma_f32_16x16x32_bf16 v[88:91], v[40:43], v[172:175], v[88:91]
  v_mfma_f32_16x16x32_bf16 v[92:95], v[40:43], v[176:179], v[92:95]
  v_mfma_f32_16x16x32_bf16 v[96:99], v[40:43], v[180:183], v[96:99]
  v_mfma_f32_16x16x32_bf16 v[100:103], v[44:47], v[172:175], v[100:103]
  v_mfma_f32_16x16x32_bf16 v[104:107], v[44:47], v[176:179], v[104:107]
  v_mfma_f32_16x16x32_bf16 v[108:111], v[44:47], v[180:183], v[108:111]
  s_waitcnt lgkmcnt(0)
  v_mfma_f32_16x16x32_bf16 v[112:115], v[48:51], v[172:175], v[112:115]
  s_barrier
  ds_read_b128 v[32:35], v8 offset:0
  ds_read_b128 v[36:39], v8 offset:4096
  v_mfma_f32_16x16x32_bf16 v[116:119], v[48:51], v[176:179], v[116:119]
  ds_read_b128 v[40:43], v9 offset:0
  ds_read_b128 v[44:47], v9 offset:4096
  v_mfma_f32_16x16x32_bf16 v[120:123], v[48:51], v[180:183], v[120:123]
  ds_read_b128 v[48:51], v10 offset:0
  v_mfma_f32_16x16x32_bf16 v[124:127], v[52:55], v[172:175], v[124:127]
  v_mfma_f32_16x16x32_bf16 v[128:131], v[52:55], v[176:179], v[128:131]
  v_mfma_f32_16x16x32_bf16 v[132:135], v[52:55], v[180:183], v[132:135]
  ds_read_b128 v[52:55], v10 offset:4096
  v_mfma_f32_16x16x32_bf16 v[136:139], v[56:59], v[172:175], v[136:139]
  v_mfma_f32_16x16x32_bf16 v[140:143], v[56:59], v[176:179], v[140:143]
  v_mfma_f32_16x16x32_bf16 v[144:147], v[56:59], v[180:183], v[144:147]
  ds_read_b128 v[56:59], v11 offset:0
  v_mfma_f32_16x16x32_bf16 v[148:151], v[60:63], v[172:175], v[148:151]
  v_mfma_f32_16x16x32_bf16 v[152:155], v[60:63], v[176:179], v[152:155]
  v_mfma_f32_16x16x32_bf16 v[156:159], v[60:63], v[180:183], v[156:159]
  ds_read_b128 v[60:63], v11 offset:4096
  v_bfe_u32 v200, v0, 4, 4
  v_lshrrev_b32 v201, 8, v0
  v_lshrrev_b32 v205, 1, v201
  s_lshl_b32 s42, s40, 3
  v_xor_b32 v205, s42, v205
  v_xor_b32 v205, v200, v205
  v_lshlrev_b32 v205, 4, v205
  v_lshl_add_u32 v204, v200, 8, v205
  v_and_b32 v205, 1, v201
  v_lshl_add_u32 v204, v205, 3, v204
  v_add_u32 v204, s46, v204
  v_xor_b32 v205, 32, v204
  v_xor_b32 v206, 64, v204
  v_xor_b32 v207, 96, v204
  s_sub_u32 s42, s46, s34
  s_sub_u32 s42, s42, 0x0
  v_add_u32 v208, s42, v8
  v_add_u32 v209, s42, v9
  v_add_u32 v210, s42, v10
  v_add_u32 v211, s42, v11
  v_cvt_pk_bf16_f32 v64, v64, v65
  v_cvt_pk_bf16_f32 v65, v66, v67
  ds_write_b64 v204, v[64:65] offset:0
  v_cvt_pk_bf16_f32 v68, v68, v69
  v_cvt_pk_bf16_f32 v69, v70, v71
  ds_write_b64 v204, v[68:69] offset:4096
  v_cvt_pk_bf16_f32 v72, v72, v73
  v_cvt_pk_bf16_f32 v73, v74, v75
  ds_write_b64 v204, v[72:73] offset:8192
  v_cvt_pk_bf16_f32 v76, v76, v77
  v_cvt_pk_bf16_f32 v77, v78, v79
  ds_write_b64 v205, v[76:77] offset:0
  v_cvt_pk_bf16_f32 v80, v80, v81
  v_cvt_pk_bf16_f32 v81, v82, v83
  ds_write_b64 v205, v[80:81] offset:4096
  v_cvt_pk_bf16_f32 v84, v84, v85
  v_cvt_pk_bf16_f32 v85, v86, v87
  ds_write_b64 v205, v[84:85] offset:8192
  v_cvt_pk_bf16_f32 v88, v88, v89
  v_cvt_pk_bf16_f32 v89, v90, v91
  ds_write_b64 v206, v[88:89] offset:0
  v_cvt_pk_bf16_f32 v92, v92, v93
  v_cvt_pk_bf16_f32 v93, v94, v95
  ds_write_b64 v206, v[92:93] offset:4096
  v_cvt_pk_bf16_f32 v96, v96, v97
  v_cvt_pk_bf16_f32 v97, v98, v99
  ds_write_b64 v206, v[96:97] offset:8192
  v_cvt_pk_bf16_f32 v100, v100, v101
  v_cvt_pk_bf16_f32 v101, v102, v103
  ds_write_b64 v207, v[100:101] offset:0
  v_cvt_pk_bf16_f32 v104, v104, v105
  v_cvt_pk_bf16_f32 v105, v106, v107
  ds_write_b64 v207, v[104:105] offset:4096
  v_cvt_pk_bf16_f32 v108, v108, v109
  v_cvt_pk_bf16_f32 v109, v110, v111
  ds_write_b64 v207, v[108:109] offset:8192
  v_cvt_pk_bf16_f32 v112, v112, v113
  v_cvt_pk_bf16_f32 v113, v114, v115
  ds_write_b64 v204, v[112:113] offset:24576
  v_cvt_pk_bf16_f32 v116, v116, v117
  v_cvt_pk_bf16_f32 v117, v118, v119
  ds_write_b64 v204, v[116:117] offset:28672
  v_cvt_pk_bf16_f32 v120, v120, v121
  v_cvt_pk_bf16_f32 v121, v122, v123
  ds_write_b64 v204, v[120:121] offset:32768
  v_cvt_pk_bf16_f32 v124, v124, v125
  v_cvt_pk_bf16_f32 v125, v126, v127
  ds_write_b64 v205, v[124:125] offset:24576
  v_cvt_pk_bf16_f32 v128, v128, v129
  v_cvt_pk_bf16_f32 v129, v130, v131
  ds_write_b64 v205, v[128:129] offset:28672
  v_cvt_pk_bf16_f32 v132, v132, v133
  v_cvt_pk_bf16_f32 v133, v134, v135
  ds_write_b64 v205, v[132:133] offset:32768
  v_cvt_pk_bf16_f32 v136, v136, v137
  v_cvt_pk_bf16_f32 v137, v138, v139
  ds_write_b64 v206, v[136:137] offset:24576
  v_cvt_pk_bf16_f32 v140, v140, v141
  v_cvt_pk_bf16_f32 v141, v142, v143
  ds_write_b64 v206, v[140:141] offset:28672
  v_cvt_pk_bf16_f32 v144, v144, v145
  v_cvt_pk_bf16_f32 v145, v146, v147
  ds_write_b64 v206, v[144:145] offset:32768
  v_cvt_pk_bf16_f32 v148, v148, v149
  v_cvt_pk_bf16_f32 v149, v150, v151
  ds_write_b64 v207, v[148:149] offset:24576
  v_cvt_pk_bf16_f32 v152, v152, v153
  v_cvt_pk_bf16_f32 v153, v154, v155
  ds_write_b64 v207, v[152:153] offset:28672
  v_cvt_pk_bf16_f32 v156, v156, v157
  v_cvt_pk_bf16_f32 v157, v158, v159
  ds_write_b64 v207, v[156:157] offset:32768
  s_waitcnt lgkmcnt(0)
  s_barrier
  ds_read_b128 a[0:3], v208 offset:0
  ds_read_b128 a[16:19], v208 offset:4096
  ds_read_b128 a[32:35], v208 offset:8192
  ds_read_b128 a[4:7], v209 offset:0
  ds_read_b128 a[20:23], v209 offset:4096
  ds_read_b128 a[36:39], v209 offset:8192
  ds_read_b128 a[8:11], v210 offset:0
  ds_read_b128 a[24:27], v210 offset:4096
  ds_read_b128 a[40:43], v210 offset:8192
  ds_read_b128 a[12:15], v211 offset:0
  ds_read_b128 a[28:31], v211 offset:4096
  ds_read_b128 a[44:47], v211 offset:8192
  ds_read_b128 a[192:195], v208 offset:24576
  ds_read_b128 a[208:211], v208 offset:28672
  ds_read_b128 a[224:227], v208 offset:32768
  ds_read_b128 a[196:199], v209 offset:24576
  ds_read_b128 a[212:215], v209 offset:28672
  ds_read_b128 a[228:231], v209 offset:32768
  ds_read_b128 a[200:203], v210 offset:24576
  ds_read_b128 a[216:219], v210 offset:28672
  ds_read_b128 a[232:235], v210 offset:32768
  ds_read_b128 a[204:207], v211 offset:24576
  ds_read_b128 a[220:223], v211 offset:28672
  ds_read_b128 a[236:239], v211 offset:32768
  s_waitcnt lgkmcnt(12)
  v_mfma_f32_16x16x32_bf16 v[64:67], v[32:35], a[0:3], 0
  v_mfma_f32_16x16x32_bf16 v[72:75], v[32:35], a[16:19], 0
  v_mfma_f32_16x16x32_bf16 v[80:83], v[32:35], a[32:35], 0
  v_mfma_f32_16x16x32_bf16 v[68:71], v[36:39], a[0:3], 0
  v_mfma_f32_16x16x32_bf16 v[76:79], v[36:39], a[16:19], 0
  v_mfma_f32_16x16x32_bf16 v[84:87], v[36:39], a[32:35], 0
  v_mfma_f32_16x16x32_bf16 v[64:67], v[40:43], a[4:7], v[64:67]
  v_mfma_f32_16x16x32_bf16 v[72:75], v[40:43], a[20:23], v[72:75]
  v_mfma_f32_16x16x32_bf16 v[80:83], v[40:43], a[36:39], v[80:83]
  v_mfma_f32_16x16x32_bf16 v[68:71], v[44:47], a[4:7], v[68:71]
  v_mfma_f32_16x16x32_bf16 v[76:79], v[44:47], a[20:23], v[76:79]
  v_mfma_f32_16x16x32_bf16 v[84:87], v[44:47], a[36:39], v[84:87]
  s_waitcnt lgkmcnt(0)
  v_mfma_f32_16x16x32_bf16 v[64:67], v[48:51], a[8:11], v[64:67]
  s_barrier
  ds_read_b128 v[32:35], v8 offset:16384
  ds_read_b128 v[36:39], v8 offset:20480
  v_mfma_f32_16x16x32_bf16 v[72:75], v[48:51], a[24:27], v[72:75]
  ds_read_b128 v[40:43], v9 offset:16384
  ds_read_b128 v[44:47], v9 offset:20480
  v_mfma_f32_16x16x32_bf16 v[80:83], v[48:51], a[40:43], v[80:83]
  ds_read_b128 v[48:51], v10 offset:16384
  v_mfma_f32_16x16x32_bf16 v[68:71], v[52:55], a[8:11], v[68:71]
  v_mfma_f32_16x16x32_bf16 v[76:79], v[52:55], a[24:27], v[76:79]
  v_mfma_f32_16x16x32_bf16 v[84:87], v[52:55], a[40:43], v[84:87]
  ds_read_b128 v[52:55], v10 offset:20480
  v_mfma_f32_16x16x32_bf16 v[64:67], v[56:59], a[12:15], v[64:67]
  v_mfma_f32_16x16x32_bf16 v[72:75], v[56:59], a[28:31], v[72:75]
  v_mfma_f32_16x16x32_bf16 v[80:83], v[56:59], a[44:47], v[80:83]
  ds_read_b128 v[56:59], v11 offset:16384
  v_mfma_f32_16x16x32_bf16 v[68:71], v[60:63], a[12:15], v[68:71]
  v_mfma_f32_16x16x32_bf16 v[76:79], v[60:63], a[28:31], v[76:79]
  v_mfma_f32_16x16x32_bf16 v[84:87], v[60:63], a[44:47], v[84:87]
  ds_read_b128 v[60:63], v11 offset:20480
  s_waitcnt lgkmcnt(6)
  v_mfma_f32_16x16x32_bf16 v[88:91], v[32:35], a[0:3], 0
  v_mfma_f32_16x16x32_bf16 v[96:99], v[32:35], a[16:19], 0
  v_mfma_f32_16x16x32_bf16 v[104:107], v[32:35], a[32:35], 0
  v_mfma_f32_16x16x32_bf16 v[92:95], v[36:39], a[0:3], 0
  v_mfma_f32_16x16x32_bf16 v[100:103], v[36:39], a[16:19], 0
  v_mfma_f32_16x16x32_bf16 v[108:111], v[36:39], a[32:35], 0
  s_waitcnt lgkmcnt(4)
  v_mfma_f32_16x16x32_bf16 v[88:91], v[40:43], a[4:7], v[88:91]
  s_add_u32 s61, s41, 0
  s_and_b32 s61, s61, 7
  v_mfma_f32_16x16x32_bf16 v[96:99], v[40:43], a[20:23], v[96:99]
  s_lshl_b32 s61, s61, 7
  s_add_u32 s61, s61, s37
  v_mfma_f32_16x16x32_bf16 v[104:107], v[40:43], a[36:39], v[104:107]
  s_add_u32 m0, s34, 0x18000
  s_add_u32 s32, s61, 0x0
  v_mfma_f32_16x16x32_bf16 v[92:95], v[44:47], a[4:7], v[92:95]
  buffer_load_dwordx4 v1, s[24:27], s32 offen offset:0 lds
  v_mfma_f32_16x16x32_bf16 v[100:103], v[44:47], a[20:23], v[100:103]
  v_mfma_f32_16x16x32_bf16 v[108:111], v[44:47], a[36:39], v[108:111]
  s_waitcnt lgkmcnt(0)
  v_mfma_f32_16x16x32_bf16 v[88:91], v[48:51], a[8:11], v[88:91]
  s_barrier
  ds_read_b128 v[32:35], v8 offset:32768
  ds_read_b128 v[36:39], v8 offset:36864
  v_mfma_f32_16x16x32_bf16 v[96:99], v[48:51], a[24:27], v[96:99]
  ds_read_b128 v[40:43], v9 offset:32768
  ds_read_b128 v[44:47], v9 offset:36864
  v_mfma_f32_16x16x32_bf16 v[104:107], v[48:51], a[40:43], v[104:107]
  ds_read_b128 v[48:51], v10 offset:32768
  v_mfma_f32_16x16x32_bf16 v[92:95], v[52:55], a[8:11], v[92:95]
  v_mfma_f32_16x16x32_bf16 v[100:103], v[52:55], a[24:27], v[100:103]
  v_mfma_f32_16x16x32_bf16 v[108:111], v[52:55], a[40:43], v[108:111]
  ds_read_b128 v[52:55], v10 offset:36864
  v_mfma_f32_16x16x32_bf16 v[88:91], v[56:59], a[12:15], v[88:91]
  v_mfma_f32_16x16x32_bf16 v[96:99], v[56:59], a[28:31], v[96:99]
  v_mfma_f32_16x16x32_bf16 v[104:107], v[56:59], a[44:47], v[104:107]
  ds_read_b128 v[56:59], v11 offset:32768
  v_mfma_f32_16x16x32_bf16 v[92:95], v[60:63], a[12:15], v[92:95]
  v_mfma_f32_16x16x32_bf16 v[100:103], v[60:63], a[28:31], v[100:103]
  v_mfma_f32_16x16x32_bf16 v[108:111], v[60:63], a[44:47], v[108:111]
  ds_read_b128 v[60:63], v11 offset:36864
  s_waitcnt lgkmcnt(6)
  v_mfma_f32_16x16x32_bf16 v[112:115], v[32:35], a[0:3], 0
  v_mfma_f32_16x16x32_bf16 v[120:123], v[32:35], a[16:19], 0
  v_mfma_f32_16x16x32_bf16 v[128:131], v[32:35], a[32:35], 0
  v_mfma_f32_16x16x32_bf16 v[116:119], v[36:39], a[0:3], 0
  buffer_load_dwordx4 v2, s[24:27], s32 offen offset:1024 lds
  v_mfma_f32_16x16x32_bf16 v[124:127], v[36:39], a[16:19], 0
  v_mfma_f32_16x16x32_bf16 v[132:135], v[36:39], a[32:35], 0
  s_waitcnt lgkmcnt(4)
  v_mfma_f32_16x16x32_bf16 v[112:115], v[40:43], a[4:7], v[112:115]
  v_mfma_f32_16x16x32_bf16 v[120:123], v[40:43], a[20:23], v[120:123]
  v_mfma_f32_16x16x32_bf16 v[128:131], v[40:43], a[36:39], v[128:131]
  v_mfma_f32_16x16x32_bf16 v[116:119], v[44:47], a[4:7], v[116:119]
  v_mfma_f32_16x16x32_bf16 v[124:127], v[44:47], a[20:23], v[124:127]
  v_mfma_f32_16x16x32_bf16 v[132:135], v[44:47], a[36:39], v[132:135]
  s_waitcnt lgkmcnt(0)
  v_mfma_f32_16x16x32_bf16 v[112:115], v[48:51], a[8:11], v[112:115]
  s_barrier
  ds_read_b128 v[32:35], v8 offset:49152
  ds_read_b128 v[36:39], v8 offset:53248
  v_mfma_f32_16x16x32_bf16 v[120:123], v[48:51], a[24:27], v[120:123]
  ds_read_b128 v[40:43], v9 offset:49152
  ds_read_b128 v[44:47], v9 offset:53248
  v_mfma_f32_16x16x32_bf16 v[128:131], v[48:51], a[40:43], v[128:131]
  ds_read_b128 v[48:51], v10 offset:49152
  v_mfma_f32_16x16x32_bf16 v[116:119], v[52:55], a[8:11], v[116:119]
  v_mfma_f32_16x16x32_bf16 v[124:127], v[52:55], a[24:27], v[124:127]
  v_mfma_f32_16x16x32_bf16 v[132:135], v[52:55], a[40:43], v[132:135]
  ds_read_b128 v[52:55], v10 offset:53248
  v_mfma_f32_16x16x32_bf16 v[112:115], v[56:59], a[12:15], v[112:115]
  v_mfma_f32_16x16x32_bf16 v[120:123], v[56:59], a[28:31], v[120:123]
  v_mfma_f32_16x16x32_bf16 v[128:131], v[56:59], a[44:47], v[128:131]
  ds_read_b128 v[56:59], v11 offset:49152
  v_mfma_f32_16x16x32_bf16 v[116:119], v[60:63], a[12:15], v[116:119]
  v_mfma_f32_16x16x32_bf16 v[124:127], v[60:63], a[28:31], v[124:127]
  v_mfma_f32_16x16x32_bf16 v[132:135], v[60:63], a[44:47], v[132:135]
  ds_read_b128 v[60:63], v11 offset:53248
  s_waitcnt lgkmcnt(6)
  v_mfma_f32_16x16x32_bf16 v[136:139], v[32:35], a[0:3], 0
  buffer_load_dwordx4 v3, s[24:27], s32 offen offset:2048 lds
  v_mfma_f32_16x16x32_bf16 v[144:147], v[32:35], a[16:19], 0
  v_mfma_f32_16x16x32_bf16 v[152:155], v[32:35], a[32:35], 0
  v_mfma_f32_16x16x32_bf16 v[140:143], v[36:39], a[0:3], 0
  v_mfma_f32_16x16x32_bf16 v[148:151], v[36:39], a[16:19], 0
  v_mfma_f32_16x16x32_bf16 v[156:159], v[36:39], a[32:35], 0
  s_waitcnt lgkmcnt(4)
  v_mfma_f32_16x16x32_bf16 v[136:139], v[40:43], a[4:7], v[136:139]
  v_mfma_f32_16x16x32_bf16 v[144:147], v[40:43], a[20:23], v[144:147]
  v_mfma_f32_16x16x32_bf16 v[152:155], v[40:43], a[36:39], v[152:155]
  v_mfma_f32_16x16x32_bf16 v[140:143], v[44:47], a[4:7], v[140:143]
  v_mfma_f32_16x16x32_bf16 v[148:151], v[44:47], a[20:23], v[148:151]
  v_mfma_f32_16x16x32_bf16 v[156:159], v[44:47], a[36:39], v[156:159]
  s_waitcnt lgkmcnt(0)
  v_mfma_f32_16x16x32_bf16 v[136:139], v[48:51], a[8:11], v[136:139]
  s_barrier
  v_add_u32 v8, 0x10000, v8
  ds_read_b128 v[32:35], v8 offset:0
  ds_read_b128 v[36:39], v8 offset:4096
  v_mfma_f32_16x16x32_bf16 v[144:147], v[48:51], a[24:27], v[144:147]
  v_add_u32 v9, 0x10000, v9
  ds_read_b128 v[40:43], v9 offset:0
  ds_read_b128 v[44:47], v9 offset:4096
  v_mfma_f32_16x16x32_bf16 v[152:155], v[48:51], a[40:43], v[152:155]
  v_add_u32 v10, 0x10000, v10
  ds_read_b128 v[48:51], v10 offset:0
  buffer_load_dwordx4 v4, s[24:27], s32 offen offset:3072 lds
  v_mfma_f32_16x16x32_bf16 v[140:143], v[52:55], a[8:11], v[140:143]
  s_add_u32 m0, s34, 0x19000
  s_add_u32 s32, s61, 0x8000
  v_mfma_f32_16x16x32_bf16 v[148:151], v[52:55], a[24:27], v[148:151]
  buffer_load_dwordx4 v1, s[24:27], s32 offen offset:0 lds
  v_mfma_f32_16x16x32_bf16 v[156:159], v[52:55], a[40:43], v[156:159]
  ds_read_b128 v[52:55], v10 offset:4096
  v_mfma_f32_16x16x32_bf16 v[136:139], v[56:59], a[12:15], v[136:139]
  v_mfma_f32_16x16x32_bf16 v[144:147], v[56:59], a[28:31], v[144:147]
  v_mfma_f32_16x16x32_bf16 v[152:155], v[56:59], a[44:47], v[152:155]
  v_add_u32 v11, 0x10000, v11
  ds_read_b128 v[56:59], v11 offset:0
  v_mfma_f32_16x16x32_bf16 v[140:143], v[60:63], a[12:15], v[140:143]
  v_mfma_f32_16x16x32_bf16 v[148:151], v[60:63], a[28:31], v[148:151]
  v_mfma_f32_16x16x32_bf16 v[156:159], v[60:63], a[44:47], v[156:159]
  ds_read_b128 v[60:63], v11 offset:4096
  s_waitcnt lgkmcnt(6)
  v_mfma_f32_16x16x32_bf16 v[160:163], v[32:35], a[0:3], 0
  v_mfma_f32_16x16x32_bf16 v[168:171], v[32:35], a[16:19], 0
  v_mfma_f32_16x16x32_bf16 v[176:179], v[32:35], a[32:35], 0
  v_mfma_f32_16x16x32_bf16 v[164:167], v[36:39], a[0:3], 0
  v_mfma_f32_16x16x32_bf16 v[172:175], v[36:39], a[16:19], 0
  v_mfma_f32_16x16x32_bf16 v[180:183], v[36:39], a[32:35], 0
  s_waitcnt lgkmcnt(4)
  v_mfma_f32_16x16x32_bf16 v[160:163], v[40:43], a[4:7], v[160:163]
  v_mfma_f32_16x16x32_bf16 v[168:171], v[40:43], a[20:23], v[168:171]
  v_mfma_f32_16x16x32_bf16 v[176:179], v[40:43], a[36:39], v[176:179]
  v_mfma_f32_16x16x32_bf16 v[164:167], v[44:47], a[4:7], v[164:167]
  buffer_load_dwordx4 v2, s[24:27], s32 offen offset:1024 lds
  v_mfma_f32_16x16x32_bf16 v[172:175], v[44:47], a[20:23], v[172:175]
  v_mfma_f32_16x16x32_bf16 v[180:183], v[44:47], a[36:39], v[180:183]
  s_waitcnt lgkmcnt(0)
  v_mfma_f32_16x16x32_bf16 v[160:163], v[48:51], a[8:11], v[160:163]
  s_barrier
  ds_read_b128 v[32:35], v8 offset:16384
  ds_read_b128 v[36:39], v8 offset:20480
  v_mfma_f32_16x16x32_bf16 v[168:171], v[48:51], a[24:27], v[168:171]
  ds_read_b128 v[40:43], v9 offset:16384
  ds_read_b128 v[44:47], v9 offset:20480
  v_mfma_f32_16x16x32_bf16 v[176:179], v[48:51], a[40:43], v[176:179]
  ds_read_b128 v[48:51], v10 offset:16384
  buffer_load_dwordx4 v3, s[24:27], s32 offen offset:2048 lds
  v_mfma_f32_16x16x32_bf16 v[164:167], v[52:55], a[8:11], v[164:167]
  buffer_load_dwordx4 v4, s[24:27], s32 offen offset:3072 lds
  v_mfma_f32_16x16x32_bf16 v[172:175], v[52:55], a[24:27], v[172:175]
  v_mfma_f32_16x16x32_bf16 v[180:183], v[52:55], a[40:43], v[180:183]
  ds_read_b128 v[52:55], v10 offset:20480
  v_mfma_f32_16x16x32_bf16 v[160:163], v[56:59], a[12:15], v[160:163]
  v_mfma_f32_16x16x32_bf16 v[168:171], v[56:59], a[28:31], v[168:171]
  v_mfma_f32_16x16x32_bf16 v[176:179], v[56:59], a[44:47], v[176:179]
  ds_read_b128 v[56:59], v11 offset:16384
  v_mfma_f32_16x16x32_bf16 v[164:167], v[60:63], a[12:15], v[164:167]
  v_mfma_f32_16x16x32_bf16 v[172:175], v[60:63], a[28:31], v[172:175]
  v_mfma_f32_16x16x32_bf16 v[180:183], v[60:63], a[44:47], v[180:183]
  ds_read_b128 v[60:63], v11 offset:20480
  s_waitcnt lgkmcnt(6)
  v_mfma_f32_16x16x32_bf16 v[184:187], v[32:35], a[0:3], 0
  v_mfma_f32_16x16x32_bf16 v[192:195], v[32:35], a[16:19], 0
  v_mfma_f32_16x16x32_bf16 v[200:203], v[32:35], a[32:35], 0
  v_mfma_f32_16x16x32_bf16 v[188:191], v[36:39], a[0:3], 0
  v_mfma_f32_16x16x32_bf16 v[196:199], v[36:39], a[16:19], 0
  v_mfma_f32_16x16x32_bf16 v[204:207], v[36:39], a[32:35], 0
  s_waitcnt lgkmcnt(4)
  v_mfma_f32_16x16x32_bf16 v[184:187], v[40:43], a[4:7], v[184:187]
  v_mfma_f32_16x16x32_bf16 v[192:195], v[40:43], a[20:23], v[192:195]
  v_mfma_f32_16x16x32_bf16 v[200:203], v[40:43], a[36:39], v[200:203]
  v_mfma_f32_16x16x32_bf16 v[188:191], v[44:47], a[4:7], v[188:191]
  v_mfma_f32_16x16x32_bf16 v[196:199], v[44:47], a[20:23], v[196:199]
  v_mfma_f32_16x16x32_bf16 v[204:207], v[44:47], a[36:39], v[204:207]
  s_waitcnt lgkmcnt(0)
  v_mfma_f32_16x16x32_bf16 v[184:187], v[48:51], a[8:11], v[184:187]
  s_barrier
  v_subrev_u32 v8, 0x10000, v8
  ds_read_b128 v[32:35], v8 offset:0
  ds_read_b128 v[36:39], v8 offset:4096
  v_mfma_f32_16x16x32_bf16 v[192:195], v[48:51], a[24:27], v[192:195]
  v_subrev_u32 v9, 0x10000, v9
  ds_read_b128 v[40:43], v9 offset:0
  ds_read_b128 v[44:47], v9 offset:4096
  v_mfma_f32_16x16x32_bf16 v[200:203], v[48:51], a[40:43], v[200:203]
  v_subrev_u32 v10, 0x10000, v10
  ds_read_b128 v[48:51], v10 offset:0
  s_add_u32 s61, s41, 1
  v_mfma_f32_16x16x32_bf16 v[188:191], v[52:55], a[8:11], v[188:191]
  s_and_b32 s61, s61, 7
  s_lshl_b32 s61, s61, 7
  v_mfma_f32_16x16x32_bf16 v[196:199], v[52:55], a[24:27], v[196:199]
  s_add_u32 s61, s61, s37
  s_add_u32 m0, s34, 0x1c000
  v_mfma_f32_16x16x32_bf16 v[204:207], v[52:55], a[40:43], v[204:207]
  ds_read_b128 v[52:55], v10 offset:4096
  s_add_u32 s32, s61, 0x0
  v_mfma_f32_16x16x32_bf16 v[184:187], v[56:59], a[12:15], v[184:187]
  buffer_load_dwordx4 v1, s[24:27], s32 offen offset:0 lds
  buffer_load_dwordx4 v2, s[24:27], s32 offen offset:1024 lds
  v_mfma_f32_16x16x32_bf16 v[192:195], v[56:59], a[28:31], v[192:195]
  buffer_load_dwordx4 v3, s[24:27], s32 offen offset:2048 lds
  buffer_load_dwordx4 v4, s[24:27], s32 offen offset:3072 lds
  v_mfma_f32_16x16x32_bf16 v[200:203], v[56:59], a[44:47], v[200:203]
  v_subrev_u32 v11, 0x10000, v11
  ds_read_b128 v[56:59], v11 offset:0
  v_mfma_f32_16x16x32_bf16 v[188:191], v[60:63], a[12:15], v[188:191]
  v_mfma_f32_16x16x32_bf16 v[196:199], v[60:63], a[28:31], v[196:199]
  v_mfma_f32_16x16x32_bf16 v[204:207], v[60:63], a[44:47], v[204:207]
  ds_read_b128 v[60:63], v11 offset:4096
  s_waitcnt lgkmcnt(6)
  v_mfma_f32_16x16x32_bf16 v[208:211], v[32:35], a[0:3], 0
  v_mfma_f32_16x16x32_bf16 v[216:219], v[32:35], a[16:19], 0
  v_mfma_f32_16x16x32_bf16 v[224:227], v[32:35], a[32:35], 0
  v_mfma_f32_16x16x32_bf16 v[212:215], v[36:39], a[0:3], 0
  v_mfma_f32_16x16x32_bf16 v[220:223], v[36:39], a[16:19], 0
  v_mfma_f32_16x16x32_bf16 v[228:231], v[36:39], a[32:35], 0
  s_waitcnt lgkmcnt(4)
  v_mfma_f32_16x16x32_bf16 v[208:211], v[40:43], a[4:7], v[208:211]
  v_mfma_f32_16x16x32_bf16 v[216:219], v[40:43], a[20:23], v[216:219]
  v_mfma_f32_16x16x32_bf16 v[224:227], v[40:43], a[36:39], v[224:227]
  v_mfma_f32_16x16x32_bf16 v[212:215], v[44:47], a[4:7], v[212:215]
  v_mfma_f32_16x16x32_bf16 v[220:223], v[44:47], a[20:23], v[220:223]
  v_mfma_f32_16x16x32_bf16 v[228:231], v[44:47], a[36:39], v[228:231]
  s_add_u32 m0, s34, 0x1d000
  s_add_u32 s32, s61, 0x8000
  s_waitcnt lgkmcnt(0)
  v_mfma_f32_16x16x32_bf16 v[208:211], v[48:51], a[8:11], v[208:211]
  s_barrier
  ds_read_b128 v[32:35], v8 offset:16384
  ds_read_b128 v[36:39], v8 offset:20480
  v_mfma_f32_16x16x32_bf16 v[216:219], v[48:51], a[24:27], v[216:219]
  ds_read_b128 v[40:43], v9 offset:16384
  ds_read_b128 v[44:47], v9 offset:20480
  v_mfma_f32_16x16x32_bf16 v[224:227], v[48:51], a[40:43], v[224:227]
  ds_read_b128 v[48:51], v10 offset:16384
  buffer_load_dwordx4 v1, s[24:27], s32 offen offset:0 lds
  v_mfma_f32_16x16x32_bf16 v[212:215], v[52:55], a[8:11], v[212:215]
  buffer_load_dwordx4 v2, s[24:27], s32 offen offset:1024 lds
  buffer_load_dwordx4 v3, s[24:27], s32 offen offset:2048 lds
  v_mfma_f32_16x16x32_bf16 v[220:223], v[52:55], a[24:27], v[220:223]
  v_mfma_f32_16x16x32_bf16 v[228:231], v[52:55], a[40:43], v[228:231]
  ds_read_b128 v[52:55], v10 offset:20480
  v_mfma_f32_16x16x32_bf16 v[208:211], v[56:59], a[12:15], v[208:211]
  v_mfma_f32_16x16x32_bf16 v[216:219], v[56:59], a[28:31], v[216:219]
  v_mfma_f32_16x16x32_bf16 v[224:227], v[56:59], a[44:47], v[224:227]
  ds_read_b128 v[56:59], v11 offset:16384
  v_mfma_f32_16x16x32_bf16 v[212:215], v[60:63], a[12:15], v[212:215]
  v_mfma_f32_16x16x32_bf16 v[220:223], v[60:63], a[28:31], v[220:223]
  v_mfma_f32_16x16x32_bf16 v[228:231], v[60:63], a[44:47], v[228:231]
  ds_read_b128 v[60:63], v11 offset:20480
  s_waitcnt lgkmcnt(6)
  v_mfma_f32_16x16x32_bf16 v[232:235], v[32:35], a[0:3], 0
  v_mfma_f32_16x16x32_bf16 v[240:243], v[32:35], a[16:19], 0
  buffer_load_dwordx4 v4, s[24:27], s32 offen offset:3072 lds
  v_mfma_f32_16x16x32_bf16 v[248:251], v[32:35], a[32:35], 0
  v_mfma_f32_16x16x32_bf16 v[236:239], v[36:39], a[0:3], 0
  v_mfma_f32_16x16x32_bf16 v[244:247], v[36:39], a[16:19], 0
  v_mfma_f32_16x16x32_bf16 v[252:255], v[36:39], a[32:35], 0
  s_waitcnt lgkmcnt(4)
  v_mfma_f32_16x16x32_bf16 v[232:235], v[40:43], a[4:7], v[232:235]
  v_mfma_f32_16x16x32_bf16 v[240:243], v[40:43], a[20:23], v[240:243]
  v_mfma_f32_16x16x32_bf16 v[248:251], v[40:43], a[36:39], v[248:251]
  v_mfma_f32_16x16x32_bf16 v[236:239], v[44:47], a[4:7], v[236:239]
  v_mfma_f32_16x16x32_bf16 v[244:247], v[44:47], a[20:23], v[244:247]
  v_mfma_f32_16x16x32_bf16 v[252:255], v[44:47], a[36:39], v[252:255]
  s_waitcnt lgkmcnt(0)
  v_mfma_f32_16x16x32_bf16 v[232:235], v[48:51], a[8:11], v[232:235]
  s_barrier
  v_mfma_f32_16x16x32_bf16 v[240:243], v[48:51], a[24:27], v[240:243]
  v_mfma_f32_16x16x32_bf16 v[248:251], v[48:51], a[40:43], v[248:251]
  v_mfma_f32_16x16x32_bf16 v[236:239], v[52:55], a[8:11], v[236:239]
  v_mfma_f32_16x16x32_bf16 v[244:247], v[52:55], a[24:27], v[244:247]
  v_mfma_f32_16x16x32_bf16 v[252:255], v[52:55], a[40:43], v[252:255]
  v_mfma_f32_16x16x32_bf16 v[232:235], v[56:59], a[12:15], v[232:235]
  v_mfma_f32_16x16x32_bf16 v[240:243], v[56:59], a[28:31], v[240:243]
  v_mfma_f32_16x16x32_bf16 v[248:251], v[56:59], a[44:47], v[248:251]
  v_mfma_f32_16x16x32_bf16 v[236:239], v[60:63], a[12:15], v[236:239]
  v_mfma_f32_16x16x32_bf16 v[244:247], v[60:63], a[28:31], v[244:247]
  v_mfma_f32_16x16x32_bf16 v[252:255], v[60:63], a[44:47], v[252:255]
  v_max3_f32 v22, v64, v65, v66
  v_max3_f32 v22, v22, v67, v68
  v_max3_f32 v22, v22, v69, v70
  v_max_f32 v22, v22, v71
  v_max3_f32 v23, v72, v73, v74
  v_max3_f32 v23, v23, v75, v76
  v_max3_f32 v23, v23, v77, v78
  v_max_f32 v23, v23, v79
  v_max3_f32 v24, v80, v81, v82
  v_max3_f32 v24, v24, v83, v84
  v_max3_f32 v24, v24, v85, v86
  v_max_f32 v24, v24, v87
  v_max3_f32 v22, v22, v88, v89
  v_max3_f32 v22, v22, v90, v91
  v_max3_f32 v22, v22, v92, v93
  v_max3_f32 v22, v22, v94, v95
  v_max3_f32 v23, v23, v96, v97
  v_max3_f32 v23, v23, v98, v99
  v_max3_f32 v23, v23, v100, v101
  v_max3_f32 v23, v23, v102, v103
  v_max3_f32 v24, v24, v104, v105
  v_max3_f32 v24, v24, v106, v107
  v_max3_f32 v24, v24, v108, v109
  v_max3_f32 v24, v24, v110, v111
  v_max3_f32 v22, v22, v112, v113
  v_max3_f32 v22, v22, v114, v115
  v_max3_f32 v22, v22, v116, v117
  v_max3_f32 v22, v22, v118, v119
  v_max3_f32 v23, v23, v120, v121
  v_max3_f32 v23, v23, v122, v123
  v_max3_f32 v23, v23, v124, v125
  v_max3_f32 v23, v23, v126, v127
  v_max3_f32 v24, v24, v128, v129
  v_max3_f32 v24, v24, v130, v131
  v_max3_f32 v24, v24, v132, v133
  v_max3_f32 v24, v24, v134, v135
  v_max3_f32 v22, v22, v136, v137
  v_max3_f32 v22, v22, v138, v139
  v_max3_f32 v22, v22, v140, v141
  v_max3_f32 v22, v22, v142, v143
  v_max3_f32 v23, v23, v144, v145
  v_max3_f32 v23, v23, v146, v147
  v_max3_f32 v23, v23, v148, v149
  v_max3_f32 v23, v23, v150, v151
  v_max3_f32 v24, v24, v152, v153
  v_max3_f32 v24, v24, v154, v155
  v_max3_f32 v24, v24, v156, v157
  v_max3_f32 v24, v24, v158, v159
  v_max3_f32 v22, v22, v160, v161
  v_max3_f32 v22, v22, v162, v163
  v_max3_f32 v22, v22, v164, v165
  v_max3_f32 v22, v22, v166, v167
  v_max3_f32 v23, v23, v168, v169
  v_max3_f32 v23, v23, v170, v171
  v_max3_f32 v23, v23, v172, v173
  v_max3_f32 v23, v23, v174, v175
  v_max3_f32 v24, v24, v176, v177
  v_max3_f32 v24, v24, v178, v179
  v_max3_f32 v24, v24, v180, v181
  v_max3_f32 v24, v24, v182, v183
  v_max3_f32 v22, v22, v184, v185
  v_max3_f32 v22, v22, v186, v187
  v_max3_f32 v22, v22, v188, v189
  v_max3_f32 v22, v22, v190, v191
  v_max3_f32 v23, v23, v192, v193
  v_max3_f32 v23, v23, v194, v195
  v_max3_f32 v23, v23, v196, v197
  v_max3_f32 v23, v23, v198, v199
  v_max3_f32 v24, v24, v200, v201
  v_max3_f32 v24, v24, v202, v203
  v_max3_f32 v24, v24, v204, v205
  v_max3_f32 v24, v24, v206, v207
  v_max3_f32 v22, v22, v208, v209
  v_max3_f32 v22, v22, v210, v211
  v_max3_f32 v22, v22, v212, v213
  v_max3_f32 v22, v22, v214, v215
  v_max3_f32 v23, v23, v216, v217
  v_max3_f32 v23, v23, v218, v219
  v_max3_f32 v23, v23, v220, v221
  v_max3_f32 v23, v23, v222, v223
  v_max3_f32 v24, v24, v224, v225
  v_max3_f32 v24, v24, v226, v227
  v_max3_f32 v24, v24, v228, v229
  v_max3_f32 v24, v24, v230, v231
  v_max3_f32 v22, v22, v232, v233
  v_max3_f32 v22, v22, v234, v235
  v_max3_f32 v22, v22, v236, v237
  v_max3_f32 v22, v22, v238, v239
  v_max3_f32 v23, v23, v240, v241
  v_max3_f32 v23, v23, v242, v243
  s_add_u32 s61, s41, 2
  v_max3_f32 v23, v23, v244, v245
  v_max3_f32 v23, v23, v246, v247
  v_max3_f32 v24, v24, v248, v249
  v_max3_f32 v24, v24, v250, v251
  v_max3_f32 v24, v24, v252, v253
  v_max3_f32 v24, v24, v254, v255
  s_and_b32 s61, s61, 7
  v_mov_b32 v25, v22
  v_mov_b32 v26, v23
  v_mov_b32 v27, v24
  v_permlane32_swap_b32 v22, v25
  v_permlane32_swap_b32 v23, v26
  v_permlane32_swap_b32 v24, v27
  s_lshl_b32 s61, s61, 7
  v_max_f32 v22, v22, v25
  v_max_f32 v23, v23, v26
  v_max_f32 v24, v24, v27
  v_mov_b32 v25, v22
  v_mov_b32 v26, v23
  v_mov_b32 v27, v24
  s_add_u32 s61, s61, s37
  v_permlane16_swap_b32 v22, v25
  v_permlane16_swap_b32 v23, v26
  v_permlane16_swap_b32 v24, v27
  v_max_f32 v22, v22, v25
  v_max_f32 v23, v23, v26
  v_max_f32 v24, v24, v27
  s_add_u32 m0, s34, 0x20000
  v_mul_f32 v22, 0xbe0293ee, v22
  v_mul_f32 v23, 0xbe0293ee, v23
  v_mul_f32 v24, 0xbe0293ee, v24
  v_fmamk_f32 v64, v64, 0x3e0293ee, v22
  v_fmamk_f32 v65, v65, 0x3e0293ee, v22
  v_fmamk_f32 v66, v66, 0x3e0293ee, v22
  v_fmamk_f32 v67, v67, 0x3e0293ee, v22
  v_fmamk_f32 v68, v68, 0x3e0293ee, v22
  s_add_u32 s32, s61, 0x0
  buffer_load_dwordx4 v1, s[24:27], s32 offen offset:0 lds
  v_fmamk_f32 v69, v69, 0x3e0293ee, v22
  v_fmamk_f32 v70, v70, 0x3e0293ee, v22
  v_fmamk_f32 v71, v71, 0x3e0293ee, v22
  v_exp_f32 v64, v64
  v_exp_f32 v65, v65
  v_exp_f32 v66, v66
  v_exp_f32 v67, v67
  v_exp_f32 v68, v68
  v_exp_f32 v69, v69
  v_exp_f32 v70, v70
  v_exp_f32 v71, v71
  v_cvt_pk_bf16_f32 v64, v64, v65
  v_cvt_pk_bf16_f32 v65, v66, v67
  v_cvt_pk_bf16_f32 v66, v68, v69
  v_cvt_pk_bf16_f32 v67, v70, v71
  v_fmamk_f32 v72, v72, 0x3e0293ee, v23
  v_fmamk_f32 v73, v73, 0x3e0293ee, v23
  v_fmamk_f32 v74, v74, 0x3e0293ee, v23
  v_fmamk_f32 v75, v75, 0x3e0293ee, v23
  v_fmamk_f32 v76, v76, 0x3e0293ee, v23
  v_fmamk_f32 v77, v77, 0x3e0293ee, v23
  v_fmamk_f32 v78, v78, 0x3e0293ee, v23
  v_fmamk_f32 v79, v79, 0x3e0293ee, v23
  v_exp_f32 v72, v72
  v_exp_f32 v73, v73
  v_exp_f32 v74, v74
  v_exp_f32 v75, v75
  v_exp_f32 v76, v76
  v_exp_f32 v77, v77
  v_exp_f32 v78, v78
  v_exp_f32 v79, v79
  v_cvt_pk_bf16_f32 v68, v72, v73
  v_cvt_pk_bf16_f32 v69, v74, v75
  v_cvt_pk_bf16_f32 v70, v76, v77
  v_cvt_pk_bf16_f32 v71, v78, v79
  buffer_load_dwordx4 v2, s[24:27], s32 offen offset:1024 lds
  v_fmamk_f32 v80, v80, 0x3e0293ee, v24
  v_fmamk_f32 v81, v81, 0x3e0293ee, v24
  v_fmamk_f32 v82, v82, 0x3e0293ee, v24
  v_fmamk_f32 v83, v83, 0x3e0293ee, v24
  v_fmamk_f32 v84, v84, 0x3e0293ee, v24
  v_fmamk_f32 v85, v85, 0x3e0293ee, v24
  v_fmamk_f32 v86, v86, 0x3e0293ee, v24
  v_fmamk_f32 v87, v87, 0x3e0293ee, v24
  v_exp_f32 v80, v80
  v_exp_f32 v81, v81
  v_exp_f32 v82, v82
  v_exp_f32 v83, v83
  v_exp_f32 v84, v84
  v_exp_f32 v85, v85
  v_exp_f32 v86, v86
  v_exp_f32 v87, v87
  v_cvt_pk_bf16_f32 v72, v80, v81
  v_cvt_pk_bf16_f32 v73, v82, v83
  v_cvt_pk_bf16_f32 v74, v84, v85
  v_cvt_pk_bf16_f32 v75, v86, v87
  v_fmamk_f32 v88, v88, 0x3e0293ee, v22
  v_fmamk_f32 v89, v89, 0x3e0293ee, v22
  v_fmamk_f32 v90, v90, 0x3e0293ee, v22
  v_fmamk_f32 v91, v91, 0x3e0293ee, v22
  v_fmamk_f32 v92, v92, 0x3e0293ee, v22
  v_fmamk_f32 v93, v93, 0x3e0293ee, v22
  v_fmamk_f32 v94, v94, 0x3e0293ee, v22
  v_fmamk_f32 v95, v95, 0x3e0293ee, v22
  v_exp_f32 v88, v88
  v_exp_f32 v89, v89
  v_exp_f32 v90, v90
  v_exp_f32 v91, v91
  v_exp_f32 v92, v92
  v_exp_f32 v93, v93
  v_exp_f32 v94, v94
  v_exp_f32 v95, v95
  v_cvt_pk_bf16_f32 v76, v88, v89
  v_cvt_pk_bf16_f32 v77, v90, v91
  v_cvt_pk_bf16_f32 v78, v92, v93
  v_cvt_pk_bf16_f32 v79, v94, v95
  v_fmamk_f32 v96, v96, 0x3e0293ee, v23
  v_fmamk_f32 v97, v97, 0x3e0293ee, v23
  v_fmamk_f32 v98, v98, 0x3e0293ee, v23
  v_fmamk_f32 v99, v99, 0x3e0293ee, v23
  v_fmamk_f32 v100, v100, 0x3e0293ee, v23
  v_fmamk_f32 v101, v101, 0x3e0293ee, v23
  v_fmamk_f32 v102, v102, 0x3e0293ee, v23
  v_fmamk_f32 v103, v103, 0x3e0293ee, v23
  v_exp_f32 v96, v96
  v_exp_f32 v97, v97
  v_exp_f32 v98, v98
  v_exp_f32 v99, v99
  v_exp_f32 v100, v100
  v_exp_f32 v101, v101
  v_exp_f32 v102, v102
  v_exp_f32 v103, v103
  v_cvt_pk_bf16_f32 v80, v96, v97
  v_cvt_pk_bf16_f32 v81, v98, v99
  v_cvt_pk_bf16_f32 v82, v100, v101
  v_cvt_pk_bf16_f32 v83, v102, v103
  buffer_load_dwordx4 v3, s[24:27], s32 offen offset:2048 lds
  v_fmamk_f32 v104, v104, 0x3e0293ee, v24
  v_fmamk_f32 v105, v105, 0x3e0293ee, v24
  v_fmamk_f32 v106, v106, 0x3e0293ee, v24
  v_fmamk_f32 v107, v107, 0x3e0293ee, v24
  v_fmamk_f32 v108, v108, 0x3e0293ee, v24
  v_fmamk_f32 v109, v109, 0x3e0293ee, v24
  v_fmamk_f32 v110, v110, 0x3e0293ee, v24
  v_fmamk_f32 v111, v111, 0x3e0293ee, v24
  v_exp_f32 v104, v104
  v_exp_f32 v105, v105
  v_exp_f32 v106, v106
  v_exp_f32 v107, v107
  v_exp_f32 v108, v108
  v_exp_f32 v109, v109
  v_exp_f32 v110, v110
  v_exp_f32 v111, v111
  v_cvt_pk_bf16_f32 v84, v104, v105
  v_cvt_pk_bf16_f32 v85, v106, v107
  v_cvt_pk_bf16_f32 v86, v108, v109
  v_cvt_pk_bf16_f32 v87, v110, v111
  v_fmamk_f32 v112, v112, 0x3e0293ee, v22
  v_fmamk_f32 v113, v113, 0x3e0293ee, v22
  v_fmamk_f32 v114, v114, 0x3e0293ee, v22
  v_fmamk_f32 v115, v115, 0x3e0293ee, v22
  v_fmamk_f32 v116, v116, 0x3e0293ee, v22
  v_fmamk_f32 v117, v117, 0x3e0293ee, v22
  v_fmamk_f32 v118, v118, 0x3e0293ee, v22
  v_fmamk_f32 v119, v119, 0x3e0293ee, v22
  v_exp_f32 v112, v112
  v_exp_f32 v113, v113
  v_exp_f32 v114, v114
  v_exp_f32 v115, v115
  v_exp_f32 v116, v116
  v_exp_f32 v117, v117
  v_exp_f32 v118, v118
  v_exp_f32 v119, v119
  v_cvt_pk_bf16_f32 v88, v112, v113
  v_cvt_pk_bf16_f32 v89, v114, v115
  v_cvt_pk_bf16_f32 v90, v116, v117
  v_cvt_pk_bf16_f32 v91, v118, v119
  v_fmamk_f32 v120, v120, 0x3e0293ee, v23
  v_fmamk_f32 v121, v121, 0x3e0293ee, v23
  v_fmamk_f32 v122, v122, 0x3e0293ee, v23
  v_fmamk_f32 v123, v123, 0x3e0293ee, v23
  v_fmamk_f32 v124, v124, 0x3e0293ee, v23
  v_fmamk_f32 v125, v125, 0x3e0293ee, v23
  v_fmamk_f32 v126, v126, 0x3e0293ee, v23
  v_fmamk_f32 v127, v127, 0x3e0293ee, v23
  v_exp_f32 v120, v120
  v_exp_f32 v121, v121
  v_exp_f32 v122, v122
  v_exp_f32 v123, v123
  v_exp_f32 v124, v124
  v_exp_f32 v125, v125
  v_exp_f32 v126, v126
  v_exp_f32 v127, v127
  v_cvt_pk_bf16_f32 v92, v120, v121
  v_cvt_pk_bf16_f32 v93, v122, v123
  v_cvt_pk_bf16_f32 v94, v124, v125
  v_cvt_pk_bf16_f32 v95, v126, v127
  buffer_load_dwordx4 v4, s[24:27], s32 offen offset:3072 lds
  v_fmamk_f32 v128, v128, 0x3e0293ee, v24
  v_fmamk_f32 v129, v129, 0x3e0293ee, v24
  v_fmamk_f32 v130, v130, 0x3e0293ee, v24
  v_fmamk_f32 v131, v131, 0x3e0293ee, v24
  v_fmamk_f32 v132, v132, 0x3e0293ee, v24
  v_fmamk_f32 v133, v133, 0x3e0293ee, v24
  v_fmamk_f32 v134, v134, 0x3e0293ee, v24
  v_fmamk_f32 v135, v135, 0x3e0293ee, v24
  v_exp_f32 v128, v128
  v_exp_f32 v129, v129
  v_exp_f32 v130, v130
  v_exp_f32 v131, v131
  v_exp_f32 v132, v132
  v_exp_f32 v133, v133
  v_exp_f32 v134, v134
  v_exp_f32 v135, v135
  v_cvt_pk_bf16_f32 v96, v128, v129
  v_cvt_pk_bf16_f32 v97, v130, v131
  v_cvt_pk_bf16_f32 v98, v132, v133
  v_cvt_pk_bf16_f32 v99, v134, v135
  v_fmamk_f32 v136, v136, 0x3e0293ee, v22
  v_fmamk_f32 v137, v137, 0x3e0293ee, v22
  v_fmamk_f32 v138, v138, 0x3e0293ee, v22
  v_fmamk_f32 v139, v139, 0x3e0293ee, v22
  v_fmamk_f32 v140, v140, 0x3e0293ee, v22
  v_fmamk_f32 v141, v141, 0x3e0293ee, v22
  v_fmamk_f32 v142, v142, 0x3e0293ee, v22
  v_fmamk_f32 v143, v143, 0x3e0293ee, v22
  v_exp_f32 v136, v136
  v_exp_f32 v137, v137
  v_exp_f32 v138, v138
  v_exp_f32 v139, v139
  v_exp_f32 v140, v140
  v_exp_f32 v141, v141
  v_exp_f32 v142, v142
  v_exp_f32 v143, v143
  v_cvt_pk_bf16_f32 v100, v136, v137
  v_cvt_pk_bf16_f32 v101, v138, v139
  v_cvt_pk_bf16_f32 v102, v140, v141
  v_cvt_pk_bf16_f32 v103, v142, v143
  v_fmamk_f32 v144, v144, 0x3e0293ee, v23
  v_fmamk_f32 v145, v145, 0x3e0293ee, v23
  v_fmamk_f32 v146, v146, 0x3e0293ee, v23
  v_fmamk_f32 v147, v147, 0x3e0293ee, v23
  v_fmamk_f32 v148, v148, 0x3e0293ee, v23
  v_fmamk_f32 v149, v149, 0x3e0293ee, v23
  v_fmamk_f32 v150, v150, 0x3e0293ee, v23
  v_fmamk_f32 v151, v151, 0x3e0293ee, v23
  v_exp_f32 v144, v144
  v_exp_f32 v145, v145
  v_exp_f32 v146, v146
  v_exp_f32 v147, v147
  v_exp_f32 v148, v148
  v_exp_f32 v149, v149
  v_exp_f32 v150, v150
  v_exp_f32 v151, v151
  v_cvt_pk_bf16_f32 v104, v144, v145
  v_cvt_pk_bf16_f32 v105, v146, v147
  v_cvt_pk_bf16_f32 v106, v148, v149
  v_cvt_pk_bf16_f32 v107, v150, v151
  s_add_u32 m0, s34, 0x21000
  s_add_u32 s32, s61, 0x8000
  v_fmamk_f32 v152, v152, 0x3e0293ee, v24
  v_fmamk_f32 v153, v153, 0x3e0293ee, v24
  v_fmamk_f32 v154, v154, 0x3e0293ee, v24
  v_fmamk_f32 v155, v155, 0x3e0293ee, v24
  v_fmamk_f32 v156, v156, 0x3e0293ee, v24
  buffer_load_dwordx4 v1, s[24:27], s32 offen offset:0 lds
  v_fmamk_f32 v157, v157, 0x3e0293ee, v24
  v_fmamk_f32 v158, v158, 0x3e0293ee, v24
  v_fmamk_f32 v159, v159, 0x3e0293ee, v24
  v_exp_f32 v152, v152
  v_exp_f32 v153, v153
  v_exp_f32 v154, v154
  v_exp_f32 v155, v155
  v_exp_f32 v156, v156
  v_exp_f32 v157, v157
  v_exp_f32 v158, v158
  v_exp_f32 v159, v159
  v_cvt_pk_bf16_f32 v108, v152, v153
  v_cvt_pk_bf16_f32 v109, v154, v155
  v_cvt_pk_bf16_f32 v110, v156, v157
  v_cvt_pk_bf16_f32 v111, v158, v159
  v_fmamk_f32 v160, v160, 0x3e0293ee, v22
  v_fmamk_f32 v161, v161, 0x3e0293ee, v22
  v_fmamk_f32 v162, v162, 0x3e0293ee, v22
  v_fmamk_f32 v163, v163, 0x3e0293ee, v22
  v_fmamk_f32 v164, v164, 0x3e0293ee, v22
  v_fmamk_f32 v165, v165, 0x3e0293ee, v22
  v_fmamk_f32 v166, v166, 0x3e0293ee, v22
  v_fmamk_f32 v167, v167, 0x3e0293ee, v22
  v_exp_f32 v160, v160
  v_exp_f32 v161, v161
  v_exp_f32 v162, v162
  v_exp_f32 v163, v163
  v_exp_f32 v164, v164
  v_exp_f32 v165, v165
  v_exp_f32 v166, v166
  v_exp_f32 v167, v167
  v_cvt_pk_bf16_f32 v112, v160, v161
  v_cvt_pk_bf16_f32 v113, v162, v163
  v_cvt_pk_bf16_f32 v114, v164, v165
  v_cvt_pk_bf16_f32 v115, v166, v167
  v_fmamk_f32 v168, v168, 0x3e0293ee, v23
  v_fmamk_f32 v169, v169, 0x3e0293ee, v23
  v_fmamk_f32 v170, v170, 0x3e0293ee, v23
  v_fmamk_f32 v171, v171, 0x3e0293ee, v23
  v_fmamk_f32 v172, v172, 0x3e0293ee, v23
  v_fmamk_f32 v173, v173, 0x3e0293ee, v23
  v_fmamk_f32 v174, v174, 0x3e0293ee, v23
  v_fmamk_f32 v175, v175, 0x3e0293ee, v23
  v_exp_f32 v168, v168
  v_exp_f32 v169, v169
  v_exp_f32 v170, v170
  v_exp_f32 v171, v171
  v_exp_f32 v172, v172
  v_exp_f32 v173, v173
  v_exp_f32 v174, v174
  v_exp_f32 v175, v175
  v_cvt_pk_bf16_f32 v116, v168, v169
  v_cvt_pk_bf16_f32 v117, v170, v171
  v_cvt_pk_bf16_f32 v118, v172, v173
  v_cvt_pk_bf16_f32 v119, v174, v175
  buffer_load_dwordx4 v2, s[24:27], s32 offen offset:1024 lds
  v_fmamk_f32 v176, v176, 0x3e0293ee, v24
  v_fmamk_f32 v177, v177, 0x3e0293ee, v24
  v_fmamk_f32 v178, v178, 0x3e0293ee, v24
  v_fmamk_f32 v179, v179, 0x3e0293ee, v24
  v_fmamk_f32 v180, v180, 0x3e0293ee, v24
  v_fmamk_f32 v181, v181, 0x3e0293ee, v24
  v_fmamk_f32 v182, v182, 0x3e0293ee, v24
  v_fmamk_f32 v183, v183, 0x3e0293ee, v24
  v_exp_f32 v176, v176
  v_exp_f32 v177, v177
  v_exp_f32 v178, v178
  v_exp_f32 v179, v179
  v_exp_f32 v180, v180
  v_exp_f32 v181, v181
  v_exp_f32 v182, v182
  v_exp_f32 v183, v183
  v_cvt_pk_bf16_f32 v120, v176, v177
  v_cvt_pk_bf16_f32 v121, v178, v179
  v_cvt_pk_bf16_f32 v122, v180, v181
  v_cvt_pk_bf16_f32 v123, v182, v183
  v_fmamk_f32 v184, v184, 0x3e0293ee, v22
  v_fmamk_f32 v185, v185, 0x3e0293ee, v22
  v_fmamk_f32 v186, v186, 0x3e0293ee, v22
  v_fmamk_f32 v187, v187, 0x3e0293ee, v22
  v_fmamk_f32 v188, v188, 0x3e0293ee, v22
  v_fmamk_f32 v189, v189, 0x3e0293ee, v22
  v_fmamk_f32 v190, v190, 0x3e0293ee, v22
  v_fmamk_f32 v191, v191, 0x3e0293ee, v22
  v_exp_f32 v184, v184
  v_exp_f32 v185, v185
  v_exp_f32 v186, v186
  v_exp_f32 v187, v187
  v_exp_f32 v188, v188
  v_exp_f32 v189, v189
  v_exp_f32 v190, v190
  v_exp_f32 v191, v191
  v_cvt_pk_bf16_f32 v124, v184, v185
  v_cvt_pk_bf16_f32 v125, v186, v187
  v_cvt_pk_bf16_f32 v126, v188, v189
  v_cvt_pk_bf16_f32 v127, v190, v191
  v_fmamk_f32 v192, v192, 0x3e0293ee, v23
  v_fmamk_f32 v193, v193, 0x3e0293ee, v23
  v_fmamk_f32 v194, v194, 0x3e0293ee, v23
  v_fmamk_f32 v195, v195, 0x3e0293ee, v23
  v_fmamk_f32 v196, v196, 0x3e0293ee, v23
  v_fmamk_f32 v197, v197, 0x3e0293ee, v23
  v_fmamk_f32 v198, v198, 0x3e0293ee, v23
  v_fmamk_f32 v199, v199, 0x3e0293ee, v23
  v_exp_f32 v192, v192
  v_exp_f32 v193, v193
  v_exp_f32 v194, v194
  v_exp_f32 v195, v195
  v_exp_f32 v196, v196
  v_exp_f32 v197, v197
  v_exp_f32 v198, v198
  v_exp_f32 v199, v199
  v_cvt_pk_bf16_f32 v128, v192, v193
  v_cvt_pk_bf16_f32 v129, v194, v195
  v_cvt_pk_bf16_f32 v130, v196, v197
  v_cvt_pk_bf16_f32 v131, v198, v199
  buffer_load_dwordx4 v3, s[24:27], s32 offen offset:2048 lds
  v_fmamk_f32 v200, v200, 0x3e0293ee, v24
  v_fmamk_f32 v201, v201, 0x3e0293ee, v24
  v_fmamk_f32 v202, v202, 0x3e0293ee, v24
  v_fmamk_f32 v203, v203, 0x3e0293ee, v24
  v_fmamk_f32 v204, v204, 0x3e0293ee, v24
  v_fmamk_f32 v205, v205, 0x3e0293ee, v24
  v_fmamk_f32 v206, v206, 0x3e0293ee, v24
  v_fmamk_f32 v207, v207, 0x3e0293ee, v24
  v_exp_f32 v200, v200
  v_exp_f32 v201, v201
  v_exp_f32 v202, v202
  v_exp_f32 v203, v203
  v_exp_f32 v204, v204
  v_exp_f32 v205, v205
  v_exp_f32 v206, v206
  v_exp_f32 v207, v207
  v_cvt_pk_bf16_f32 v132, v200, v201
  v_cvt_pk_bf16_f32 v133, v202, v203
  v_cvt_pk_bf16_f32 v134, v204, v205
  v_cvt_pk_bf16_f32 v135, v206, v207
  s_barrier
  v_fmamk_f32 v208, v208, 0x3e0293ee, v22
  v_fmamk_f32 v209, v209, 0x3e0293ee, v22
  v_fmamk_f32 v210, v210, 0x3e0293ee, v22
  v_fmamk_f32 v211, v211, 0x3e0293ee, v22
  v_fmamk_f32 v212, v212, 0x3e0293ee, v22
  ds_read_b64_tr_b16 v[32:33], v12 offset:32768
  v_fmamk_f32 v213, v213, 0x3e0293ee, v22
  v_fmamk_f32 v214, v214, 0x3e0293ee, v22
  v_fmamk_f32 v215, v215, 0x3e0293ee, v22
  v_exp_f32 v208, v208
  v_exp_f32 v209, v209
  ds_read_b64_tr_b16 v[34:35], v12 offset:36864
  v_exp_f32 v210, v210
  v_exp_f32 v211, v211
  v_exp_f32 v212, v212
  v_exp_f32 v213, v213
  v_exp_f32 v214, v214
  ds_read_b64_tr_b16 v[36:37], v13 offset:32768
  v_exp_f32 v215, v215
  v_cvt_pk_bf16_f32 v136, v208, v209
  v_cvt_pk_bf16_f32 v137, v210, v211
  v_cvt_pk_bf16_f32 v138, v212, v213
  v_cvt_pk_bf16_f32 v139, v214, v215
  ds_read_b64_tr_b16 v[38:39], v13 offset:36864
  v_fmamk_f32 v216, v216, 0x3e0293ee, v23
  v_fmamk_f32 v217, v217, 0x3e0293ee, v23
  v_fmamk_f32 v218, v218, 0x3e0293ee, v23
  v_fmamk_f32 v219, v219, 0x3e0293ee, v23
  v_fmamk_f32 v220, v220, 0x3e0293ee, v23
  ds_read_b64_tr_b16 v[40:41], v14 offset:32768
  v_fmamk_f32 v221, v221, 0x3e0293ee, v23
  v_fmamk_f32 v222, v222, 0x3e0293ee, v23
  v_fmamk_f32 v223, v223, 0x3e0293ee, v23
  v_exp_f32 v216, v216
  v_exp_f32 v217, v217
  ds_read_b64_tr_b16 v[42:43], v14 offset:36864
  v_exp_f32 v218, v218
  v_exp_f32 v219, v219
  v_exp_f32 v220, v220
  v_exp_f32 v221, v221
  v_exp_f32 v222, v222
  ds_read_b64_tr_b16 v[44:45], v15 offset:32768
  v_exp_f32 v223, v223
  v_cvt_pk_bf16_f32 v140, v216, v217
  v_cvt_pk_bf16_f32 v141, v218, v219
  v_cvt_pk_bf16_f32 v142, v220, v221
  v_cvt_pk_bf16_f32 v143, v222, v223
  ds_read_b64_tr_b16 v[46:47], v15 offset:36864
  v_fmamk_f32 v224, v224, 0x3e0293ee, v24
  v_fmamk_f32 v225, v225, 0x3e0293ee, v24
  v_fmamk_f32 v226, v226, 0x3e0293ee, v24
  v_fmamk_f32 v227, v227, 0x3e0293ee, v24
  v_fmamk_f32 v228, v228, 0x3e0293ee, v24
  ds_read_b64_tr_b16 v[48:49], v16 offset:32768
  v_fmamk_f32 v229, v229, 0x3e0293ee, v24
  v_fmamk_f32 v230, v230, 0x3e0293ee, v24
  v_fmamk_f32 v231, v231, 0x3e0293ee, v24
  v_exp_f32 v224, v224
  v_exp_f32 v225, v225
  ds_read_b64_tr_b16 v[50:51], v16 offset:36864
  v_exp_f32 v226, v226
  v_exp_f32 v227, v227
  v_exp_f32 v228, v228
  v_exp_f32 v229, v229
  v_exp_f32 v230, v230
  ds_read_b64_tr_b16 v[52:53], v17 offset:32768
  v_exp_f32 v231, v231
  v_cvt_pk_bf16_f32 v144, v224, v225
  v_cvt_pk_bf16_f32 v145, v226, v227
  v_cvt_pk_bf16_f32 v146, v228, v229
  v_cvt_pk_bf16_f32 v147, v230, v231
  ds_read_b64_tr_b16 v[54:55], v17 offset:36864
  v_fmamk_f32 v232, v232, 0x3e0293ee, v22
  v_fmamk_f32 v233, v233, 0x3e0293ee, v22
  v_fmamk_f32 v234, v234, 0x3e0293ee, v22
  v_fmamk_f32 v235, v235, 0x3e0293ee, v22
  v_fmamk_f32 v236, v236, 0x3e0293ee, v22
  ds_read_b64_tr_b16 v[56:57], v18 offset:32768
  v_fmamk_f32 v237, v237, 0x3e0293ee, v22
  v_fmamk_f32 v238, v238, 0x3e0293ee, v22
  v_fmamk_f32 v239, v239, 0x3e0293ee, v22
  v_exp_f32 v232, v232
  v_exp_f32 v233, v233
  ds_read_b64_tr_b16 v[58:59], v18 offset:36864
  v_exp_f32 v234, v234
  v_exp_f32 v235, v235
  v_exp_f32 v236, v236
  v_exp_f32 v237, v237
  v_exp_f32 v238, v238
  ds_read_b64_tr_b16 v[60:61], v19 offset:32768
  v_exp_f32 v239, v239
  v_cvt_pk_bf16_f32 v148, v232, v233
  v_cvt_pk_bf16_f32 v149, v234, v235
  v_cvt_pk_bf16_f32 v150, v236, v237
  v_cvt_pk_bf16_f32 v151, v238, v239
  ds_read_b64_tr_b16 v[62:63], v19 offset:36864
  v_fmamk_f32 v240, v240, 0x3e0293ee, v23
  v_fmamk_f32 v241, v241, 0x3e0293ee, v23
  v_fmamk_f32 v242, v242, 0x3e0293ee, v23
  v_fmamk_f32 v243, v243, 0x3e0293ee, v23
  v_fmamk_f32 v244, v244, 0x3e0293ee, v23
  buffer_load_dwordx4 v4, s[24:27], s32 offen offset:3072 lds
  v_fmamk_f32 v245, v245, 0x3e0293ee, v23
  v_fmamk_f32 v246, v246, 0x3e0293ee, v23
  v_fmamk_f32 v247, v247, 0x3e0293ee, v23
  v_exp_f32 v240, v240
  v_exp_f32 v241, v241
  v_exp_f32 v242, v242
  v_exp_f32 v243, v243
  v_exp_f32 v244, v244
  v_exp_f32 v245, v245
  v_exp_f32 v246, v246
  v_exp_f32 v247, v247
  v_cvt_pk_bf16_f32 v152, v240, v241
  v_cvt_pk_bf16_f32 v153, v242, v243
  v_cvt_pk_bf16_f32 v154, v244, v245
  v_cvt_pk_bf16_f32 v155, v246, v247
  v_fmamk_f32 v248, v248, 0x3e0293ee, v24
  v_fmamk_f32 v249, v249, 0x3e0293ee, v24
  v_fmamk_f32 v250, v250, 0x3e0293ee, v24
  v_fmamk_f32 v251, v251, 0x3e0293ee, v24
  v_fmamk_f32 v252, v252, 0x3e0293ee, v24
  v_fmamk_f32 v253, v253, 0x3e0293ee, v24
  v_fmamk_f32 v254, v254, 0x3e0293ee, v24
  v_fmamk_f32 v255, v255, 0x3e0293ee, v24
  v_exp_f32 v248, v248
  v_exp_f32 v249, v249
  v_exp_f32 v250, v250
  v_exp_f32 v251, v251
  v_exp_f32 v252, v252
  v_exp_f32 v253, v253
  v_exp_f32 v254, v254
  v_exp_f32 v255, v255
  v_cvt_pk_bf16_f32 v156, v248, v249
  v_cvt_pk_bf16_f32 v157, v250, v251
  v_cvt_pk_bf16_f32 v158, v252, v253
  v_cvt_pk_bf16_f32 v159, v254, v255
  s_waitcnt lgkmcnt(12)
  v_mfma_f32_16x16x32_bf16 v[160:163], v[32:35], v[64:67], 0
  v_mfma_f32_16x16x32_bf16 v[164:167], v[32:35], v[68:71], 0
  v_mfma_f32_16x16x32_bf16 v[168:171], v[32:35], v[72:75], 0
  v_mfma_f32_16x16x32_bf16 v[172:175], v[36:39], v[64:67], 0
  v_mfma_f32_16x16x32_bf16 v[176:179], v[36:39], v[68:71], 0
  v_mfma_f32_16x16x32_bf16 v[180:183], v[36:39], v[72:75], 0
  s_waitcnt lgkmcnt(8)
  v_mfma_f32_16x16x32_bf16 v[184:187], v[40:43], v[64:67], 0
  v_mfma_f32_16x16x32_bf16 v[188:191], v[40:43], v[68:71], 0
  v_mfma_f32_16x16x32_bf16 v[192:195], v[40:43], v[72:75], 0
  v_mfma_f32_16x16x32_bf16 v[196:199], v[44:47], v[64:67], 0
  v_mfma_f32_16x16x32_bf16 v[200:203], v[44:47], v[68:71], 0
  v_mfma_f32_16x16x32_bf16 v[204:207], v[44:47], v[72:75], 0
  s_waitcnt lgkmcnt(0)
  v_mfma_f32_16x16x32_bf16 v[208:211], v[48:51], v[64:67], 0
  s_barrier
  ds_read_b64_tr_b16 v[32:33], v12 offset:49152
  ds_read_b64_tr_b16 v[34:35], v12 offset:53248
  v_mfma_f32_16x16x32_bf16 v[212:215], v[48:51], v[68:71], 0
  ds_read_b64_tr_b16 v[36:37], v13 offset:49152
  ds_read_b64_tr_b16 v[38:39], v13 offset:53248
  v_mfma_f32_16x16x32_bf16 v[216:219], v[48:51], v[72:75], 0
  ds_read_b64_tr_b16 v[40:41], v14 offset:49152
  ds_read_b64_tr_b16 v[42:43], v14 offset:53248
  v_mfma_f32_16x16x32_bf16 v[220:223], v[52:55], v[64:67], 0
  ds_read_b64_tr_b16 v[44:45], v15 offset:49152
  ds_read_b64_tr_b16 v[46:47], v15 offset:53248
  v_mfma_f32_16x16x32_bf16 v[224:227], v[52:55], v[68:71], 0
  ds_read_b64_tr_b16 v[48:49], v16 offset:49152
  ds_read_b64_tr_b16 v[50:51], v16 offset:53248
  v_mfma_f32_16x16x32_bf16 v[228:231], v[52:55], v[72:75], 0
  ds_read_b64_tr_b16 v[52:53], v17 offset:49152
  ds_read_b64_tr_b16 v[54:55], v17 offset:53248
  v_mfma_f32_16x16x32_bf16 v[232:235], v[56:59], v[64:67], 0
  v_mfma_f32_16x16x32_bf16 v[236:239], v[56:59], v[68:71], 0
  v_mfma_f32_16x16x32_bf16 v[240:243], v[56:59], v[72:75], 0
  ds_read_b64_tr_b16 v[56:57], v18 offset:49152
  ds_read_b64_tr_b16 v[58:59], v18 offset:53248
  v_mfma_f32_16x16x32_bf16 v[244:247], v[60:63], v[64:67], 0
  v_mfma_f32_16x16x32_bf16 v[248:251], v[60:63], v[68:71], 0
  v_mfma_f32_16x16x32_bf16 v[252:255], v[60:63], v[72:75], 0
  ds_read_b64_tr_b16 v[60:61], v19 offset:49152
  ds_read_b64_tr_b16 v[62:63], v19 offset:53248
  v_mfma_f32_16x16x32_bf16 a[240:243], a[252:255], v[64:67], 0
  v_mfma_f32_16x16x32_bf16 a[244:247], a[252:255], v[68:71], 0
  v_mfma_f32_16x16x32_bf16 a[248:251], a[252:255], v[72:75], 0
  s_waitcnt lgkmcnt(12)
  v_mfma_f32_16x16x32_bf16 v[160:163], v[32:35], v[76:79], v[160:163]
  v_mfma_f32_16x16x32_bf16 v[164:167], v[32:35], v[80:83], v[164:167]
  v_mfma_f32_16x16x32_bf16 v[168:171], v[32:35], v[84:87], v[168:171]
  v_mfma_f32_16x16x32_bf16 v[172:175], v[36:39], v[76:79], v[172:175]
  v_mfma_f32_16x16x32_bf16 v[176:179], v[36:39], v[80:83], v[176:179]
  v_mfma_f32_16x16x32_bf16 v[180:183], v[36:39], v[84:87], v[180:183]
  s_waitcnt lgkmcnt(8)
  v_mfma_f32_16x16x32_bf16 v[184:187], v[40:43], v[76:79], v[184:187]
  v_mfma_f32_16x16x32_bf16 v[188:191], v[40:43], v[80:83], v[188:191]
  v_mfma_f32_16x16x32_bf16 v[192:195], v[40:43], v[84:87], v[192:195]
  v_mfma_f32_16x16x32_bf16 v[196:199], v[44:47], v[76:79], v[196:199]
  v_mfma_f32_16x16x32_bf16 v[200:203], v[44:47], v[80:83], v[200:203]
  v_mfma_f32_16x16x32_bf16 v[204:207], v[44:47], v[84:87], v[204:207]
  s_waitcnt lgkmcnt(0)
  v_mfma_f32_16x16x32_bf16 v[208:211], v[48:51], v[76:79], v[208:211]
  s_barrier
  v_add_u32 v12, 0x10000, v12
  ds_read_b64_tr_b16 v[32:33], v12 offset:0
  ds_read_b64_tr_b16 v[34:35], v12 offset:4096
  v_mfma_f32_16x16x32_bf16 v[212:215], v[48:51], v[80:83], v[212:215]
  v_add_u32 v13, 0x10000, v13
  ds_read_b64_tr_b16 v[36:37], v13 offset:0
  ds_read_b64_tr_b16 v[38:39], v13 offset:4096
  v_mfma_f32_16x16x32_bf16 v[216:219], v[48:51], v[84:87], v[216:219]
  v_add_u32 v14, 0x10000, v14
  ds_read_b64_tr_b16 v[40:41], v14 offset:0
  ds_read_b64_tr_b16 v[42:43], v14 offset:4096
  v_mfma_f32_16x16x32_bf16 v[220:223], v[52:55], v[76:79], v[220:223]
  v_add_u32 v15, 0x10000, v15
  ds_read_b64_tr_b16 v[44:45], v15 offset:0
  ds_read_b64_tr_b16 v[46:47], v15 offset:4096
  v_mfma_f32_16x16x32_bf16 v[224:227], v[52:55], v[80:83], v[224:227]
  v_add_u32 v16, 0x10000, v16
  ds_read_b64_tr_b16 v[48:49], v16 offset:0
  ds_read_b64_tr_b16 v[50:51], v16 offset:4096
  v_mfma_f32_16x16x32_bf16 v[228:231], v[52:55], v[84:87], v[228:231]
  v_add_u32 v17, 0x10000, v17
  ds_read_b64_tr_b16 v[52:53], v17 offset:0
  ds_read_b64_tr_b16 v[54:55], v17 offset:4096
  v_mfma_f32_16x16x32_bf16 v[232:235], v[56:59], v[76:79], v[232:235]
  v_mfma_f32_16x16x32_bf16 v[236:239], v[56:59], v[80:83], v[236:239]
  v_mfma_f32_16x16x32_bf16 v[240:243], v[56:59], v[84:87], v[240:243]
  v_add_u32 v18, 0x10000, v18
  ds_read_b64_tr_b16 v[56:57], v18 offset:0
  ds_read_b64_tr_b16 v[58:59], v18 offset:4096
  v_mfma_f32_16x16x32_bf16 v[244:247], v[60:63], v[76:79], v[244:247]
  v_mfma_f32_16x16x32_bf16 v[248:251], v[60:63], v[80:83], v[248:251]
  v_mfma_f32_16x16x32_bf16 v[252:255], v[60:63], v[84:87], v[252:255]
  v_add_u32 v19, 0x10000, v19
  ds_read_b64_tr_b16 v[60:61], v19 offset:0
  ds_read_b64_tr_b16 v[62:63], v19 offset:4096
  v_mfma_f32_16x16x32_bf16 a[240:243], a[252:255], v[76:79], a[240:243]
  v_mfma_f32_16x16x32_bf16 a[244:247], a[252:255], v[80:83], a[244:247]
  v_mfma_f32_16x16x32_bf16 a[248:251], a[252:255], v[84:87], a[248:251]
  s_waitcnt lgkmcnt(12)
  v_mfma_f32_16x16x32_bf16 v[160:163], v[32:35], v[88:91], v[160:163]
  v_mfma_f32_16x16x32_bf16 v[164:167], v[32:35], v[92:95], v[164:167]
  v_mfma_f32_16x16x32_bf16 v[168:171], v[32:35], v[96:99], v[168:171]
  v_mfma_f32_16x16x32_bf16 v[172:175], v[36:39], v[88:91], v[172:175]
  v_mfma_f32_16x16x32_bf16 v[176:179], v[36:39], v[92:95], v[176:179]
  v_mfma_f32_16x16x32_bf16 v[180:183], v[36:39], v[96:99], v[180:183]
  s_waitcnt lgkmcnt(8)
  v_mfma_f32_16x16x32_bf16 v[184:187], v[40:43], v[88:91], v[184:187]
  v_mfma_f32_16x16x32_bf16 v[188:191], v[40:43], v[92:95], v[188:191]
  v_mfma_f32_16x16x32_bf16 v[192:195], v[40:43], v[96:99], v[192:195]
  v_mfma_f32_16x16x32_bf16 v[196:199], v[44:47], v[88:91], v[196:199]
  v_mfma_f32_16x16x32_bf16 v[200:203], v[44:47], v[92:95], v[200:203]
  v_mfma_f32_16x16x32_bf16 v[204:207], v[44:47], v[96:99], v[204:207]
  s_waitcnt lgkmcnt(0)
  v_mfma_f32_16x16x32_bf16 v[208:211], v[48:51], v[88:91], v[208:211]
  s_barrier
  ds_read_b64_tr_b16 v[32:33], v12 offset:16384
  ds_read_b64_tr_b16 v[34:35], v12 offset:20480
  v_mfma_f32_16x16x32_bf16 v[212:215], v[48:51], v[92:95], v[212:215]
  ds_read_b64_tr_b16 v[36:37], v13 offset:16384
  ds_read_b64_tr_b16 v[38:39], v13 offset:20480
  v_mfma_f32_16x16x32_bf16 v[216:219], v[48:51], v[96:99], v[216:219]
  ds_read_b64_tr_b16 v[40:41], v14 offset:16384
  ds_read_b64_tr_b16 v[42:43], v14 offset:20480
  v_mfma_f32_16x16x32_bf16 v[220:223], v[52:55], v[88:91], v[220:223]
  ds_read_b64_tr_b16 v[44:45], v15 offset:16384
  ds_read_b64_tr_b16 v[46:47], v15 offset:20480
  v_mfma_f32_16x16x32_bf16 v[224:227], v[52:55], v[92:95], v[224:227]
  ds_read_b64_tr_b16 v[48:49], v16 offset:16384
  ds_read_b64_tr_b16 v[50:51], v16 offset:20480
  v_mfma_f32_16x16x32_bf16 v[228:231], v[52:55], v[96:99], v[228:231]
  ds_read_b64_tr_b16 v[52:53], v17 offset:16384
  ds_read_b64_tr_b16 v[54:55], v17 offset:20480
  v_mfma_f32_16x16x32_bf16 v[232:235], v[56:59], v[88:91], v[232:235]
  v_mfma_f32_16x16x32_bf16 v[236:239], v[56:59], v[92:95], v[236:239]
  v_mfma_f32_16x16x32_bf16 v[240:243], v[56:59], v[96:99], v[240:243]
  ds_read_b64_tr_b16 v[56:57], v18 offset:16384
  ds_read_b64_tr_b16 v[58:59], v18 offset:20480
  v_mfma_f32_16x16x32_bf16 v[244:247], v[60:63], v[88:91], v[244:247]
  v_mfma_f32_16x16x32_bf16 v[248:251], v[60:63], v[92:95], v[248:251]
  v_mfma_f32_16x16x32_bf16 v[252:255], v[60:63], v[96:99], v[252:255]
  ds_read_b64_tr_b16 v[60:61], v19 offset:16384
  ds_read_b64_tr_b16 v[62:63], v19 offset:20480
  v_mfma_f32_16x16x32_bf16 a[240:243], a[252:255], v[88:91], a[240:243]
  v_mfma_f32_16x16x32_bf16 a[244:247], a[252:255], v[92:95], a[244:247]
  v_mfma_f32_16x16x32_bf16 a[248:251], a[252:255], v[96:99], a[248:251]
  s_waitcnt lgkmcnt(12)
  v_mfma_f32_16x16x32_bf16 v[160:163], v[32:35], v[100:103], v[160:163]
  v_mfma_f32_16x16x32_bf16 v[164:167], v[32:35], v[104:107], v[164:167]
  v_mfma_f32_16x16x32_bf16 v[168:171], v[32:35], v[108:111], v[168:171]
  v_mfma_f32_16x16x32_bf16 v[172:175], v[36:39], v[100:103], v[172:175]
  v_mfma_f32_16x16x32_bf16 v[176:179], v[36:39], v[104:107], v[176:179]
  v_mfma_f32_16x16x32_bf16 v[180:183], v[36:39], v[108:111], v[180:183]
  s_waitcnt lgkmcnt(8)
  v_mfma_f32_16x16x32_bf16 v[184:187], v[40:43], v[100:103], v[184:187]
  v_mfma_f32_16x16x32_bf16 v[188:191], v[40:43], v[104:107], v[188:191]
  v_mfma_f32_16x16x32_bf16 v[192:195], v[40:43], v[108:111], v[192:195]
  v_mfma_f32_16x16x32_bf16 v[196:199], v[44:47], v[100:103], v[196:199]
  v_mfma_f32_16x16x32_bf16 v[200:203], v[44:47], v[104:107], v[200:203]
  v_mfma_f32_16x16x32_bf16 v[204:207], v[44:47], v[108:111], v[204:207]
  s_waitcnt lgkmcnt(0)
  v_mfma_f32_16x16x32_bf16 v[208:211], v[48:51], v[100:103], v[208:211]
  s_barrier
  v_subrev_u32 v12, 0x10000, v12
  ds_read_b64_tr_b16 v[32:33], v12 offset:0
  ds_read_b64_tr_b16 v[34:35], v12 offset:4096
  v_mfma_f32_16x16x32_bf16 v[212:215], v[48:51], v[104:107], v[212:215]
  v_subrev_u32 v13, 0x10000, v13
  ds_read_b64_tr_b16 v[36:37], v13 offset:0
  ds_read_b64_tr_b16 v[38:39], v13 offset:4096
  v_mfma_f32_16x16x32_bf16 v[216:219], v[48:51], v[108:111], v[216:219]
  v_subrev_u32 v14, 0x10000, v14
  ds_read_b64_tr_b16 v[40:41], v14 offset:0
  ds_read_b64_tr_b16 v[42:43], v14 offset:4096
  v_mfma_f32_16x16x32_bf16 v[220:223], v[52:55], v[100:103], v[220:223]
  v_subrev_u32 v15, 0x10000, v15
  ds_read_b64_tr_b16 v[44:45], v15 offset:0
  ds_read_b64_tr_b16 v[46:47], v15 offset:4096
  v_mfma_f32_16x16x32_bf16 v[224:227], v[52:55], v[104:107], v[224:227]
  v_subrev_u32 v16, 0x10000, v16
  ds_read_b64_tr_b16 v[48:49], v16 offset:0
  ds_read_b64_tr_b16 v[50:51], v16 offset:4096
  v_mfma_f32_16x16x32_bf16 v[228:231], v[52:55], v[108:111], v[228:231]
  v_subrev_u32 v17, 0x10000, v17
  ds_read_b64_tr_b16 v[52:53], v17 offset:0
  ds_read_b64_tr_b16 v[54:55], v17 offset:4096
  v_mfma_f32_16x16x32_bf16 v[232:235], v[56:59], v[100:103], v[232:235]
  v_mfma_f32_16x16x32_bf16 v[236:239], v[56:59], v[104:107], v[236:239]
  v_mfma_f32_16x16x32_bf16 v[240:243], v[56:59], v[108:111], v[240:243]
  v_subrev_u32 v18, 0x10000, v18
  ds_read_b64_tr_b16 v[56:57], v18 offset:0
  ds_read_b64_tr_b16 v[58:59], v18 offset:4096
  v_mfma_f32_16x16x32_bf16 v[244:247], v[60:63], v[100:103], v[244:247]
  v_mfma_f32_16x16x32_bf16 v[248:251], v[60:63], v[104:107], v[248:251]
  v_mfma_f32_16x16x32_bf16 v[252:255], v[60:63], v[108:111], v[252:255]
  v_subrev_u32 v19, 0x10000, v19
  ds_read_b64_tr_b16 v[60:61], v19 offset:0
  ds_read_b64_tr_b16 v[62:63], v19 offset:4096
  v_mfma_f32_16x16x32_bf16 a[240:243], a[252:255], v[100:103], a[240:243]
  v_mfma_f32_16x16x32_bf16 a[244:247], a[252:255], v[104:107], a[244:247]
  v_mfma_f32_16x16x32_bf16 a[248:251], a[252:255], v[108:111], a[248:251]
  s_waitcnt lgkmcnt(12)
  v_mfma_f32_16x16x32_bf16 v[160:163], v[32:35], v[112:115], v[160:163]
  v_mfma_f32_16x16x32_bf16 v[164:167], v[32:35], v[116:119], v[164:167]
  v_mfma_f32_16x16x32_bf16 v[168:171], v[32:35], v[120:123], v[168:171]
  v_mfma_f32_16x16x32_bf16 v[172:175], v[36:39], v[112:115], v[172:175]
  v_mfma_f32_16x16x32_bf16 v[176:179], v[36:39], v[116:119], v[176:179]
  v_mfma_f32_16x16x32_bf16 v[180:183], v[36:39], v[120:123], v[180:183]
  s_waitcnt lgkmcnt(8)
  v_mfma_f32_16x16x32_bf16 v[184:187], v[40:43], v[112:115], v[184:187]
  v_mfma_f32_16x16x32_bf16 v[188:191], v[40:43], v[116:119], v[188:191]
  v_mfma_f32_16x16x32_bf16 v[192:195], v[40:43], v[120:123], v[192:195]
  v_mfma_f32_16x16x32_bf16 v[196:199], v[44:47], v[112:115], v[196:199]
  v_mfma_f32_16x16x32_bf16 v[200:203], v[44:47], v[116:119], v[200:203]
  v_mfma_f32_16x16x32_bf16 v[204:207], v[44:47], v[120:123], v[204:207]
  s_waitcnt lgkmcnt(0)
  v_mfma_f32_16x16x32_bf16 v[208:211], v[48:51], v[112:115], v[208:211]
  s_barrier
  ds_read_b64_tr_b16 v[32:33], v12 offset:16384
  ds_read_b64_tr_b16 v[34:35], v12 offset:20480
  v_mfma_f32_16x16x32_bf16 v[212:215], v[48:51], v[116:119], v[212:215]
  ds_read_b64_tr_b16 v[36:37], v13 offset:16384
  ds_read_b64_tr_b16 v[38:39], v13 offset:20480
  v_mfma_f32_16x16x32_bf16 v[216:219], v[48:51], v[120:123], v[216:219]
  ds_read_b64_tr_b16 v[40:41], v14 offset:16384
  ds_read_b64_tr_b16 v[42:43], v14 offset:20480
  v_mfma_f32_16x16x32_bf16 v[220:223], v[52:55], v[112:115], v[220:223]
  ds_read_b64_tr_b16 v[44:45], v15 offset:16384
  ds_read_b64_tr_b16 v[46:47], v15 offset:20480
  v_mfma_f32_16x16x32_bf16 v[224:227], v[52:55], v[116:119], v[224:227]
  ds_read_b64_tr_b16 v[48:49], v16 offset:16384
  ds_read_b64_tr_b16 v[50:51], v16 offset:20480
  v_mfma_f32_16x16x32_bf16 v[228:231], v[52:55], v[120:123], v[228:231]
  ds_read_b64_tr_b16 v[52:53], v17 offset:16384
  ds_read_b64_tr_b16 v[54:55], v17 offset:20480
  v_mfma_f32_16x16x32_bf16 v[232:235], v[56:59], v[112:115], v[232:235]
  v_mfma_f32_16x16x32_bf16 v[236:239], v[56:59], v[116:119], v[236:239]
  v_mfma_f32_16x16x32_bf16 v[240:243], v[56:59], v[120:123], v[240:243]
  ds_read_b64_tr_b16 v[56:57], v18 offset:16384
  ds_read_b64_tr_b16 v[58:59], v18 offset:20480
  v_mfma_f32_16x16x32_bf16 v[244:247], v[60:63], v[112:115], v[244:247]
  v_mfma_f32_16x16x32_bf16 v[248:251], v[60:63], v[116:119], v[248:251]
  v_mfma_f32_16x16x32_bf16 v[252:255], v[60:63], v[120:123], v[252:255]
  ds_read_b64_tr_b16 v[60:61], v19 offset:16384
  ds_read_b64_tr_b16 v[62:63], v19 offset:20480
  v_mfma_f32_16x16x32_bf16 a[240:243], a[252:255], v[112:115], a[240:243]
  v_mfma_f32_16x16x32_bf16 a[244:247], a[252:255], v[116:119], a[244:247]
  v_mfma_f32_16x16x32_bf16 a[248:251], a[252:255], v[120:123], a[248:251]
  s_waitcnt lgkmcnt(12)
  v_mfma_f32_16x16x32_bf16 v[160:163], v[32:35], v[124:127], v[160:163]
  v_mfma_f32_16x16x32_bf16 v[164:167], v[32:35], v[128:131], v[164:167]
  v_mfma_f32_16x16x32_bf16 v[168:171], v[32:35], v[132:135], v[168:171]
  v_mfma_f32_16x16x32_bf16 v[172:175], v[36:39], v[124:127], v[172:175]
  v_mfma_f32_16x16x32_bf16 v[176:179], v[36:39], v[128:131], v[176:179]
  v_mfma_f32_16x16x32_bf16 v[180:183], v[36:39], v[132:135], v[180:183]
  s_waitcnt lgkmcnt(8)
  v_mfma_f32_16x16x32_bf16 v[184:187], v[40:43], v[124:127], v[184:187]
  v_mfma_f32_16x16x32_bf16 v[188:191], v[40:43], v[128:131], v[188:191]
  v_mfma_f32_16x16x32_bf16 v[192:195], v[40:43], v[132:135], v[192:195]
  v_mfma_f32_16x16x32_bf16 v[196:199], v[44:47], v[124:127], v[196:199]
  v_mfma_f32_16x16x32_bf16 v[200:203], v[44:47], v[128:131], v[200:203]
  v_mfma_f32_16x16x32_bf16 v[204:207], v[44:47], v[132:135], v[204:207]
  s_waitcnt lgkmcnt(0)
  v_mfma_f32_16x16x32_bf16 v[208:211], v[48:51], v[124:127], v[208:211]
  s_barrier
  ds_read_b64_tr_b16 v[32:33], v12 offset:32768
  ds_read_b64_tr_b16 v[34:35], v12 offset:36864
  v_mfma_f32_16x16x32_bf16 v[212:215], v[48:51], v[128:131], v[212:215]
  ds_read_b64_tr_b16 v[36:37], v13 offset:32768
  ds_read_b64_tr_b16 v[38:39], v13 offset:36864
  v_mfma_f32_16x16x32_bf16 v[216:219], v[48:51], v[132:135], v[216:219]
  ds_read_b64_tr_b16 v[40:41], v14 offset:32768
  ds_read_b64_tr_b16 v[42:43], v14 offset:36864
  v_mfma_f32_16x16x32_bf16 v[220:223], v[52:55], v[124:127], v[220:223]
  ds_read_b64_tr_b16 v[44:45], v15 offset:32768
  ds_read_b64_tr_b16 v[46:47], v15 offset:36864
  v_mfma_f32_16x16x32_bf16 v[224:227], v[52:55], v[128:131], v[224:227]
  ds_read_b64_tr_b16 v[48:49], v16 offset:32768
  ds_read_b64_tr_b16 v[50:51], v16 offset:36864
  v_mfma_f32_16x16x32_bf16 v[228:231], v[52:55], v[132:135], v[228:231]
  ds_read_b64_tr_b16 v[52:53], v17 offset:32768
  ds_read_b64_tr_b16 v[54:55], v17 offset:36864
  v_mfma_f32_16x16x32_bf16 v[232:235], v[56:59], v[124:127], v[232:235]
  v_mfma_f32_16x16x32_bf16 v[236:239], v[56:59], v[128:131], v[236:239]
  v_mfma_f32_16x16x32_bf16 v[240:243], v[56:59], v[132:135], v[240:243]
  ds_read_b64_tr_b16 v[56:57], v18 offset:32768
  ds_read_b64_tr_b16 v[58:59], v18 offset:36864
  v_mfma_f32_16x16x32_bf16 v[244:247], v[60:63], v[124:127], v[244:247]
  v_mfma_f32_16x16x32_bf16 v[248:251], v[60:63], v[128:131], v[248:251]
  v_mfma_f32_16x16x32_bf16 v[252:255], v[60:63], v[132:135], v[252:255]
  ds_read_b64_tr_b16 v[60:61], v19 offset:32768
  ds_read_b64_tr_b16 v[62:63], v19 offset:36864
  v_mfma_f32_16x16x32_bf16 a[240:243], a[252:255], v[124:127], a[240:243]
  v_mfma_f32_16x16x32_bf16 a[244:247], a[252:255], v[128:131], a[244:247]
  v_mfma_f32_16x16x32_bf16 a[248:251], a[252:255], v[132:135], a[248:251]
  s_waitcnt lgkmcnt(12)
  v_mfma_f32_16x16x32_bf16 v[160:163], v[32:35], v[136:139], v[160:163]
  v_mfma_f32_16x16x32_bf16 v[164:167], v[32:35], v[140:143], v[164:167]
  v_mfma_f32_16x16x32_bf16 v[168:171], v[32:35], v[144:147], v[168:171]
  v_mfma_f32_16x16x32_bf16 v[172:175], v[36:39], v[136:139], v[172:175]
  v_mfma_f32_16x16x32_bf16 v[176:179], v[36:39], v[140:143], v[176:179]
  v_mfma_f32_16x16x32_bf16 v[180:183], v[36:39], v[144:147], v[180:183]
  s_waitcnt lgkmcnt(8)
  v_mfma_f32_16x16x32_bf16 v[184:187], v[40:43], v[136:139], v[184:187]
  v_mfma_f32_16x16x32_bf16 v[188:191], v[40:43], v[140:143], v[188:191]
  v_mfma_f32_16x16x32_bf16 v[192:195], v[40:43], v[144:147], v[192:195]
  v_mfma_f32_16x16x32_bf16 v[196:199], v[44:47], v[136:139], v[196:199]
  v_mfma_f32_16x16x32_bf16 v[200:203], v[44:47], v[140:143], v[200:203]
  v_mfma_f32_16x16x32_bf16 v[204:207], v[44:47], v[144:147], v[204:207]
  s_waitcnt lgkmcnt(0)
  v_mfma_f32_16x16x32_bf16 v[208:211], v[48:51], v[136:139], v[208:211]
  s_barrier
  ds_read_b64_tr_b16 v[32:33], v12 offset:49152
  ds_read_b64_tr_b16 v[34:35], v12 offset:53248
  v_mfma_f32_16x16x32_bf16 v[212:215], v[48:51], v[140:143], v[212:215]
  ds_read_b64_tr_b16 v[36:37], v13 offset:49152
  ds_read_b64_tr_b16 v[38:39], v13 offset:53248
  v_mfma_f32_16x16x32_bf16 v[216:219], v[48:51], v[144:147], v[216:219]
  ds_read_b64_tr_b16 v[40:41], v14 offset:49152
  ds_read_b64_tr_b16 v[42:43], v14 offset:53248
  v_mfma_f32_16x16x32_bf16 v[220:223], v[52:55], v[136:139], v[220:223]
  ds_read_b64_tr_b16 v[44:45], v15 offset:49152
  ds_read_b64_tr_b16 v[46:47], v15 offset:53248
  v_mfma_f32_16x16x32_bf16 v[224:227], v[52:55], v[140:143], v[224:227]
  ds_read_b64_tr_b16 v[48:49], v16 offset:49152
  ds_read_b64_tr_b16 v[50:51], v16 offset:53248
  v_mfma_f32_16x16x32_bf16 v[228:231], v[52:55], v[144:147], v[228:231]
  ds_read_b64_tr_b16 v[52:53], v17 offset:49152
  ds_read_b64_tr_b16 v[54:55], v17 offset:53248
  v_mfma_f32_16x16x32_bf16 v[232:235], v[56:59], v[136:139], v[232:235]
  v_mfma_f32_16x16x32_bf16 v[236:239], v[56:59], v[140:143], v[236:239]
  v_mfma_f32_16x16x32_bf16 v[240:243], v[56:59], v[144:147], v[240:243]
  ds_read_b64_tr_b16 v[56:57], v18 offset:49152
  ds_read_b64_tr_b16 v[58:59], v18 offset:53248
  v_mfma_f32_16x16x32_bf16 v[244:247], v[60:63], v[136:139], v[244:247]
  v_mfma_f32_16x16x32_bf16 v[248:251], v[60:63], v[140:143], v[248:251]
  v_mfma_f32_16x16x32_bf16 v[252:255], v[60:63], v[144:147], v[252:255]
  ds_read_b64_tr_b16 v[60:61], v19 offset:49152
  ds_read_b64_tr_b16 v[62:63], v19 offset:53248
  v_mfma_f32_16x16x32_bf16 a[240:243], a[252:255], v[136:139], a[240:243]
  v_mfma_f32_16x16x32_bf16 a[244:247], a[252:255], v[140:143], a[244:247]
  v_mfma_f32_16x16x32_bf16 a[248:251], a[252:255], v[144:147], a[248:251]
  s_waitcnt lgkmcnt(12)
  v_mfma_f32_16x16x32_bf16 v[160:163], v[32:35], v[148:151], v[160:163]
  v_mfma_f32_16x16x32_bf16 v[164:167], v[32:35], v[152:155], v[164:167]
  v_mfma_f32_16x16x32_bf16 v[168:171], v[32:35], v[156:159], v[168:171]
  v_mfma_f32_16x16x32_bf16 v[172:175], v[36:39], v[148:151], v[172:175]
  v_mfma_f32_16x16x32_bf16 v[176:179], v[36:39], v[152:155], v[176:179]
  v_mfma_f32_16x16x32_bf16 v[180:183], v[36:39], v[156:159], v[180:183]
  s_waitcnt lgkmcnt(8)
  v_mfma_f32_16x16x32_bf16 v[184:187], v[40:43], v[148:151], v[184:187]
  v_mfma_f32_16x16x32_bf16 v[188:191], v[40:43], v[152:155], v[188:191]
  v_mfma_f32_16x16x32_bf16 v[192:195], v[40:43], v[156:159], v[192:195]
  v_mfma_f32_16x16x32_bf16 v[196:199], v[44:47], v[148:151], v[196:199]
  v_mfma_f32_16x16x32_bf16 v[200:203], v[44:47], v[152:155], v[200:203]
  v_mfma_f32_16x16x32_bf16 v[204:207], v[44:47], v[156:159], v[204:207]
  s_waitcnt lgkmcnt(0)
  v_mfma_f32_16x16x32_bf16 v[208:211], v[48:51], v[148:151], v[208:211]
  s_waitcnt vmcnt(16)
  s_barrier
  ds_read_b64_tr_b16 v[32:33], v20 offset:0
  ds_read_b64_tr_b16 v[34:35], v20 offset:512
  v_mfma_f32_16x16x32_bf16 v[212:215], v[48:51], v[152:155], v[212:215]
  ds_read_b64_tr_b16 v[36:37], v21 offset:0
  ds_read_b64_tr_b16 v[38:39], v21 offset:512
  v_mfma_f32_16x16x32_bf16 v[216:219], v[48:51], v[156:159], v[216:219]
  ds_read_b64_tr_b16 v[40:41], v20 offset:4096
  ds_read_b64_tr_b16 v[42:43], v20 offset:4608
  v_mfma_f32_16x16x32_bf16 v[220:223], v[52:55], v[148:151], v[220:223]
  ds_read_b64_tr_b16 v[44:45], v21 offset:4096
  ds_read_b64_tr_b16 v[46:47], v21 offset:4608
  v_mfma_f32_16x16x32_bf16 v[224:227], v[52:55], v[152:155], v[224:227]
  ds_read_b64_tr_b16 v[48:49], v20 offset:8192
  ds_read_b64_tr_b16 v[50:51], v20 offset:8704
  v_mfma_f32_16x16x32_bf16 v[228:231], v[52:55], v[156:159], v[228:231]
  ds_read_b64_tr_b16 v[52:53], v21 offset:8192
  ds_read_b64_tr_b16 v[54:55], v21 offset:8704
  v_mfma_f32_16x16x32_bf16 v[232:235], v[56:59], v[148:151], v[232:235]
  v_mfma_f32_16x16x32_bf16 v[236:239], v[56:59], v[152:155], v[236:239]
  v_mfma_f32_16x16x32_bf16 v[240:243], v[56:59], v[156:159], v[240:243]
  ds_read_b64_tr_b16 v[56:57], v20 offset:12288
  ds_read_b64_tr_b16 v[58:59], v20 offset:12800
  v_mfma_f32_16x16x32_bf16 v[244:247], v[60:63], v[148:151], v[244:247]
  v_mfma_f32_16x16x32_bf16 v[248:251], v[60:63], v[152:155], v[248:251]
  v_mfma_f32_16x16x32_bf16 v[252:255], v[60:63], v[156:159], v[252:255]
  ds_read_b64_tr_b16 v[60:61], v21 offset:12288
  ds_read_b64_tr_b16 v[62:63], v21 offset:12800
  v_mfma_f32_16x16x32_bf16 a[240:243], a[252:255], v[148:151], a[240:243]
  v_mfma_f32_16x16x32_bf16 a[244:247], a[252:255], v[152:155], a[244:247]
  v_mfma_f32_16x16x32_bf16 a[248:251], a[252:255], v[156:159], a[248:251]
  v_add_u32 v112, s47, v0
  v_add_u32 v113, s48, v0
  v_lshrrev_b32 v115, 1, v0
  v_add_u32 v114, s49, v115
  v_add_u32 v115, s50, v115
  ds_write_b128 v112, v[208:211] offset:0
  ds_write_b128 v112, v[212:215] offset:1024
  ds_write_b128 v112, v[216:219] offset:2048
  ds_write_b128 v112, v[220:223] offset:3072
  ds_write_b128 v112, v[224:227] offset:4096
  ds_write_b128 v112, v[228:231] offset:5120
  ds_write_b128 v112, v[232:235] offset:6144
  ds_write_b128 v112, v[236:239] offset:7168
  ds_write_b128 v112, v[240:243] offset:8192
  ds_write_b128 v112, v[244:247] offset:9216
  ds_write_b128 v112, v[248:251] offset:10240
  ds_write_b128 v112, v[252:255] offset:11264
  v_mov_b32 v116, v22
  v_accvgpr_read_b32 v117, a240
  v_mov_b32 v118, v23
  v_accvgpr_read_b32 v119, a244
  v_mov_b32 v120, v24
  v_accvgpr_read_b32 v121, a248
  ds_write_b64 v114, v[116:117] offset:0
  ds_write_b64 v114, v[118:119] offset:512
  ds_write_b64 v114, v[120:121] offset:1024
  v_bfe_u32 v128, v0, 4, 4
  v_lshrrev_b32 v129, 8, v0
  v_lshrrev_b32 v131, 1, v128
  v_lshrrev_b32 v132, 1, v129
  v_xor_b32 v132, v131, v132
  v_lshlrev_b32 v132, 4, v132
  v_lshl_add_u32 v130, v128, 7, v132
  v_and_b32 v132, 1, v129
  v_lshl_add_u32 v130, v132, 3, v130
  v_add_u32 v130, s48, v130
  v_xor_b32 v134, v129, v131
  v_lshlrev_b32 v134, 4, v134
  v_lshl_add_u32 v134, v128, 7, v134
  v_add_u32 v134, s51, v134
  v_xor_b32 v135, 64, v134
  v_xor_b32 v131, 32, v130
  v_xor_b32 v132, 64, v130
  v_xor_b32 v133, 96, v130
  s_waitcnt lgkmcnt(0)
  s_barrier
  ds_read_b64 v[122:123], v115 offset:0
  ds_read_b64 v[124:125], v115 offset:512
  ds_read_b64 v[126:127], v115 offset:1024
  ds_read_b128 v[64:67], v113 offset:0
  ds_read_b128 v[68:71], v113 offset:1024
  ds_read_b128 v[72:75], v113 offset:2048
  ds_read_b128 v[76:79], v113 offset:3072
  ds_read_b128 v[80:83], v113 offset:4096
  ds_read_b128 v[84:87], v113 offset:5120
  ds_read_b128 v[88:91], v113 offset:6144
  ds_read_b128 v[92:95], v113 offset:7168
  ds_read_b128 v[96:99], v113 offset:8192
  ds_read_b128 v[100:103], v113 offset:9216
  ds_read_b128 v[104:107], v113 offset:10240
  ds_read_b128 v[108:111], v113 offset:11264
  s_waitcnt lgkmcnt(12)
  v_min_f32 v142, v116, v122
  v_min_f32 v143, v118, v124
  v_min_f32 v144, v120, v126
  v_sub_f32 v136, v142, v116
  v_sub_f32 v137, v143, v118
  v_sub_f32 v138, v144, v120
  v_sub_f32 v139, v142, v122
  v_sub_f32 v140, v143, v124
  v_sub_f32 v141, v144, v126
  v_exp_f32 v136, v136
  v_exp_f32 v137, v137
  v_exp_f32 v138, v138
  v_exp_f32 v139, v139
  v_exp_f32 v140, v140
  v_exp_f32 v141, v141
  v_mul_f32 v142, v117, v136
  v_mul_f32 v143, v119, v137
  v_mul_f32 v144, v121, v138
  v_fmac_f32 v142, v123, v139
  v_fmac_f32 v143, v125, v140
  v_fmac_f32 v144, v127, v141
  v_rcp_f32 v142, v142
  v_rcp_f32 v143, v143
  v_rcp_f32 v144, v144
  v_mul_f32 v136, v136, v142
  v_mul_f32 v137, v137, v143
  v_mul_f32 v138, v138, v144
  v_mul_f32 v139, v139, v142
  v_mul_f32 v140, v140, v143
  v_mul_f32 v141, v141, v144
  v_mul_f32 v160, v160, v136
  v_mul_f32 v161, v161, v136
  v_mul_f32 v162, v162, v136
  v_mul_f32 v163, v163, v136
  s_waitcnt lgkmcnt(11)
  v_fmac_f32 v160, v64, v139
  v_fmac_f32 v161, v65, v139
  v_fmac_f32 v162, v66, v139
  v_fmac_f32 v163, v67, v139
  v_cvt_pk_bf16_f32 v160, v160, v161
  v_cvt_pk_bf16_f32 v161, v162, v163
  ds_write_b64 v130, v[160:161] offset:0
  v_mul_f32 v164, v164, v137
  v_mul_f32 v165, v165, v137
  v_mul_f32 v166, v166, v137
  v_mul_f32 v167, v167, v137
  s_waitcnt lgkmcnt(11)
  v_fmac_f32 v164, v68, v140
  v_fmac_f32 v165, v69, v140
  v_fmac_f32 v166, v70, v140
  v_fmac_f32 v167, v71, v140
  v_cvt_pk_bf16_f32 v164, v164, v165
  v_cvt_pk_bf16_f32 v165, v166, v167
  ds_write_b64 v130, v[164:165] offset:2048
  v_mul_f32 v168, v168, v138
  v_mul_f32 v169, v169, v138
  v_mul_f32 v170, v170, v138
  v_mul_f32 v171, v171, v138
  s_waitcnt lgkmcnt(11)
  v_fmac_f32 v168, v72, v141
  v_fmac_f32 v169, v73, v141
  v_fmac_f32 v170, v74, v141
  v_fmac_f32 v171, v75, v141
  v_cvt_pk_bf16_f32 v168, v168, v169
  v_cvt_pk_bf16_f32 v169, v170, v171
  ds_write_b64 v130, v[168:169] offset:4096
  v_mul_f32 v172, v172, v136
  v_mul_f32 v173, v173, v136
  v_mul_f32 v174, v174, v136
  v_mul_f32 v175, v175, v136
  s_waitcnt lgkmcnt(11)
  v_fmac_f32 v172, v76, v139
  v_fmac_f32 v173, v77, v139
  v_fmac_f32 v174, v78, v139
  v_fmac_f32 v175, v79, v139
  v_cvt_pk_bf16_f32 v172, v172, v173
  v_cvt_pk_bf16_f32 v173, v174, v175
  ds_write_b64 v131, v[172:173] offset:0
  v_mul_f32 v176, v176, v137
  v_mul_f32 v177, v177, v137
  v_mul_f32 v178, v178, v137
  v_mul_f32 v179, v179, v137
  s_waitcnt lgkmcnt(11)
  v_fmac_f32 v176, v80, v140
  v_fmac_f32 v177, v81, v140
  v_fmac_f32 v178, v82, v140
  v_fmac_f32 v179, v83, v140
  v_cvt_pk_bf16_f32 v176, v176, v177
  v_cvt_pk_bf16_f32 v177, v178, v179
  ds_write_b64 v131, v[176:177] offset:2048
  v_mul_f32 v180, v180, v138
  v_mul_f32 v181, v181, v138
  v_mul_f32 v182, v182, v138
  v_mul_f32 v183, v183, v138
  s_waitcnt lgkmcnt(11)
  v_fmac_f32 v180, v84, v141
  v_fmac_f32 v181, v85, v141
  v_fmac_f32 v182, v86, v141
  v_fmac_f32 v183, v87, v141
  v_cvt_pk_bf16_f32 v180, v180, v181
  v_cvt_pk_bf16_f32 v181, v182, v183
  ds_write_b64 v131, v[180:181] offset:4096
  v_mul_f32 v184, v184, v136
  v_mul_f32 v185, v185, v136
  v_mul_f32 v186, v186, v136
  v_mul_f32 v187, v187, v136
  s_waitcnt lgkmcnt(11)
  v_fmac_f32 v184, v88, v139
  v_fmac_f32 v185, v89, v139
  v_fmac_f32 v186, v90, v139
  v_fmac_f32 v187, v91, v139
  v_cvt_pk_bf16_f32 v184, v184, v185
  v_cvt_pk_bf16_f32 v185, v186, v187
  ds_write_b64 v132, v[184:185] offset:0
  v_mul_f32 v188, v188, v137
  v_mul_f32 v189, v189, v137
  v_mul_f32 v190, v190, v137
  v_mul_f32 v191, v191, v137
  s_waitcnt lgkmcnt(11)
  v_fmac_f32 v188, v92, v140
  v_fmac_f32 v189, v93, v140
  v_fmac_f32 v190, v94, v140
  v_fmac_f32 v191, v95, v140
  v_cvt_pk_bf16_f32 v188, v188, v189
  v_cvt_pk_bf16_f32 v189, v190, v191
  ds_write_b64 v132, v[188:189] offset:2048
  v_mul_f32 v192, v192, v138
  v_mul_f32 v193, v193, v138
  v_mul_f32 v194, v194, v138
  v_mul_f32 v195, v195, v138
  s_waitcnt lgkmcnt(11)
  v_fmac_f32 v192, v96, v141
  v_fmac_f32 v193, v97, v141
  v_fmac_f32 v194, v98, v141
  v_fmac_f32 v195, v99, v141
  v_cvt_pk_bf16_f32 v192, v192, v193
  v_cvt_pk_bf16_f32 v193, v194, v195
  ds_write_b64 v132, v[192:193] offset:4096
  v_mul_f32 v196, v196, v136
  v_mul_f32 v197, v197, v136
  v_mul_f32 v198, v198, v136
  v_mul_f32 v199, v199, v136
  s_waitcnt lgkmcnt(11)
  v_fmac_f32 v196, v100, v139
  v_fmac_f32 v197, v101, v139
  v_fmac_f32 v198, v102, v139
  v_fmac_f32 v199, v103, v139
  v_cvt_pk_bf16_f32 v196, v196, v197
  v_cvt_pk_bf16_f32 v197, v198, v199
  ds_write_b64 v133, v[196:197] offset:0
  v_mul_f32 v200, v200, v137
  v_mul_f32 v201, v201, v137
  v_mul_f32 v202, v202, v137
  v_mul_f32 v203, v203, v137
  s_waitcnt lgkmcnt(11)
  v_fmac_f32 v200, v104, v140
  v_fmac_f32 v201, v105, v140
  v_fmac_f32 v202, v106, v140
  v_fmac_f32 v203, v107, v140
  v_cvt_pk_bf16_f32 v200, v200, v201
  v_cvt_pk_bf16_f32 v201, v202, v203
  ds_write_b64 v133, v[200:201] offset:2048
  v_mul_f32 v204, v204, v138
  v_mul_f32 v205, v205, v138
  v_mul_f32 v206, v206, v138
  v_mul_f32 v207, v207, v138
  s_waitcnt lgkmcnt(11)
  v_fmac_f32 v204, v108, v141
  v_fmac_f32 v205, v109, v141
  v_fmac_f32 v206, v110, v141
  v_fmac_f32 v207, v111, v141
  v_cvt_pk_bf16_f32 v204, v204, v205
  v_cvt_pk_bf16_f32 v205, v206, v207
  ds_write_b64 v133, v[204:205] offset:4096
  s_waitcnt lgkmcnt(0)
  s_barrier
  ds_read_b128 v[64:67], v134 offset:12288
  ds_read_b128 v[80:83], v134 offset:14336
  ds_read_b128 v[96:99], v134 offset:16384
  ds_read_b128 v[68:71], v135 offset:12288
  ds_read_b128 v[84:87], v135 offset:14336
  ds_read_b128 v[100:103], v135 offset:16384
  ds_read_b128 v[72:75], v134 offset:0
  ds_read_b128 v[88:91], v134 offset:2048
  ds_read_b128 v[104:107], v134 offset:4096
  ds_read_b128 v[76:79], v135 offset:0
  ds_read_b128 v[92:95], v135 offset:2048
  ds_read_b128 v[108:111], v135 offset:4096
  s_add_u32 s61, s41, 3
  s_and_b32 s61, s61, 7
  s_lshl_b32 s61, s61, 7
  s_add_u32 s61, s61, s37
  s_add_u32 m0, s34, 0x24000
  s_add_u32 s32, s61, 0x0
  buffer_load_dwordx4 v1, s[24:27], s32 offen offset:0 lds
  buffer_load_dwordx4 v2, s[24:27], s32 offen offset:1024 lds
  buffer_load_dwordx4 v3, s[24:27], s32 offen offset:2048 lds
  buffer_load_dwordx4 v4, s[24:27], s32 offen offset:3072 lds
  s_add_u32 m0, s34, 0x25000
  s_add_u32 s32, s61, 0x8000
  s_waitcnt lgkmcnt(0)
  v_mfma_f32_16x16x32_bf16 a[0:3], v[32:35], v[64:67], 0
  buffer_load_dwordx4 v1, s[24:27], s32 offen offset:0 lds
  buffer_load_dwordx4 v2, s[24:27], s32 offen offset:1024 lds
  v_mfma_f32_16x16x32_bf16 a[4:7], v[32:35], v[80:83], 0
  buffer_load_dwordx4 v3, s[24:27], s32 offen offset:2048 lds
  buffer_load_dwordx4 v4, s[24:27], s32 offen offset:3072 lds
  v_mfma_f32_16x16x32_bf16 a[8:11], v[32:35], v[96:99], 0
  v_mfma_f32_16x16x32_bf16 a[12:15], v[36:39], v[64:67], 0
  v_mfma_f32_16x16x32_bf16 a[16:19], v[36:39], v[80:83], 0
  v_mfma_f32_16x16x32_bf16 a[20:23], v[36:39], v[96:99], 0
  v_mfma_f32_16x16x32_bf16 a[0:3], v[40:43], v[68:71], a[0:3]
  v_mfma_f32_16x16x32_bf16 a[4:7], v[40:43], v[84:87], a[4:7]
  v_mfma_f32_16x16x32_bf16 a[8:11], v[40:43], v[100:103], a[8:11]
  v_mfma_f32_16x16x32_bf16 a[12:15], v[44:47], v[68:71], a[12:15]
  v_mfma_f32_16x16x32_bf16 a[16:19], v[44:47], v[84:87], a[16:19]
  v_mfma_f32_16x16x32_bf16 a[20:23], v[44:47], v[100:103], a[20:23]
  v_mfma_f32_16x16x32_bf16 a[0:3], v[48:51], v[72:75], a[0:3]
  s_waitcnt vmcnt(16)
  s_barrier
  ds_read_b64_tr_b16 v[32:33], v20 offset:16384
  ds_read_b64_tr_b16 v[34:35], v20 offset:16896
  v_mfma_f32_16x16x32_bf16 a[4:7], v[48:51], v[88:91], a[4:7]
  ds_read_b64_tr_b16 v[36:37], v21 offset:16384
  ds_read_b64_tr_b16 v[38:39], v21 offset:16896
  v_mfma_f32_16x16x32_bf16 a[8:11], v[48:51], v[104:107], a[8:11]
  ds_read_b64_tr_b16 v[40:41], v20 offset:20480
  ds_read_b64_tr_b16 v[42:43], v20 offset:20992
  v_mfma_f32_16x16x32_bf16 a[12:15], v[52:55], v[72:75], a[12:15]
  ds_read_b64_tr_b16 v[44:45], v21 offset:20480
  ds_read_b64_tr_b16 v[46:47], v21 offset:20992
  v_mfma_f32_16x16x32_bf16 a[16:19], v[52:55], v[88:91], a[16:19]
  ds_read_b64_tr_b16 v[48:49], v20 offset:24576
  ds_read_b64_tr_b16 v[50:51], v20 offset:25088
  v_mfma_f32_16x16x32_bf16 a[20:23], v[52:55], v[104:107], a[20:23]
  ds_read_b64_tr_b16 v[52:53], v21 offset:24576
  ds_read_b64_tr_b16 v[54:55], v21 offset:25088
  v_mfma_f32_16x16x32_bf16 a[0:3], v[56:59], v[76:79], a[0:3]
  s_add_u32 s61, s41, 4
  s_and_b32 s61, s61, 7
  v_mfma_f32_16x16x32_bf16 a[4:7], v[56:59], v[92:95], a[4:7]
  s_lshl_b32 s61, s61, 7
  s_add_u32 s61, s61, s37
  v_mfma_f32_16x16x32_bf16 a[8:11], v[56:59], v[108:111], a[8:11]
  ds_read_b64_tr_b16 v[56:57], v20 offset:28672
  ds_read_b64_tr_b16 v[58:59], v20 offset:29184
  v_mfma_f32_16x16x32_bf16 a[12:15], v[60:63], v[76:79], a[12:15]
  s_add_u32 m0, s34, 0x18000
  s_add_u32 s32, s61, 0x0
  v_mfma_f32_16x16x32_bf16 a[16:19], v[60:63], v[92:95], a[16:19]
  buffer_load_dwordx4 v1, s[24:27], s32 offen offset:0 lds
  buffer_load_dwordx4 v2, s[24:27], s32 offen offset:1024 lds
  v_mfma_f32_16x16x32_bf16 a[20:23], v[60:63], v[108:111], a[20:23]
  ds_read_b64_tr_b16 v[60:61], v21 offset:28672
  ds_read_b64_tr_b16 v[62:63], v21 offset:29184
  s_waitcnt lgkmcnt(12)
  v_mfma_f32_16x16x32_bf16 a[24:27], v[32:35], v[64:67], 0
  buffer_load_dwordx4 v3, s[24:27], s32 offen offset:2048 lds
  buffer_load_dwordx4 v4, s[24:27], s32 offen offset:3072 lds
  v_mfma_f32_16x16x32_bf16 a[28:31], v[32:35], v[80:83], 0
  s_add_u32 m0, s34, 0x19000
  s_add_u32 s32, s61, 0x8000
  v_mfma_f32_16x16x32_bf16 a[32:35], v[32:35], v[96:99], 0
  buffer_load_dwordx4 v1, s[24:27], s32 offen offset:0 lds
  buffer_load_dwordx4 v2, s[24:27], s32 offen offset:1024 lds
  v_mfma_f32_16x16x32_bf16 a[36:39], v[36:39], v[64:67], 0
  buffer_load_dwordx4 v3, s[24:27], s32 offen offset:2048 lds
  buffer_load_dwordx4 v4, s[24:27], s32 offen offset:3072 lds
  v_mfma_f32_16x16x32_bf16 a[40:43], v[36:39], v[80:83], 0
  v_mfma_f32_16x16x32_bf16 a[44:47], v[36:39], v[96:99], 0
  s_waitcnt lgkmcnt(8)
  v_mfma_f32_16x16x32_bf16 a[24:27], v[40:43], v[68:71], a[24:27]
  v_mfma_f32_16x16x32_bf16 a[28:31], v[40:43], v[84:87], a[28:31]
  v_mfma_f32_16x16x32_bf16 a[32:35], v[40:43], v[100:103], a[32:35]
  v_mfma_f32_16x16x32_bf16 a[36:39], v[44:47], v[68:71], a[36:39]
  v_mfma_f32_16x16x32_bf16 a[40:43], v[44:47], v[84:87], a[40:43]
  v_mfma_f32_16x16x32_bf16 a[44:47], v[44:47], v[100:103], a[44:47]
  s_waitcnt lgkmcnt(0)
  v_mfma_f32_16x16x32_bf16 a[24:27], v[48:51], v[72:75], a[24:27]
  s_waitcnt vmcnt(16)
  s_barrier
  ds_read_b64_tr_b16 v[32:33], v20 offset:32768
  ds_read_b64_tr_b16 v[34:35], v20 offset:33280
  v_mfma_f32_16x16x32_bf16 a[28:31], v[48:51], v[88:91], a[28:31]
  ds_read_b64_tr_b16 v[36:37], v21 offset:32768
  ds_read_b64_tr_b16 v[38:39], v21 offset:33280
  v_mfma_f32_16x16x32_bf16 a[32:35], v[48:51], v[104:107], a[32:35]
  ds_read_b64_tr_b16 v[40:41], v20 offset:36864
  ds_read_b64_tr_b16 v[42:43], v20 offset:37376
  v_mfma_f32_16x16x32_bf16 a[36:39], v[52:55], v[72:75], a[36:39]
  ds_read_b64_tr_b16 v[44:45], v21 offset:36864
  ds_read_b64_tr_b16 v[46:47], v21 offset:37376
  v_mfma_f32_16x16x32_bf16 a[40:43], v[52:55], v[88:91], a[40:43]
  ds_read_b64_tr_b16 v[48:49], v20 offset:40960
  ds_read_b64_tr_b16 v[50:51], v20 offset:41472
  v_mfma_f32_16x16x32_bf16 a[44:47], v[52:55], v[104:107], a[44:47]
  ds_read_b64_tr_b16 v[52:53], v21 offset:40960
  ds_read_b64_tr_b16 v[54:55], v21 offset:41472
  v_mfma_f32_16x16x32_bf16 a[24:27], v[56:59], v[76:79], a[24:27]
  s_add_u32 s61, s41, 5
  s_and_b32 s61, s61, 7
  v_mfma_f32_16x16x32_bf16 a[28:31], v[56:59], v[92:95], a[28:31]
  s_lshl_b32 s61, s61, 7
  s_add_u32 s61, s61, s37
  v_mfma_f32_16x16x32_bf16 a[32:35], v[56:59], v[108:111], a[32:35]
  ds_read_b64_tr_b16 v[56:57], v20 offset:45056
  ds_read_b64_tr_b16 v[58:59], v20 offset:45568
  v_mfma_f32_16x16x32_bf16 a[36:39], v[60:63], v[76:79], a[36:39]
  s_add_u32 m0, s34, 0x1c000
  s_add_u32 s32, s61, 0x0
  v_mfma_f32_16x16x32_bf16 a[40:43], v[60:63], v[92:95], a[40:43]
  buffer_load_dwordx4 v1, s[24:27], s32 offen offset:0 lds
  buffer_load_dwordx4 v2, s[24:27], s32 offen offset:1024 lds
  v_mfma_f32_16x16x32_bf16 a[44:47], v[60:63], v[108:111], a[44:47]
  ds_read_b64_tr_b16 v[60:61], v21 offset:45056
  ds_read_b64_tr_b16 v[62:63], v21 offset:45568
  s_waitcnt lgkmcnt(12)
  v_mfma_f32_16x16x32_bf16 a[48:51], v[32:35], v[64:67], 0
  buffer_load_dwordx4 v3, s[24:27], s32 offen offset:2048 lds
  buffer_load_dwordx4 v4, s[24:27], s32 offen offset:3072 lds
  v_mfma_f32_16x16x32_bf16 a[52:55], v[32:35], v[80:83], 0
  s_add_u32 m0, s34, 0x1d000
  s_add_u32 s32, s61, 0x8000
  v_mfma_f32_16x16x32_bf16 a[56:59], v[32:35], v[96:99], 0
  buffer_load_dwordx4 v1, s[24:27], s32 offen offset:0 lds
  buffer_load_dwordx4 v2, s[24:27], s32 offen offset:1024 lds
  v_mfma_f32_16x16x32_bf16 a[60:63], v[36:39], v[64:67], 0
  buffer_load_dwordx4 v3, s[24:27], s32 offen offset:2048 lds
  buffer_load_dwordx4 v4, s[24:27], s32 offen offset:3072 lds
  v_mfma_f32_16x16x32_bf16 a[64:67], v[36:39], v[80:83], 0
  v_mfma_f32_16x16x32_bf16 a[68:71], v[36:39], v[96:99], 0
  s_waitcnt lgkmcnt(8)
  v_mfma_f32_16x16x32_bf16 a[48:51], v[40:43], v[68:71], a[48:51]
  v_mfma_f32_16x16x32_bf16 a[52:55], v[40:43], v[84:87], a[52:55]
  v_mfma_f32_16x16x32_bf16 a[56:59], v[40:43], v[100:103], a[56:59]
  v_mfma_f32_16x16x32_bf16 a[60:63], v[44:47], v[68:71], a[60:63]
  v_mfma_f32_16x16x32_bf16 a[64:67], v[44:47], v[84:87], a[64:67]
  v_mfma_f32_16x16x32_bf16 a[68:71], v[44:47], v[100:103], a[68:71]
  s_waitcnt lgkmcnt(0)
  v_mfma_f32_16x16x32_bf16 a[48:51], v[48:51], v[72:75], a[48:51]
  s_waitcnt vmcnt(16)
  s_barrier
  ds_read_b64_tr_b16 v[32:33], v20 offset:49152
  ds_read_b64_tr_b16 v[34:35], v20 offset:49664
  v_mfma_f32_16x16x32_bf16 a[52:55], v[48:51], v[88:91], a[52:55]
  ds_read_b64_tr_b16 v[36:37], v21 offset:49152
  ds_read_b64_tr_b16 v[38:39], v21 offset:49664
  v_mfma_f32_16x16x32_bf16 a[56:59], v[48:51], v[104:107], a[56:59]
  ds_read_b64_tr_b16 v[40:41], v20 offset:53248
  ds_read_b64_tr_b16 v[42:43], v20 offset:53760
  v_mfma_f32_16x16x32_bf16 a[60:63], v[52:55], v[72:75], a[60:63]
  ds_read_b64_tr_b16 v[44:45], v21 offset:53248
  ds_read_b64_tr_b16 v[46:47], v21 offset:53760
  v_mfma_f32_16x16x32_bf16 a[64:67], v[52:55], v[88:91], a[64:67]
  ds_read_b64_tr_b16 v[48:49], v20 offset:57344
  ds_read_b64_tr_b16 v[50:51], v20 offset:57856
  v_mfma_f32_16x16x32_bf16 a[68:71], v[52:55], v[104:107], a[68:71]
  ds_read_b64_tr_b16 v[52:53], v21 offset:57344
  ds_read_b64_tr_b16 v[54:55], v21 offset:57856
  v_mfma_f32_16x16x32_bf16 a[48:51], v[56:59], v[76:79], a[48:51]
  s_add_u32 s61, s41, 6
  s_and_b32 s61, s61, 7
  v_mfma_f32_16x16x32_bf16 a[52:55], v[56:59], v[92:95], a[52:55]
  s_lshl_b32 s61, s61, 7
  s_add_u32 s61, s61, s37
  v_mfma_f32_16x16x32_bf16 a[56:59], v[56:59], v[108:111], a[56:59]
  ds_read_b64_tr_b16 v[56:57], v20 offset:61440
  ds_read_b64_tr_b16 v[58:59], v20 offset:61952
  v_mfma_f32_16x16x32_bf16 a[60:63], v[60:63], v[76:79], a[60:63]
  s_add_u32 m0, s34, 0x20000
  s_add_u32 s32, s61, 0x0
  v_mfma_f32_16x16x32_bf16 a[64:67], v[60:63], v[92:95], a[64:67]
  buffer_load_dwordx4 v1, s[24:27], s32 offen offset:0 lds
  buffer_load_dwordx4 v2, s[24:27], s32 offen offset:1024 lds
  v_mfma_f32_16x16x32_bf16 a[68:71], v[60:63], v[108:111], a[68:71]
  ds_read_b64_tr_b16 v[60:61], v21 offset:61440
  ds_read_b64_tr_b16 v[62:63], v21 offset:61952
  s_waitcnt lgkmcnt(12)
  v_mfma_f32_16x16x32_bf16 a[72:75], v[32:35], v[64:67], 0
  buffer_load_dwordx4 v3, s[24:27], s32 offen offset:2048 lds
  buffer_load_dwordx4 v4, s[24:27], s32 offen offset:3072 lds
  v_mfma_f32_16x16x32_bf16 a[76:79], v[32:35], v[80:83], 0
  s_add_u32 m0, s34, 0x21000
  s_add_u32 s32, s61, 0x8000
  v_mfma_f32_16x16x32_bf16 a[80:83], v[32:35], v[96:99], 0
  buffer_load_dwordx4 v1, s[24:27], s32 offen offset:0 lds
  buffer_load_dwordx4 v2, s[24:27], s32 offen offset:1024 lds
  v_mfma_f32_16x16x32_bf16 a[84:87], v[36:39], v[64:67], 0
  buffer_load_dwordx4 v3, s[24:27], s32 offen offset:2048 lds
  buffer_load_dwordx4 v4, s[24:27], s32 offen offset:3072 lds
  v_mfma_f32_16x16x32_bf16 a[88:91], v[36:39], v[80:83], 0
  v_mfma_f32_16x16x32_bf16 a[92:95], v[36:39], v[96:99], 0
  s_waitcnt lgkmcnt(8)
  v_mfma_f32_16x16x32_bf16 a[72:75], v[40:43], v[68:71], a[72:75]
  v_mfma_f32_16x16x32_bf16 a[76:79], v[40:43], v[84:87], a[76:79]
  v_mfma_f32_16x16x32_bf16 a[80:83], v[40:43], v[100:103], a[80:83]
  v_mfma_f32_16x16x32_bf16 a[84:87], v[44:47], v[68:71], a[84:87]
  v_mfma_f32_16x16x32_bf16 a[88:91], v[44:47], v[84:87], a[88:91]
  v_mfma_f32_16x16x32_bf16 a[92:95], v[44:47], v[100:103], a[92:95]
  s_waitcnt lgkmcnt(0)
  v_mfma_f32_16x16x32_bf16 a[72:75], v[48:51], v[72:75], a[72:75]
  s_waitcnt vmcnt(16)
  s_barrier
  ds_read_b64_tr_b16 v[32:33], v20 offset:0
  ds_read_b64_tr_b16 v[34:35], v20 offset:512
  v_mfma_f32_16x16x32_bf16 a[76:79], v[48:51], v[88:91], a[76:79]
  ds_read_b64_tr_b16 v[36:37], v21 offset:0
  ds_read_b64_tr_b16 v[38:39], v21 offset:512
  v_mfma_f32_16x16x32_bf16 a[80:83], v[48:51], v[104:107], a[80:83]
  ds_read_b64_tr_b16 v[40:41], v20 offset:4096
  ds_read_b64_tr_b16 v[42:43], v20 offset:4608
  v_mfma_f32_16x16x32_bf16 a[84:87], v[52:55], v[72:75], a[84:87]
  ds_read_b64_tr_b16 v[44:45], v21 offset:4096
  ds_read_b64_tr_b16 v[46:47], v21 offset:4608
  v_mfma_f32_16x16x32_bf16 a[88:91], v[52:55], v[88:91], a[88:91]
  ds_read_b64_tr_b16 v[48:49], v20 offset:8192
  ds_read_b64_tr_b16 v[50:51], v20 offset:8704
  v_mfma_f32_16x16x32_bf16 a[92:95], v[52:55], v[104:107], a[92:95]
  ds_read_b64_tr_b16 v[52:53], v21 offset:8192
  ds_read_b64_tr_b16 v[54:55], v21 offset:8704
  v_mfma_f32_16x16x32_bf16 a[72:75], v[56:59], v[76:79], a[72:75]
  s_add_u32 s61, s41, 7
  s_and_b32 s61, s61, 7
  v_mfma_f32_16x16x32_bf16 a[76:79], v[56:59], v[92:95], a[76:79]
  s_lshl_b32 s61, s61, 7
  s_add_u32 s61, s61, s37
  v_mfma_f32_16x16x32_bf16 a[80:83], v[56:59], v[108:111], a[80:83]
  ds_read_b64_tr_b16 v[56:57], v20 offset:12288
  ds_read_b64_tr_b16 v[58:59], v20 offset:12800
  v_mfma_f32_16x16x32_bf16 a[84:87], v[60:63], v[76:79], a[84:87]
  s_add_u32 m0, s34, 0x24000
  s_add_u32 s32, s61, 0x0
  v_mfma_f32_16x16x32_bf16 a[88:91], v[60:63], v[92:95], a[88:91]
  buffer_load_dwordx4 v1, s[24:27], s32 offen offset:0 lds
  buffer_load_dwordx4 v2, s[24:27], s32 offen offset:1024 lds
  v_mfma_f32_16x16x32_bf16 a[92:95], v[60:63], v[108:111], a[92:95]
  ds_read_b64_tr_b16 v[60:61], v21 offset:12288
  ds_read_b64_tr_b16 v[62:63], v21 offset:12800
  s_waitcnt lgkmcnt(12)
  v_mfma_f32_16x16x32_bf16 a[96:99], v[32:35], v[64:67], 0
  buffer_load_dwordx4 v3, s[24:27], s32 offen offset:2048 lds
  buffer_load_dwordx4 v4, s[24:27], s32 offen offset:3072 lds
  v_mfma_f32_16x16x32_bf16 a[100:103], v[32:35], v[80:83], 0
  s_add_u32 m0, s34, 0x25000
  s_add_u32 s32, s61, 0x8000
  v_mfma_f32_16x16x32_bf16 a[104:107], v[32:35], v[96:99], 0
  buffer_load_dwordx4 v1, s[24:27], s32 offen offset:0 lds
  buffer_load_dwordx4 v2, s[24:27], s32 offen offset:1024 lds
  v_mfma_f32_16x16x32_bf16 a[108:111], v[36:39], v[64:67], 0
  buffer_load_dwordx4 v3, s[24:27], s32 offen offset:2048 lds
  buffer_load_dwordx4 v4, s[24:27], s32 offen offset:3072 lds
  v_mfma_f32_16x16x32_bf16 a[112:115], v[36:39], v[80:83], 0
  v_mfma_f32_16x16x32_bf16 a[116:119], v[36:39], v[96:99], 0
  s_waitcnt lgkmcnt(8)
  v_mfma_f32_16x16x32_bf16 a[96:99], v[40:43], v[68:71], a[96:99]
  v_mfma_f32_16x16x32_bf16 a[100:103], v[40:43], v[84:87], a[100:103]
  v_mfma_f32_16x16x32_bf16 a[104:107], v[40:43], v[100:103], a[104:107]
  v_mfma_f32_16x16x32_bf16 a[108:111], v[44:47], v[68:71], a[108:111]
  v_mfma_f32_16x16x32_bf16 a[112:115], v[44:47], v[84:87], a[112:115]
  v_mfma_f32_16x16x32_bf16 a[116:119], v[44:47], v[100:103], a[116:119]
  s_waitcnt lgkmcnt(0)
  v_mfma_f32_16x16x32_bf16 a[96:99], v[48:51], v[72:75], a[96:99]
  s_waitcnt vmcnt(16)
  s_barrier
  ds_read_b64_tr_b16 v[32:33], v20 offset:16384
  ds_read_b64_tr_b16 v[34:35], v20 offset:16896
  v_mfma_f32_16x16x32_bf16 a[100:103], v[48:51], v[88:91], a[100:103]
  ds_read_b64_tr_b16 v[36:37], v21 offset:16384
  ds_read_b64_tr_b16 v[38:39], v21 offset:16896
  v_mfma_f32_16x16x32_bf16 a[104:107], v[48:51], v[104:107], a[104:107]
  ds_read_b64_tr_b16 v[40:41], v20 offset:20480
  ds_read_b64_tr_b16 v[42:43], v20 offset:20992
  v_mfma_f32_16x16x32_bf16 a[108:111], v[52:55], v[72:75], a[108:111]
  ds_read_b64_tr_b16 v[44:45], v21 offset:20480
  ds_read_b64_tr_b16 v[46:47], v21 offset:20992
  v_mfma_f32_16x16x32_bf16 a[112:115], v[52:55], v[88:91], a[112:115]
  ds_read_b64_tr_b16 v[48:49], v20 offset:24576
  ds_read_b64_tr_b16 v[50:51], v20 offset:25088
  v_mfma_f32_16x16x32_bf16 a[116:119], v[52:55], v[104:107], a[116:119]
  ds_read_b64_tr_b16 v[52:53], v21 offset:24576
  ds_read_b64_tr_b16 v[54:55], v21 offset:25088
  v_mfma_f32_16x16x32_bf16 a[96:99], v[56:59], v[76:79], a[96:99]
  v_mfma_f32_16x16x32_bf16 a[100:103], v[56:59], v[92:95], a[100:103]
  v_mfma_f32_16x16x32_bf16 a[104:107], v[56:59], v[108:111], a[104:107]
  ds_read_b64_tr_b16 v[56:57], v20 offset:28672
  ds_read_b64_tr_b16 v[58:59], v20 offset:29184
  v_mfma_f32_16x16x32_bf16 a[108:111], v[60:63], v[76:79], a[108:111]
  v_mfma_f32_16x16x32_bf16 a[112:115], v[60:63], v[92:95], a[112:115]
  v_mfma_f32_16x16x32_bf16 a[116:119], v[60:63], v[108:111], a[116:119]
  ds_read_b64_tr_b16 v[60:61], v21 offset:28672
  ds_read_b64_tr_b16 v[62:63], v21 offset:29184
  s_waitcnt lgkmcnt(12)
  v_mfma_f32_16x16x32_bf16 a[120:123], v[32:35], v[64:67], 0
  v_mfma_f32_16x16x32_bf16 a[124:127], v[32:35], v[80:83], 0
  v_mfma_f32_16x16x32_bf16 a[128:131], v[32:35], v[96:99], 0
  v_mfma_f32_16x16x32_bf16 a[132:135], v[36:39], v[64:67], 0
  v_mfma_f32_16x16x32_bf16 a[136:139], v[36:39], v[80:83], 0
  v_mfma_f32_16x16x32_bf16 a[140:143], v[36:39], v[96:99], 0
  s_waitcnt lgkmcnt(8)
  v_mfma_f32_16x16x32_bf16 a[120:123], v[40:43], v[68:71], a[120:123]
  v_mfma_f32_16x16x32_bf16 a[124:127], v[40:43], v[84:87], a[124:127]
  v_mfma_f32_16x16x32_bf16 a[128:131], v[40:43], v[100:103], a[128:131]
  v_mfma_f32_16x16x32_bf16 a[132:135], v[44:47], v[68:71], a[132:135]
  v_mfma_f32_16x16x32_bf16 a[136:139], v[44:47], v[84:87], a[136:139]
  v_mfma_f32_16x16x32_bf16 a[140:143], v[44:47], v[100:103], a[140:143]
  s_waitcnt lgkmcnt(0)
  v_mfma_f32_16x16x32_bf16 a[120:123], v[48:51], v[72:75], a[120:123]
  s_waitcnt vmcnt(8)
  s_barrier
  ds_read_b64_tr_b16 v[32:33], v20 offset:32768
  ds_read_b64_tr_b16 v[34:35], v20 offset:33280
  v_mfma_f32_16x16x32_bf16 a[124:127], v[48:51], v[88:91], a[124:127]
  ds_read_b64_tr_b16 v[36:37], v21 offset:32768
  ds_read_b64_tr_b16 v[38:39], v21 offset:33280
  v_mfma_f32_16x16x32_bf16 a[128:131], v[48:51], v[104:107], a[128:131]
  ds_read_b64_tr_b16 v[40:41], v20 offset:36864
  ds_read_b64_tr_b16 v[42:43], v20 offset:37376
  v_mfma_f32_16x16x32_bf16 a[132:135], v[52:55], v[72:75], a[132:135]
  ds_read_b64_tr_b16 v[44:45], v21 offset:36864
  ds_read_b64_tr_b16 v[46:47], v21 offset:37376
  v_mfma_f32_16x16x32_bf16 a[136:139], v[52:55], v[88:91], a[136:139]
  ds_read_b64_tr_b16 v[48:49], v20 offset:40960
  ds_read_b64_tr_b16 v[50:51], v20 offset:41472
  v_mfma_f32_16x16x32_bf16 a[140:143], v[52:55], v[104:107], a[140:143]
  ds_read_b64_tr_b16 v[52:53], v21 offset:40960
  ds_read_b64_tr_b16 v[54:55], v21 offset:41472
  v_mfma_f32_16x16x32_bf16 a[120:123], v[56:59], v[76:79], a[120:123]
  v_mfma_f32_16x16x32_bf16 a[124:127], v[56:59], v[92:95], a[124:127]
  v_mfma_f32_16x16x32_bf16 a[128:131], v[56:59], v[108:111], a[128:131]
  ds_read_b64_tr_b16 v[56:57], v20 offset:45056
  ds_read_b64_tr_b16 v[58:59], v20 offset:45568
  v_mfma_f32_16x16x32_bf16 a[132:135], v[60:63], v[76:79], a[132:135]
  v_mfma_f32_16x16x32_bf16 a[136:139], v[60:63], v[92:95], a[136:139]
  v_mfma_f32_16x16x32_bf16 a[140:143], v[60:63], v[108:111], a[140:143]
  ds_read_b64_tr_b16 v[60:61], v21 offset:45056
  ds_read_b64_tr_b16 v[62:63], v21 offset:45568
  s_waitcnt lgkmcnt(12)
  v_mfma_f32_16x16x32_bf16 a[144:147], v[32:35], v[64:67], 0
  v_mfma_f32_16x16x32_bf16 a[148:151], v[32:35], v[80:83], 0
  v_mfma_f32_16x16x32_bf16 a[152:155], v[32:35], v[96:99], 0
  v_mfma_f32_16x16x32_bf16 a[156:159], v[36:39], v[64:67], 0
  v_mfma_f32_16x16x32_bf16 a[160:163], v[36:39], v[80:83], 0
  v_mfma_f32_16x16x32_bf16 a[164:167], v[36:39], v[96:99], 0
  s_waitcnt lgkmcnt(8)
  v_mfma_f32_16x16x32_bf16 a[144:147], v[40:43], v[68:71], a[144:147]
  v_mfma_f32_16x16x32_bf16 a[148:151], v[40:43], v[84:87], a[148:151]
  v_mfma_f32_16x16x32_bf16 a[152:155], v[40:43], v[100:103], a[152:155]
  v_mfma_f32_16x16x32_bf16 a[156:159], v[44:47], v[68:71], a[156:159]
  v_mfma_f32_16x16x32_bf16 a[160:163], v[44:47], v[84:87], a[160:163]
  v_mfma_f32_16x16x32_bf16 a[164:167], v[44:47], v[100:103], a[164:167]
  s_waitcnt lgkmcnt(0)
  v_mfma_f32_16x16x32_bf16 a[144:147], v[48:51], v[72:75], a[144:147]
  s_waitcnt vmcnt(0)
  s_barrier
  ds_read_b64_tr_b16 v[32:33], v20 offset:49152
  ds_read_b64_tr_b16 v[34:35], v20 offset:49664
  v_mfma_f32_16x16x32_bf16 a[148:151], v[48:51], v[88:91], a[148:151]
  ds_read_b64_tr_b16 v[36:37], v21 offset:49152
  ds_read_b64_tr_b16 v[38:39], v21 offset:49664
  v_mfma_f32_16x16x32_bf16 a[152:155], v[48:51], v[104:107], a[152:155]
  ds_read_b64_tr_b16 v[40:41], v20 offset:53248
  ds_read_b64_tr_b16 v[42:43], v20 offset:53760
  v_mfma_f32_16x16x32_bf16 a[156:159], v[52:55], v[72:75], a[156:159]
  ds_read_b64_tr_b16 v[44:45], v21 offset:53248
  ds_read_b64_tr_b16 v[46:47], v21 offset:53760
  v_mfma_f32_16x16x32_bf16 a[160:163], v[52:55], v[88:91], a[160:163]
  ds_read_b64_tr_b16 v[48:49], v20 offset:57344
  ds_read_b64_tr_b16 v[50:51], v20 offset:57856
  v_mfma_f32_16x16x32_bf16 a[164:167], v[52:55], v[104:107], a[164:167]
  ds_read_b64_tr_b16 v[52:53], v21 offset:57344
  ds_read_b64_tr_b16 v[54:55], v21 offset:57856
  v_mfma_f32_16x16x32_bf16 a[144:147], v[56:59], v[76:79], a[144:147]
  v_mfma_f32_16x16x32_bf16 a[148:151], v[56:59], v[92:95], a[148:151]
  v_mfma_f32_16x16x32_bf16 a[152:155], v[56:59], v[108:111], a[152:155]
  ds_read_b64_tr_b16 v[56:57], v20 offset:61440
  ds_read_b64_tr_b16 v[58:59], v20 offset:61952
  v_mfma_f32_16x16x32_bf16 a[156:159], v[60:63], v[76:79], a[156:159]
  v_mfma_f32_16x16x32_bf16 a[160:163], v[60:63], v[92:95], a[160:163]
  v_mfma_f32_16x16x32_bf16 a[164:167], v[60:63], v[108:111], a[164:167]
  ds_read_b64_tr_b16 v[60:61], v21 offset:61440
  ds_read_b64_tr_b16 v[62:63], v21 offset:61952
  s_waitcnt lgkmcnt(12)
  v_mfma_f32_16x16x32_bf16 a[168:171], v[32:35], v[64:67], 0
  v_mfma_f32_16x16x32_bf16 a[172:175], v[32:35], v[80:83], 0
  v_mfma_f32_16x16x32_bf16 a[176:179], v[32:35], v[96:99], 0
  v_mfma_f32_16x16x32_bf16 a[180:183], v[36:39], v[64:67], 0
  v_mfma_f32_16x16x32_bf16 a[184:187], v[36:39], v[80:83], 0
  v_mfma_f32_16x16x32_bf16 a[188:191], v[36:39], v[96:99], 0
  s_waitcnt lgkmcnt(8)
  v_mfma_f32_16x16x32_bf16 a[168:171], v[40:43], v[68:71], a[168:171]
  v_mfma_f32_16x16x32_bf16 a[172:175], v[40:43], v[84:87], a[172:175]
  v_mfma_f32_16x16x32_bf16 a[176:179], v[40:43], v[100:103], a[176:179]
  v_mfma_f32_16x16x32_bf16 a[180:183], v[44:47], v[68:71], a[180:183]
  v_mfma_f32_16x16x32_bf16 a[184:187], v[44:47], v[84:87], a[184:187]
  v_mfma_f32_16x16x32_bf16 a[188:191], v[44:47], v[100:103], a[188:191]
  s_waitcnt lgkmcnt(0)
  v_mfma_f32_16x16x32_bf16 a[168:171], v[48:51], v[72:75], a[168:171]
  s_barrier
  v_add_u32 v8, 0x10000, v8
  ds_read_b128 v[32:35], v8 offset:0
  ds_read_b128 v[36:39], v8 offset:4096
  v_mfma_f32_16x16x32_bf16 a[172:175], v[48:51], v[88:91], a[172:175]
  v_add_u32 v9, 0x10000, v9
  ds_read_b128 v[40:43], v9 offset:0
  ds_read_b128 v[44:47], v9 offset:4096
  v_mfma_f32_16x16x32_bf16 a[176:179], v[48:51], v[104:107], a[176:179]
  v_add_u32 v10, 0x10000, v10
  ds_read_b128 v[48:51], v10 offset:0
  v_mfma_f32_16x16x32_bf16 a[180:183], v[52:55], v[72:75], a[180:183]
  v_mfma_f32_16x16x32_bf16 a[184:187], v[52:55], v[88:91], a[184:187]
  v_mfma_f32_16x16x32_bf16 a[188:191], v[52:55], v[104:107], a[188:191]
  ds_read_b128 v[52:55], v10 offset:4096
  v_mfma_f32_16x16x32_bf16 a[168:171], v[56:59], v[76:79], a[168:171]
  v_mfma_f32_16x16x32_bf16 a[172:175], v[56:59], v[92:95], a[172:175]
  v_mfma_f32_16x16x32_bf16 a[176:179], v[56:59], v[108:111], a[176:179]
  v_add_u32 v11, 0x10000, v11
  ds_read_b128 v[56:59], v11 offset:0
  v_mfma_f32_16x16x32_bf16 a[180:183], v[60:63], v[76:79], a[180:183]
  v_mfma_f32_16x16x32_bf16 a[184:187], v[60:63], v[92:95], a[184:187]
  v_mfma_f32_16x16x32_bf16 a[188:191], v[60:63], v[108:111], a[188:191]
  ds_read_b128 v[60:63], v11 offset:4096
  s_waitcnt lgkmcnt(6)
  v_mfma_f32_16x16x32_bf16 v[64:67], v[32:35], a[192:195], 0
  v_mfma_f32_16x16x32_bf16 v[72:75], v[32:35], a[208:211], 0
  v_mfma_f32_16x16x32_bf16 v[80:83], v[32:35], a[224:227], 0
  v_mfma_f32_16x16x32_bf16 v[68:71], v[36:39], a[192:195], 0
  v_mfma_f32_16x16x32_bf16 v[76:79], v[36:39], a[208:211], 0
  v_mfma_f32_16x16x32_bf16 v[84:87], v[36:39], a[224:227], 0
  s_waitcnt lgkmcnt(4)
  v_mfma_f32_16x16x32_bf16 v[64:67], v[40:43], a[196:199], v[64:67]
  v_mfma_f32_16x16x32_bf16 v[72:75], v[40:43], a[212:215], v[72:75]
  v_mfma_f32_16x16x32_bf16 v[80:83], v[40:43], a[228:231], v[80:83]
  v_mfma_f32_16x16x32_bf16 v[68:71], v[44:47], a[196:199], v[68:71]
  v_mfma_f32_16x16x32_bf16 v[76:79], v[44:47], a[212:215], v[76:79]
  v_mfma_f32_16x16x32_bf16 v[84:87], v[44:47], a[228:231], v[84:87]
  s_waitcnt lgkmcnt(0)
  v_mfma_f32_16x16x32_bf16 v[64:67], v[48:51], a[200:203], v[64:67]
  s_barrier
  ds_read_b128 v[32:35], v8 offset:16384
  ds_read_b128 v[36:39], v8 offset:20480
  v_mfma_f32_16x16x32_bf16 v[72:75], v[48:51], a[216:219], v[72:75]
  ds_read_b128 v[40:43], v9 offset:16384
  ds_read_b128 v[44:47], v9 offset:20480
  v_mfma_f32_16x16x32_bf16 v[80:83], v[48:51], a[232:235], v[80:83]
  ds_read_b128 v[48:51], v10 offset:16384
  v_mfma_f32_16x16x32_bf16 v[68:71], v[52:55], a[200:203], v[68:71]
  v_mfma_f32_16x16x32_bf16 v[76:79], v[52:55], a[216:219], v[76:79]
  v_mfma_f32_16x16x32_bf16 v[84:87], v[52:55], a[232:235], v[84:87]
  ds_read_b128 v[52:55], v10 offset:20480
  v_mfma_f32_16x16x32_bf16 v[64:67], v[56:59], a[204:207], v[64:67]
  v_mfma_f32_16x16x32_bf16 v[72:75], v[56:59], a[220:223], v[72:75]
  v_mfma_f32_16x16x32_bf16 v[80:83], v[56:59], a[236:239], v[80:83]
  ds_read_b128 v[56:59], v11 offset:16384
  v_mfma_f32_16x16x32_bf16 v[68:71], v[60:63], a[204:207], v[68:71]
  v_mfma_f32_16x16x32_bf16 v[76:79], v[60:63], a[220:223], v[76:79]
  v_mfma_f32_16x16x32_bf16 v[84:87], v[60:63], a[236:239], v[84:87]
  ds_read_b128 v[60:63], v11 offset:20480
  s_waitcnt lgkmcnt(6)
  v_mfma_f32_16x16x32_bf16 v[88:91], v[32:35], a[192:195], 0
  v_mfma_f32_16x16x32_bf16 v[96:99], v[32:35], a[208:211], 0
  v_mfma_f32_16x16x32_bf16 v[104:107], v[32:35], a[224:227], 0
  v_mfma_f32_16x16x32_bf16 v[92:95], v[36:39], a[192:195], 0
  v_mfma_f32_16x16x32_bf16 v[100:103], v[36:39], a[208:211], 0
  v_mfma_f32_16x16x32_bf16 v[108:111], v[36:39], a[224:227], 0
  s_waitcnt lgkmcnt(4)
  v_mfma_f32_16x16x32_bf16 v[88:91], v[40:43], a[196:199], v[88:91]
  s_add_u32 s61, s41, 0
  s_and_b32 s61, s61, 7
  v_mfma_f32_16x16x32_bf16 v[96:99], v[40:43], a[212:215], v[96:99]
  s_lshl_b32 s61, s61, 7
  s_add_u32 s61, s61, s37
  v_mfma_f32_16x16x32_bf16 v[104:107], v[40:43], a[228:231], v[104:107]
  s_add_u32 m0, s34, 0x18000
  s_add_u32 s32, s61, 0x20000
  v_mfma_f32_16x16x32_bf16 v[92:95], v[44:47], a[196:199], v[92:95]
  buffer_load_dwordx4 v1, s[24:27], s32 offen offset:0 lds
  v_mfma_f32_16x16x32_bf16 v[100:103], v[44:47], a[212:215], v[100:103]
  v_mfma_f32_16x16x32_bf16 v[108:111], v[44:47], a[228:231], v[108:111]
  s_waitcnt lgkmcnt(0)
  v_mfma_f32_16x16x32_bf16 v[88:91], v[48:51], a[200:203], v[88:91]
  s_barrier
  v_subrev_u32 v8, 0x10000, v8
  ds_read_b128 v[32:35], v8 offset:0
  ds_read_b128 v[36:39], v8 offset:4096
  v_mfma_f32_16x16x32_bf16 v[96:99], v[48:51], a[216:219], v[96:99]
  v_subrev_u32 v9, 0x10000, v9
  ds_read_b128 v[40:43], v9 offset:0
  ds_read_b128 v[44:47], v9 offset:4096
  v_mfma_f32_16x16x32_bf16 v[104:107], v[48:51], a[232:235], v[104:107]
  v_subrev_u32 v10, 0x10000, v10
  ds_read_b128 v[48:51], v10 offset:0
  v_mfma_f32_16x16x32_bf16 v[92:95], v[52:55], a[200:203], v[92:95]
  v_mfma_f32_16x16x32_bf16 v[100:103], v[52:55], a[216:219], v[100:103]
  v_mfma_f32_16x16x32_bf16 v[108:111], v[52:55], a[232:235], v[108:111]
  ds_read_b128 v[52:55], v10 offset:4096
  v_mfma_f32_16x16x32_bf16 v[88:91], v[56:59], a[204:207], v[88:91]
  v_mfma_f32_16x16x32_bf16 v[96:99], v[56:59], a[220:223], v[96:99]
  v_mfma_f32_16x16x32_bf16 v[104:107], v[56:59], a[236:239], v[104:107]
  v_subrev_u32 v11, 0x10000, v11
  ds_read_b128 v[56:59], v11 offset:0
  v_mfma_f32_16x16x32_bf16 v[92:95], v[60:63], a[204:207], v[92:95]
  v_mfma_f32_16x16x32_bf16 v[100:103], v[60:63], a[220:223], v[100:103]
  v_mfma_f32_16x16x32_bf16 v[108:111], v[60:63], a[236:239], v[108:111]
  ds_read_b128 v[60:63], v11 offset:4096
  s_waitcnt lgkmcnt(6)
  v_mfma_f32_16x16x32_bf16 v[112:115], v[32:35], a[192:195], 0
  v_mfma_f32_16x16x32_bf16 v[120:123], v[32:35], a[208:211], 0
  v_mfma_f32_16x16x32_bf16 v[128:131], v[32:35], a[224:227], 0
  v_mfma_f32_16x16x32_bf16 v[116:119], v[36:39], a[192:195], 0
  buffer_load_dwordx4 v2, s[24:27], s32 offen offset:1024 lds
  v_mfma_f32_16x16x32_bf16 v[124:127], v[36:39], a[208:211], 0
  v_mfma_f32_16x16x32_bf16 v[132:135], v[36:39], a[224:227], 0
  s_waitcnt lgkmcnt(4)
  v_mfma_f32_16x16x32_bf16 v[112:115], v[40:43], a[196:199], v[112:115]
  v_mfma_f32_16x16x32_bf16 v[120:123], v[40:43], a[212:215], v[120:123]
  v_mfma_f32_16x16x32_bf16 v[128:131], v[40:43], a[228:231], v[128:131]
  v_mfma_f32_16x16x32_bf16 v[116:119], v[44:47], a[196:199], v[116:119]
  v_mfma_f32_16x16x32_bf16 v[124:127], v[44:47], a[212:215], v[124:127]
  v_mfma_f32_16x16x32_bf16 v[132:135], v[44:47], a[228:231], v[132:135]
  s_waitcnt lgkmcnt(0)
  v_mfma_f32_16x16x32_bf16 v[112:115], v[48:51], a[200:203], v[112:115]
  s_barrier
  ds_read_b128 v[32:35], v8 offset:16384
  ds_read_b128 v[36:39], v8 offset:20480
  v_mfma_f32_16x16x32_bf16 v[120:123], v[48:51], a[216:219], v[120:123]
  ds_read_b128 v[40:43], v9 offset:16384
  ds_read_b128 v[44:47], v9 offset:20480
  v_mfma_f32_16x16x32_bf16 v[128:131], v[48:51], a[232:235], v[128:131]
  ds_read_b128 v[48:51], v10 offset:16384
  v_mfma_f32_16x16x32_bf16 v[116:119], v[52:55], a[200:203], v[116:119]
  v_mfma_f32_16x16x32_bf16 v[124:127], v[52:55], a[216:219], v[124:127]
  v_mfma_f32_16x16x32_bf16 v[132:135], v[52:55], a[232:235], v[132:135]
  ds_read_b128 v[52:55], v10 offset:20480
  v_mfma_f32_16x16x32_bf16 v[112:115], v[56:59], a[204:207], v[112:115]
  v_mfma_f32_16x16x32_bf16 v[120:123], v[56:59], a[220:223], v[120:123]
  v_mfma_f32_16x16x32_bf16 v[128:131], v[56:59], a[236:239], v[128:131]
  ds_read_b128 v[56:59], v11 offset:16384
  v_mfma_f32_16x16x32_bf16 v[116:119], v[60:63], a[204:207], v[116:119]
  v_mfma_f32_16x16x32_bf16 v[124:127], v[60:63], a[220:223], v[124:127]
  v_mfma_f32_16x16x32_bf16 v[132:135], v[60:63], a[236:239], v[132:135]
  ds_read_b128 v[60:63], v11 offset:20480
  s_waitcnt lgkmcnt(6)
  v_mfma_f32_16x16x32_bf16 v[136:139], v[32:35], a[192:195], 0
  buffer_load_dwordx4 v3, s[24:27], s32 offen offset:2048 lds
  v_mfma_f32_16x16x32_bf16 v[144:147], v[32:35], a[208:211], 0
  v_mfma_f32_16x16x32_bf16 v[152:155], v[32:35], a[224:227], 0
  v_mfma_f32_16x16x32_bf16 v[140:143], v[36:39], a[192:195], 0
  v_mfma_f32_16x16x32_bf16 v[148:151], v[36:39], a[208:211], 0
  v_mfma_f32_16x16x32_bf16 v[156:159], v[36:39], a[224:227], 0
  s_waitcnt lgkmcnt(4)
  v_mfma_f32_16x16x32_bf16 v[136:139], v[40:43], a[196:199], v[136:139]
  v_mfma_f32_16x16x32_bf16 v[144:147], v[40:43], a[212:215], v[144:147]
  v_mfma_f32_16x16x32_bf16 v[152:155], v[40:43], a[228:231], v[152:155]
  v_mfma_f32_16x16x32_bf16 v[140:143], v[44:47], a[196:199], v[140:143]
  v_mfma_f32_16x16x32_bf16 v[148:151], v[44:47], a[212:215], v[148:151]
  v_mfma_f32_16x16x32_bf16 v[156:159], v[44:47], a[228:231], v[156:159]
  s_waitcnt lgkmcnt(0)
  v_mfma_f32_16x16x32_bf16 v[136:139], v[48:51], a[200:203], v[136:139]
  s_barrier
  ds_read_b128 v[32:35], v8 offset:32768
  ds_read_b128 v[36:39], v8 offset:36864
  v_mfma_f32_16x16x32_bf16 v[144:147], v[48:51], a[216:219], v[144:147]
  ds_read_b128 v[40:43], v9 offset:32768
  ds_read_b128 v[44:47], v9 offset:36864
  v_mfma_f32_16x16x32_bf16 v[152:155], v[48:51], a[232:235], v[152:155]
  ds_read_b128 v[48:51], v10 offset:32768
  buffer_load_dwordx4 v4, s[24:27], s32 offen offset:3072 lds
  v_mfma_f32_16x16x32_bf16 v[140:143], v[52:55], a[200:203], v[140:143]
  s_add_u32 m0, s34, 0x19000
  s_add_u32 s32, s61, 0x28000
  v_mfma_f32_16x16x32_bf16 v[148:151], v[52:55], a[216:219], v[148:151]
  buffer_load_dwordx4 v1, s[24:27], s32 offen offset:0 lds
  v_mfma_f32_16x16x32_bf16 v[156:159], v[52:55], a[232:235], v[156:159]
  ds_read_b128 v[52:55], v10 offset:36864
  v_mfma_f32_16x16x32_bf16 v[136:139], v[56:59], a[204:207], v[136:139]
  v_mfma_f32_16x16x32_bf16 v[144:147], v[56:59], a[220:223], v[144:147]
  v_mfma_f32_16x16x32_bf16 v[152:155], v[56:59], a[236:239], v[152:155]
  ds_read_b128 v[56:59], v11 offset:32768
  v_mfma_f32_16x16x32_bf16 v[140:143], v[60:63], a[204:207], v[140:143]
  v_mfma_f32_16x16x32_bf16 v[148:151], v[60:63], a[220:223], v[148:151]
  buffer_load_dwordx4 v2, s[24:27], s32 offen offset:1024 lds
  v_mfma_f32_16x16x32_bf16 v[156:159], v[60:63], a[236:239], v[156:159]
  ds_read_b128 v[60:63], v11 offset:36864
  s_waitcnt lgkmcnt(6)
  v_mfma_f32_16x16x32_bf16 v[160:163], v[32:35], a[192:195], 0
  v_mfma_f32_16x16x32_bf16 v[168:171], v[32:35], a[208:211], 0
  v_mfma_f32_16x16x32_bf16 v[176:179], v[32:35], a[224:227], 0
  v_mfma_f32_16x16x32_bf16 v[164:167], v[36:39], a[192:195], 0
  v_mfma_f32_16x16x32_bf16 v[172:175], v[36:39], a[208:211], 0
  v_mfma_f32_16x16x32_bf16 v[180:183], v[36:39], a[224:227], 0
  s_waitcnt lgkmcnt(4)
  v_mfma_f32_16x16x32_bf16 v[160:163], v[40:43], a[196:199], v[160:163]
  v_mfma_f32_16x16x32_bf16 v[168:171], v[40:43], a[212:215], v[168:171]
  v_mfma_f32_16x16x32_bf16 v[176:179], v[40:43], a[228:231], v[176:179]
  v_mfma_f32_16x16x32_bf16 v[164:167], v[44:47], a[196:199], v[164:167]
  v_mfma_f32_16x16x32_bf16 v[172:175], v[44:47], a[212:215], v[172:175]
  v_mfma_f32_16x16x32_bf16 v[180:183], v[44:47], a[228:231], v[180:183]
  s_waitcnt lgkmcnt(0)
  v_mfma_f32_16x16x32_bf16 v[160:163], v[48:51], a[200:203], v[160:163]
  s_barrier
  ds_read_b128 v[32:35], v8 offset:49152
  ds_read_b128 v[36:39], v8 offset:53248
  v_mfma_f32_16x16x32_bf16 v[168:171], v[48:51], a[216:219], v[168:171]
  ds_read_b128 v[40:43], v9 offset:49152
  ds_read_b128 v[44:47], v9 offset:53248
  v_mfma_f32_16x16x32_bf16 v[176:179], v[48:51], a[232:235], v[176:179]
  ds_read_b128 v[48:51], v10 offset:49152
  buffer_load_dwordx4 v3, s[24:27], s32 offen offset:2048 lds
  v_mfma_f32_16x16x32_bf16 v[164:167], v[52:55], a[200:203], v[164:167]
  buffer_load_dwordx4 v4, s[24:27], s32 offen offset:3072 lds
  v_mfma_f32_16x16x32_bf16 v[172:175], v[52:55], a[216:219], v[172:175]
  v_mfma_f32_16x16x32_bf16 v[180:183], v[52:55], a[232:235], v[180:183]
  ds_read_b128 v[52:55], v10 offset:53248
  v_mfma_f32_16x16x32_bf16 v[160:163], v[56:59], a[204:207], v[160:163]
  v_mfma_f32_16x16x32_bf16 v[168:171], v[56:59], a[220:223], v[168:171]
  v_mfma_f32_16x16x32_bf16 v[176:179], v[56:59], a[236:239], v[176:179]
  ds_read_b128 v[56:59], v11 offset:49152
  v_mfma_f32_16x16x32_bf16 v[164:167], v[60:63], a[204:207], v[164:167]
  v_mfma_f32_16x16x32_bf16 v[172:175], v[60:63], a[220:223], v[172:175]
  v_mfma_f32_16x16x32_bf16 v[180:183], v[60:63], a[236:239], v[180:183]
  ds_read_b128 v[60:63], v11 offset:53248
  s_waitcnt lgkmcnt(6)
  v_mfma_f32_16x16x32_bf16 v[184:187], v[32:35], a[192:195], 0
  v_mfma_f32_16x16x32_bf16 v[192:195], v[32:35], a[208:211], 0
  v_mfma_f32_16x16x32_bf16 v[200:203], v[32:35], a[224:227], 0
  v_mfma_f32_16x16x32_bf16 v[188:191], v[36:39], a[192:195], 0
  v_mfma_f32_16x16x32_bf16 v[196:199], v[36:39], a[208:211], 0
  v_mfma_f32_16x16x32_bf16 v[204:207], v[36:39], a[224:227], 0
  s_add_u32 s61, s41, 1
  s_and_b32 s61, s61, 7
  s_waitcnt lgkmcnt(4)
  v_mfma_f32_16x16x32_bf16 v[184:187], v[40:43], a[196:199], v[184:187]
  s_lshl_b32 s61, s61, 7
  s_add_u32 s61, s61, s37
  v_mfma_f32_16x16x32_bf16 v[192:195], v[40:43], a[212:215], v[192:195]
  s_add_u32 m0, s34, 0x1c000
  s_add_u32 s32, s61, 0x20000
  v_mfma_f32_16x16x32_bf16 v[200:203], v[40:43], a[228:231], v[200:203]
  buffer_load_dwordx4 v1, s[24:27], s32 offen offset:0 lds
  v_mfma_f32_16x16x32_bf16 v[188:191], v[44:47], a[196:199], v[188:191]
  v_mfma_f32_16x16x32_bf16 v[196:199], v[44:47], a[212:215], v[196:199]
  v_mfma_f32_16x16x32_bf16 v[204:207], v[44:47], a[228:231], v[204:207]
  s_waitcnt lgkmcnt(0)
  v_mfma_f32_16x16x32_bf16 v[184:187], v[48:51], a[200:203], v[184:187]
  s_barrier
  v_add_u32 v8, 0x10000, v8
  ds_read_b128 v[32:35], v8 offset:0
  ds_read_b128 v[36:39], v8 offset:4096
  v_mfma_f32_16x16x32_bf16 v[192:195], v[48:51], a[216:219], v[192:195]
  v_add_u32 v9, 0x10000, v9
  ds_read_b128 v[40:43], v9 offset:0
  ds_read_b128 v[44:47], v9 offset:4096
  v_mfma_f32_16x16x32_bf16 v[200:203], v[48:51], a[232:235], v[200:203]
  v_add_u32 v10, 0x10000, v10
  ds_read_b128 v[48:51], v10 offset:0
  buffer_load_dwordx4 v2, s[24:27], s32 offen offset:1024 lds
  v_mfma_f32_16x16x32_bf16 v[188:191], v[52:55], a[200:203], v[188:191]
  buffer_load_dwordx4 v3, s[24:27], s32 offen offset:2048 lds
  buffer_load_dwordx4 v4, s[24:27], s32 offen offset:3072 lds
  v_mfma_f32_16x16x32_bf16 v[196:199], v[52:55], a[216:219], v[196:199]
  v_mfma_f32_16x16x32_bf16 v[204:207], v[52:55], a[232:235], v[204:207]
  ds_read_b128 v[52:55], v10 offset:4096
  v_mfma_f32_16x16x32_bf16 v[184:187], v[56:59], a[204:207], v[184:187]
  v_mfma_f32_16x16x32_bf16 v[192:195], v[56:59], a[220:223], v[192:195]
  v_mfma_f32_16x16x32_bf16 v[200:203], v[56:59], a[236:239], v[200:203]
  v_add_u32 v11, 0x10000, v11
  ds_read_b128 v[56:59], v11 offset:0
  v_mfma_f32_16x16x32_bf16 v[188:191], v[60:63], a[204:207], v[188:191]
  v_mfma_f32_16x16x32_bf16 v[196:199], v[60:63], a[220:223], v[196:199]
  v_mfma_f32_16x16x32_bf16 v[204:207], v[60:63], a[236:239], v[204:207]
  ds_read_b128 v[60:63], v11 offset:4096
  s_waitcnt lgkmcnt(6)
  v_mfma_f32_16x16x32_bf16 v[208:211], v[32:35], a[192:195], 0
  v_mfma_f32_16x16x32_bf16 v[216:219], v[32:35], a[208:211], 0
  v_mfma_f32_16x16x32_bf16 v[224:227], v[32:35], a[224:227], 0
  v_mfma_f32_16x16x32_bf16 v[212:215], v[36:39], a[192:195], 0
  v_mfma_f32_16x16x32_bf16 v[220:223], v[36:39], a[208:211], 0
  v_mfma_f32_16x16x32_bf16 v[228:231], v[36:39], a[224:227], 0
  s_waitcnt lgkmcnt(4)
  v_mfma_f32_16x16x32_bf16 v[208:211], v[40:43], a[196:199], v[208:211]
  v_mfma_f32_16x16x32_bf16 v[216:219], v[40:43], a[212:215], v[216:219]
  v_mfma_f32_16x16x32_bf16 v[224:227], v[40:43], a[228:231], v[224:227]
  v_mfma_f32_16x16x32_bf16 v[212:215], v[44:47], a[196:199], v[212:215]
  v_mfma_f32_16x16x32_bf16 v[220:223], v[44:47], a[212:215], v[220:223]
  v_mfma_f32_16x16x32_bf16 v[228:231], v[44:47], a[228:231], v[228:231]
  s_add_u32 m0, s34, 0x1d000
  s_add_u32 s32, s61, 0x28000
  s_waitcnt lgkmcnt(0)
  v_mfma_f32_16x16x32_bf16 v[208:211], v[48:51], a[200:203], v[208:211]
  s_barrier
  ds_read_b128 v[32:35], v8 offset:16384
  ds_read_b128 v[36:39], v8 offset:20480
  v_mfma_f32_16x16x32_bf16 v[216:219], v[48:51], a[216:219], v[216:219]
  ds_read_b128 v[40:43], v9 offset:16384
  ds_read_b128 v[44:47], v9 offset:20480
  v_mfma_f32_16x16x32_bf16 v[224:227], v[48:51], a[232:235], v[224:227]
  ds_read_b128 v[48:51], v10 offset:16384
  buffer_load_dwordx4 v1, s[24:27], s32 offen offset:0 lds
  v_mfma_f32_16x16x32_bf16 v[212:215], v[52:55], a[200:203], v[212:215]
  buffer_load_dwordx4 v2, s[24:27], s32 offen offset:1024 lds
  buffer_load_dwordx4 v3, s[24:27], s32 offen offset:2048 lds
  v_mfma_f32_16x16x32_bf16 v[220:223], v[52:55], a[216:219], v[220:223]
  v_mfma_f32_16x16x32_bf16 v[228:231], v[52:55], a[232:235], v[228:231]
  ds_read_b128 v[52:55], v10 offset:20480
  v_mfma_f32_16x16x32_bf16 v[208:211], v[56:59], a[204:207], v[208:211]
  v_mfma_f32_16x16x32_bf16 v[216:219], v[56:59], a[220:223], v[216:219]
  v_mfma_f32_16x16x32_bf16 v[224:227], v[56:59], a[236:239], v[224:227]
  ds_read_b128 v[56:59], v11 offset:16384
  v_mfma_f32_16x16x32_bf16 v[212:215], v[60:63], a[204:207], v[212:215]
  v_mfma_f32_16x16x32_bf16 v[220:223], v[60:63], a[220:223], v[220:223]
  v_mfma_f32_16x16x32_bf16 v[228:231], v[60:63], a[236:239], v[228:231]
  ds_read_b128 v[60:63], v11 offset:20480
  s_waitcnt lgkmcnt(6)
  v_mfma_f32_16x16x32_bf16 v[232:235], v[32:35], a[192:195], 0
  v_mfma_f32_16x16x32_bf16 v[240:243], v[32:35], a[208:211], 0
  buffer_load_dwordx4 v4, s[24:27], s32 offen offset:3072 lds
  v_mfma_f32_16x16x32_bf16 v[248:251], v[32:35], a[224:227], 0
  v_mfma_f32_16x16x32_bf16 v[236:239], v[36:39], a[192:195], 0
  v_mfma_f32_16x16x32_bf16 v[244:247], v[36:39], a[208:211], 0
  v_mfma_f32_16x16x32_bf16 v[252:255], v[36:39], a[224:227], 0
  s_waitcnt lgkmcnt(4)
  v_mfma_f32_16x16x32_bf16 v[232:235], v[40:43], a[196:199], v[232:235]
  v_mfma_f32_16x16x32_bf16 v[240:243], v[40:43], a[212:215], v[240:243]
  v_mfma_f32_16x16x32_bf16 v[248:251], v[40:43], a[228:231], v[248:251]
  v_mfma_f32_16x16x32_bf16 v[236:239], v[44:47], a[196:199], v[236:239]
  v_mfma_f32_16x16x32_bf16 v[244:247], v[44:47], a[212:215], v[244:247]
  v_mfma_f32_16x16x32_bf16 v[252:255], v[44:47], a[228:231], v[252:255]
  s_waitcnt lgkmcnt(0)
  v_mfma_f32_16x16x32_bf16 v[232:235], v[48:51], a[200:203], v[232:235]
  s_barrier
  v_mfma_f32_16x16x32_bf16 v[240:243], v[48:51], a[216:219], v[240:243]
  v_mfma_f32_16x16x32_bf16 v[248:251], v[48:51], a[232:235], v[248:251]
  v_mfma_f32_16x16x32_bf16 v[236:239], v[52:55], a[200:203], v[236:239]
  v_mfma_f32_16x16x32_bf16 v[244:247], v[52:55], a[216:219], v[244:247]
  v_mfma_f32_16x16x32_bf16 v[252:255], v[52:55], a[232:235], v[252:255]
  v_mfma_f32_16x16x32_bf16 v[232:235], v[56:59], a[204:207], v[232:235]
  v_mfma_f32_16x16x32_bf16 v[240:243], v[56:59], a[220:223], v[240:243]
  v_mfma_f32_16x16x32_bf16 v[248:251], v[56:59], a[236:239], v[248:251]
  v_mfma_f32_16x16x32_bf16 v[236:239], v[60:63], a[204:207], v[236:239]
  v_mfma_f32_16x16x32_bf16 v[244:247], v[60:63], a[220:223], v[244:247]
  v_mfma_f32_16x16x32_bf16 v[252:255], v[60:63], a[236:239], v[252:255]
  v_max3_f32 v22, v64, v65, v66
  v_max3_f32 v22, v22, v67, v68
  v_max3_f32 v22, v22, v69, v70
  v_max_f32 v22, v22, v71
  v_max3_f32 v23, v72, v73, v74
  v_max3_f32 v23, v23, v75, v76
  v_max3_f32 v23, v23, v77, v78
  v_max_f32 v23, v23, v79
  v_max3_f32 v24, v80, v81, v82
  v_max3_f32 v24, v24, v83, v84
  v_max3_f32 v24, v24, v85, v86
  v_max_f32 v24, v24, v87
  v_max3_f32 v22, v22, v88, v89
  v_max3_f32 v22, v22, v90, v91
  v_max3_f32 v22, v22, v92, v93
  v_max3_f32 v22, v22, v94, v95
  v_max3_f32 v23, v23, v96, v97
  v_max3_f32 v23, v23, v98, v99
  v_max3_f32 v23, v23, v100, v101
  v_max3_f32 v23, v23, v102, v103
  v_max3_f32 v24, v24, v104, v105
  v_max3_f32 v24, v24, v106, v107
  v_max3_f32 v24, v24, v108, v109
  v_max3_f32 v24, v24, v110, v111
  v_max3_f32 v22, v22, v112, v113
  v_max3_f32 v22, v22, v114, v115
  v_max3_f32 v22, v22, v116, v117
  v_max3_f32 v22, v22, v118, v119
  v_max3_f32 v23, v23, v120, v121
  v_max3_f32 v23, v23, v122, v123
  v_max3_f32 v23, v23, v124, v125
  v_max3_f32 v23, v23, v126, v127
  v_max3_f32 v24, v24, v128, v129
  v_max3_f32 v24, v24, v130, v131
  v_max3_f32 v24, v24, v132, v133
  v_max3_f32 v24, v24, v134, v135
  v_max3_f32 v22, v22, v136, v137
  v_max3_f32 v22, v22, v138, v139
  v_max3_f32 v22, v22, v140, v141
  v_max3_f32 v22, v22, v142, v143
  v_max3_f32 v23, v23, v144, v145
  v_max3_f32 v23, v23, v146, v147
  v_max3_f32 v23, v23, v148, v149
  v_max3_f32 v23, v23, v150, v151
  v_max3_f32 v24, v24, v152, v153
  v_max3_f32 v24, v24, v154, v155
  v_max3_f32 v24, v24, v156, v157
  v_max3_f32 v24, v24, v158, v159
  v_max3_f32 v22, v22, v160, v161
  v_max3_f32 v22, v22, v162, v163
  v_max3_f32 v22, v22, v164, v165
  v_max3_f32 v22, v22, v166, v167
  v_max3_f32 v23, v23, v168, v169
  v_max3_f32 v23, v23, v170, v171
  v_max3_f32 v23, v23, v172, v173
  v_max3_f32 v23, v23, v174, v175
  v_max3_f32 v24, v24, v176, v177
  v_max3_f32 v24, v24, v178, v179
  v_max3_f32 v24, v24, v180, v181
  v_max3_f32 v24, v24, v182, v183
  v_max3_f32 v22, v22, v184, v185
  v_max3_f32 v22, v22, v186, v187
  v_max3_f32 v22, v22, v188, v189
  v_max3_f32 v22, v22, v190, v191
  v_max3_f32 v23, v23, v192, v193
  v_max3_f32 v23, v23, v194, v195
  v_max3_f32 v23, v23, v196, v197
  v_max3_f32 v23, v23, v198, v199
  v_max3_f32 v24, v24, v200, v201
  v_max3_f32 v24, v24, v202, v203
  v_max3_f32 v24, v24, v204, v205
  v_max3_f32 v24, v24, v206, v207
  v_max3_f32 v22, v22, v208, v209
  v_max3_f32 v22, v22, v210, v211
  v_max3_f32 v22, v22, v212, v213
  v_max3_f32 v22, v22, v214, v215
  v_max3_f32 v23, v23, v216, v217
  v_max3_f32 v23, v23, v218, v219
  v_max3_f32 v23, v23, v220, v221
  v_max3_f32 v23, v23, v222, v223
  v_max3_f32 v24, v24, v224, v225
  v_max3_f32 v24, v24, v226, v227
  v_max3_f32 v24, v24, v228, v229
  v_max3_f32 v24, v24, v230, v231
  v_max3_f32 v22, v22, v232, v233
  v_max3_f32 v22, v22, v234, v235
  v_max3_f32 v22, v22, v236, v237
  v_max3_f32 v22, v22, v238, v239
  v_max3_f32 v23, v23, v240, v241
  v_max3_f32 v23, v23, v242, v243
  s_add_u32 s61, s41, 2
  v_max3_f32 v23, v23, v244, v245
  v_max3_f32 v23, v23, v246, v247
  v_max3_f32 v24, v24, v248, v249
  v_max3_f32 v24, v24, v250, v251
  v_max3_f32 v24, v24, v252, v253
  v_max3_f32 v24, v24, v254, v255
  s_and_b32 s61, s61, 7
  v_mov_b32 v25, v22
  v_mov_b32 v26, v23
  v_mov_b32 v27, v24
  v_permlane32_swap_b32 v22, v25
  v_permlane32_swap_b32 v23, v26
  v_permlane32_swap_b32 v24, v27
  s_lshl_b32 s61, s61, 7
  v_max_f32 v22, v22, v25
  v_max_f32 v23, v23, v26
  v_max_f32 v24, v24, v27
  v_mov_b32 v25, v22
  v_mov_b32 v26, v23
  v_mov_b32 v27, v24
  s_add_u32 s61, s61, s37
  v_permlane16_swap_b32 v22, v25
  v_permlane16_swap_b32 v23, v26
  v_permlane16_swap_b32 v24, v27
  v_max_f32 v22, v22, v25
  v_max_f32 v23, v23, v26
  v_max_f32 v24, v24, v27
  s_add_u32 m0, s34, 0x20000
  v_mul_f32 v22, 0xbe0293ee, v22
  v_mul_f32 v23, 0xbe0293ee, v23
  v_mul_f32 v24, 0xbe0293ee, v24
  v_fmamk_f32 v64, v64, 0x3e0293ee, v22
  v_fmamk_f32 v65, v65, 0x3e0293ee, v22
  v_fmamk_f32 v66, v66, 0x3e0293ee, v22
  v_fmamk_f32 v67, v67, 0x3e0293ee, v22
  v_fmamk_f32 v68, v68, 0x3e0293ee, v22
  s_add_u32 s32, s61, 0x20000
  buffer_load_dwordx4 v1, s[24:27], s32 offen offset:0 lds
  v_fmamk_f32 v69, v69, 0x3e0293ee, v22
  v_fmamk_f32 v70, v70, 0x3e0293ee, v22
  v_fmamk_f32 v71, v71, 0x3e0293ee, v22
  v_exp_f32 v64, v64
  v_exp_f32 v65, v65
  v_exp_f32 v66, v66
  v_exp_f32 v67, v67
  v_exp_f32 v68, v68
  v_exp_f32 v69, v69
  v_exp_f32 v70, v70
  v_exp_f32 v71, v71
  v_cvt_pk_bf16_f32 v64, v64, v65
  v_cvt_pk_bf16_f32 v65, v66, v67
  v_cvt_pk_bf16_f32 v66, v68, v69
  v_cvt_pk_bf16_f32 v67, v70, v71
  v_fmamk_f32 v72, v72, 0x3e0293ee, v23
  v_fmamk_f32 v73, v73, 0x3e0293ee, v23
  v_fmamk_f32 v74, v74, 0x3e0293ee, v23
  v_fmamk_f32 v75, v75, 0x3e0293ee, v23
  v_fmamk_f32 v76, v76, 0x3e0293ee, v23
  v_fmamk_f32 v77, v77, 0x3e0293ee, v23
  v_fmamk_f32 v78, v78, 0x3e0293ee, v23
  v_fmamk_f32 v79, v79, 0x3e0293ee, v23
  v_exp_f32 v72, v72
  v_exp_f32 v73, v73
  v_exp_f32 v74, v74
  v_exp_f32 v75, v75
  v_exp_f32 v76, v76
  v_exp_f32 v77, v77
  v_exp_f32 v78, v78
  v_exp_f32 v79, v79
  v_cvt_pk_bf16_f32 v68, v72, v73
  v_cvt_pk_bf16_f32 v69, v74, v75
  v_cvt_pk_bf16_f32 v70, v76, v77
  v_cvt_pk_bf16_f32 v71, v78, v79
  buffer_load_dwordx4 v2, s[24:27], s32 offen offset:1024 lds
  v_fmamk_f32 v80, v80, 0x3e0293ee, v24
  v_fmamk_f32 v81, v81, 0x3e0293ee, v24
  v_fmamk_f32 v82, v82, 0x3e0293ee, v24
  v_fmamk_f32 v83, v83, 0x3e0293ee, v24
  v_fmamk_f32 v84, v84, 0x3e0293ee, v24
  v_fmamk_f32 v85, v85, 0x3e0293ee, v24
  v_fmamk_f32 v86, v86, 0x3e0293ee, v24
  v_fmamk_f32 v87, v87, 0x3e0293ee, v24
  v_exp_f32 v80, v80
  v_exp_f32 v81, v81
  v_exp_f32 v82, v82
  v_exp_f32 v83, v83
  v_exp_f32 v84, v84
  v_exp_f32 v85, v85
  v_exp_f32 v86, v86
  v_exp_f32 v87, v87
  v_cvt_pk_bf16_f32 v72, v80, v81
  v_cvt_pk_bf16_f32 v73, v82, v83
  v_cvt_pk_bf16_f32 v74, v84, v85
  v_cvt_pk_bf16_f32 v75, v86, v87
  v_fmamk_f32 v88, v88, 0x3e0293ee, v22
  v_fmamk_f32 v89, v89, 0x3e0293ee, v22
  v_fmamk_f32 v90, v90, 0x3e0293ee, v22
  v_fmamk_f32 v91, v91, 0x3e0293ee, v22
  v_fmamk_f32 v92, v92, 0x3e0293ee, v22
  v_fmamk_f32 v93, v93, 0x3e0293ee, v22
  v_fmamk_f32 v94, v94, 0x3e0293ee, v22
  v_fmamk_f32 v95, v95, 0x3e0293ee, v22
  v_exp_f32 v88, v88
  v_exp_f32 v89, v89
  v_exp_f32 v90, v90
  v_exp_f32 v91, v91
  v_exp_f32 v92, v92
  v_exp_f32 v93, v93
  v_exp_f32 v94, v94
  v_exp_f32 v95, v95
  v_cvt_pk_bf16_f32 v76, v88, v89
  v_cvt_pk_bf16_f32 v77, v90, v91
  v_cvt_pk_bf16_f32 v78, v92, v93
  v_cvt_pk_bf16_f32 v79, v94, v95
  v_fmamk_f32 v96, v96, 0x3e0293ee, v23
  v_fmamk_f32 v97, v97, 0x3e0293ee, v23
  v_fmamk_f32 v98, v98, 0x3e0293ee, v23
  v_fmamk_f32 v99, v99, 0x3e0293ee, v23
  v_fmamk_f32 v100, v100, 0x3e0293ee, v23
  v_fmamk_f32 v101, v101, 0x3e0293ee, v23
  v_fmamk_f32 v102, v102, 0x3e0293ee, v23
  v_fmamk_f32 v103, v103, 0x3e0293ee, v23
  v_exp_f32 v96, v96
  v_exp_f32 v97, v97
  v_exp_f32 v98, v98
  v_exp_f32 v99, v99
  v_exp_f32 v100, v100
  v_exp_f32 v101, v101
  v_exp_f32 v102, v102
  v_exp_f32 v103, v103
  v_cvt_pk_bf16_f32 v80, v96, v97
  v_cvt_pk_bf16_f32 v81, v98, v99
  v_cvt_pk_bf16_f32 v82, v100, v101
  v_cvt_pk_bf16_f32 v83, v102, v103
  buffer_load_dwordx4 v3, s[24:27], s32 offen offset:2048 lds
  v_fmamk_f32 v104, v104, 0x3e0293ee, v24
  v_fmamk_f32 v105, v105, 0x3e0293ee, v24
  v_fmamk_f32 v106, v106, 0x3e0293ee, v24
  v_fmamk_f32 v107, v107, 0x3e0293ee, v24
  v_fmamk_f32 v108, v108, 0x3e0293ee, v24
  v_fmamk_f32 v109, v109, 0x3e0293ee, v24
  v_fmamk_f32 v110, v110, 0x3e0293ee, v24
  v_fmamk_f32 v111, v111, 0x3e0293ee, v24
  v_exp_f32 v104, v104
  v_exp_f32 v105, v105
  v_exp_f32 v106, v106
  v_exp_f32 v107, v107
  v_exp_f32 v108, v108
  v_exp_f32 v109, v109
  v_exp_f32 v110, v110
  v_exp_f32 v111, v111
  v_cvt_pk_bf16_f32 v84, v104, v105
  v_cvt_pk_bf16_f32 v85, v106, v107
  v_cvt_pk_bf16_f32 v86, v108, v109
  v_cvt_pk_bf16_f32 v87, v110, v111
  v_fmamk_f32 v112, v112, 0x3e0293ee, v22
  v_fmamk_f32 v113, v113, 0x3e0293ee, v22
  v_fmamk_f32 v114, v114, 0x3e0293ee, v22
  v_fmamk_f32 v115, v115, 0x3e0293ee, v22
  v_fmamk_f32 v116, v116, 0x3e0293ee, v22
  v_fmamk_f32 v117, v117, 0x3e0293ee, v22
  v_fmamk_f32 v118, v118, 0x3e0293ee, v22
  v_fmamk_f32 v119, v119, 0x3e0293ee, v22
  v_exp_f32 v112, v112
  v_exp_f32 v113, v113
  v_exp_f32 v114, v114
  v_exp_f32 v115, v115
  v_exp_f32 v116, v116
  v_exp_f32 v117, v117
  v_exp_f32 v118, v118
  v_exp_f32 v119, v119
  v_cvt_pk_bf16_f32 v88, v112, v113
  v_cvt_pk_bf16_f32 v89, v114, v115
  v_cvt_pk_bf16_f32 v90, v116, v117
  v_cvt_pk_bf16_f32 v91, v118, v119
  v_fmamk_f32 v120, v120, 0x3e0293ee, v23
  v_fmamk_f32 v121, v121, 0x3e0293ee, v23
  v_fmamk_f32 v122, v122, 0x3e0293ee, v23
  v_fmamk_f32 v123, v123, 0x3e0293ee, v23
  v_fmamk_f32 v124, v124, 0x3e0293ee, v23
  v_fmamk_f32 v125, v125, 0x3e0293ee, v23
  v_fmamk_f32 v126, v126, 0x3e0293ee, v23
  v_fmamk_f32 v127, v127, 0x3e0293ee, v23
  v_exp_f32 v120, v120
  v_exp_f32 v121, v121
  v_exp_f32 v122, v122
  v_exp_f32 v123, v123
  v_exp_f32 v124, v124
  v_exp_f32 v125, v125
  v_exp_f32 v126, v126
  v_exp_f32 v127, v127
  v_cvt_pk_bf16_f32 v92, v120, v121
  v_cvt_pk_bf16_f32 v93, v122, v123
  v_cvt_pk_bf16_f32 v94, v124, v125
  v_cvt_pk_bf16_f32 v95, v126, v127
  buffer_load_dwordx4 v4, s[24:27], s32 offen offset:3072 lds
  v_fmamk_f32 v128, v128, 0x3e0293ee, v24
  v_fmamk_f32 v129, v129, 0x3e0293ee, v24
  v_fmamk_f32 v130, v130, 0x3e0293ee, v24
  v_fmamk_f32 v131, v131, 0x3e0293ee, v24
  v_fmamk_f32 v132, v132, 0x3e0293ee, v24
  v_fmamk_f32 v133, v133, 0x3e0293ee, v24
  v_fmamk_f32 v134, v134, 0x3e0293ee, v24
  v_fmamk_f32 v135, v135, 0x3e0293ee, v24
  v_exp_f32 v128, v128
  v_exp_f32 v129, v129
  v_exp_f32 v130, v130
  v_exp_f32 v131, v131
  v_exp_f32 v132, v132
  v_exp_f32 v133, v133
  v_exp_f32 v134, v134
  v_exp_f32 v135, v135
  v_cvt_pk_bf16_f32 v96, v128, v129
  v_cvt_pk_bf16_f32 v97, v130, v131
  v_cvt_pk_bf16_f32 v98, v132, v133
  v_cvt_pk_bf16_f32 v99, v134, v135
  v_fmamk_f32 v136, v136, 0x3e0293ee, v22
  v_fmamk_f32 v137, v137, 0x3e0293ee, v22
  v_fmamk_f32 v138, v138, 0x3e0293ee, v22
  v_fmamk_f32 v139, v139, 0x3e0293ee, v22
  v_fmamk_f32 v140, v140, 0x3e0293ee, v22
  v_fmamk_f32 v141, v141, 0x3e0293ee, v22
  v_fmamk_f32 v142, v142, 0x3e0293ee, v22
  v_fmamk_f32 v143, v143, 0x3e0293ee, v22
  v_exp_f32 v136, v136
  v_exp_f32 v137, v137
  v_exp_f32 v138, v138
  v_exp_f32 v139, v139
  v_exp_f32 v140, v140
  v_exp_f32 v141, v141
  v_exp_f32 v142, v142
  v_exp_f32 v143, v143
  v_cvt_pk_bf16_f32 v100, v136, v137
  v_cvt_pk_bf16_f32 v101, v138, v139
  v_cvt_pk_bf16_f32 v102, v140, v141
  v_cvt_pk_bf16_f32 v103, v142, v143
  v_fmamk_f32 v144, v144, 0x3e0293ee, v23
  v_fmamk_f32 v145, v145, 0x3e0293ee, v23
  v_fmamk_f32 v146, v146, 0x3e0293ee, v23
  v_fmamk_f32 v147, v147, 0x3e0293ee, v23
  v_fmamk_f32 v148, v148, 0x3e0293ee, v23
  v_fmamk_f32 v149, v149, 0x3e0293ee, v23
  v_fmamk_f32 v150, v150, 0x3e0293ee, v23
  v_fmamk_f32 v151, v151, 0x3e0293ee, v23
  v_exp_f32 v144, v144
  v_exp_f32 v145, v145
  v_exp_f32 v146, v146
  v_exp_f32 v147, v147
  v_exp_f32 v148, v148
  v_exp_f32 v149, v149
  v_exp_f32 v150, v150
  v_exp_f32 v151, v151
  v_cvt_pk_bf16_f32 v104, v144, v145
  v_cvt_pk_bf16_f32 v105, v146, v147
  v_cvt_pk_bf16_f32 v106, v148, v149
  v_cvt_pk_bf16_f32 v107, v150, v151
  s_add_u32 m0, s34, 0x21000
  s_add_u32 s32, s61, 0x28000
  v_fmamk_f32 v152, v152, 0x3e0293ee, v24
  v_fmamk_f32 v153, v153, 0x3e0293ee, v24
  v_fmamk_f32 v154, v154, 0x3e0293ee, v24
  v_fmamk_f32 v155, v155, 0x3e0293ee, v24
  v_fmamk_f32 v156, v156, 0x3e0293ee, v24
  buffer_load_dwordx4 v1, s[24:27], s32 offen offset:0 lds
  v_fmamk_f32 v157, v157, 0x3e0293ee, v24
  v_fmamk_f32 v158, v158, 0x3e0293ee, v24
  v_fmamk_f32 v159, v159, 0x3e0293ee, v24
  v_exp_f32 v152, v152
  v_exp_f32 v153, v153
  v_exp_f32 v154, v154
  v_exp_f32 v155, v155
  v_exp_f32 v156, v156
  v_exp_f32 v157, v157
  v_exp_f32 v158, v158
  v_exp_f32 v159, v159
  v_cvt_pk_bf16_f32 v108, v152, v153
  v_cvt_pk_bf16_f32 v109, v154, v155
  v_cvt_pk_bf16_f32 v110, v156, v157
  v_cvt_pk_bf16_f32 v111, v158, v159
  v_fmamk_f32 v160, v160, 0x3e0293ee, v22
  v_fmamk_f32 v161, v161, 0x3e0293ee, v22
  v_fmamk_f32 v162, v162, 0x3e0293ee, v22
  v_fmamk_f32 v163, v163, 0x3e0293ee, v22
  v_fmamk_f32 v164, v164, 0x3e0293ee, v22
  v_fmamk_f32 v165, v165, 0x3e0293ee, v22
  v_fmamk_f32 v166, v166, 0x3e0293ee, v22
  v_fmamk_f32 v167, v167, 0x3e0293ee, v22
  v_exp_f32 v160, v160
  v_exp_f32 v161, v161
  v_exp_f32 v162, v162
  v_exp_f32 v163, v163
  v_exp_f32 v164, v164
  v_exp_f32 v165, v165
  v_exp_f32 v166, v166
  v_exp_f32 v167, v167
  v_cvt_pk_bf16_f32 v112, v160, v161
  v_cvt_pk_bf16_f32 v113, v162, v163
  v_cvt_pk_bf16_f32 v114, v164, v165
  v_cvt_pk_bf16_f32 v115, v166, v167
  v_fmamk_f32 v168, v168, 0x3e0293ee, v23
  v_fmamk_f32 v169, v169, 0x3e0293ee, v23
  v_fmamk_f32 v170, v170, 0x3e0293ee, v23
  v_fmamk_f32 v171, v171, 0x3e0293ee, v23
  v_fmamk_f32 v172, v172, 0x3e0293ee, v23
  v_fmamk_f32 v173, v173, 0x3e0293ee, v23
  v_fmamk_f32 v174, v174, 0x3e0293ee, v23
  v_fmamk_f32 v175, v175, 0x3e0293ee, v23
  v_exp_f32 v168, v168
  v_exp_f32 v169, v169
  v_exp_f32 v170, v170
  v_exp_f32 v171, v171
  v_exp_f32 v172, v172
  v_exp_f32 v173, v173
  v_exp_f32 v174, v174
  v_exp_f32 v175, v175
  v_cvt_pk_bf16_f32 v116, v168, v169
  v_cvt_pk_bf16_f32 v117, v170, v171
  v_cvt_pk_bf16_f32 v118, v172, v173
  v_cvt_pk_bf16_f32 v119, v174, v175
  buffer_load_dwordx4 v2, s[24:27], s32 offen offset:1024 lds
  v_fmamk_f32 v176, v176, 0x3e0293ee, v24
  v_fmamk_f32 v177, v177, 0x3e0293ee, v24
  v_fmamk_f32 v178, v178, 0x3e0293ee, v24
  v_fmamk_f32 v179, v179, 0x3e0293ee, v24
  v_fmamk_f32 v180, v180, 0x3e0293ee, v24
  v_fmamk_f32 v181, v181, 0x3e0293ee, v24
  v_fmamk_f32 v182, v182, 0x3e0293ee, v24
  v_fmamk_f32 v183, v183, 0x3e0293ee, v24
  v_exp_f32 v176, v176
  v_exp_f32 v177, v177
  v_exp_f32 v178, v178
  v_exp_f32 v179, v179
  v_exp_f32 v180, v180
  v_exp_f32 v181, v181
  v_exp_f32 v182, v182
  v_exp_f32 v183, v183
  v_cvt_pk_bf16_f32 v120, v176, v177
  v_cvt_pk_bf16_f32 v121, v178, v179
  v_cvt_pk_bf16_f32 v122, v180, v181
  v_cvt_pk_bf16_f32 v123, v182, v183
  v_fmamk_f32 v184, v184, 0x3e0293ee, v22
  v_fmamk_f32 v185, v185, 0x3e0293ee, v22
  v_fmamk_f32 v186, v186, 0x3e0293ee, v22
  v_fmamk_f32 v187, v187, 0x3e0293ee, v22
  v_fmamk_f32 v188, v188, 0x3e0293ee, v22
  v_fmamk_f32 v189, v189, 0x3e0293ee, v22
  v_fmamk_f32 v190, v190, 0x3e0293ee, v22
  v_fmamk_f32 v191, v191, 0x3e0293ee, v22
  v_exp_f32 v184, v184
  v_exp_f32 v185, v185
  v_exp_f32 v186, v186
  v_exp_f32 v187, v187
  v_exp_f32 v188, v188
  v_exp_f32 v189, v189
  v_exp_f32 v190, v190
  v_exp_f32 v191, v191
  v_cvt_pk_bf16_f32 v124, v184, v185
  v_cvt_pk_bf16_f32 v125, v186, v187
  v_cvt_pk_bf16_f32 v126, v188, v189
  v_cvt_pk_bf16_f32 v127, v190, v191
  v_fmamk_f32 v192, v192, 0x3e0293ee, v23
  v_fmamk_f32 v193, v193, 0x3e0293ee, v23
  v_fmamk_f32 v194, v194, 0x3e0293ee, v23
  v_fmamk_f32 v195, v195, 0x3e0293ee, v23
  v_fmamk_f32 v196, v196, 0x3e0293ee, v23
  v_fmamk_f32 v197, v197, 0x3e0293ee, v23
  v_fmamk_f32 v198, v198, 0x3e0293ee, v23
  v_fmamk_f32 v199, v199, 0x3e0293ee, v23
  v_exp_f32 v192, v192
  v_exp_f32 v193, v193
  v_exp_f32 v194, v194
  v_exp_f32 v195, v195
  v_exp_f32 v196, v196
  v_exp_f32 v197, v197
  v_exp_f32 v198, v198
  v_exp_f32 v199, v199
  v_cvt_pk_bf16_f32 v128, v192, v193
  v_cvt_pk_bf16_f32 v129, v194, v195
  v_cvt_pk_bf16_f32 v130, v196, v197
  v_cvt_pk_bf16_f32 v131, v198, v199
  buffer_load_dwordx4 v3, s[24:27], s32 offen offset:2048 lds
  v_fmamk_f32 v200, v200, 0x3e0293ee, v24
  v_fmamk_f32 v201, v201, 0x3e0293ee, v24
  v_fmamk_f32 v202, v202, 0x3e0293ee, v24
  v_fmamk_f32 v203, v203, 0x3e0293ee, v24
  v_fmamk_f32 v204, v204, 0x3e0293ee, v24
  v_fmamk_f32 v205, v205, 0x3e0293ee, v24
  v_fmamk_f32 v206, v206, 0x3e0293ee, v24
  v_fmamk_f32 v207, v207, 0x3e0293ee, v24
  v_exp_f32 v200, v200
  v_exp_f32 v201, v201
  v_exp_f32 v202, v202
  v_exp_f32 v203, v203
  v_exp_f32 v204, v204
  v_exp_f32 v205, v205
  v_exp_f32 v206, v206
  v_exp_f32 v207, v207
  v_cvt_pk_bf16_f32 v132, v200, v201
  v_cvt_pk_bf16_f32 v133, v202, v203
  v_cvt_pk_bf16_f32 v134, v204, v205
  v_cvt_pk_bf16_f32 v135, v206, v207
  s_barrier
  v_fmamk_f32 v208, v208, 0x3e0293ee, v22
  v_fmamk_f32 v209, v209, 0x3e0293ee, v22
  v_fmamk_f32 v210, v210, 0x3e0293ee, v22
  v_fmamk_f32 v211, v211, 0x3e0293ee, v22
  v_fmamk_f32 v212, v212, 0x3e0293ee, v22
  ds_read_b64_tr_b16 v[32:33], v12 offset:0
  v_fmamk_f32 v213, v213, 0x3e0293ee, v22
  v_fmamk_f32 v214, v214, 0x3e0293ee, v22
  v_fmamk_f32 v215, v215, 0x3e0293ee, v22
  v_exp_f32 v208, v208
  v_exp_f32 v209, v209
  ds_read_b64_tr_b16 v[34:35], v12 offset:4096
  v_exp_f32 v210, v210
  v_exp_f32 v211, v211
  v_exp_f32 v212, v212
  v_exp_f32 v213, v213
  v_exp_f32 v214, v214
  ds_read_b64_tr_b16 v[36:37], v13 offset:0
  v_exp_f32 v215, v215
  v_cvt_pk_bf16_f32 v136, v208, v209
  v_cvt_pk_bf16_f32 v137, v210, v211
  v_cvt_pk_bf16_f32 v138, v212, v213
  v_cvt_pk_bf16_f32 v139, v214, v215
  ds_read_b64_tr_b16 v[38:39], v13 offset:4096
  v_fmamk_f32 v216, v216, 0x3e0293ee, v23
  v_fmamk_f32 v217, v217, 0x3e0293ee, v23
  v_fmamk_f32 v218, v218, 0x3e0293ee, v23
  v_fmamk_f32 v219, v219, 0x3e0293ee, v23
  v_fmamk_f32 v220, v220, 0x3e0293ee, v23
  ds_read_b64_tr_b16 v[40:41], v14 offset:0
  v_fmamk_f32 v221, v221, 0x3e0293ee, v23
  v_fmamk_f32 v222, v222, 0x3e0293ee, v23
  v_fmamk_f32 v223, v223, 0x3e0293ee, v23
  v_exp_f32 v216, v216
  v_exp_f32 v217, v217
  ds_read_b64_tr_b16 v[42:43], v14 offset:4096
  v_exp_f32 v218, v218
  v_exp_f32 v219, v219
  v_exp_f32 v220, v220
  v_exp_f32 v221, v221
  v_exp_f32 v222, v222
  ds_read_b64_tr_b16 v[44:45], v15 offset:0
  v_exp_f32 v223, v223
  v_cvt_pk_bf16_f32 v140, v216, v217
  v_cvt_pk_bf16_f32 v141, v218, v219
  v_cvt_pk_bf16_f32 v142, v220, v221
  v_cvt_pk_bf16_f32 v143, v222, v223
  ds_read_b64_tr_b16 v[46:47], v15 offset:4096
  v_fmamk_f32 v224, v224, 0x3e0293ee, v24
  v_fmamk_f32 v225, v225, 0x3e0293ee, v24
  v_fmamk_f32 v226, v226, 0x3e0293ee, v24
  v_fmamk_f32 v227, v227, 0x3e0293ee, v24
  v_fmamk_f32 v228, v228, 0x3e0293ee, v24
  ds_read_b64_tr_b16 v[48:49], v16 offset:0
  v_fmamk_f32 v229, v229, 0x3e0293ee, v24
  v_fmamk_f32 v230, v230, 0x3e0293ee, v24
  v_fmamk_f32 v231, v231, 0x3e0293ee, v24
  v_exp_f32 v224, v224
  v_exp_f32 v225, v225
  ds_read_b64_tr_b16 v[50:51], v16 offset:4096
  v_exp_f32 v226, v226
  v_exp_f32 v227, v227
  v_exp_f32 v228, v228
  v_exp_f32 v229, v229
  v_exp_f32 v230, v230
  ds_read_b64_tr_b16 v[52:53], v17 offset:0
  v_exp_f32 v231, v231
  v_cvt_pk_bf16_f32 v144, v224, v225
  v_cvt_pk_bf16_f32 v145, v226, v227
  v_cvt_pk_bf16_f32 v146, v228, v229
  v_cvt_pk_bf16_f32 v147, v230, v231
  ds_read_b64_tr_b16 v[54:55], v17 offset:4096
  v_fmamk_f32 v232, v232, 0x3e0293ee, v22
  v_fmamk_f32 v233, v233, 0x3e0293ee, v22
  v_fmamk_f32 v234, v234, 0x3e0293ee, v22
  v_fmamk_f32 v235, v235, 0x3e0293ee, v22
  v_fmamk_f32 v236, v236, 0x3e0293ee, v22
  ds_read_b64_tr_b16 v[56:57], v18 offset:0
  v_fmamk_f32 v237, v237, 0x3e0293ee, v22
  v_fmamk_f32 v238, v238, 0x3e0293ee, v22
  v_fmamk_f32 v239, v239, 0x3e0293ee, v22
  v_exp_f32 v232, v232
  v_exp_f32 v233, v233
  ds_read_b64_tr_b16 v[58:59], v18 offset:4096
  v_exp_f32 v234, v234
  v_exp_f32 v235, v235
  v_exp_f32 v236, v236
  v_exp_f32 v237, v237
  v_exp_f32 v238, v238
  ds_read_b64_tr_b16 v[60:61], v19 offset:0
  v_exp_f32 v239, v239
  v_cvt_pk_bf16_f32 v148, v232, v233
  v_cvt_pk_bf16_f32 v149, v234, v235
  v_cvt_pk_bf16_f32 v150, v236, v237
  v_cvt_pk_bf16_f32 v151, v238, v239
  ds_read_b64_tr_b16 v[62:63], v19 offset:4096
  v_fmamk_f32 v240, v240, 0x3e0293ee, v23
  v_fmamk_f32 v241, v241, 0x3e0293ee, v23
  v_fmamk_f32 v242, v242, 0x3e0293ee, v23
  v_fmamk_f32 v243, v243, 0x3e0293ee, v23
  v_fmamk_f32 v244, v244, 0x3e0293ee, v23
  buffer_load_dwordx4 v4, s[24:27], s32 offen offset:3072 lds
  v_fmamk_f32 v245, v245, 0x3e0293ee, v23
  v_fmamk_f32 v246, v246, 0x3e0293ee, v23
  v_fmamk_f32 v247, v247, 0x3e0293ee, v23
  v_exp_f32 v240, v240
  v_exp_f32 v241, v241
  v_exp_f32 v242, v242
  v_exp_f32 v243, v243
  v_exp_f32 v244, v244
  v_exp_f32 v245, v245
  v_exp_f32 v246, v246
  v_exp_f32 v247, v247
  v_cvt_pk_bf16_f32 v152, v240, v241
  v_cvt_pk_bf16_f32 v153, v242, v243
  v_cvt_pk_bf16_f32 v154, v244, v245
  v_cvt_pk_bf16_f32 v155, v246, v247
  v_fmamk_f32 v248, v248, 0x3e0293ee, v24
  v_fmamk_f32 v249, v249, 0x3e0293ee, v24
  v_fmamk_f32 v250, v250, 0x3e0293ee, v24
  v_fmamk_f32 v251, v251, 0x3e0293ee, v24
  v_fmamk_f32 v252, v252, 0x3e0293ee, v24
  v_fmamk_f32 v253, v253, 0x3e0293ee, v24
  v_fmamk_f32 v254, v254, 0x3e0293ee, v24
  v_fmamk_f32 v255, v255, 0x3e0293ee, v24
  v_exp_f32 v248, v248
  v_exp_f32 v249, v249
  v_exp_f32 v250, v250
  v_exp_f32 v251, v251
  v_exp_f32 v252, v252
  v_exp_f32 v253, v253
  v_exp_f32 v254, v254
  v_exp_f32 v255, v255
  v_cvt_pk_bf16_f32 v156, v248, v249
  v_cvt_pk_bf16_f32 v157, v250, v251
  v_cvt_pk_bf16_f32 v158, v252, v253
  v_cvt_pk_bf16_f32 v159, v254, v255
  s_waitcnt lgkmcnt(12)
  v_mfma_f32_16x16x32_bf16 v[160:163], v[32:35], v[64:67], 0
  v_mfma_f32_16x16x32_bf16 v[164:167], v[32:35], v[68:71], 0
  v_mfma_f32_16x16x32_bf16 v[168:171], v[32:35], v[72:75], 0
  v_mfma_f32_16x16x32_bf16 v[172:175], v[36:39], v[64:67], 0
  v_mfma_f32_16x16x32_bf16 v[176:179], v[36:39], v[68:71], 0
  v_mfma_f32_16x16x32_bf16 v[180:183], v[36:39], v[72:75], 0
  s_waitcnt lgkmcnt(8)
  v_mfma_f32_16x16x32_bf16 v[184:187], v[40:43], v[64:67], 0
  v_mfma_f32_16x16x32_bf16 v[188:191], v[40:43], v[68:71], 0
  v_mfma_f32_16x16x32_bf16 v[192:195], v[40:43], v[72:75], 0
  v_mfma_f32_16x16x32_bf16 v[196:199], v[44:47], v[64:67], 0
  v_mfma_f32_16x16x32_bf16 v[200:203], v[44:47], v[68:71], 0
  v_mfma_f32_16x16x32_bf16 v[204:207], v[44:47], v[72:75], 0
  s_waitcnt lgkmcnt(0)
  v_mfma_f32_16x16x32_bf16 v[208:211], v[48:51], v[64:67], 0
  s_barrier
  ds_read_b64_tr_b16 v[32:33], v12 offset:16384
  ds_read_b64_tr_b16 v[34:35], v12 offset:20480
  v_mfma_f32_16x16x32_bf16 v[212:215], v[48:51], v[68:71], 0
  ds_read_b64_tr_b16 v[36:37], v13 offset:16384
  ds_read_b64_tr_b16 v[38:39], v13 offset:20480
  v_mfma_f32_16x16x32_bf16 v[216:219], v[48:51], v[72:75], 0
  ds_read_b64_tr_b16 v[40:41], v14 offset:16384
  ds_read_b64_tr_b16 v[42:43], v14 offset:20480
  v_mfma_f32_16x16x32_bf16 v[220:223], v[52:55], v[64:67], 0
  ds_read_b64_tr_b16 v[44:45], v15 offset:16384
  ds_read_b64_tr_b16 v[46:47], v15 offset:20480
  v_mfma_f32_16x16x32_bf16 v[224:227], v[52:55], v[68:71], 0
  ds_read_b64_tr_b16 v[48:49], v16 offset:16384
  ds_read_b64_tr_b16 v[50:51], v16 offset:20480
  v_mfma_f32_16x16x32_bf16 v[228:231], v[52:55], v[72:75], 0
  ds_read_b64_tr_b16 v[52:53], v17 offset:16384
  ds_read_b64_tr_b16 v[54:55], v17 offset:20480
  v_mfma_f32_16x16x32_bf16 v[232:235], v[56:59], v[64:67], 0
  v_mfma_f32_16x16x32_bf16 v[236:239], v[56:59], v[68:71], 0
  v_mfma_f32_16x16x32_bf16 v[240:243], v[56:59], v[72:75], 0
  ds_read_b64_tr_b16 v[56:57], v18 offset:16384
  ds_read_b64_tr_b16 v[58:59], v18 offset:20480
  v_mfma_f32_16x16x32_bf16 v[244:247], v[60:63], v[64:67], 0
  v_mfma_f32_16x16x32_bf16 v[248:251], v[60:63], v[68:71], 0
  v_mfma_f32_16x16x32_bf16 v[252:255], v[60:63], v[72:75], 0
  ds_read_b64_tr_b16 v[60:61], v19 offset:16384
  ds_read_b64_tr_b16 v[62:63], v19 offset:20480
  v_mfma_f32_16x16x32_bf16 a[240:243], a[252:255], v[64:67], 0
  v_mfma_f32_16x16x32_bf16 a[244:247], a[252:255], v[68:71], 0
  v_mfma_f32_16x16x32_bf16 a[248:251], a[252:255], v[72:75], 0
  s_waitcnt lgkmcnt(12)
  v_mfma_f32_16x16x32_bf16 v[160:163], v[32:35], v[76:79], v[160:163]
  v_mfma_f32_16x16x32_bf16 v[164:167], v[32:35], v[80:83], v[164:167]
  v_mfma_f32_16x16x32_bf16 v[168:171], v[32:35], v[84:87], v[168:171]
  v_mfma_f32_16x16x32_bf16 v[172:175], v[36:39], v[76:79], v[172:175]
  v_mfma_f32_16x16x32_bf16 v[176:179], v[36:39], v[80:83], v[176:179]
  v_mfma_f32_16x16x32_bf16 v[180:183], v[36:39], v[84:87], v[180:183]
  s_waitcnt lgkmcnt(8)
  v_mfma_f32_16x16x32_bf16 v[184:187], v[40:43], v[76:79], v[184:187]
  v_mfma_f32_16x16x32_bf16 v[188:191], v[40:43], v[80:83], v[188:191]
  v_mfma_f32_16x16x32_bf16 v[192:195], v[40:43], v[84:87], v[192:195]
  v_mfma_f32_16x16x32_bf16 v[196:199], v[44:47], v[76:79], v[196:199]
  v_mfma_f32_16x16x32_bf16 v[200:203], v[44:47], v[80:83], v[200:203]
  v_mfma_f32_16x16x32_bf16 v[204:207], v[44:47], v[84:87], v[204:207]
  s_waitcnt lgkmcnt(0)
  v_mfma_f32_16x16x32_bf16 v[208:211], v[48:51], v[76:79], v[208:211]
  s_barrier
  ds_read_b64_tr_b16 v[32:33], v12 offset:32768
  ds_read_b64_tr_b16 v[34:35], v12 offset:36864
  v_mfma_f32_16x16x32_bf16 v[212:215], v[48:51], v[80:83], v[212:215]
  ds_read_b64_tr_b16 v[36:37], v13 offset:32768
  ds_read_b64_tr_b16 v[38:39], v13 offset:36864
  v_mfma_f32_16x16x32_bf16 v[216:219], v[48:51], v[84:87], v[216:219]
  ds_read_b64_tr_b16 v[40:41], v14 offset:32768
  ds_read_b64_tr_b16 v[42:43], v14 offset:36864
  v_mfma_f32_16x16x32_bf16 v[220:223], v[52:55], v[76:79], v[220:223]
  ds_read_b64_tr_b16 v[44:45], v15 offset:32768
  ds_read_b64_tr_b16 v[46:47], v15 offset:36864
  v_mfma_f32_16x16x32_bf16 v[224:227], v[52:55], v[80:83], v[224:227]
  ds_read_b64_tr_b16 v[48:49], v16 offset:32768
  ds_read_b64_tr_b16 v[50:51], v16 offset:36864
  v_mfma_f32_16x16x32_bf16 v[228:231], v[52:55], v[84:87], v[228:231]
  ds_read_b64_tr_b16 v[52:53], v17 offset:32768
  ds_read_b64_tr_b16 v[54:55], v17 offset:36864
  v_mfma_f32_16x16x32_bf16 v[232:235], v[56:59], v[76:79], v[232:235]
  v_mfma_f32_16x16x32_bf16 v[236:239], v[56:59], v[80:83], v[236:239]
  v_mfma_f32_16x16x32_bf16 v[240:243], v[56:59], v[84:87], v[240:243]
  ds_read_b64_tr_b16 v[56:57], v18 offset:32768
  ds_read_b64_tr_b16 v[58:59], v18 offset:36864
  v_mfma_f32_16x16x32_bf16 v[244:247], v[60:63], v[76:79], v[244:247]
  v_mfma_f32_16x16x32_bf16 v[248:251], v[60:63], v[80:83], v[248:251]
  v_mfma_f32_16x16x32_bf16 v[252:255], v[60:63], v[84:87], v[252:255]
  ds_read_b64_tr_b16 v[60:61], v19 offset:32768
  ds_read_b64_tr_b16 v[62:63], v19 offset:36864
  v_mfma_f32_16x16x32_bf16 a[240:243], a[252:255], v[76:79], a[240:243]
  v_mfma_f32_16x16x32_bf16 a[244:247], a[252:255], v[80:83], a[244:247]
  v_mfma_f32_16x16x32_bf16 a[248:251], a[252:255], v[84:87], a[248:251]
  s_waitcnt lgkmcnt(12)
  v_mfma_f32_16x16x32_bf16 v[160:163], v[32:35], v[88:91], v[160:163]
  v_mfma_f32_16x16x32_bf16 v[164:167], v[32:35], v[92:95], v[164:167]
  v_mfma_f32_16x16x32_bf16 v[168:171], v[32:35], v[96:99], v[168:171]
  v_mfma_f32_16x16x32_bf16 v[172:175], v[36:39], v[88:91], v[172:175]
  v_mfma_f32_16x16x32_bf16 v[176:179], v[36:39], v[92:95], v[176:179]
  v_mfma_f32_16x16x32_bf16 v[180:183], v[36:39], v[96:99], v[180:183]
  s_waitcnt lgkmcnt(8)
  v_mfma_f32_16x16x32_bf16 v[184:187], v[40:43], v[88:91], v[184:187]
  v_mfma_f32_16x16x32_bf16 v[188:191], v[40:43], v[92:95], v[188:191]
  v_mfma_f32_16x16x32_bf16 v[192:195], v[40:43], v[96:99], v[192:195]
  v_mfma_f32_16x16x32_bf16 v[196:199], v[44:47], v[88:91], v[196:199]
  v_mfma_f32_16x16x32_bf16 v[200:203], v[44:47], v[92:95], v[200:203]
  v_mfma_f32_16x16x32_bf16 v[204:207], v[44:47], v[96:99], v[204:207]
  s_waitcnt lgkmcnt(0)
  v_mfma_f32_16x16x32_bf16 v[208:211], v[48:51], v[88:91], v[208:211]
  s_barrier
  ds_read_b64_tr_b16 v[32:33], v12 offset:49152
  ds_read_b64_tr_b16 v[34:35], v12 offset:53248
  v_mfma_f32_16x16x32_bf16 v[212:215], v[48:51], v[92:95], v[212:215]
  ds_read_b64_tr_b16 v[36:37], v13 offset:49152
  ds_read_b64_tr_b16 v[38:39], v13 offset:53248
  v_mfma_f32_16x16x32_bf16 v[216:219], v[48:51], v[96:99], v[216:219]
  ds_read_b64_tr_b16 v[40:41], v14 offset:49152
  ds_read_b64_tr_b16 v[42:43], v14 offset:53248
  v_mfma_f32_16x16x32_bf16 v[220:223], v[52:55], v[88:91], v[220:223]
  ds_read_b64_tr_b16 v[44:45], v15 offset:49152
  ds_read_b64_tr_b16 v[46:47], v15 offset:53248
  v_mfma_f32_16x16x32_bf16 v[224:227], v[52:55], v[92:95], v[224:227]
  ds_read_b64_tr_b16 v[48:49], v16 offset:49152
  ds_read_b64_tr_b16 v[50:51], v16 offset:53248
  v_mfma_f32_16x16x32_bf16 v[228:231], v[52:55], v[96:99], v[228:231]
  ds_read_b64_tr_b16 v[52:53], v17 offset:49152
  ds_read_b64_tr_b16 v[54:55], v17 offset:53248
  v_mfma_f32_16x16x32_bf16 v[232:235], v[56:59], v[88:91], v[232:235]
  v_mfma_f32_16x16x32_bf16 v[236:239], v[56:59], v[92:95], v[236:239]
  v_mfma_f32_16x16x32_bf16 v[240:243], v[56:59], v[96:99], v[240:243]
  ds_read_b64_tr_b16 v[56:57], v18 offset:49152
  ds_read_b64_tr_b16 v[58:59], v18 offset:53248
  v_mfma_f32_16x16x32_bf16 v[244:247], v[60:63], v[88:91], v[244:247]
  v_mfma_f32_16x16x32_bf16 v[248:251], v[60:63], v[92:95], v[248:251]
  v_mfma_f32_16x16x32_bf16 v[252:255], v[60:63], v[96:99], v[252:255]
  ds_read_b64_tr_b16 v[60:61], v19 offset:49152
  ds_read_b64_tr_b16 v[62:63], v19 offset:53248
  v_mfma_f32_16x16x32_bf16 a[240:243], a[252:255], v[88:91], a[240:243]
  v_mfma_f32_16x16x32_bf16 a[244:247], a[252:255], v[92:95], a[244:247]
  v_mfma_f32_16x16x32_bf16 a[248:251], a[252:255], v[96:99], a[248:251]
  s_waitcnt lgkmcnt(12)
  v_mfma_f32_16x16x32_bf16 v[160:163], v[32:35], v[100:103], v[160:163]
  v_mfma_f32_16x16x32_bf16 v[164:167], v[32:35], v[104:107], v[164:167]
  v_mfma_f32_16x16x32_bf16 v[168:171], v[32:35], v[108:111], v[168:171]
  v_mfma_f32_16x16x32_bf16 v[172:175], v[36:39], v[100:103], v[172:175]
  v_mfma_f32_16x16x32_bf16 v[176:179], v[36:39], v[104:107], v[176:179]
  v_mfma_f32_16x16x32_bf16 v[180:183], v[36:39], v[108:111], v[180:183]
  s_waitcnt lgkmcnt(8)
  v_mfma_f32_16x16x32_bf16 v[184:187], v[40:43], v[100:103], v[184:187]
  v_mfma_f32_16x16x32_bf16 v[188:191], v[40:43], v[104:107], v[188:191]
  v_mfma_f32_16x16x32_bf16 v[192:195], v[40:43], v[108:111], v[192:195]
  v_mfma_f32_16x16x32_bf16 v[196:199], v[44:47], v[100:103], v[196:199]
  v_mfma_f32_16x16x32_bf16 v[200:203], v[44:47], v[104:107], v[200:203]
  v_mfma_f32_16x16x32_bf16 v[204:207], v[44:47], v[108:111], v[204:207]
  s_waitcnt lgkmcnt(0)
  v_mfma_f32_16x16x32_bf16 v[208:211], v[48:51], v[100:103], v[208:211]
  s_barrier
  v_add_u32 v12, 0x10000, v12
  ds_read_b64_tr_b16 v[32:33], v12 offset:0
  ds_read_b64_tr_b16 v[34:35], v12 offset:4096
  v_mfma_f32_16x16x32_bf16 v[212:215], v[48:51], v[104:107], v[212:215]
  v_add_u32 v13, 0x10000, v13
  ds_read_b64_tr_b16 v[36:37], v13 offset:0
  ds_read_b64_tr_b16 v[38:39], v13 offset:4096
  v_mfma_f32_16x16x32_bf16 v[216:219], v[48:51], v[108:111], v[216:219]
  v_add_u32 v14, 0x10000, v14
  ds_read_b64_tr_b16 v[40:41], v14 offset:0
  ds_read_b64_tr_b16 v[42:43], v14 offset:4096
  v_mfma_f32_16x16x32_bf16 v[220:223], v[52:55], v[100:103], v[220:223]
  v_add_u32 v15, 0x10000, v15
  ds_read_b64_tr_b16 v[44:45], v15 offset:0
  ds_read_b64_tr_b16 v[46:47], v15 offset:4096
  v_mfma_f32_16x16x32_bf16 v[224:227], v[52:55], v[104:107], v[224:227]
  v_add_u32 v16, 0x10000, v16
  ds_read_b64_tr_b16 v[48:49], v16 offset:0
  ds_read_b64_tr_b16 v[50:51], v16 offset:4096
  v_mfma_f32_16x16x32_bf16 v[228:231], v[52:55], v[108:111], v[228:231]
  v_add_u32 v17, 0x10000, v17
  ds_read_b64_tr_b16 v[52:53], v17 offset:0
  ds_read_b64_tr_b16 v[54:55], v17 offset:4096
  v_mfma_f32_16x16x32_bf16 v[232:235], v[56:59], v[100:103], v[232:235]
  v_mfma_f32_16x16x32_bf16 v[236:239], v[56:59], v[104:107], v[236:239]
  v_mfma_f32_16x16x32_bf16 v[240:243], v[56:59], v[108:111], v[240:243]
  v_add_u32 v18, 0x10000, v18
  ds_read_b64_tr_b16 v[56:57], v18 offset:0
  ds_read_b64_tr_b16 v[58:59], v18 offset:4096
  v_mfma_f32_16x16x32_bf16 v[244:247], v[60:63], v[100:103], v[244:247]
  v_mfma_f32_16x16x32_bf16 v[248:251], v[60:63], v[104:107], v[248:251]
  v_mfma_f32_16x16x32_bf16 v[252:255], v[60:63], v[108:111], v[252:255]
  v_add_u32 v19, 0x10000, v19
  ds_read_b64_tr_b16 v[60:61], v19 offset:0
  ds_read_b64_tr_b16 v[62:63], v19 offset:4096
  v_mfma_f32_16x16x32_bf16 a[240:243], a[252:255], v[100:103], a[240:243]
  v_mfma_f32_16x16x32_bf16 a[244:247], a[252:255], v[104:107], a[244:247]
  v_mfma_f32_16x16x32_bf16 a[248:251], a[252:255], v[108:111], a[248:251]
  s_waitcnt lgkmcnt(12)
  v_mfma_f32_16x16x32_bf16 v[160:163], v[32:35], v[112:115], v[160:163]
  v_mfma_f32_16x16x32_bf16 v[164:167], v[32:35], v[116:119], v[164:167]
  v_mfma_f32_16x16x32_bf16 v[168:171], v[32:35], v[120:123], v[168:171]
  v_mfma_f32_16x16x32_bf16 v[172:175], v[36:39], v[112:115], v[172:175]
  v_mfma_f32_16x16x32_bf16 v[176:179], v[36:39], v[116:119], v[176:179]
  v_mfma_f32_16x16x32_bf16 v[180:183], v[36:39], v[120:123], v[180:183]
  s_waitcnt lgkmcnt(8)
  v_mfma_f32_16x16x32_bf16 v[184:187], v[40:43], v[112:115], v[184:187]
  v_mfma_f32_16x16x32_bf16 v[188:191], v[40:43], v[116:119], v[188:191]
  v_mfma_f32_16x16x32_bf16 v[192:195], v[40:43], v[120:123], v[192:195]
  v_mfma_f32_16x16x32_bf16 v[196:199], v[44:47], v[112:115], v[196:199]
  v_mfma_f32_16x16x32_bf16 v[200:203], v[44:47], v[116:119], v[200:203]
  v_mfma_f32_16x16x32_bf16 v[204:207], v[44:47], v[120:123], v[204:207]
  s_waitcnt lgkmcnt(0)
  v_mfma_f32_16x16x32_bf16 v[208:211], v[48:51], v[112:115], v[208:211]
  s_barrier
  ds_read_b64_tr_b16 v[32:33], v12 offset:16384
  ds_read_b64_tr_b16 v[34:35], v12 offset:20480
  v_mfma_f32_16x16x32_bf16 v[212:215], v[48:51], v[116:119], v[212:215]
  ds_read_b64_tr_b16 v[36:37], v13 offset:16384
  ds_read_b64_tr_b16 v[38:39], v13 offset:20480
  v_mfma_f32_16x16x32_bf16 v[216:219], v[48:51], v[120:123], v[216:219]
  ds_read_b64_tr_b16 v[40:41], v14 offset:16384
  ds_read_b64_tr_b16 v[42:43], v14 offset:20480
  v_mfma_f32_16x16x32_bf16 v[220:223], v[52:55], v[112:115], v[220:223]
  ds_read_b64_tr_b16 v[44:45], v15 offset:16384
  ds_read_b64_tr_b16 v[46:47], v15 offset:20480
  v_mfma_f32_16x16x32_bf16 v[224:227], v[52:55], v[116:119], v[224:227]
  ds_read_b64_tr_b16 v[48:49], v16 offset:16384
  ds_read_b64_tr_b16 v[50:51], v16 offset:20480
  v_mfma_f32_16x16x32_bf16 v[228:231], v[52:55], v[120:123], v[228:231]
  ds_read_b64_tr_b16 v[52:53], v17 offset:16384
  ds_read_b64_tr_b16 v[54:55], v17 offset:20480
  v_mfma_f32_16x16x32_bf16 v[232:235], v[56:59], v[112:115], v[232:235]
  s_add_u32 s61, s41, 4
  s_and_b32 s61, s61, 7
  v_mfma_f32_16x16x32_bf16 v[236:239], v[56:59], v[116:119], v[236:239]
  s_lshl_b32 s61, s61, 7
  s_add_u32 s61, s61, s37
  v_mfma_f32_16x16x32_bf16 v[240:243], v[56:59], v[120:123], v[240:243]
  ds_read_b64_tr_b16 v[56:57], v18 offset:16384
  ds_read_b64_tr_b16 v[58:59], v18 offset:20480
  v_mfma_f32_16x16x32_bf16 v[244:247], v[60:63], v[112:115], v[244:247]
  s_add_u32 m0, s34, 0x10000
  s_add_u32 s32, s61, 0x20000
  v_mfma_f32_16x16x32_bf16 v[248:251], v[60:63], v[116:119], v[248:251]
  buffer_load_dwordx4 v1, s[24:27], s32 offen offset:0 lds
  buffer_load_dwordx4 v2, s[24:27], s32 offen offset:1024 lds
  v_mfma_f32_16x16x32_bf16 v[252:255], v[60:63], v[120:123], v[252:255]
  ds_read_b64_tr_b16 v[60:61], v19 offset:16384
  ds_read_b64_tr_b16 v[62:63], v19 offset:20480
  v_mfma_f32_16x16x32_bf16 a[240:243], a[252:255], v[112:115], a[240:243]
  buffer_load_dwordx4 v3, s[24:27], s32 offen offset:2048 lds
  buffer_load_dwordx4 v4, s[24:27], s32 offen offset:3072 lds
  v_mfma_f32_16x16x32_bf16 a[244:247], a[252:255], v[116:119], a[244:247]
  v_mfma_f32_16x16x32_bf16 a[248:251], a[252:255], v[120:123], a[248:251]
  s_waitcnt lgkmcnt(12)
  v_mfma_f32_16x16x32_bf16 v[160:163], v[32:35], v[124:127], v[160:163]
  v_mfma_f32_16x16x32_bf16 v[164:167], v[32:35], v[128:131], v[164:167]
  s_add_u32 m0, s34, 0x11000
  s_add_u32 s32, s61, 0x28000
  v_mfma_f32_16x16x32_bf16 v[168:171], v[32:35], v[132:135], v[168:171]
  buffer_load_dwordx4 v1, s[24:27], s32 offen offset:0 lds
  v_mfma_f32_16x16x32_bf16 v[172:175], v[36:39], v[124:127], v[172:175]
  v_mfma_f32_16x16x32_bf16 v[176:179], v[36:39], v[128:131], v[176:179]
  v_mfma_f32_16x16x32_bf16 v[180:183], v[36:39], v[132:135], v[180:183]
  buffer_load_dwordx4 v2, s[24:27], s32 offen offset:1024 lds
  s_waitcnt lgkmcnt(8)
  v_mfma_f32_16x16x32_bf16 v[184:187], v[40:43], v[124:127], v[184:187]
  v_mfma_f32_16x16x32_bf16 v[188:191], v[40:43], v[128:131], v[188:191]
  v_mfma_f32_16x16x32_bf16 v[192:195], v[40:43], v[132:135], v[192:195]
  v_mfma_f32_16x16x32_bf16 v[196:199], v[44:47], v[124:127], v[196:199]
  buffer_load_dwordx4 v3, s[24:27], s32 offen offset:2048 lds
  v_mfma_f32_16x16x32_bf16 v[200:203], v[44:47], v[128:131], v[200:203]
  v_mfma_f32_16x16x32_bf16 v[204:207], v[44:47], v[132:135], v[204:207]
  s_waitcnt lgkmcnt(0)
  v_mfma_f32_16x16x32_bf16 v[208:211], v[48:51], v[124:127], v[208:211]
  s_barrier
  v_subrev_u32 v12, 0x10000, v12
  ds_read_b64_tr_b16 v[32:33], v12 offset:0
  ds_read_b64_tr_b16 v[34:35], v12 offset:4096
  v_mfma_f32_16x16x32_bf16 v[212:215], v[48:51], v[128:131], v[212:215]
  v_subrev_u32 v13, 0x10000, v13
  ds_read_b64_tr_b16 v[36:37], v13 offset:0
  ds_read_b64_tr_b16 v[38:39], v13 offset:4096
  v_mfma_f32_16x16x32_bf16 v[216:219], v[48:51], v[132:135], v[216:219]
  v_subrev_u32 v14, 0x10000, v14
  ds_read_b64_tr_b16 v[40:41], v14 offset:0
  ds_read_b64_tr_b16 v[42:43], v14 offset:4096
  v_mfma_f32_16x16x32_bf16 v[220:223], v[52:55], v[124:127], v[220:223]
  v_subrev_u32 v15, 0x10000, v15
  ds_read_b64_tr_b16 v[44:45], v15 offset:0
  ds_read_b64_tr_b16 v[46:47], v15 offset:4096
  v_mfma_f32_16x16x32_bf16 v[224:227], v[52:55], v[128:131], v[224:227]
  v_subrev_u32 v16, 0x10000, v16
  ds_read_b64_tr_b16 v[48:49], v16 offset:0
  ds_read_b64_tr_b16 v[50:51], v16 offset:4096
  v_mfma_f32_16x16x32_bf16 v[228:231], v[52:55], v[132:135], v[228:231]
  v_subrev_u32 v17, 0x10000, v17
  ds_read_b64_tr_b16 v[52:53], v17 offset:0
  ds_read_b64_tr_b16 v[54:55], v17 offset:4096
  v_mfma_f32_16x16x32_bf16 v[232:235], v[56:59], v[124:127], v[232:235]
  buffer_load_dwordx4 v4, s[24:27], s32 offen offset:3072 lds
  s_add_u32 s61, s41, 5
  v_mfma_f32_16x16x32_bf16 v[236:239], v[56:59], v[128:131], v[236:239]
  s_and_b32 s61, s61, 7
  s_lshl_b32 s61, s61, 7
  v_mfma_f32_16x16x32_bf16 v[240:243], v[56:59], v[132:135], v[240:243]
  v_subrev_u32 v18, 0x10000, v18
  ds_read_b64_tr_b16 v[56:57], v18 offset:0
  ds_read_b64_tr_b16 v[58:59], v18 offset:4096
  v_mfma_f32_16x16x32_bf16 v[244:247], v[60:63], v[124:127], v[244:247]
  s_add_u32 s61, s61, s37
  s_add_u32 m0, s34, 0x14000
  v_mfma_f32_16x16x32_bf16 v[248:251], v[60:63], v[128:131], v[248:251]
  s_add_u32 s32, s61, 0x20000
  buffer_load_dwordx4 v1, s[24:27], s32 offen offset:0 lds
  v_mfma_f32_16x16x32_bf16 v[252:255], v[60:63], v[132:135], v[252:255]
  v_subrev_u32 v19, 0x10000, v19
  ds_read_b64_tr_b16 v[60:61], v19 offset:0
  ds_read_b64_tr_b16 v[62:63], v19 offset:4096
  v_mfma_f32_16x16x32_bf16 a[240:243], a[252:255], v[124:127], a[240:243]
  buffer_load_dwordx4 v2, s[24:27], s32 offen offset:1024 lds
  buffer_load_dwordx4 v3, s[24:27], s32 offen offset:2048 lds
  v_mfma_f32_16x16x32_bf16 a[244:247], a[252:255], v[128:131], a[244:247]
  buffer_load_dwordx4 v4, s[24:27], s32 offen offset:3072 lds
  v_mfma_f32_16x16x32_bf16 a[248:251], a[252:255], v[132:135], a[248:251]
  s_waitcnt lgkmcnt(12)
  v_mfma_f32_16x16x32_bf16 v[160:163], v[32:35], v[136:139], v[160:163]
  v_mfma_f32_16x16x32_bf16 v[164:167], v[32:35], v[140:143], v[164:167]
  s_add_u32 m0, s34, 0x15000
  s_add_u32 s32, s61, 0x28000
  v_mfma_f32_16x16x32_bf16 v[168:171], v[32:35], v[144:147], v[168:171]
  buffer_load_dwordx4 v1, s[24:27], s32 offen offset:0 lds
  v_mfma_f32_16x16x32_bf16 v[172:175], v[36:39], v[136:139], v[172:175]
  v_mfma_f32_16x16x32_bf16 v[176:179], v[36:39], v[140:143], v[176:179]
  v_mfma_f32_16x16x32_bf16 v[180:183], v[36:39], v[144:147], v[180:183]
  buffer_load_dwordx4 v2, s[24:27], s32 offen offset:1024 lds
  s_waitcnt lgkmcnt(8)
  v_mfma_f32_16x16x32_bf16 v[184:187], v[40:43], v[136:139], v[184:187]
  v_mfma_f32_16x16x32_bf16 v[188:191], v[40:43], v[140:143], v[188:191]
  v_mfma_f32_16x16x32_bf16 v[192:195], v[40:43], v[144:147], v[192:195]
  v_mfma_f32_16x16x32_bf16 v[196:199], v[44:47], v[136:139], v[196:199]
  buffer_load_dwordx4 v3, s[24:27], s32 offen offset:2048 lds
  v_mfma_f32_16x16x32_bf16 v[200:203], v[44:47], v[140:143], v[200:203]
  v_mfma_f32_16x16x32_bf16 v[204:207], v[44:47], v[144:147], v[204:207]
  s_waitcnt lgkmcnt(0)
  v_mfma_f32_16x16x32_bf16 v[208:211], v[48:51], v[136:139], v[208:211]
  s_barrier
  ds_read_b64_tr_b16 v[32:33], v12 offset:16384
  ds_read_b64_tr_b16 v[34:35], v12 offset:20480
  v_mfma_f32_16x16x32_bf16 v[212:215], v[48:51], v[140:143], v[212:215]
  ds_read_b64_tr_b16 v[36:37], v13 offset:16384
  ds_read_b64_tr_b16 v[38:39], v13 offset:20480
  v_mfma_f32_16x16x32_bf16 v[216:219], v[48:51], v[144:147], v[216:219]
  ds_read_b64_tr_b16 v[40:41], v14 offset:16384
  ds_read_b64_tr_b16 v[42:43], v14 offset:20480
  v_mfma_f32_16x16x32_bf16 v[220:223], v[52:55], v[136:139], v[220:223]
  ds_read_b64_tr_b16 v[44:45], v15 offset:16384
  ds_read_b64_tr_b16 v[46:47], v15 offset:20480
  v_mfma_f32_16x16x32_bf16 v[224:227], v[52:55], v[140:143], v[224:227]
  ds_read_b64_tr_b16 v[48:49], v16 offset:16384
  ds_read_b64_tr_b16 v[50:51], v16 offset:20480
  v_mfma_f32_16x16x32_bf16 v[228:231], v[52:55], v[144:147], v[228:231]
  ds_read_b64_tr_b16 v[52:53], v17 offset:16384
  ds_read_b64_tr_b16 v[54:55], v17 offset:20480
  v_mfma_f32_16x16x32_bf16 v[232:235], v[56:59], v[136:139], v[232:235]
  buffer_load_dwordx4 v4, s[24:27], s32 offen offset:3072 lds
  s_add_u32 s61, s41, 6
  v_mfma_f32_16x16x32_bf16 v[236:239], v[56:59], v[140:143], v[236:239]
  s_and_b32 s61, s61, 7
  s_lshl_b32 s61, s61, 7
  v_mfma_f32_16x16x32_bf16 v[240:243], v[56:59], v[144:147], v[240:243]
  ds_read_b64_tr_b16 v[56:57], v18 offset:16384
  ds_read_b64_tr_b16 v[58:59], v18 offset:20480
  v_mfma_f32_16x16x32_bf16 v[244:247], v[60:63], v[136:139], v[244:247]
  s_add_u32 s61, s61, s37
  s_add_u32 m0, s34, 0x0
  v_mfma_f32_16x16x32_bf16 v[248:251], v[60:63], v[140:143], v[248:251]
  s_add_u32 s32, s61, 0x20000
  buffer_load_dwordx4 v1, s[24:27], s32 offen offset:0 lds
  v_mfma_f32_16x16x32_bf16 v[252:255], v[60:63], v[144:147], v[252:255]
  ds_read_b64_tr_b16 v[60:61], v19 offset:16384
  ds_read_b64_tr_b16 v[62:63], v19 offset:20480
  v_mfma_f32_16x16x32_bf16 a[240:243], a[252:255], v[136:139], a[240:243]
  buffer_load_dwordx4 v2, s[24:27], s32 offen offset:1024 lds
  buffer_load_dwordx4 v3, s[24:27], s32 offen offset:2048 lds
  v_mfma_f32_16x16x32_bf16 a[244:247], a[252:255], v[140:143], a[244:247]
  buffer_load_dwordx4 v4, s[24:27], s32 offen offset:3072 lds
  v_mfma_f32_16x16x32_bf16 a[248:251], a[252:255], v[144:147], a[248:251]
  s_waitcnt lgkmcnt(12)
  v_mfma_f32_16x16x32_bf16 v[160:163], v[32:35], v[148:151], v[160:163]
  v_mfma_f32_16x16x32_bf16 v[164:167], v[32:35], v[152:155], v[164:167]
  s_add_u32 m0, s34, 0x1000
  s_add_u32 s32, s61, 0x28000
  v_mfma_f32_16x16x32_bf16 v[168:171], v[32:35], v[156:159], v[168:171]
  buffer_load_dwordx4 v1, s[24:27], s32 offen offset:0 lds
  v_mfma_f32_16x16x32_bf16 v[172:175], v[36:39], v[148:151], v[172:175]
  v_mfma_f32_16x16x32_bf16 v[176:179], v[36:39], v[152:155], v[176:179]
  v_mfma_f32_16x16x32_bf16 v[180:183], v[36:39], v[156:159], v[180:183]
  buffer_load_dwordx4 v2, s[24:27], s32 offen offset:1024 lds
  s_waitcnt lgkmcnt(8)
  v_mfma_f32_16x16x32_bf16 v[184:187], v[40:43], v[148:151], v[184:187]
  v_mfma_f32_16x16x32_bf16 v[188:191], v[40:43], v[152:155], v[188:191]
  v_mfma_f32_16x16x32_bf16 v[192:195], v[40:43], v[156:159], v[192:195]
  v_mfma_f32_16x16x32_bf16 v[196:199], v[44:47], v[148:151], v[196:199]
  buffer_load_dwordx4 v3, s[24:27], s32 offen offset:2048 lds
  v_mfma_f32_16x16x32_bf16 v[200:203], v[44:47], v[152:155], v[200:203]
  v_mfma_f32_16x16x32_bf16 v[204:207], v[44:47], v[156:159], v[204:207]
  s_waitcnt lgkmcnt(0)
  v_mfma_f32_16x16x32_bf16 v[208:211], v[48:51], v[148:151], v[208:211]
  s_waitcnt vmcnt(39)
  s_barrier
  ds_read_b64_tr_b16 v[32:33], v20 offset:0
  ds_read_b64_tr_b16 v[34:35], v20 offset:512
  v_mfma_f32_16x16x32_bf16 v[212:215], v[48:51], v[152:155], v[212:215]
  ds_read_b64_tr_b16 v[36:37], v21 offset:0
  ds_read_b64_tr_b16 v[38:39], v21 offset:512
  v_mfma_f32_16x16x32_bf16 v[216:219], v[48:51], v[156:159], v[216:219]
  ds_read_b64_tr_b16 v[40:41], v20 offset:4096
  ds_read_b64_tr_b16 v[42:43], v20 offset:4608
  v_mfma_f32_16x16x32_bf16 v[220:223], v[52:55], v[148:151], v[220:223]
  ds_read_b64_tr_b16 v[44:45], v21 offset:4096
  ds_read_b64_tr_b16 v[46:47], v21 offset:4608
  v_mfma_f32_16x16x32_bf16 v[224:227], v[52:55], v[152:155], v[224:227]
  ds_read_b64_tr_b16 v[48:49], v20 offset:8192
  ds_read_b64_tr_b16 v[50:51], v20 offset:8704
  v_mfma_f32_16x16x32_bf16 v[228:231], v[52:55], v[156:159], v[228:231]
  ds_read_b64_tr_b16 v[52:53], v21 offset:8192
  ds_read_b64_tr_b16 v[54:55], v21 offset:8704
  v_mfma_f32_16x16x32_bf16 v[232:235], v[56:59], v[148:151], v[232:235]
  buffer_load_dwordx4 v4, s[24:27], s32 offen offset:3072 lds
  v_mfma_f32_16x16x32_bf16 v[236:239], v[56:59], v[152:155], v[236:239]
  v_mfma_f32_16x16x32_bf16 v[240:243], v[56:59], v[156:159], v[240:243]
  ds_read_b64_tr_b16 v[56:57], v20 offset:12288
  ds_read_b64_tr_b16 v[58:59], v20 offset:12800
  v_mfma_f32_16x16x32_bf16 v[244:247], v[60:63], v[148:151], v[244:247]
  v_mfma_f32_16x16x32_bf16 v[248:251], v[60:63], v[152:155], v[248:251]
  v_mfma_f32_16x16x32_bf16 v[252:255], v[60:63], v[156:159], v[252:255]
  ds_read_b64_tr_b16 v[60:61], v21 offset:12288
  ds_read_b64_tr_b16 v[62:63], v21 offset:12800
  v_mfma_f32_16x16x32_bf16 a[240:243], a[252:255], v[148:151], a[240:243]
  v_mfma_f32_16x16x32_bf16 a[244:247], a[252:255], v[152:155], a[244:247]
  v_mfma_f32_16x16x32_bf16 a[248:251], a[252:255], v[156:159], a[248:251]
  v_add_u32 v112, s47, v0
  v_add_u32 v113, s48, v0
  v_lshrrev_b32 v115, 1, v0
  v_add_u32 v114, s49, v115
  v_add_u32 v115, s50, v115
  ds_write_b128 v112, v[208:211] offset:0
  ds_write_b128 v112, v[212:215] offset:1024
  ds_write_b128 v112, v[216:219] offset:2048
  ds_write_b128 v112, v[220:223] offset:3072
  ds_write_b128 v112, v[224:227] offset:4096
  ds_write_b128 v112, v[228:231] offset:5120
  ds_write_b128 v112, v[232:235] offset:6144
  ds_write_b128 v112, v[236:239] offset:7168
  ds_write_b128 v112, v[240:243] offset:8192
  ds_write_b128 v112, v[244:247] offset:9216
  ds_write_b128 v112, v[248:251] offset:10240
  ds_write_b128 v112, v[252:255] offset:11264
  v_mov_b32 v116, v22
  v_accvgpr_read_b32 v117, a240
  v_mov_b32 v118, v23
  v_accvgpr_read_b32 v119, a244
  v_mov_b32 v120, v24
  v_accvgpr_read_b32 v121, a248
  ds_write_b64 v114, v[116:117] offset:0
  ds_write_b64 v114, v[118:119] offset:512
  ds_write_b64 v114, v[120:121] offset:1024
  v_bfe_u32 v128, v0, 4, 4
  v_lshrrev_b32 v129, 8, v0
  v_lshrrev_b32 v131, 1, v128
  v_lshrrev_b32 v132, 1, v129
  v_xor_b32 v132, v131, v132
  v_lshlrev_b32 v132, 4, v132
  v_lshl_add_u32 v130, v128, 7, v132
  v_and_b32 v132, 1, v129
  v_lshl_add_u32 v130, v132, 3, v130
  v_add_u32 v130, s48, v130
  v_xor_b32 v134, v129, v131
  v_lshlrev_b32 v134, 4, v134
  v_lshl_add_u32 v134, v128, 7, v134
  v_add_u32 v134, s51, v134
  v_xor_b32 v135, 64, v134
  v_xor_b32 v131, 32, v130
  v_xor_b32 v132, 64, v130
  v_xor_b32 v133, 96, v130
  s_waitcnt lgkmcnt(0)
  s_barrier
  ds_read_b64 v[122:123], v115 offset:0
  ds_read_b64 v[124:125], v115 offset:512
  ds_read_b64 v[126:127], v115 offset:1024
  ds_read_b128 v[64:67], v113 offset:0
  ds_read_b128 v[68:71], v113 offset:1024
  ds_read_b128 v[72:75], v113 offset:2048
  ds_read_b128 v[76:79], v113 offset:3072
  ds_read_b128 v[80:83], v113 offset:4096
  ds_read_b128 v[84:87], v113 offset:5120
  ds_read_b128 v[88:91], v113 offset:6144
  ds_read_b128 v[92:95], v113 offset:7168
  ds_read_b128 v[96:99], v113 offset:8192
  ds_read_b128 v[100:103], v113 offset:9216
  ds_read_b128 v[104:107], v113 offset:10240
  ds_read_b128 v[108:111], v113 offset:11264
  s_waitcnt lgkmcnt(12)
  v_min_f32 v142, v116, v122
  v_min_f32 v143, v118, v124
  v_min_f32 v144, v120, v126
  v_sub_f32 v136, v142, v116
  v_sub_f32 v137, v143, v118
  v_sub_f32 v138, v144, v120
  v_sub_f32 v139, v142, v122
  v_sub_f32 v140, v143, v124
  v_sub_f32 v141, v144, v126
  v_exp_f32 v136, v136
  v_exp_f32 v137, v137
  v_exp_f32 v138, v138
  v_exp_f32 v139, v139
  v_exp_f32 v140, v140
  v_exp_f32 v141, v141
  v_mul_f32 v142, v117, v136
  v_mul_f32 v143, v119, v137
  v_mul_f32 v144, v121, v138
  v_fmac_f32 v142, v123, v139
  v_fmac_f32 v143, v125, v140
  v_fmac_f32 v144, v127, v141
  v_rcp_f32 v142, v142
  v_rcp_f32 v143, v143
  v_rcp_f32 v144, v144
  v_mul_f32 v136, v136, v142
  v_mul_f32 v137, v137, v143
  v_mul_f32 v138, v138, v144
  v_mul_f32 v139, v139, v142
  v_mul_f32 v140, v140, v143
  v_mul_f32 v141, v141, v144
  v_mul_f32 v160, v160, v136
  v_mul_f32 v161, v161, v136
  v_mul_f32 v162, v162, v136
  v_mul_f32 v163, v163, v136
  s_waitcnt lgkmcnt(11)
  v_fmac_f32 v160, v64, v139
  v_fmac_f32 v161, v65, v139
  v_fmac_f32 v162, v66, v139
  v_fmac_f32 v163, v67, v139
  v_cvt_pk_bf16_f32 v160, v160, v161
  v_cvt_pk_bf16_f32 v161, v162, v163
  ds_write_b64 v130, v[160:161] offset:0
  v_mul_f32 v164, v164, v137
  v_mul_f32 v165, v165, v137
  v_mul_f32 v166, v166, v137
  v_mul_f32 v167, v167, v137
  s_waitcnt lgkmcnt(11)
  v_fmac_f32 v164, v68, v140
  v_fmac_f32 v165, v69, v140
  v_fmac_f32 v166, v70, v140
  v_fmac_f32 v167, v71, v140
  v_cvt_pk_bf16_f32 v164, v164, v165
  v_cvt_pk_bf16_f32 v165, v166, v167
  ds_write_b64 v130, v[164:165] offset:2048
  v_mul_f32 v168, v168, v138
  v_mul_f32 v169, v169, v138
  v_mul_f32 v170, v170, v138
  v_mul_f32 v171, v171, v138
  s_waitcnt lgkmcnt(11)
  v_fmac_f32 v168, v72, v141
  v_fmac_f32 v169, v73, v141
  v_fmac_f32 v170, v74, v141
  v_fmac_f32 v171, v75, v141
  v_cvt_pk_bf16_f32 v168, v168, v169
  v_cvt_pk_bf16_f32 v169, v170, v171
  ds_write_b64 v130, v[168:169] offset:4096
  v_mul_f32 v172, v172, v136
  v_mul_f32 v173, v173, v136
  v_mul_f32 v174, v174, v136
  v_mul_f32 v175, v175, v136
  s_waitcnt lgkmcnt(11)
  v_fmac_f32 v172, v76, v139
  v_fmac_f32 v173, v77, v139
  v_fmac_f32 v174, v78, v139
  v_fmac_f32 v175, v79, v139
  v_cvt_pk_bf16_f32 v172, v172, v173
  v_cvt_pk_bf16_f32 v173, v174, v175
  ds_write_b64 v131, v[172:173] offset:0
  v_mul_f32 v176, v176, v137
  v_mul_f32 v177, v177, v137
  v_mul_f32 v178, v178, v137
  v_mul_f32 v179, v179, v137
  s_waitcnt lgkmcnt(11)
  v_fmac_f32 v176, v80, v140
  v_fmac_f32 v177, v81, v140
  v_fmac_f32 v178, v82, v140
  v_fmac_f32 v179, v83, v140
  v_cvt_pk_bf16_f32 v176, v176, v177
  v_cvt_pk_bf16_f32 v177, v178, v179
  ds_write_b64 v131, v[176:177] offset:2048
  v_mul_f32 v180, v180, v138
  v_mul_f32 v181, v181, v138
  v_mul_f32 v182, v182, v138
  v_mul_f32 v183, v183, v138
  s_waitcnt lgkmcnt(11)
  v_fmac_f32 v180, v84, v141
  v_fmac_f32 v181, v85, v141
  v_fmac_f32 v182, v86, v141
  v_fmac_f32 v183, v87, v141
  v_cvt_pk_bf16_f32 v180, v180, v181
  v_cvt_pk_bf16_f32 v181, v182, v183
  ds_write_b64 v131, v[180:181] offset:4096
  v_mul_f32 v184, v184, v136
  v_mul_f32 v185, v185, v136
  v_mul_f32 v186, v186, v136
  v_mul_f32 v187, v187, v136
  s_waitcnt lgkmcnt(11)
  v_fmac_f32 v184, v88, v139
  v_fmac_f32 v185, v89, v139
  v_fmac_f32 v186, v90, v139
  v_fmac_f32 v187, v91, v139
  v_cvt_pk_bf16_f32 v184, v184, v185
  v_cvt_pk_bf16_f32 v185, v186, v187
  ds_write_b64 v132, v[184:185] offset:0
  v_mul_f32 v188, v188, v137
  v_mul_f32 v189, v189, v137
  v_mul_f32 v190, v190, v137
  v_mul_f32 v191, v191, v137
  s_waitcnt lgkmcnt(11)
  v_fmac_f32 v188, v92, v140
  v_fmac_f32 v189, v93, v140
  v_fmac_f32 v190, v94, v140
  v_fmac_f32 v191, v95, v140
  v_cvt_pk_bf16_f32 v188, v188, v189
  v_cvt_pk_bf16_f32 v189, v190, v191
  ds_write_b64 v132, v[188:189] offset:2048
  v_mul_f32 v192, v192, v138
  v_mul_f32 v193, v193, v138
  v_mul_f32 v194, v194, v138
  v_mul_f32 v195, v195, v138
  s_waitcnt lgkmcnt(11)
  v_fmac_f32 v192, v96, v141
  v_fmac_f32 v193, v97, v141
  v_fmac_f32 v194, v98, v141
  v_fmac_f32 v195, v99, v141
  v_cvt_pk_bf16_f32 v192, v192, v193
  v_cvt_pk_bf16_f32 v193, v194, v195
  ds_write_b64 v132, v[192:193] offset:4096
  v_mul_f32 v196, v196, v136
  v_mul_f32 v197, v197, v136
  v_mul_f32 v198, v198, v136
  v_mul_f32 v199, v199, v136
  s_waitcnt lgkmcnt(11)
  v_fmac_f32 v196, v100, v139
  v_fmac_f32 v197, v101, v139
  v_fmac_f32 v198, v102, v139
  v_fmac_f32 v199, v103, v139
  v_cvt_pk_bf16_f32 v196, v196, v197
  v_cvt_pk_bf16_f32 v197, v198, v199
  ds_write_b64 v133, v[196:197] offset:0
  v_mul_f32 v200, v200, v137
  v_mul_f32 v201, v201, v137
  v_mul_f32 v202, v202, v137
  v_mul_f32 v203, v203, v137
  s_waitcnt lgkmcnt(11)
  v_fmac_f32 v200, v104, v140
  v_fmac_f32 v201, v105, v140
  v_fmac_f32 v202, v106, v140
  v_fmac_f32 v203, v107, v140
  v_cvt_pk_bf16_f32 v200, v200, v201
  v_cvt_pk_bf16_f32 v201, v202, v203
  ds_write_b64 v133, v[200:201] offset:2048
  v_mul_f32 v204, v204, v138
  v_mul_f32 v205, v205, v138
  v_mul_f32 v206, v206, v138
  v_mul_f32 v207, v207, v138
  s_waitcnt lgkmcnt(11)
  v_fmac_f32 v204, v108, v141
  v_fmac_f32 v205, v109, v141
  v_fmac_f32 v206, v110, v141
  v_fmac_f32 v207, v111, v141
  v_cvt_pk_bf16_f32 v204, v204, v205
  v_cvt_pk_bf16_f32 v205, v206, v207
  ds_write_b64 v133, v[204:205] offset:4096
  s_waitcnt lgkmcnt(0)
  s_barrier
  ds_read_b128 v[64:67], v134 offset:12288
  ds_read_b128 v[80:83], v134 offset:14336
  ds_read_b128 v[96:99], v134 offset:16384
  ds_read_b128 v[68:71], v135 offset:12288
  ds_read_b128 v[84:87], v135 offset:14336
  ds_read_b128 v[100:103], v135 offset:16384
  ds_read_b128 v[72:75], v134 offset:0
  ds_read_b128 v[88:91], v134 offset:2048
  ds_read_b128 v[104:107], v134 offset:4096
  ds_read_b128 v[76:79], v135 offset:0
  ds_read_b128 v[92:95], v135 offset:2048
  ds_read_b128 v[108:111], v135 offset:4096
  s_add_u32 s61, s41, 3
  s_and_b32 s61, s61, 7
  s_lshl_b32 s61, s61, 7
  s_add_u32 s61, s61, s37
  s_add_u32 m0, s34, 0x24000
  s_add_u32 s32, s61, 0x20000
  buffer_load_dwordx4 v1, s[24:27], s32 offen offset:0 lds
  buffer_load_dwordx4 v2, s[24:27], s32 offen offset:1024 lds
  buffer_load_dwordx4 v3, s[24:27], s32 offen offset:2048 lds
  buffer_load_dwordx4 v4, s[24:27], s32 offen offset:3072 lds
  s_add_u32 m0, s34, 0x25000
  s_add_u32 s32, s61, 0x28000
  s_waitcnt lgkmcnt(0)
  v_mfma_f32_16x16x32_bf16 a[0:3], v[32:35], v[64:67], a[0:3]
  buffer_load_dwordx4 v1, s[24:27], s32 offen offset:0 lds
  buffer_load_dwordx4 v2, s[24:27], s32 offen offset:1024 lds
  v_mfma_f32_16x16x32_bf16 a[4:7], v[32:35], v[80:83], a[4:7]
  buffer_load_dwordx4 v3, s[24:27], s32 offen offset:2048 lds
  buffer_load_dwordx4 v4, s[24:27], s32 offen offset:3072 lds
  v_mfma_f32_16x16x32_bf16 a[8:11], v[32:35], v[96:99], a[8:11]
  v_mfma_f32_16x16x32_bf16 a[12:15], v[36:39], v[64:67], a[12:15]
  v_mfma_f32_16x16x32_bf16 a[16:19], v[36:39], v[80:83], a[16:19]
  v_mfma_f32_16x16x32_bf16 a[20:23], v[36:39], v[96:99], a[20:23]
  v_mfma_f32_16x16x32_bf16 a[0:3], v[40:43], v[68:71], a[0:3]
  v_mfma_f32_16x16x32_bf16 a[4:7], v[40:43], v[84:87], a[4:7]
  v_mfma_f32_16x16x32_bf16 a[8:11], v[40:43], v[100:103], a[8:11]
  v_mfma_f32_16x16x32_bf16 a[12:15], v[44:47], v[68:71], a[12:15]
  v_mfma_f32_16x16x32_bf16 a[16:19], v[44:47], v[84:87], a[16:19]
  v_mfma_f32_16x16x32_bf16 a[20:23], v[44:47], v[100:103], a[20:23]
  v_mfma_f32_16x16x32_bf16 a[0:3], v[48:51], v[72:75], a[0:3]
  s_waitcnt vmcnt(40)
  s_barrier
  ds_read_b64_tr_b16 v[32:33], v20 offset:16384
  ds_read_b64_tr_b16 v[34:35], v20 offset:16896
  v_mfma_f32_16x16x32_bf16 a[4:7], v[48:51], v[88:91], a[4:7]
  ds_read_b64_tr_b16 v[36:37], v21 offset:16384
  ds_read_b64_tr_b16 v[38:39], v21 offset:16896
  v_mfma_f32_16x16x32_bf16 a[8:11], v[48:51], v[104:107], a[8:11]
  ds_read_b64_tr_b16 v[40:41], v20 offset:20480
  ds_read_b64_tr_b16 v[42:43], v20 offset:20992
  v_mfma_f32_16x16x32_bf16 a[12:15], v[52:55], v[72:75], a[12:15]
  ds_read_b64_tr_b16 v[44:45], v21 offset:20480
  ds_read_b64_tr_b16 v[46:47], v21 offset:20992
  v_mfma_f32_16x16x32_bf16 a[16:19], v[52:55], v[88:91], a[16:19]
  ds_read_b64_tr_b16 v[48:49], v20 offset:24576
  ds_read_b64_tr_b16 v[50:51], v20 offset:25088
  v_mfma_f32_16x16x32_bf16 a[20:23], v[52:55], v[104:107], a[20:23]
  ds_read_b64_tr_b16 v[52:53], v21 offset:24576
  ds_read_b64_tr_b16 v[54:55], v21 offset:25088
  v_mfma_f32_16x16x32_bf16 a[0:3], v[56:59], v[76:79], a[0:3]
  s_add_u32 s61, s41, 7
  s_and_b32 s61, s61, 7
  v_mfma_f32_16x16x32_bf16 a[4:7], v[56:59], v[92:95], a[4:7]
  s_lshl_b32 s61, s61, 7
  s_add_u32 s61, s61, s37
  v_mfma_f32_16x16x32_bf16 a[8:11], v[56:59], v[108:111], a[8:11]
  ds_read_b64_tr_b16 v[56:57], v20 offset:28672
  ds_read_b64_tr_b16 v[58:59], v20 offset:29184
  v_mfma_f32_16x16x32_bf16 a[12:15], v[60:63], v[76:79], a[12:15]
  s_add_u32 m0, s34, 0x18000
  s_add_u32 s32, s61, 0x20000
  v_mfma_f32_16x16x32_bf16 a[16:19], v[60:63], v[92:95], a[16:19]
  buffer_load_dwordx4 v1, s[24:27], s32 offen offset:0 lds
  buffer_load_dwordx4 v2, s[24:27], s32 offen offset:1024 lds
  v_mfma_f32_16x16x32_bf16 a[20:23], v[60:63], v[108:111], a[20:23]
  ds_read_b64_tr_b16 v[60:61], v21 offset:28672
  ds_read_b64_tr_b16 v[62:63], v21 offset:29184
  buffer_load_dwordx4 v3, s[24:27], s32 offen offset:2048 lds
  buffer_load_dwordx4 v4, s[24:27], s32 offen offset:3072 lds
  s_add_u32 m0, s34, 0x19000
  s_add_u32 s32, s61, 0x28000
  buffer_load_dwordx4 v1, s[24:27], s32 offen offset:0 lds
  buffer_load_dwordx4 v2, s[24:27], s32 offen offset:1024 lds
  buffer_load_dwordx4 v3, s[24:27], s32 offen offset:2048 lds
  buffer_load_dwordx4 v4, s[24:27], s32 offen offset:3072 lds
  s_waitcnt lgkmcnt(12)
  v_mfma_f32_16x16x32_bf16 a[24:27], v[32:35], v[64:67], a[24:27]
  v_mfma_f32_16x16x32_bf16 a[28:31], v[32:35], v[80:83], a[28:31]
  v_mfma_f32_16x16x32_bf16 a[32:35], v[32:35], v[96:99], a[32:35]
  v_mfma_f32_16x16x32_bf16 a[36:39], v[36:39], v[64:67], a[36:39]
  v_mfma_f32_16x16x32_bf16 a[40:43], v[36:39], v[80:83], a[40:43]
  s_add_u32 s33, s41, 0
  s_and_b32 s33, s33, 7
  v_mfma_f32_16x16x32_bf16 a[44:47], v[36:39], v[96:99], a[44:47]
  s_mul_i32 s33, s33, 3072
  v_accvgpr_read_b32 v112, a0
  s_waitcnt lgkmcnt(8)
  v_mfma_f32_16x16x32_bf16 a[24:27], v[40:43], v[68:71], a[24:27]
  v_accvgpr_read_b32 v113, a1
  v_accvgpr_read_b32 v114, a2
  v_mfma_f32_16x16x32_bf16 a[28:31], v[40:43], v[84:87], a[28:31]
  v_accvgpr_read_b32 v115, a3
  v_accvgpr_read_b32 v116, a12
  v_mfma_f32_16x16x32_bf16 a[32:35], v[40:43], v[100:103], a[32:35]
  v_accvgpr_read_b32 v117, a13
  v_accvgpr_read_b32 v118, a14
  v_mfma_f32_16x16x32_bf16 a[36:39], v[44:47], v[68:71], a[36:39]
  v_accvgpr_read_b32 v119, a15
  v_cvt_pk_bf16_f32 v136, v112, v113
  v_mfma_f32_16x16x32_bf16 a[40:43], v[44:47], v[84:87], a[40:43]
  v_cvt_pk_bf16_f32 v137, v114, v115
  v_cvt_pk_bf16_f32 v138, v116, v117
  v_mfma_f32_16x16x32_bf16 a[44:47], v[44:47], v[100:103], a[44:47]
  v_cvt_pk_bf16_f32 v139, v118, v119
  v_accvgpr_read_b32 v120, a4
  s_waitcnt lgkmcnt(0)
  v_mfma_f32_16x16x32_bf16 a[24:27], v[48:51], v[72:75], a[24:27]
  s_waitcnt vmcnt(40)
  s_barrier
  ds_read_b64_tr_b16 v[32:33], v20 offset:32768
  ds_read_b64_tr_b16 v[34:35], v20 offset:33280
  v_mfma_f32_16x16x32_bf16 a[28:31], v[48:51], v[88:91], a[28:31]
  ds_read_b64_tr_b16 v[36:37], v21 offset:32768
  ds_read_b64_tr_b16 v[38:39], v21 offset:33280
  v_mfma_f32_16x16x32_bf16 a[32:35], v[48:51], v[104:107], a[32:35]
  ds_read_b64_tr_b16 v[40:41], v20 offset:36864
  ds_read_b64_tr_b16 v[42:43], v20 offset:37376
  v_mfma_f32_16x16x32_bf16 a[36:39], v[52:55], v[72:75], a[36:39]
  ds_read_b64_tr_b16 v[44:45], v21 offset:36864
  ds_read_b64_tr_b16 v[46:47], v21 offset:37376
  v_mfma_f32_16x16x32_bf16 a[40:43], v[52:55], v[88:91], a[40:43]
  ds_read_b64_tr_b16 v[48:49], v20 offset:40960
  ds_read_b64_tr_b16 v[50:51], v20 offset:41472
  v_mfma_f32_16x16x32_bf16 a[44:47], v[52:55], v[104:107], a[44:47]
  ds_read_b64_tr_b16 v[52:53], v21 offset:40960
  ds_read_b64_tr_b16 v[54:55], v21 offset:41472
  v_mfma_f32_16x16x32_bf16 a[24:27], v[56:59], v[76:79], a[24:27]
  v_accvgpr_read_b32 v121, a5
  v_accvgpr_read_b32 v122, a6
  v_mfma_f32_16x16x32_bf16 a[28:31], v[56:59], v[92:95], a[28:31]
  v_accvgpr_read_b32 v123, a7
  v_accvgpr_read_b32 v124, a16
  v_mfma_f32_16x16x32_bf16 a[32:35], v[56:59], v[108:111], a[32:35]
  ds_read_b64_tr_b16 v[56:57], v20 offset:45056
  ds_read_b64_tr_b16 v[58:59], v20 offset:45568
  v_mfma_f32_16x16x32_bf16 a[36:39], v[60:63], v[76:79], a[36:39]
  v_accvgpr_read_b32 v125, a17
  v_accvgpr_read_b32 v126, a18
  v_mfma_f32_16x16x32_bf16 a[40:43], v[60:63], v[92:95], a[40:43]
  v_accvgpr_read_b32 v127, a19
  v_permlane16_swap_b32 v136, v138
  v_mfma_f32_16x16x32_bf16 a[44:47], v[60:63], v[108:111], a[44:47]
  ds_read_b64_tr_b16 v[60:61], v21 offset:45056
  ds_read_b64_tr_b16 v[62:63], v21 offset:45568
  v_permlane16_swap_b32 v137, v139
  v_cvt_pk_bf16_f32 v140, v120, v121
  v_cvt_pk_bf16_f32 v141, v122, v123
  v_cvt_pk_bf16_f32 v142, v124, v125
  v_cvt_pk_bf16_f32 v143, v126, v127
  v_accvgpr_read_b32 v128, a8
  v_accvgpr_read_b32 v129, a9
  v_accvgpr_read_b32 v130, a10
  v_accvgpr_read_b32 v131, a11
  v_accvgpr_read_b32 v132, a20
  v_accvgpr_read_b32 v133, a21
  v_accvgpr_read_b32 v134, a22
  v_accvgpr_read_b32 v135, a23
  buffer_store_dwordx4 v[136:139], v0, s[28:31], s33 offen offset:0 sc1
  v_permlane16_swap_b32 v140, v142
  v_permlane16_swap_b32 v141, v143
  v_cvt_pk_bf16_f32 v144, v128, v129
  v_cvt_pk_bf16_f32 v145, v130, v131
  v_cvt_pk_bf16_f32 v146, v132, v133
  v_cvt_pk_bf16_f32 v147, v134, v135
  buffer_store_dwordx4 v[140:143], v0, s[28:31], s33 offen offset:1024 sc1
  s_nop 0
  v_permlane16_swap_b32 v144, v146
  v_permlane16_swap_b32 v145, v147
  buffer_store_dwordx4 v[144:147], v0, s[28:31], s33 offen offset:2048 sc1
  s_waitcnt lgkmcnt(12)
  v_mfma_f32_16x16x32_bf16 a[48:51], v[32:35], v[64:67], a[48:51]
  v_mfma_f32_16x16x32_bf16 a[52:55], v[32:35], v[80:83], a[52:55]
  v_mfma_f32_16x16x32_bf16 a[56:59], v[32:35], v[96:99], a[56:59]
  v_mfma_f32_16x16x32_bf16 a[60:63], v[36:39], v[64:67], a[60:63]
  v_mfma_f32_16x16x32_bf16 a[64:67], v[36:39], v[80:83], a[64:67]
  s_add_u32 s33, s41, 1
  s_and_b32 s33, s33, 7
  v_mfma_f32_16x16x32_bf16 a[68:71], v[36:39], v[96:99], a[68:71]
  s_mul_i32 s33, s33, 3072
  v_accvgpr_read_b32 v112, a24
  s_waitcnt lgkmcnt(8)
  v_mfma_f32_16x16x32_bf16 a[48:51], v[40:43], v[68:71], a[48:51]
  v_accvgpr_read_b32 v113, a25
  v_accvgpr_read_b32 v114, a26
  v_mfma_f32_16x16x32_bf16 a[52:55], v[40:43], v[84:87], a[52:55]
  v_accvgpr_read_b32 v115, a27
  v_accvgpr_read_b32 v116, a36
  v_mfma_f32_16x16x32_bf16 a[56:59], v[40:43], v[100:103], a[56:59]
  v_accvgpr_read_b32 v117, a37
  v_accvgpr_read_b32 v118, a38
  v_mfma_f32_16x16x32_bf16 a[60:63], v[44:47], v[68:71], a[60:63]
  v_accvgpr_read_b32 v119, a39
  v_cvt_pk_bf16_f32 v136, v112, v113
  v_mfma_f32_16x16x32_bf16 a[64:67], v[44:47], v[84:87], a[64:67]
  v_cvt_pk_bf16_f32 v137, v114, v115
  v_cvt_pk_bf16_f32 v138, v116, v117
  v_mfma_f32_16x16x32_bf16 a[68:71], v[44:47], v[100:103], a[68:71]
  v_cvt_pk_bf16_f32 v139, v118, v119
  v_accvgpr_read_b32 v120, a28
  s_waitcnt lgkmcnt(0)
  v_mfma_f32_16x16x32_bf16 a[48:51], v[48:51], v[72:75], a[48:51]
  s_waitcnt vmcnt(11)
  s_barrier
  ds_read_b64_tr_b16 v[32:33], v20 offset:49152
  ds_read_b64_tr_b16 v[34:35], v20 offset:49664
  v_mfma_f32_16x16x32_bf16 a[52:55], v[48:51], v[88:91], a[52:55]
  ds_read_b64_tr_b16 v[36:37], v21 offset:49152
  ds_read_b64_tr_b16 v[38:39], v21 offset:49664
  v_mfma_f32_16x16x32_bf16 a[56:59], v[48:51], v[104:107], a[56:59]
  ds_read_b64_tr_b16 v[40:41], v20 offset:53248
  ds_read_b64_tr_b16 v[42:43], v20 offset:53760
  v_mfma_f32_16x16x32_bf16 a[60:63], v[52:55], v[72:75], a[60:63]
  ds_read_b64_tr_b16 v[44:45], v21 offset:53248
  ds_read_b64_tr_b16 v[46:47], v21 offset:53760
  v_mfma_f32_16x16x32_bf16 a[64:67], v[52:55], v[88:91], a[64:67]
  ds_read_b64_tr_b16 v[48:49], v20 offset:57344
  ds_read_b64_tr_b16 v[50:51], v20 offset:57856
  v_mfma_f32_16x16x32_bf16 a[68:71], v[52:55], v[104:107], a[68:71]
  ds_read_b64_tr_b16 v[52:53], v21 offset:57344
  ds_read_b64_tr_b16 v[54:55], v21 offset:57856
  v_mfma_f32_16x16x32_bf16 a[48:51], v[56:59], v[76:79], a[48:51]
  v_accvgpr_read_b32 v121, a29
  v_accvgpr_read_b32 v122, a30
  v_mfma_f32_16x16x32_bf16 a[52:55], v[56:59], v[92:95], a[52:55]
  v_accvgpr_read_b32 v123, a31
  v_accvgpr_read_b32 v124, a40
  v_mfma_f32_16x16x32_bf16 a[56:59], v[56:59], v[108:111], a[56:59]
  ds_read_b64_tr_b16 v[56:57], v20 offset:61440
  ds_read_b64_tr_b16 v[58:59], v20 offset:61952
  v_mfma_f32_16x16x32_bf16 a[60:63], v[60:63], v[76:79], a[60:63]
  v_accvgpr_read_b32 v125, a41
  v_accvgpr_read_b32 v126, a42
  v_mfma_f32_16x16x32_bf16 a[64:67], v[60:63], v[92:95], a[64:67]
  v_accvgpr_read_b32 v127, a43
  v_permlane16_swap_b32 v136, v138
  v_mfma_f32_16x16x32_bf16 a[68:71], v[60:63], v[108:111], a[68:71]
  ds_read_b64_tr_b16 v[60:61], v21 offset:61440
  ds_read_b64_tr_b16 v[62:63], v21 offset:61952
  v_permlane16_swap_b32 v137, v139
  v_cvt_pk_bf16_f32 v140, v120, v121
  v_cvt_pk_bf16_f32 v141, v122, v123
  v_cvt_pk_bf16_f32 v142, v124, v125
  v_cvt_pk_bf16_f32 v143, v126, v127
  v_accvgpr_read_b32 v128, a32
  v_accvgpr_read_b32 v129, a33
  v_accvgpr_read_b32 v130, a34
  v_accvgpr_read_b32 v131, a35
  v_accvgpr_read_b32 v132, a44
  v_accvgpr_read_b32 v133, a45
  v_accvgpr_read_b32 v134, a46
  v_accvgpr_read_b32 v135, a47
  buffer_store_dwordx4 v[136:139], v0, s[28:31], s33 offen offset:0 sc1
  v_permlane16_swap_b32 v140, v142
  v_permlane16_swap_b32 v141, v143
  v_cvt_pk_bf16_f32 v144, v128, v129
  v_cvt_pk_bf16_f32 v145, v130, v131
  v_cvt_pk_bf16_f32 v146, v132, v133
  v_cvt_pk_bf16_f32 v147, v134, v135
  buffer_store_dwordx4 v[140:143], v0, s[28:31], s33 offen offset:1024 sc1
  s_nop 0
  v_permlane16_swap_b32 v144, v146
  v_permlane16_swap_b32 v145, v147
  buffer_store_dwordx4 v[144:147], v0, s[28:31], s33 offen offset:2048 sc1
  s_waitcnt lgkmcnt(12)
  v_mfma_f32_16x16x32_bf16 a[72:75], v[32:35], v[64:67], a[72:75]
  v_mfma_f32_16x16x32_bf16 a[76:79], v[32:35], v[80:83], a[76:79]
  v_mfma_f32_16x16x32_bf16 a[80:83], v[32:35], v[96:99], a[80:83]
  v_mfma_f32_16x16x32_bf16 a[84:87], v[36:39], v[64:67], a[84:87]
  v_mfma_f32_16x16x32_bf16 a[88:91], v[36:39], v[80:83], a[88:91]
  s_add_u32 s33, s41, 2
  s_and_b32 s33, s33, 7
  v_mfma_f32_16x16x32_bf16 a[92:95], v[36:39], v[96:99], a[92:95]
  s_mul_i32 s33, s33, 3072
  v_accvgpr_read_b32 v112, a48
  s_waitcnt lgkmcnt(8)
  v_mfma_f32_16x16x32_bf16 a[72:75], v[40:43], v[68:71], a[72:75]
  v_accvgpr_read_b32 v113, a49
  v_accvgpr_read_b32 v114, a50
  v_mfma_f32_16x16x32_bf16 a[76:79], v[40:43], v[84:87], a[76:79]
  v_accvgpr_read_b32 v115, a51
  v_accvgpr_read_b32 v116, a60
  v_mfma_f32_16x16x32_bf16 a[80:83], v[40:43], v[100:103], a[80:83]
  v_accvgpr_read_b32 v117, a61
  v_accvgpr_read_b32 v118, a62
  v_mfma_f32_16x16x32_bf16 a[84:87], v[44:47], v[68:71], a[84:87]
  v_accvgpr_read_b32 v119, a63
  v_cvt_pk_bf16_f32 v136, v112, v113
  v_mfma_f32_16x16x32_bf16 a[88:91], v[44:47], v[84:87], a[88:91]
  v_cvt_pk_bf16_f32 v137, v114, v115
  v_cvt_pk_bf16_f32 v138, v116, v117
  v_mfma_f32_16x16x32_bf16 a[92:95], v[44:47], v[100:103], a[92:95]
  v_cvt_pk_bf16_f32 v139, v118, v119
  v_accvgpr_read_b32 v120, a52
  s_waitcnt lgkmcnt(0)
  v_mfma_f32_16x16x32_bf16 a[72:75], v[48:51], v[72:75], a[72:75]
  s_barrier
  v_subrev_u32 v20, 0x8000, v20
  ds_read_b64_tr_b16 v[32:33], v20 offset:0
  ds_read_b64_tr_b16 v[34:35], v20 offset:512
  v_mfma_f32_16x16x32_bf16 a[76:79], v[48:51], v[88:91], a[76:79]
  v_subrev_u32 v21, 0x8000, v21
  ds_read_b64_tr_b16 v[36:37], v21 offset:0
  ds_read_b64_tr_b16 v[38:39], v21 offset:512
  v_mfma_f32_16x16x32_bf16 a[80:83], v[48:51], v[104:107], a[80:83]
  ds_read_b64_tr_b16 v[40:41], v20 offset:4096
  ds_read_b64_tr_b16 v[42:43], v20 offset:4608
  v_mfma_f32_16x16x32_bf16 a[84:87], v[52:55], v[72:75], a[84:87]
  ds_read_b64_tr_b16 v[44:45], v21 offset:4096
  ds_read_b64_tr_b16 v[46:47], v21 offset:4608
  v_mfma_f32_16x16x32_bf16 a[88:91], v[52:55], v[88:91], a[88:91]
  ds_read_b64_tr_b16 v[48:49], v20 offset:8192
  ds_read_b64_tr_b16 v[50:51], v20 offset:8704
  v_mfma_f32_16x16x32_bf16 a[92:95], v[52:55], v[104:107], a[92:95]
  ds_read_b64_tr_b16 v[52:53], v21 offset:8192
  ds_read_b64_tr_b16 v[54:55], v21 offset:8704
  v_mfma_f32_16x16x32_bf16 a[72:75], v[56:59], v[76:79], a[72:75]
  v_accvgpr_read_b32 v121, a53
  v_accvgpr_read_b32 v122, a54
  v_mfma_f32_16x16x32_bf16 a[76:79], v[56:59], v[92:95], a[76:79]
  v_accvgpr_read_b32 v123, a55
  v_accvgpr_read_b32 v124, a64
  v_mfma_f32_16x16x32_bf16 a[80:83], v[56:59], v[108:111], a[80:83]
  ds_read_b64_tr_b16 v[56:57], v20 offset:12288
  ds_read_b64_tr_b16 v[58:59], v20 offset:12800
  v_mfma_f32_16x16x32_bf16 a[84:87], v[60:63], v[76:79], a[84:87]
  v_accvgpr_read_b32 v125, a65
  v_accvgpr_read_b32 v126, a66
  v_mfma_f32_16x16x32_bf16 a[88:91], v[60:63], v[92:95], a[88:91]
  v_accvgpr_read_b32 v127, a67
  v_permlane16_swap_b32 v136, v138
  v_mfma_f32_16x16x32_bf16 a[92:95], v[60:63], v[108:111], a[92:95]
  ds_read_b64_tr_b16 v[60:61], v21 offset:12288
  ds_read_b64_tr_b16 v[62:63], v21 offset:12800
  v_permlane16_swap_b32 v137, v139
  v_cvt_pk_bf16_f32 v140, v120, v121
  v_cvt_pk_bf16_f32 v141, v122, v123
  v_cvt_pk_bf16_f32 v142, v124, v125
  v_cvt_pk_bf16_f32 v143, v126, v127
  v_accvgpr_read_b32 v128, a56
  v_accvgpr_read_b32 v129, a57
  v_accvgpr_read_b32 v130, a58
  v_accvgpr_read_b32 v131, a59
  v_accvgpr_read_b32 v132, a68
  v_accvgpr_read_b32 v133, a69
  v_accvgpr_read_b32 v134, a70
  v_accvgpr_read_b32 v135, a71
  buffer_store_dwordx4 v[136:139], v0, s[28:31], s33 offen offset:0 sc1
  v_permlane16_swap_b32 v140, v142
  v_permlane16_swap_b32 v141, v143
  v_cvt_pk_bf16_f32 v144, v128, v129
  v_cvt_pk_bf16_f32 v145, v130, v131
  v_cvt_pk_bf16_f32 v146, v132, v133
  v_cvt_pk_bf16_f32 v147, v134, v135
  buffer_store_dwordx4 v[140:143], v0, s[28:31], s33 offen offset:1024 sc1
  s_nop 0
  v_permlane16_swap_b32 v144, v146
  v_permlane16_swap_b32 v145, v147
  buffer_store_dwordx4 v[144:147], v0, s[28:31], s33 offen offset:2048 sc1
  s_waitcnt lgkmcnt(12)
  v_mfma_f32_16x16x32_bf16 a[96:99], v[32:35], v[64:67], a[96:99]
  v_mfma_f32_16x16x32_bf16 a[100:103], v[32:35], v[80:83], a[100:103]
  v_mfma_f32_16x16x32_bf16 a[104:107], v[32:35], v[96:99], a[104:107]
  v_mfma_f32_16x16x32_bf16 a[108:111], v[36:39], v[64:67], a[108:111]
  v_mfma_f32_16x16x32_bf16 a[112:115], v[36:39], v[80:83], a[112:115]
  s_add_u32 s33, s41, 3
  s_and_b32 s33, s33, 7
  v_mfma_f32_16x16x32_bf16 a[116:119], v[36:39], v[96:99], a[116:119]
  s_mul_i32 s33, s33, 3072
  v_accvgpr_read_b32 v112, a72
  s_waitcnt lgkmcnt(8)
  v_mfma_f32_16x16x32_bf16 a[96:99], v[40:43], v[68:71], a[96:99]
  v_accvgpr_read_b32 v113, a73
  v_accvgpr_read_b32 v114, a74
  v_mfma_f32_16x16x32_bf16 a[100:103], v[40:43], v[84:87], a[100:103]
  v_accvgpr_read_b32 v115, a75
  v_accvgpr_read_b32 v116, a84
  v_mfma_f32_16x16x32_bf16 a[104:107], v[40:43], v[100:103], a[104:107]
  v_accvgpr_read_b32 v117, a85
  v_accvgpr_read_b32 v118, a86
  v_mfma_f32_16x16x32_bf16 a[108:111], v[44:47], v[68:71], a[108:111]
  v_accvgpr_read_b32 v119, a87
  v_cvt_pk_bf16_f32 v136, v112, v113
  v_mfma_f32_16x16x32_bf16 a[112:115], v[44:47], v[84:87], a[112:115]
  v_cvt_pk_bf16_f32 v137, v114, v115
  v_cvt_pk_bf16_f32 v138, v116, v117
  v_mfma_f32_16x16x32_bf16 a[116:119], v[44:47], v[100:103], a[116:119]
  v_cvt_pk_bf16_f32 v139, v118, v119
  v_accvgpr_read_b32 v120, a76
  s_waitcnt lgkmcnt(0)
  v_mfma_f32_16x16x32_bf16 a[96:99], v[48:51], v[72:75], a[96:99]
  s_barrier
  ds_read_b64_tr_b16 v[32:33], v20 offset:16384
  ds_read_b64_tr_b16 v[34:35], v20 offset:16896
  v_mfma_f32_16x16x32_bf16 a[100:103], v[48:51], v[88:91], a[100:103]
  ds_read_b64_tr_b16 v[36:37], v21 offset:16384
  ds_read_b64_tr_b16 v[38:39], v21 offset:16896
  v_mfma_f32_16x16x32_bf16 a[104:107], v[48:51], v[104:107], a[104:107]
  ds_read_b64_tr_b16 v[40:41], v20 offset:20480
  ds_read_b64_tr_b16 v[42:43], v20 offset:20992
  v_mfma_f32_16x16x32_bf16 a[108:111], v[52:55], v[72:75], a[108:111]
  ds_read_b64_tr_b16 v[44:45], v21 offset:20480
  ds_read_b64_tr_b16 v[46:47], v21 offset:20992
  v_mfma_f32_16x16x32_bf16 a[112:115], v[52:55], v[88:91], a[112:115]
  ds_read_b64_tr_b16 v[48:49], v20 offset:24576
  ds_read_b64_tr_b16 v[50:51], v20 offset:25088
  v_mfma_f32_16x16x32_bf16 a[116:119], v[52:55], v[104:107], a[116:119]
  ds_read_b64_tr_b16 v[52:53], v21 offset:24576
  ds_read_b64_tr_b16 v[54:55], v21 offset:25088
  v_mfma_f32_16x16x32_bf16 a[96:99], v[56:59], v[76:79], a[96:99]
  v_accvgpr_read_b32 v121, a77
  v_accvgpr_read_b32 v122, a78
  v_mfma_f32_16x16x32_bf16 a[100:103], v[56:59], v[92:95], a[100:103]
  v_accvgpr_read_b32 v123, a79
  v_accvgpr_read_b32 v124, a88
  v_mfma_f32_16x16x32_bf16 a[104:107], v[56:59], v[108:111], a[104:107]
  ds_read_b64_tr_b16 v[56:57], v20 offset:28672
  ds_read_b64_tr_b16 v[58:59], v20 offset:29184
  v_mfma_f32_16x16x32_bf16 a[108:111], v[60:63], v[76:79], a[108:111]
  v_accvgpr_read_b32 v125, a89
  v_accvgpr_read_b32 v126, a90
  v_mfma_f32_16x16x32_bf16 a[112:115], v[60:63], v[92:95], a[112:115]
  v_accvgpr_read_b32 v127, a91
  v_permlane16_swap_b32 v136, v138
  v_mfma_f32_16x16x32_bf16 a[116:119], v[60:63], v[108:111], a[116:119]
  ds_read_b64_tr_b16 v[60:61], v21 offset:28672
  ds_read_b64_tr_b16 v[62:63], v21 offset:29184
  v_permlane16_swap_b32 v137, v139
  v_cvt_pk_bf16_f32 v140, v120, v121
  v_cvt_pk_bf16_f32 v141, v122, v123
  v_cvt_pk_bf16_f32 v142, v124, v125
  v_cvt_pk_bf16_f32 v143, v126, v127
  v_accvgpr_read_b32 v128, a80
  v_accvgpr_read_b32 v129, a81
  v_accvgpr_read_b32 v130, a82
  v_accvgpr_read_b32 v131, a83
  v_accvgpr_read_b32 v132, a92
  v_accvgpr_read_b32 v133, a93
  v_accvgpr_read_b32 v134, a94
  v_accvgpr_read_b32 v135, a95
  buffer_store_dwordx4 v[136:139], v0, s[28:31], s33 offen offset:0 sc1
  v_permlane16_swap_b32 v140, v142
  v_permlane16_swap_b32 v141, v143
  v_cvt_pk_bf16_f32 v144, v128, v129
  v_cvt_pk_bf16_f32 v145, v130, v131
  v_cvt_pk_bf16_f32 v146, v132, v133
  v_cvt_pk_bf16_f32 v147, v134, v135
  buffer_store_dwordx4 v[140:143], v0, s[28:31], s33 offen offset:1024 sc1
  s_nop 0
  v_permlane16_swap_b32 v144, v146
  v_permlane16_swap_b32 v145, v147
  buffer_store_dwordx4 v[144:147], v0, s[28:31], s33 offen offset:2048 sc1
  s_waitcnt lgkmcnt(12)
  v_mfma_f32_16x16x32_bf16 a[120:123], v[32:35], v[64:67], a[120:123]
  v_mfma_f32_16x16x32_bf16 a[124:127], v[32:35], v[80:83], a[124:127]
  v_mfma_f32_16x16x32_bf16 a[128:131], v[32:35], v[96:99], a[128:131]
  v_mfma_f32_16x16x32_bf16 a[132:135], v[36:39], v[64:67], a[132:135]
  v_mfma_f32_16x16x32_bf16 a[136:139], v[36:39], v[80:83], a[136:139]
  s_add_u32 s33, s41, 4
  s_and_b32 s33, s33, 7
  v_mfma_f32_16x16x32_bf16 a[140:143], v[36:39], v[96:99], a[140:143]
  s_mul_i32 s33, s33, 3072
  v_accvgpr_read_b32 v112, a96
  s_waitcnt lgkmcnt(8)
  v_mfma_f32_16x16x32_bf16 a[120:123], v[40:43], v[68:71], a[120:123]
  v_accvgpr_read_b32 v113, a97
  v_accvgpr_read_b32 v114, a98
  v_mfma_f32_16x16x32_bf16 a[124:127], v[40:43], v[84:87], a[124:127]
  v_accvgpr_read_b32 v115, a99
  v_accvgpr_read_b32 v116, a108
  v_mfma_f32_16x16x32_bf16 a[128:131], v[40:43], v[100:103], a[128:131]
  v_accvgpr_read_b32 v117, a109
  v_accvgpr_read_b32 v118, a110
  v_mfma_f32_16x16x32_bf16 a[132:135], v[44:47], v[68:71], a[132:135]
  v_accvgpr_read_b32 v119, a111
  v_cvt_pk_bf16_f32 v136, v112, v113
  v_mfma_f32_16x16x32_bf16 a[136:139], v[44:47], v[84:87], a[136:139]
  v_cvt_pk_bf16_f32 v137, v114, v115
  v_cvt_pk_bf16_f32 v138, v116, v117
  v_mfma_f32_16x16x32_bf16 a[140:143], v[44:47], v[100:103], a[140:143]
  v_cvt_pk_bf16_f32 v139, v118, v119
  v_accvgpr_read_b32 v120, a100
  s_waitcnt lgkmcnt(0)
  v_mfma_f32_16x16x32_bf16 a[120:123], v[48:51], v[72:75], a[120:123]
  s_barrier
  v_subrev_u32 v20, 0x10000, v20
  ds_read_b64_tr_b16 v[32:33], v20 offset:0
  ds_read_b64_tr_b16 v[34:35], v20 offset:512
  v_mfma_f32_16x16x32_bf16 a[124:127], v[48:51], v[88:91], a[124:127]
  v_subrev_u32 v21, 0x10000, v21
  ds_read_b64_tr_b16 v[36:37], v21 offset:0
  ds_read_b64_tr_b16 v[38:39], v21 offset:512
  v_mfma_f32_16x16x32_bf16 a[128:131], v[48:51], v[104:107], a[128:131]
  ds_read_b64_tr_b16 v[40:41], v20 offset:4096
  ds_read_b64_tr_b16 v[42:43], v20 offset:4608
  v_mfma_f32_16x16x32_bf16 a[132:135], v[52:55], v[72:75], a[132:135]
  ds_read_b64_tr_b16 v[44:45], v21 offset:4096
  ds_read_b64_tr_b16 v[46:47], v21 offset:4608
  v_mfma_f32_16x16x32_bf16 a[136:139], v[52:55], v[88:91], a[136:139]
  ds_read_b64_tr_b16 v[48:49], v20 offset:8192
  ds_read_b64_tr_b16 v[50:51], v20 offset:8704
  v_mfma_f32_16x16x32_bf16 a[140:143], v[52:55], v[104:107], a[140:143]
  ds_read_b64_tr_b16 v[52:53], v21 offset:8192
  ds_read_b64_tr_b16 v[54:55], v21 offset:8704
  v_mfma_f32_16x16x32_bf16 a[120:123], v[56:59], v[76:79], a[120:123]
  v_accvgpr_read_b32 v121, a101
  v_accvgpr_read_b32 v122, a102
  v_mfma_f32_16x16x32_bf16 a[124:127], v[56:59], v[92:95], a[124:127]
  v_accvgpr_read_b32 v123, a103
  v_accvgpr_read_b32 v124, a112
  v_mfma_f32_16x16x32_bf16 a[128:131], v[56:59], v[108:111], a[128:131]
  ds_read_b64_tr_b16 v[56:57], v20 offset:12288
  ds_read_b64_tr_b16 v[58:59], v20 offset:12800
  v_mfma_f32_16x16x32_bf16 a[132:135], v[60:63], v[76:79], a[132:135]
  v_accvgpr_read_b32 v125, a113
  v_accvgpr_read_b32 v126, a114
  v_mfma_f32_16x16x32_bf16 a[136:139], v[60:63], v[92:95], a[136:139]
  v_accvgpr_read_b32 v127, a115
  v_permlane16_swap_b32 v136, v138
  v_mfma_f32_16x16x32_bf16 a[140:143], v[60:63], v[108:111], a[140:143]
  ds_read_b64_tr_b16 v[60:61], v21 offset:12288
  ds_read_b64_tr_b16 v[62:63], v21 offset:12800
  v_permlane16_swap_b32 v137, v139
  v_cvt_pk_bf16_f32 v140, v120, v121
  v_cvt_pk_bf16_f32 v141, v122, v123
  v_cvt_pk_bf16_f32 v142, v124, v125
  v_cvt_pk_bf16_f32 v143, v126, v127
  v_accvgpr_read_b32 v128, a104
  v_accvgpr_read_b32 v129, a105
  v_accvgpr_read_b32 v130, a106
  v_accvgpr_read_b32 v131, a107
  v_accvgpr_read_b32 v132, a116
  v_accvgpr_read_b32 v133, a117
  v_accvgpr_read_b32 v134, a118
  v_accvgpr_read_b32 v135, a119
  buffer_store_dwordx4 v[136:139], v0, s[28:31], s33 offen offset:0 sc1
  v_permlane16_swap_b32 v140, v142
  v_permlane16_swap_b32 v141, v143
  v_cvt_pk_bf16_f32 v144, v128, v129
  v_cvt_pk_bf16_f32 v145, v130, v131
  v_cvt_pk_bf16_f32 v146, v132, v133
  v_cvt_pk_bf16_f32 v147, v134, v135
  buffer_store_dwordx4 v[140:143], v0, s[28:31], s33 offen offset:1024 sc1
  s_nop 0
  v_permlane16_swap_b32 v144, v146
  v_permlane16_swap_b32 v145, v147
  buffer_store_dwordx4 v[144:147], v0, s[28:31], s33 offen offset:2048 sc1
  s_waitcnt lgkmcnt(12)
  v_mfma_f32_16x16x32_bf16 a[144:147], v[32:35], v[64:67], a[144:147]
  v_mfma_f32_16x16x32_bf16 a[148:151], v[32:35], v[80:83], a[148:151]
  v_mfma_f32_16x16x32_bf16 a[152:155], v[32:35], v[96:99], a[152:155]
  v_mfma_f32_16x16x32_bf16 a[156:159], v[36:39], v[64:67], a[156:159]
  v_mfma_f32_16x16x32_bf16 a[160:163], v[36:39], v[80:83], a[160:163]
  s_add_u32 s33, s41, 5
  s_and_b32 s33, s33, 7
  v_mfma_f32_16x16x32_bf16 a[164:167], v[36:39], v[96:99], a[164:167]
  s_mul_i32 s33, s33, 3072
  v_accvgpr_read_b32 v112, a120
  s_waitcnt lgkmcnt(8)
  v_mfma_f32_16x16x32_bf16 a[144:147], v[40:43], v[68:71], a[144:147]
  v_accvgpr_read_b32 v113, a121
  v_accvgpr_read_b32 v114, a122
  v_mfma_f32_16x16x32_bf16 a[148:151], v[40:43], v[84:87], a[148:151]
  v_accvgpr_read_b32 v115, a123
  v_accvgpr_read_b32 v116, a132
  v_mfma_f32_16x16x32_bf16 a[152:155], v[40:43], v[100:103], a[152:155]
  v_accvgpr_read_b32 v117, a133
  v_accvgpr_read_b32 v118, a134
  v_mfma_f32_16x16x32_bf16 a[156:159], v[44:47], v[68:71], a[156:159]
  v_accvgpr_read_b32 v119, a135
  v_cvt_pk_bf16_f32 v136, v112, v113
  v_mfma_f32_16x16x32_bf16 a[160:163], v[44:47], v[84:87], a[160:163]
  v_cvt_pk_bf16_f32 v137, v114, v115
  v_cvt_pk_bf16_f32 v138, v116, v117
  v_mfma_f32_16x16x32_bf16 a[164:167], v[44:47], v[100:103], a[164:167]
  v_cvt_pk_bf16_f32 v139, v118, v119
  v_accvgpr_read_b32 v120, a124
  s_waitcnt lgkmcnt(0)
  v_mfma_f32_16x16x32_bf16 a[144:147], v[48:51], v[72:75], a[144:147]
  s_waitcnt vmcnt(15)
  s_barrier
  v_add_u32 v20, 0x18000, v20
  ds_read_b64_tr_b16 v[32:33], v20 offset:0
  ds_read_b64_tr_b16 v[34:35], v20 offset:512
  v_mfma_f32_16x16x32_bf16 a[148:151], v[48:51], v[88:91], a[148:151]
  v_add_u32 v21, 0x18000, v21
  ds_read_b64_tr_b16 v[36:37], v21 offset:0
  ds_read_b64_tr_b16 v[38:39], v21 offset:512
  v_mfma_f32_16x16x32_bf16 a[152:155], v[48:51], v[104:107], a[152:155]
  ds_read_b64_tr_b16 v[40:41], v20 offset:4096
  ds_read_b64_tr_b16 v[42:43], v20 offset:4608
  v_mfma_f32_16x16x32_bf16 a[156:159], v[52:55], v[72:75], a[156:159]
  ds_read_b64_tr_b16 v[44:45], v21 offset:4096
  ds_read_b64_tr_b16 v[46:47], v21 offset:4608
  v_mfma_f32_16x16x32_bf16 a[160:163], v[52:55], v[88:91], a[160:163]
  ds_read_b64_tr_b16 v[48:49], v20 offset:8192
  ds_read_b64_tr_b16 v[50:51], v20 offset:8704
  v_mfma_f32_16x16x32_bf16 a[164:167], v[52:55], v[104:107], a[164:167]
  ds_read_b64_tr_b16 v[52:53], v21 offset:8192
  ds_read_b64_tr_b16 v[54:55], v21 offset:8704
  v_mfma_f32_16x16x32_bf16 a[144:147], v[56:59], v[76:79], a[144:147]
  v_accvgpr_read_b32 v121, a125
  v_accvgpr_read_b32 v122, a126
  v_mfma_f32_16x16x32_bf16 a[148:151], v[56:59], v[92:95], a[148:151]
  v_accvgpr_read_b32 v123, a127
  v_accvgpr_read_b32 v124, a136
  v_mfma_f32_16x16x32_bf16 a[152:155], v[56:59], v[108:111], a[152:155]
  ds_read_b64_tr_b16 v[56:57], v20 offset:12288
  ds_read_b64_tr_b16 v[58:59], v20 offset:12800
  v_mfma_f32_16x16x32_bf16 a[156:159], v[60:63], v[76:79], a[156:159]
  v_accvgpr_read_b32 v125, a137
  v_accvgpr_read_b32 v126, a138
  v_mfma_f32_16x16x32_bf16 a[160:163], v[60:63], v[92:95], a[160:163]
  v_accvgpr_read_b32 v127, a139
  v_permlane16_swap_b32 v136, v138
  v_mfma_f32_16x16x32_bf16 a[164:167], v[60:63], v[108:111], a[164:167]
  ds_read_b64_tr_b16 v[60:61], v21 offset:12288
  ds_read_b64_tr_b16 v[62:63], v21 offset:12800
  v_permlane16_swap_b32 v137, v139
  v_cvt_pk_bf16_f32 v140, v120, v121
  v_cvt_pk_bf16_f32 v141, v122, v123
  v_cvt_pk_bf16_f32 v142, v124, v125
  v_cvt_pk_bf16_f32 v143, v126, v127
  v_accvgpr_read_b32 v128, a128
  v_accvgpr_read_b32 v129, a129
  v_accvgpr_read_b32 v130, a130
  v_accvgpr_read_b32 v131, a131
  v_accvgpr_read_b32 v132, a140
  v_accvgpr_read_b32 v133, a141
  v_accvgpr_read_b32 v134, a142
  v_accvgpr_read_b32 v135, a143
  buffer_store_dwordx4 v[136:139], v0, s[28:31], s33 offen offset:0 sc1
  v_permlane16_swap_b32 v140, v142
  v_permlane16_swap_b32 v141, v143
  v_cvt_pk_bf16_f32 v144, v128, v129
  v_cvt_pk_bf16_f32 v145, v130, v131
  v_cvt_pk_bf16_f32 v146, v132, v133
  v_cvt_pk_bf16_f32 v147, v134, v135
  buffer_store_dwordx4 v[140:143], v0, s[28:31], s33 offen offset:1024 sc1
  s_nop 0
  v_permlane16_swap_b32 v144, v146
  v_permlane16_swap_b32 v145, v147
  buffer_store_dwordx4 v[144:147], v0, s[28:31], s33 offen offset:2048 sc1
  s_waitcnt lgkmcnt(12)
  v_mfma_f32_16x16x32_bf16 a[168:171], v[32:35], v[64:67], a[168:171]
  v_mfma_f32_16x16x32_bf16 a[172:175], v[32:35], v[80:83], a[172:175]
  v_mfma_f32_16x16x32_bf16 a[176:179], v[32:35], v[96:99], a[176:179]
  v_mfma_f32_16x16x32_bf16 a[180:183], v[36:39], v[64:67], a[180:183]
  v_mfma_f32_16x16x32_bf16 a[184:187], v[36:39], v[80:83], a[184:187]
  s_add_u32 s33, s41, 6
  s_and_b32 s33, s33, 7
  v_mfma_f32_16x16x32_bf16 a[188:191], v[36:39], v[96:99], a[188:191]
  s_mul_i32 s33, s33, 3072
  v_accvgpr_read_b32 v112, a144
  s_waitcnt lgkmcnt(8)
  v_mfma_f32_16x16x32_bf16 a[168:171], v[40:43], v[68:71], a[168:171]
  v_accvgpr_read_b32 v113, a145
  v_accvgpr_read_b32 v114, a146
  v_mfma_f32_16x16x32_bf16 a[172:175], v[40:43], v[84:87], a[172:175]
  v_accvgpr_read_b32 v115, a147
  v_accvgpr_read_b32 v116, a156
  v_mfma_f32_16x16x32_bf16 a[176:179], v[40:43], v[100:103], a[176:179]
  v_accvgpr_read_b32 v117, a157
  v_accvgpr_read_b32 v118, a158
  v_mfma_f32_16x16x32_bf16 a[180:183], v[44:47], v[68:71], a[180:183]
  v_accvgpr_read_b32 v119, a159
  v_cvt_pk_bf16_f32 v136, v112, v113
  v_mfma_f32_16x16x32_bf16 a[184:187], v[44:47], v[84:87], a[184:187]
  v_cvt_pk_bf16_f32 v137, v114, v115
  v_cvt_pk_bf16_f32 v138, v116, v117
  v_mfma_f32_16x16x32_bf16 a[188:191], v[44:47], v[100:103], a[188:191]
  v_cvt_pk_bf16_f32 v139, v118, v119
  v_accvgpr_read_b32 v120, a148
  s_waitcnt lgkmcnt(0)
  v_mfma_f32_16x16x32_bf16 a[168:171], v[48:51], v[72:75], a[168:171]
  s_barrier
  v_accvgpr_read_b32 v121, a149
  v_accvgpr_read_b32 v122, a150
  v_mfma_f32_16x16x32_bf16 a[172:175], v[48:51], v[88:91], a[172:175]
  v_accvgpr_read_b32 v123, a151
  v_accvgpr_read_b32 v124, a160
  v_mfma_f32_16x16x32_bf16 a[176:179], v[48:51], v[104:107], a[176:179]
  v_accvgpr_read_b32 v125, a161
  v_accvgpr_read_b32 v126, a162
  v_mfma_f32_16x16x32_bf16 a[180:183], v[52:55], v[72:75], a[180:183]
  v_accvgpr_read_b32 v127, a163
  v_permlane16_swap_b32 v136, v138
  v_mfma_f32_16x16x32_bf16 a[184:187], v[52:55], v[88:91], a[184:187]
  v_permlane16_swap_b32 v137, v139
  v_cvt_pk_bf16_f32 v140, v120, v121
  v_mfma_f32_16x16x32_bf16 a[188:191], v[52:55], v[104:107], a[188:191]
  v_cvt_pk_bf16_f32 v141, v122, v123
  v_cvt_pk_bf16_f32 v142, v124, v125
  v_mfma_f32_16x16x32_bf16 a[168:171], v[56:59], v[76:79], a[168:171]
  v_cvt_pk_bf16_f32 v143, v126, v127
  v_accvgpr_read_b32 v128, a152
  v_mfma_f32_16x16x32_bf16 a[172:175], v[56:59], v[92:95], a[172:175]
  v_accvgpr_read_b32 v129, a153
  v_accvgpr_read_b32 v130, a154
  v_mfma_f32_16x16x32_bf16 a[176:179], v[56:59], v[108:111], a[176:179]
  v_accvgpr_read_b32 v131, a155
  v_accvgpr_read_b32 v132, a164
  v_mfma_f32_16x16x32_bf16 a[180:183], v[60:63], v[76:79], a[180:183]
  v_accvgpr_read_b32 v133, a165
  v_accvgpr_read_b32 v134, a166
  v_mfma_f32_16x16x32_bf16 a[184:187], v[60:63], v[92:95], a[184:187]
  v_accvgpr_read_b32 v135, a167
  buffer_store_dwordx4 v[136:139], v0, s[28:31], s33 offen offset:0 sc1
  v_mfma_f32_16x16x32_bf16 a[188:191], v[60:63], v[108:111], a[188:191]
  v_permlane16_swap_b32 v140, v142
  v_permlane16_swap_b32 v141, v143
  v_cvt_pk_bf16_f32 v144, v128, v129
  v_cvt_pk_bf16_f32 v145, v130, v131
  v_cvt_pk_bf16_f32 v146, v132, v133
  v_cvt_pk_bf16_f32 v147, v134, v135
  buffer_store_dwordx4 v[140:143], v0, s[28:31], s33 offen offset:1024 sc1
  s_nop 0
  v_permlane16_swap_b32 v144, v146
  v_permlane16_swap_b32 v145, v147
  buffer_store_dwordx4 v[144:147], v0, s[28:31], s33 offen offset:2048 sc1
  s_nop 7
  s_and_b32 s3, s2, 3
  s_lshl_b32 s3, s3, 2
  s_lshr_b32 s22, s2, 6
  s_add_u32 s22, s22, s3
  s_lshr_b32 s3, s2, 3
  s_and_b32 s23, s3, 7
  s_lshr_b32 s3, s2, 2
  s_and_b32 s24, s3, 1
  s_lshl_b32 s25, s24, 3
  s_add_u32 s25, s25, s23
  v_lshrrev_b32 v2, 4, v0
  v_lshrrev_b32 v172, 2, v0
  v_mov_b32 v1, 0
  v_mov_b32 v5, 0x27100
  s_mov_b32 s16, s98
  s_mov_b32 s17, s99
  s_mov_b32 s18, 256
  s_mov_b32 s19, 0x20000
  s_lshl_b32 s36, s25, 4
  s_lshl_b32 s3, s25, 7
  s_add_u32 s3, s3, 0x2000000
  s_add_u32 s56, s62, s3
  s_addc_u32 s57, s63, 0
  s_mov_b32 s58, 64
  s_mov_b32 s59, 0x20000
  s_lshl_b32 s37, 1, s22
  s_add_u32 s33, s41, 7
  s_and_b32 s33, s33, 7
  s_mul_i32 s33, s33, 3072
  v_accvgpr_read_b32 v112, a168
  v_accvgpr_read_b32 v113, a169
  v_accvgpr_read_b32 v114, a170
  v_accvgpr_read_b32 v115, a171
  v_accvgpr_read_b32 v116, a180
  v_accvgpr_read_b32 v117, a181
  v_accvgpr_read_b32 v118, a182
  v_accvgpr_read_b32 v119, a183
  v_cvt_pk_bf16_f32 v136, v112, v113
  v_cvt_pk_bf16_f32 v137, v114, v115
  v_cvt_pk_bf16_f32 v138, v116, v117
  v_cvt_pk_bf16_f32 v139, v118, v119
  v_accvgpr_read_b32 v120, a172
  v_accvgpr_read_b32 v121, a173
  v_accvgpr_read_b32 v122, a174
  v_accvgpr_read_b32 v123, a175
  v_accvgpr_read_b32 v124, a184
  v_accvgpr_read_b32 v125, a185
  v_accvgpr_read_b32 v126, a186
  v_accvgpr_read_b32 v127, a187
  v_permlane16_swap_b32 v136, v138
  v_permlane16_swap_b32 v137, v139
  v_cvt_pk_bf16_f32 v140, v120, v121
  v_cvt_pk_bf16_f32 v141, v122, v123
  v_cvt_pk_bf16_f32 v142, v124, v125
  v_cvt_pk_bf16_f32 v143, v126, v127
  v_accvgpr_read_b32 v128, a176
  v_accvgpr_read_b32 v129, a177
  v_accvgpr_read_b32 v130, a178
  v_accvgpr_read_b32 v131, a179
  v_accvgpr_read_b32 v132, a188
  v_accvgpr_read_b32 v133, a189
  v_accvgpr_read_b32 v134, a190
  v_accvgpr_read_b32 v135, a191
  buffer_store_dwordx4 v[136:139], v0, s[28:31], s33 offen offset:0 sc1
  v_permlane16_swap_b32 v140, v142
  v_permlane16_swap_b32 v141, v143
  v_cvt_pk_bf16_f32 v144, v128, v129
  v_cvt_pk_bf16_f32 v145, v130, v131
  v_cvt_pk_bf16_f32 v146, v132, v133
  v_cvt_pk_bf16_f32 v147, v134, v135
  buffer_store_dwordx4 v[140:143], v0, s[28:31], s33 offen offset:1024 sc1
  s_nop 0
  v_permlane16_swap_b32 v144, v146
  v_permlane16_swap_b32 v145, v147
  buffer_store_dwordx4 v[144:147], v0, s[28:31], s33 offen offset:2048 sc1
  s_load_dwordx2 s[4:5], s[0:1], 80
  s_mul_i32 s26, s22, 6
  s_lshl_b32 s3, s38, 1
  s_add_u32 s26, s26, s3
  s_max_u32 s26, s26, 2
  s_sub_u32 s26, s26, 2
  s_mul_i32 s3, s25, 1572864
  s_lshl_b32 s27, s26, 10
  s_add_u32 s3, s3, s27
  s_add_u32 s8, s62, s3
  s_addc_u32 s9, s63, 0
  s_mov_b32 s10, 1476608
  s_mov_b32 s11, 0x20000
  s_mul_i32 s44, s26, 2731
  s_lshr_b32 s44, s44, 16
  s_mul_i32 s45, s44, 24
  s_sub_u32 s45, s26, s45
  s_mul_i32 s46, s45, 21846
  s_lshr_b32 s46, s46, 16
  s_mul_i32 s47, s46, 3
  s_sub_u32 s47, s45, s47
  s_mul_i32 s52, s23, 96
  s_lshr_b32 s48, s44, 1
  s_mul_i32 s48, s48, 48
  s_add_u32 s52, s52, s48
  s_lshl_b32 s48, s47, 4
  s_add_u32 s52, s52, s48
  s_lshl_b32 s52, s52, 11
  s_lshl_b32 s48, s24, 10
  s_add_u32 s52, s52, s48
  s_lshl_b32 s48, s46, 7
  s_add_u32 s52, s52, s48
  s_and_b32 s48, s44, 1
  s_lshl_b32 s48, s48, 6
  s_add_u32 s52, s52, s48
  s_add_u32 s27, s26, 1
  s_mul_i32 s44, s27, 2731
  s_lshr_b32 s44, s44, 16
  s_mul_i32 s45, s44, 24
  s_sub_u32 s45, s27, s45
  s_mul_i32 s46, s45, 21846
  s_lshr_b32 s46, s46, 16
  s_mul_i32 s47, s46, 3
  s_sub_u32 s47, s45, s47
  s_mul_i32 s53, s23, 96
  s_lshr_b32 s48, s44, 1
  s_mul_i32 s48, s48, 48
  s_add_u32 s53, s53, s48
  s_lshl_b32 s48, s47, 4
  s_add_u32 s53, s53, s48
  s_lshl_b32 s53, s53, 11
  s_lshl_b32 s48, s24, 10
  s_add_u32 s53, s53, s48
  s_lshl_b32 s48, s46, 7
  s_add_u32 s53, s53, s48
  s_and_b32 s48, s44, 1
  s_lshl_b32 s48, s48, 6
  s_add_u32 s53, s53, s48
  v_and_b32 v4, 15, v2
  v_lshlrev_b32 v4, 11, v4
  v_bfe_u32 v6, v2, 4, 1
  v_lshl_add_u32 v4, v6, 5, v4
  v_lshrrev_b32 v6, 5, v2
  v_lshl_add_u32 v4, v6, 4, v4
  s_mov_b32 s40, 0
  s_mov_b32 s41, 0
  s_waitcnt vmcnt(0) lgkmcnt(0)
  s_mov_b32 s28, s4
  s_mov_b32 s29, s5
  s_mov_b32 s30, 1572864
  s_mov_b32 s31, 0x20000
  s_barrier
FZ_POLLR1:
  ds_read_b32 v6, v5
  s_waitcnt lgkmcnt(0)
  v_readfirstlane_b32 s42, v6
  s_nop 3
  s_andn2_b32 s43, s42, s40
  s_or_b32 s40, s40, s43
  s_cmp_eq_u32 s43, 0
  s_cbranch_scc1 FZ_NONER1
  s_bitcmp1_b32 s43, 0
  s_cbranch_scc0 FZ_S0R1
  s_mov_b32 s49, 0
  buffer_load_dwordx4 v[8:11], v0, s[8:11], s49 offen sc1
  buffer_load_dwordx4 v[72:75], v0, s[8:11], s49 offen offset:1024 sc1
FZ_S0R1:
  s_bitcmp1_b32 s43, 1
  s_cbranch_scc0 FZ_S1R1
  s_mov_b32 s49, 98304
  buffer_load_dwordx4 v[12:15], v0, s[8:11], s49 offen sc1
  buffer_load_dwordx4 v[76:79], v0, s[8:11], s49 offen offset:1024 sc1
FZ_S1R1:
  s_bitcmp1_b32 s43, 2
  s_cbranch_scc0 FZ_S2R1
  s_mov_b32 s49, 196608
  buffer_load_dwordx4 v[16:19], v0, s[8:11], s49 offen sc1
  buffer_load_dwordx4 v[80:83], v0, s[8:11], s49 offen offset:1024 sc1
FZ_S2R1:
  s_bitcmp1_b32 s43, 3
  s_cbranch_scc0 FZ_S3R1
  s_mov_b32 s49, 294912
  buffer_load_dwordx4 v[20:23], v0, s[8:11], s49 offen sc1
  buffer_load_dwordx4 v[84:87], v0, s[8:11], s49 offen offset:1024 sc1
FZ_S3R1:
  s_bitcmp1_b32 s43, 4
  s_cbranch_scc0 FZ_S4R1
  s_mov_b32 s49, 393216
  buffer_load_dwordx4 v[24:27], v0, s[8:11], s49 offen sc1
  buffer_load_dwordx4 v[88:91], v0, s[8:11], s49 offen offset:1024 sc1
FZ_S4R1:
  s_bitcmp1_b32 s43, 5
  s_cbranch_scc0 FZ_S5R1
  s_mov_b32 s49, 491520
  buffer_load_dwordx4 v[28:31], v0, s[8:11], s49 offen sc1
  buffer_load_dwordx4 v[92:95], v0, s[8:11], s49 offen offset:1024 sc1
FZ_S5R1:
  s_bitcmp1_b32 s43, 6
  s_cbranch_scc0 FZ_S6R1
  s_mov_b32 s49, 589824
  buffer_load_dwordx4 v[32:35], v0, s[8:11], s49 offen sc1
  buffer_load_dwordx4 v[96:99], v0, s[8:11], s49 offen offset:1024 sc1
FZ_S6R1:
  s_bitcmp1_b32 s43, 7
  s_cbranch_scc0 FZ_S7R1
  s_mov_b32 s49, 688128
  buffer_load_dwordx4 v[36:39], v0, s[8:11], s49 offen sc1
  buffer_load_dwordx4 v[100:103], v0, s[8:11], s49 offen offset:1024 sc1
FZ_S7R1:
  s_bitcmp1_b32 s43, 8
  s_cbranch_scc0 FZ_S8R1
  s_mov_b32 s49, 786432
  buffer_load_dwordx4 v[40:43], v0, s[8:11], s49 offen sc1
  buffer_load_dwordx4 v[104:107], v0, s[8:11], s49 offen offset:1024 sc1
FZ_S8R1:
  s_bitcmp1_b32 s43, 9
  s_cbranch_scc0 FZ_S9R1
  s_mov_b32 s49, 884736
  buffer_load_dwordx4 v[44:47], v0, s[8:11], s49 offen sc1
  buffer_load_dwordx4 v[108:111], v0, s[8:11], s49 offen offset:1024 sc1
FZ_S9R1:
  s_bitcmp1_b32 s43, 10
  s_cbranch_scc0 FZ_S10R1
  s_mov_b32 s49, 983040
  buffer_load_dwordx4 v[48:51], v0, s[8:11], s49 offen sc1
  buffer_load_dwordx4 v[112:115], v0, s[8:11], s49 offen offset:1024 sc1
FZ_S10R1:
  s_bitcmp1_b32 s43, 11
  s_cbranch_scc0 FZ_S11R1
  s_mov_b32 s49, 1081344
  buffer_load_dwordx4 v[52:55], v0, s[8:11], s49 offen sc1
  buffer_load_dwordx4 v[116:119], v0, s[8:11], s49 offen offset:1024 sc1
FZ_S11R1:
  s_bitcmp1_b32 s43, 12
  s_cbranch_scc0 FZ_S12R1
  s_mov_b32 s49, 1179648
  buffer_load_dwordx4 v[56:59], v0, s[8:11], s49 offen sc1
  buffer_load_dwordx4 v[120:123], v0, s[8:11], s49 offen offset:1024 sc1
FZ_S12R1:
  s_bitcmp1_b32 s43, 13
  s_cbranch_scc0 FZ_S13R1
  s_mov_b32 s49, 1277952
  buffer_load_dwordx4 v[60:63], v0, s[8:11], s49 offen sc1
  buffer_load_dwordx4 v[124:127], v0, s[8:11], s49 offen offset:1024 sc1
FZ_S13R1:
  s_bitcmp1_b32 s43, 14
  s_cbranch_scc0 FZ_S14R1
  s_mov_b32 s49, 1376256
  buffer_load_dwordx4 v[64:67], v0, s[8:11], s49 offen sc1
  buffer_load_dwordx4 v[128:131], v0, s[8:11], s49 offen offset:1024 sc1
FZ_S14R1:
  s_bitcmp1_b32 s43, 15
  s_cbranch_scc0 FZ_S15R1
  s_mov_b32 s49, 1474560
  buffer_load_dwordx4 v[68:71], v0, s[8:11], s49 offen sc1
  buffer_load_dwordx4 v[132:135], v0, s[8:11], s49 offen offset:1024 sc1
FZ_S15R1:
FZ_NONER1:
  s_add_u32 s41, s41, 1
  s_cmp_ge_u32 s41, 3200000
  s_cbranch_scc1 FZ_DONER1
  s_cmp_eq_u32 s40, 0xffff
  s_cbranch_scc0 FZ_POLLR1
FZ_DONER1:
  s_mov_b32 s27, 0xffff0000
  s_waitcnt vmcnt(0)
  v_lshlrev_b32 v140, 16, v8
  v_and_b32 v141, s27, v8
  v_lshlrev_b32 v142, 16, v9
  v_and_b32 v143, s27, v9
  v_lshlrev_b32 v144, 16, v10
  v_and_b32 v145, s27, v10
  v_lshlrev_b32 v146, 16, v11
  v_and_b32 v147, s27, v11
  v_lshlrev_b32 v174, 16, v12
  v_and_b32 v175, s27, v12
  v_pk_add_f32 v[140:141], v[140:141], v[174:175]
  v_lshlrev_b32 v176, 16, v13
  v_and_b32 v177, s27, v13
  v_pk_add_f32 v[142:143], v[142:143], v[176:177]
  v_lshlrev_b32 v174, 16, v14
  v_and_b32 v175, s27, v14
  v_pk_add_f32 v[144:145], v[144:145], v[174:175]
  v_lshlrev_b32 v176, 16, v15
  v_and_b32 v177, s27, v15
  v_pk_add_f32 v[146:147], v[146:147], v[176:177]
  v_lshlrev_b32 v174, 16, v16
  v_and_b32 v175, s27, v16
  v_pk_add_f32 v[140:141], v[140:141], v[174:175]
  v_lshlrev_b32 v176, 16, v17
  v_and_b32 v177, s27, v17
  v_pk_add_f32 v[142:143], v[142:143], v[176:177]
  v_lshlrev_b32 v174, 16, v18
  v_and_b32 v175, s27, v18
  v_pk_add_f32 v[144:145], v[144:145], v[174:175]
  v_lshlrev_b32 v176, 16, v19
  v_and_b32 v177, s27, v19
  v_pk_add_f32 v[146:147], v[146:147], v[176:177]
  v_lshlrev_b32 v174, 16, v20
  v_and_b32 v175, s27, v20
  v_pk_add_f32 v[140:141], v[140:141], v[174:175]
  v_lshlrev_b32 v176, 16, v21
  v_and_b32 v177, s27, v21
  v_pk_add_f32 v[142:143], v[142:143], v[176:177]
  v_lshlrev_b32 v174, 16, v22
  v_and_b32 v175, s27, v22
  v_pk_add_f32 v[144:145], v[144:145], v[174:175]
  v_lshlrev_b32 v176, 16, v23
  v_and_b32 v177, s27, v23
  v_pk_add_f32 v[146:147], v[146:147], v[176:177]
  v_lshlrev_b32 v174, 16, v24
  v_and_b32 v175, s27, v24
  v_pk_add_f32 v[140:141], v[140:141], v[174:175]
  v_lshlrev_b32 v176, 16, v25
  v_and_b32 v177, s27, v25
  v_pk_add_f32 v[142:143], v[142:143], v[176:177]
  v_lshlrev_b32 v174, 16, v26
  v_and_b32 v175, s27, v26
  v_pk_add_f32 v[144:145], v[144:145], v[174:175]
  v_lshlrev_b32 v176, 16, v27
  v_and_b32 v177, s27, v27
  v_pk_add_f32 v[146:147], v[146:147], v[176:177]
  v_lshlrev_b32 v174, 16, v28
  v_and_b32 v175, s27, v28
  v_pk_add_f32 v[140:141], v[140:141], v[174:175]
  v_lshlrev_b32 v176, 16, v29
  v_and_b32 v177, s27, v29
  v_pk_add_f32 v[142:143], v[142:143], v[176:177]
  v_lshlrev_b32 v174, 16, v30
  v_and_b32 v175, s27, v30
  v_pk_add_f32 v[144:145], v[144:145], v[174:175]
  v_lshlrev_b32 v176, 16, v31
  v_and_b32 v177, s27, v31
  v_pk_add_f32 v[146:147], v[146:147], v[176:177]
  v_lshlrev_b32 v174, 16, v32
  v_and_b32 v175, s27, v32
  v_pk_add_f32 v[140:141], v[140:141], v[174:175]
  v_lshlrev_b32 v176, 16, v33
  v_and_b32 v177, s27, v33
  v_pk_add_f32 v[142:143], v[142:143], v[176:177]
  v_lshlrev_b32 v174, 16, v34
  v_and_b32 v175, s27, v34
  v_pk_add_f32 v[144:145], v[144:145], v[174:175]
  v_lshlrev_b32 v176, 16, v35
  v_and_b32 v177, s27, v35
  v_pk_add_f32 v[146:147], v[146:147], v[176:177]
  v_lshlrev_b32 v174, 16, v36
  v_and_b32 v175, s27, v36
  v_pk_add_f32 v[140:141], v[140:141], v[174:175]
  v_lshlrev_b32 v176, 16, v37
  v_and_b32 v177, s27, v37
  v_pk_add_f32 v[142:143], v[142:143], v[176:177]
  v_lshlrev_b32 v174, 16, v38
  v_and_b32 v175, s27, v38
  v_pk_add_f32 v[144:145], v[144:145], v[174:175]
  v_lshlrev_b32 v176, 16, v39
  v_and_b32 v177, s27, v39
  v_pk_add_f32 v[146:147], v[146:147], v[176:177]
  v_lshlrev_b32 v174, 16, v40
  v_and_b32 v175, s27, v40
  v_pk_add_f32 v[140:141], v[140:141], v[174:175]
  v_lshlrev_b32 v176, 16, v41
  v_and_b32 v177, s27, v41
  v_pk_add_f32 v[142:143], v[142:143], v[176:177]
  v_lshlrev_b32 v174, 16, v42
  v_and_b32 v175, s27, v42
  v_pk_add_f32 v[144:145], v[144:145], v[174:175]
  v_lshlrev_b32 v176, 16, v43
  v_and_b32 v177, s27, v43
  v_pk_add_f32 v[146:147], v[146:147], v[176:177]
  v_lshlrev_b32 v174, 16, v44
  v_and_b32 v175, s27, v44
  v_pk_add_f32 v[140:141], v[140:141], v[174:175]
  v_lshlrev_b32 v176, 16, v45
  v_and_b32 v177, s27, v45
  v_pk_add_f32 v[142:143], v[142:143], v[176:177]
  v_lshlrev_b32 v174, 16, v46
  v_and_b32 v175, s27, v46
  v_pk_add_f32 v[144:145], v[144:145], v[174:175]
  v_lshlrev_b32 v176, 16, v47
  v_and_b32 v177, s27, v47
  v_pk_add_f32 v[146:147], v[146:147], v[176:177]
  v_lshlrev_b32 v174, 16, v48
  v_and_b32 v175, s27, v48
  v_pk_add_f32 v[140:141], v[140:141], v[174:175]
  v_lshlrev_b32 v176, 16, v49
  v_and_b32 v177, s27, v49
  v_pk_add_f32 v[142:143], v[142:143], v[176:177]
  v_lshlrev_b32 v174, 16, v50
  v_and_b32 v175, s27, v50
  v_pk_add_f32 v[144:145], v[144:145], v[174:175]
  v_lshlrev_b32 v176, 16, v51
  v_and_b32 v177, s27, v51
  v_pk_add_f32 v[146:147], v[146:147], v[176:177]
  v_lshlrev_b32 v174, 16, v52
  v_and_b32 v175, s27, v52
  v_pk_add_f32 v[140:141], v[140:141], v[174:175]
  v_lshlrev_b32 v176, 16, v53
  v_and_b32 v177, s27, v53
  v_pk_add_f32 v[142:143], v[142:143], v[176:177]
  v_lshlrev_b32 v174, 16, v54
  v_and_b32 v175, s27, v54
  v_pk_add_f32 v[144:145], v[144:145], v[174:175]
  v_lshlrev_b32 v176, 16, v55
  v_and_b32 v177, s27, v55
  v_pk_add_f32 v[146:147], v[146:147], v[176:177]
  v_lshlrev_b32 v174, 16, v56
  v_and_b32 v175, s27, v56
  v_pk_add_f32 v[140:141], v[140:141], v[174:175]
  v_lshlrev_b32 v176, 16, v57
  v_and_b32 v177, s27, v57
  v_pk_add_f32 v[142:143], v[142:143], v[176:177]
  v_lshlrev_b32 v174, 16, v58
  v_and_b32 v175, s27, v58
  v_pk_add_f32 v[144:145], v[144:145], v[174:175]
  v_lshlrev_b32 v176, 16, v59
  v_and_b32 v177, s27, v59
  v_pk_add_f32 v[146:147], v[146:147], v[176:177]
  v_lshlrev_b32 v174, 16, v60
  v_and_b32 v175, s27, v60
  v_pk_add_f32 v[140:141], v[140:141], v[174:175]
  v_lshlrev_b32 v176, 16, v61
  v_and_b32 v177, s27, v61
  v_pk_add_f32 v[142:143], v[142:143], v[176:177]
  v_lshlrev_b32 v174, 16, v62
  v_and_b32 v175, s27, v62
  v_pk_add_f32 v[144:145], v[144:145], v[174:175]
  v_lshlrev_b32 v176, 16, v63
  v_and_b32 v177, s27, v63
  v_pk_add_f32 v[146:147], v[146:147], v[176:177]
  v_lshlrev_b32 v174, 16, v64
  v_and_b32 v175, s27, v64
  v_pk_add_f32 v[140:141], v[140:141], v[174:175]
  v_lshlrev_b32 v176, 16, v65
  v_and_b32 v177, s27, v65
  v_pk_add_f32 v[142:143], v[142:143], v[176:177]
  v_lshlrev_b32 v174, 16, v66
  v_and_b32 v175, s27, v66
  v_pk_add_f32 v[144:145], v[144:145], v[174:175]
  v_lshlrev_b32 v176, 16, v67
  v_and_b32 v177, s27, v67
  v_pk_add_f32 v[146:147], v[146:147], v[176:177]
  v_lshlrev_b32 v174, 16, v68
  v_and_b32 v175, s27, v68
  v_pk_add_f32 v[140:141], v[140:141], v[174:175]
  v_lshlrev_b32 v176, 16, v69
  v_and_b32 v177, s27, v69
  v_pk_add_f32 v[142:143], v[142:143], v[176:177]
  v_lshlrev_b32 v174, 16, v70
  v_and_b32 v175, s27, v70
  v_pk_add_f32 v[144:145], v[144:145], v[174:175]
  v_lshlrev_b32 v176, 16, v71
  v_and_b32 v177, s27, v71
  v_pk_add_f32 v[146:147], v[146:147], v[176:177]
  v_cvt_pk_bf16_f32 v160, v140, v141
  v_cvt_pk_bf16_f32 v161, v142, v143
  v_cvt_pk_bf16_f32 v162, v144, v145
  v_cvt_pk_bf16_f32 v163, v146, v147
  buffer_store_dwordx4 v[160:163], v4, s[28:31], s52 offen
  v_lshlrev_b32 v150, 16, v72
  v_and_b32 v151, s27, v72
  v_lshlrev_b32 v152, 16, v73
  v_and_b32 v153, s27, v73
  v_lshlrev_b32 v154, 16, v74
  v_and_b32 v155, s27, v74
  v_lshlrev_b32 v156, 16, v75
  v_and_b32 v157, s27, v75
  v_lshlrev_b32 v174, 16, v76
  v_and_b32 v175, s27, v76
  v_pk_add_f32 v[150:151], v[150:151], v[174:175]
  v_lshlrev_b32 v176, 16, v77
  v_and_b32 v177, s27, v77
  v_pk_add_f32 v[152:153], v[152:153], v[176:177]
  v_lshlrev_b32 v174, 16, v78
  v_and_b32 v175, s27, v78
  v_pk_add_f32 v[154:155], v[154:155], v[174:175]
  v_lshlrev_b32 v176, 16, v79
  v_and_b32 v177, s27, v79
  v_pk_add_f32 v[156:157], v[156:157], v[176:177]
  v_lshlrev_b32 v174, 16, v80
  v_and_b32 v175, s27, v80
  v_pk_add_f32 v[150:151], v[150:151], v[174:175]
  v_lshlrev_b32 v176, 16, v81
  v_and_b32 v177, s27, v81
  v_pk_add_f32 v[152:153], v[152:153], v[176:177]
  v_lshlrev_b32 v174, 16, v82
  v_and_b32 v175, s27, v82
  v_pk_add_f32 v[154:155], v[154:155], v[174:175]
  v_lshlrev_b32 v176, 16, v83
  v_and_b32 v177, s27, v83
  v_pk_add_f32 v[156:157], v[156:157], v[176:177]
  v_lshlrev_b32 v174, 16, v84
  v_and_b32 v175, s27, v84
  v_pk_add_f32 v[150:151], v[150:151], v[174:175]
  v_lshlrev_b32 v176, 16, v85
  v_and_b32 v177, s27, v85
  v_pk_add_f32 v[152:153], v[152:153], v[176:177]
  v_lshlrev_b32 v174, 16, v86
  v_and_b32 v175, s27, v86
  v_pk_add_f32 v[154:155], v[154:155], v[174:175]
  v_lshlrev_b32 v176, 16, v87
  v_and_b32 v177, s27, v87
  v_pk_add_f32 v[156:157], v[156:157], v[176:177]
  v_lshlrev_b32 v174, 16, v88
  v_and_b32 v175, s27, v88
  v_pk_add_f32 v[150:151], v[150:151], v[174:175]
  v_lshlrev_b32 v176, 16, v89
  v_and_b32 v177, s27, v89
  v_pk_add_f32 v[152:153], v[152:153], v[176:177]
  v_lshlrev_b32 v174, 16, v90
  v_and_b32 v175, s27, v90
  v_pk_add_f32 v[154:155], v[154:155], v[174:175]
  v_lshlrev_b32 v176, 16, v91
  v_and_b32 v177, s27, v91
  v_pk_add_f32 v[156:157], v[156:157], v[176:177]
  v_lshlrev_b32 v174, 16, v92
  v_and_b32 v175, s27, v92
  v_pk_add_f32 v[150:151], v[150:151], v[174:175]
  v_lshlrev_b32 v176, 16, v93
  v_and_b32 v177, s27, v93
  v_pk_add_f32 v[152:153], v[152:153], v[176:177]
  v_lshlrev_b32 v174, 16, v94
  v_and_b32 v175, s27, v94
  v_pk_add_f32 v[154:155], v[154:155], v[174:175]
  v_lshlrev_b32 v176, 16, v95
  v_and_b32 v177, s27, v95
  v_pk_add_f32 v[156:157], v[156:157], v[176:177]
  v_lshlrev_b32 v174, 16, v96
  v_and_b32 v175, s27, v96
  v_pk_add_f32 v[150:151], v[150:151], v[174:175]
  v_lshlrev_b32 v176, 16, v97
  v_and_b32 v177, s27, v97
  v_pk_add_f32 v[152:153], v[152:153], v[176:177]
  v_lshlrev_b32 v174, 16, v98
  v_and_b32 v175, s27, v98
  v_pk_add_f32 v[154:155], v[154:155], v[174:175]
  v_lshlrev_b32 v176, 16, v99
  v_and_b32 v177, s27, v99
  v_pk_add_f32 v[156:157], v[156:157], v[176:177]
  v_lshlrev_b32 v174, 16, v100
  v_and_b32 v175, s27, v100
  v_pk_add_f32 v[150:151], v[150:151], v[174:175]
  v_lshlrev_b32 v176, 16, v101
  v_and_b32 v177, s27, v101
  v_pk_add_f32 v[152:153], v[152:153], v[176:177]
  v_lshlrev_b32 v174, 16, v102
  v_and_b32 v175, s27, v102
  v_pk_add_f32 v[154:155], v[154:155], v[174:175]
  v_lshlrev_b32 v176, 16, v103
  v_and_b32 v177, s27, v103
  v_pk_add_f32 v[156:157], v[156:157], v[176:177]
  v_lshlrev_b32 v174, 16, v104
  v_and_b32 v175, s27, v104
  v_pk_add_f32 v[150:151], v[150:151], v[174:175]
  v_lshlrev_b32 v176, 16, v105
  v_and_b32 v177, s27, v105
  v_pk_add_f32 v[152:153], v[152:153], v[176:177]
  v_lshlrev_b32 v174, 16, v106
  v_and_b32 v175, s27, v106
  v_pk_add_f32 v[154:155], v[154:155], v[174:175]
  v_lshlrev_b32 v176, 16, v107
  v_and_b32 v177, s27, v107
  v_pk_add_f32 v[156:157], v[156:157], v[176:177]
  v_lshlrev_b32 v174, 16, v108
  v_and_b32 v175, s27, v108
  v_pk_add_f32 v[150:151], v[150:151], v[174:175]
  v_lshlrev_b32 v176, 16, v109
  v_and_b32 v177, s27, v109
  v_pk_add_f32 v[152:153], v[152:153], v[176:177]
  v_lshlrev_b32 v174, 16, v110
  v_and_b32 v175, s27, v110
  v_pk_add_f32 v[154:155], v[154:155], v[174:175]
  v_lshlrev_b32 v176, 16, v111
  v_and_b32 v177, s27, v111
  v_pk_add_f32 v[156:157], v[156:157], v[176:177]
  v_lshlrev_b32 v174, 16, v112
  v_and_b32 v175, s27, v112
  v_pk_add_f32 v[150:151], v[150:151], v[174:175]
  v_lshlrev_b32 v176, 16, v113
  v_and_b32 v177, s27, v113
  v_pk_add_f32 v[152:153], v[152:153], v[176:177]
  v_lshlrev_b32 v174, 16, v114
  v_and_b32 v175, s27, v114
  v_pk_add_f32 v[154:155], v[154:155], v[174:175]
  v_lshlrev_b32 v176, 16, v115
  v_and_b32 v177, s27, v115
  v_pk_add_f32 v[156:157], v[156:157], v[176:177]
  v_lshlrev_b32 v174, 16, v116
  v_and_b32 v175, s27, v116
  v_pk_add_f32 v[150:151], v[150:151], v[174:175]
  v_lshlrev_b32 v176, 16, v117
  v_and_b32 v177, s27, v117
  v_pk_add_f32 v[152:153], v[152:153], v[176:177]
  v_lshlrev_b32 v174, 16, v118
  v_and_b32 v175, s27, v118
  v_pk_add_f32 v[154:155], v[154:155], v[174:175]
  v_lshlrev_b32 v176, 16, v119
  v_and_b32 v177, s27, v119
  v_pk_add_f32 v[156:157], v[156:157], v[176:177]
  v_lshlrev_b32 v174, 16, v120
  v_and_b32 v175, s27, v120
  v_pk_add_f32 v[150:151], v[150:151], v[174:175]
  v_lshlrev_b32 v176, 16, v121
  v_and_b32 v177, s27, v121
  v_pk_add_f32 v[152:153], v[152:153], v[176:177]
  v_lshlrev_b32 v174, 16, v122
  v_and_b32 v175, s27, v122
  v_pk_add_f32 v[154:155], v[154:155], v[174:175]
  v_lshlrev_b32 v176, 16, v123
  v_and_b32 v177, s27, v123
  v_pk_add_f32 v[156:157], v[156:157], v[176:177]
  v_lshlrev_b32 v174, 16, v124
  v_and_b32 v175, s27, v124
  v_pk_add_f32 v[150:151], v[150:151], v[174:175]
  v_lshlrev_b32 v176, 16, v125
  v_and_b32 v177, s27, v125
  v_pk_add_f32 v[152:153], v[152:153], v[176:177]
  v_lshlrev_b32 v174, 16, v126
  v_and_b32 v175, s27, v126
  v_pk_add_f32 v[154:155], v[154:155], v[174:175]
  v_lshlrev_b32 v176, 16, v127
  v_and_b32 v177, s27, v127
  v_pk_add_f32 v[156:157], v[156:157], v[176:177]
  v_lshlrev_b32 v174, 16, v128
  v_and_b32 v175, s27, v128
  v_pk_add_f32 v[150:151], v[150:151], v[174:175]
  v_lshlrev_b32 v176, 16, v129
  v_and_b32 v177, s27, v129
  v_pk_add_f32 v[152:153], v[152:153], v[176:177]
  v_lshlrev_b32 v174, 16, v130
  v_and_b32 v175, s27, v130
  v_pk_add_f32 v[154:155], v[154:155], v[174:175]
  v_lshlrev_b32 v176, 16, v131
  v_and_b32 v177, s27, v131
  v_pk_add_f32 v[156:157], v[156:157], v[176:177]
  v_lshlrev_b32 v174, 16, v132
  v_and_b32 v175, s27, v132
  v_pk_add_f32 v[150:151], v[150:151], v[174:175]
  v_lshlrev_b32 v176, 16, v133
  v_and_b32 v177, s27, v133
  v_pk_add_f32 v[152:153], v[152:153], v[176:177]
  v_lshlrev_b32 v174, 16, v134
  v_and_b32 v175, s27, v134
  v_pk_add_f32 v[154:155], v[154:155], v[174:175]
  v_lshlrev_b32 v176, 16, v135
  v_and_b32 v177, s27, v135
  v_pk_add_f32 v[156:157], v[156:157], v[176:177]
  v_cvt_pk_bf16_f32 v164, v150, v151
  v_cvt_pk_bf16_f32 v165, v152, v153
  v_cvt_pk_bf16_f32 v166, v154, v155
  v_cvt_pk_bf16_f32 v167, v156, v157
  buffer_store_dwordx4 v[164:167], v4, s[28:31], s53 offen
FZ_ENDR1:
  s_mov_b64 exec, -1
  s_endpgm
K1_EXIT:
  s_endpgm
TEXT_END:
.section .rodata,"a"
.p2align 6
.amdhsa_kernel mha_fused_kernel
  .amdhsa_next_free_vgpr 512
  .amdhsa_next_free_sgpr 102
  .amdhsa_accum_offset 256
  .amdhsa_group_segment_fixed_size 0
  .amdhsa_kernarg_size 104
  .amdhsa_user_sgpr_count 2
  .amdhsa_user_sgpr_kernarg_segment_ptr 1
  .amdhsa_system_sgpr_workgroup_id_x 1
.end_amdhsa_kernel
.p2align 6
```
